```python
import torch

def _softmax(x, axis=-1):
    return torch.softmax(x, dim=axis)
def _gelu(x):
    return torch.nn.functional.gelu(x, approximate="tanh")
def _silu(x):
    return torch.nn.functional.silu(x)
def _sigmoid(x):
    return torch.sigmoid(x)
def _layernorm(x, axis=-1, eps=1e-5):
    m = x.mean(dim=axis, keepdim=True)
    v = x.var(dim=axis, keepdim=True, unbiased=False)
    return (x - m) / torch.sqrt(v + eps)
def _scatter_add(tgt, idx, src, axis=0):
    return tgt.clone().index_add_(axis, idx, src)
def _segment_sum(src, seg, n):
    out = torch.zeros((n,) + src.shape[1:], dtype=src.dtype)
    return out.index_add_(0, seg, src)
def _pad(x, pw):
    flat = tuple(v for pair in reversed(pw) for v in pair)
    return torch.nn.functional.pad(x, flat)

kernel_name = 'recurrent_scan__mha_block_cached__moe_arch_mod__prompt'

def setup_inputs():

    _w = (lambda a: (lambda t: t.to(torch.bfloat16) if t.is_floating_point() else t)(torch.as_tensor(a)))
    def _A_setup():
        B, Sq, D = 1, 2048, 512
        H, Sk, Dh = 32, 2048, 128
        return {
            "x": _w((lambda *s: torch.randn(*s, dtype=torch.bfloat16) * 0.05)(B, Sq, D)),
            "k_cache": _w((lambda *s: torch.randn(*s, dtype=torch.bfloat16) * 1.6)(B, H, Sk, Dh)),
            "v_cache": _w((lambda *s: torch.randn(*s, dtype=torch.bfloat16) * 0.2)(B, H, Sk, Dh)),
            "wq": _w((lambda *s: torch.randn(*s, dtype=torch.bfloat16) * 1.6)(D, H * Dh) * (D ** -0.5)),
            "wo": _w((lambda *s: torch.randn(*s, dtype=torch.bfloat16) * 0.2)(H * Dh, D) * ((H * Dh) ** -0.5)),
        }
    _A_in = _A_setup()

    def _B_setup():
        B, S, D, F, C = 1, 2048, 512, 1376, 1
        return {
            "x": _w((lambda *s: torch.randn(*s, dtype=torch.bfloat16) * 0.05)(B, S, D)),
            "w_r": _w((lambda *s: torch.randn(*s, dtype=torch.bfloat16) * 0.2)(D)),
            "w_gate": _w((lambda *s: torch.randn(*s, dtype=torch.bfloat16) * 0.1)(D, F)),
            "w_up": _w((lambda *s: torch.randn(*s, dtype=torch.bfloat16) * 0.1)(D, F)),
            "w_down": _w((lambda *s: torch.randn(*s, dtype=torch.bfloat16) * 0.1)(F, D)),
        }
    _B_in = _B_setup()

    return {
        "A_x": _A_in["x"],
        "A_k_cache": _A_in["k_cache"],
        "A_v_cache": _A_in["v_cache"],
        "A_wq": _A_in["wq"],
        "A_wo": _A_in["wo"],
        "B_x": _B_in["x"],
        "B_w_r": _B_in["w_r"],
        "B_w_gate": _B_in["w_gate"],
        "B_w_up": _B_in["w_up"],
        "B_w_down": _B_in["w_down"],
    }

def reference(A_x, A_k_cache, A_v_cache, A_wq, A_wo, B_x, B_w_r, B_w_gate, B_w_up, B_w_down):
    def _A_ref(x, k_cache, v_cache, wq, wo):
        B, Sq, D = x.shape
        H, Dh = 32, 128
        q = (lambda x, *d: x.permute(*d))((x @ wq).reshape(B, Sq, H, Dh), 0, 2, 1, 3)
        scores = torch.einsum("bhqd,bhkd->bhqk", q, k_cache) * (Dh ** -0.5)
        p = _softmax(scores, axis=-1)
        o = torch.einsum("bhqk,bhkd->bhqd", p, v_cache)
        return (lambda x, *d: x.permute(*d))(o, 0, 2, 1, 3).reshape(B, Sq, H * Dh) @ wo

    def _B_ref(x, w_r, w_gate, w_up, w_down):
        B, S, D = x.shape
        C = 1
        r = x @ w_r
        idx = torch.argsort(-r, axis=-1)[:, :C]
        idx_e = (lambda x, n, axis: torch.repeat_interleave(x, n, dim=axis))(idx.reshape(B, C, 1), D, axis=2)
        x_sel = (lambda x, i, axis: torch.take_along_dim(x, i, dim=axis))(x, idx_e, axis=1)
        g = _silu(x_sel @ w_gate)
        u = x_sel @ w_up
        y = (g * u) @ w_down
        r_sel = _sigmoid((lambda x, i, axis: torch.take_along_dim(x, i, dim=axis))(r, idx, axis=1))
        y = y * r_sel.reshape(B, C, 1)
        b_off = (torch.arange(B) * S).reshape(B, 1)
        flat_idx = (idx + b_off).reshape(B * C)
        zero = (x * 0.0).reshape(B * S, D)
        upd = _scatter_add(zero, flat_idx, y.reshape(B * C, D), axis=0)
        return x + upd.reshape(B, S, D)

    x = A_x
    xn = _layernorm(x, axis=-1)
    s = _A_ref(xn, A_k_cache, A_v_cache, A_wq, A_wo)
    g = _silu(_B_ref(xn, B_w_r, B_w_gate, B_w_up, B_w_down))
    return x + s * g
```

```asm
; @launch grid=(256,1,1) block=(256,1,1) lds=163840
.amdgcn_target "amdgcn-amd-amdhsa--gfx950"
.text
.globl recurrent_scan__mha_block_cached__moe_arch_mod__prompt_kernel
.p2align 8
.type recurrent_scan__mha_block_cached__moe_arch_mod__prompt_kernel,@function
recurrent_scan__mha_block_cached__moe_arch_mod__prompt_kernel:
    s_cmp_ge_u32 s2, 256
    s_cbranch_scc1 F_END
    s_load_dwordx16 s[60:75], s[0:1], 0
    s_load_dwordx8 s[76:83], s[0:1], 64
    s_load_dwordx2 s[4:5], s[0:1], 96
    v_lshrrev_b32 v1, 6, v0
    v_and_b32 v2, 63, v0
    s_getpc_b64 s[98:99]
F_PC0:
    v_readfirstlane_b32 s3, v1
    s_and_b32 s28, s2, 31
    s_lshr_b32 s29, s2, 5
    s_lshr_b32 s42, s2, 3
    v_lshlrev_b32 v104, 7, v2
    s_lshl_b32 s42, s42, 11
    v_lshl_add_u32 v104, v1, 9, v104
    v_add_u32 v104, s42, v104
    v_min_u32 v104, F_FB-F_PC0-4, v104
    s_mov_b64 exec, 15
    global_load_dword v105, v104, s[98:99]
    s_mov_b64 exec, -1
    v_lshrrev_b32 v3, 4, v2
    v_and_b32 v4, 15, v2
    v_lshlrev_b32 v222, 4, v2
    s_lshl_b32 s42, s2, 3
    s_lshl_b32 s43, s3, 1
    s_add_u32 s42, s42, s43
    s_lshl_b32 s43, s42, 10
    v_add_u32 v5, s43, v222
    v_lshlrev_b32 v6, 2, v3
    v_xor_b32 v6, v4, v6
    v_lshlrev_b32 v6, 4, v6
    v_lshl_add_u32 v7, v1, 4, v3
    v_lshl_add_u32 v212, v7, 13, v6
    v_add_u32 v213, 31744, v212
    v_add_u32 v214, 63488, v212
    v_add_u32 v215, 95232, v212
    v_and_b32 v6, 7, v2
    v_xor_b32 v6, v6, v3
    v_lshlrev_b32 v6, 4, v6
    v_lshrrev_b32 v7, 3, v2
    v_lshl_add_u32 v208, v7, 10, v6
    v_xor_b32 v6, 64, v208
    v_add_u32 v209, 7168, v6
    v_add_u32 v210, 14336, v208
    v_add_u32 v211, 14336, v209
    s_lshl_b32 s30, s3, 13
    s_lshl_b32 s6, s3, 12
    s_lshl_b32 s52, s28, 8
    s_lshl_b32 s53, s29, 2
    s_add_u32 s53, s53, s3
    s_lshl_b32 s54, s53, 16
    s_waitcnt lgkmcnt(0)
    global_load_dwordx4 v[160:163], v5, s[60:61]
    global_load_dwordx4 v[164:167], v5, s[60:61] offset:1024
    s_add_u32 s56, s4, 3407872
    s_addc_u32 s57, s5, 0
    s_load_dword s44, s[56:57], 0
    s_add_u32 s16, s66, s52
    s_addc_u32 s17, s67, 0
    s_sub_u32 s18, 4194304, s52
    s_mov_b32 s19, 0x00020000
    s_mov_b32 s43, 0
    s_add_u32 m0, s6, 98304
    s_nop 0
    buffer_load_dwordx4 v212, s[16:19], s43 offen offset:0 lds
    buffer_load_dwordx4 v213, s[16:19], s43 offen offset:1024 lds
    buffer_load_dwordx4 v214, s[16:19], s43 offen offset:2048 lds
    buffer_load_dwordx4 v215, s[16:19], s43 offen offset:3072 lds
    global_load_dwordx4 a[136:139], v222, s[72:73]
    s_add_u32 s20, s60, s54
    s_addc_u32 s21, s61, 0
    s_mov_b32 s22, 65536
    s_mov_b32 s23, 0x00020000
    s_mov_b32 s72, 0
    s_add_u32 m0, s30, 32768
    s_lshl_b32 s54, s28, 19
    buffer_load_dwordx4 v208, s[20:23], s72 offen offset:0 lds
    s_add_u32 s8, s62, s54
    s_addc_u32 s9, s63, 0
    s_mov_b32 s10, 524288
    s_mov_b32 s11, 0x00020000
    s_add_u32 s12, s64, s54
    s_addc_u32 s13, s65, 0
    s_mov_b32 s14, 524288
    buffer_load_dwordx4 v209, s[20:23], s72 offen offset:1024 lds
    s_mov_b32 s15, 0x00020000
    s_lshl_b32 s54, s53, 19
    s_lshl_b32 s55, s28, 12
    s_add_u32 s54, s54, s55
    s_add_u32 s54, s54, 8388608
    s_add_u32 s24, s4, s54
    s_addc_u32 s25, s5, 0
    s_mov_b32 s26, 397312
    buffer_load_dwordx4 v210, s[20:23], s72 offen offset:2048 lds
    s_mov_b32 s27, 0x00020000
    s_mov_b32 s48, s4
    s_mov_b32 s49, s5
    s_mov_b32 s50, 41943040
    s_mov_b32 s51, 0x00020000
    s_mov_b32 s36, 3216550459
    s_mov_b32 s37, 0
    s_cmp_eq_u32 s3, 0
    s_cselect_b64 s[84:85], 1, 0
    buffer_load_dwordx4 v211, s[20:23], s72 offen offset:3072 lds
    s_mov_b32 s66, 0
    s_and_b32 s7, s2, 7
    s_lshl_b32 s7, s7, 2
    s_add_u32 s7, s7, s3
    s_lshl_b32 s7, s7, 15
    s_lshr_b32 s54, s2, 6
    s_lshl_b32 s54, s54, 20
    s_add_u32 s7, s7, s54
    s_mov_b32 s72, 32768
    s_add_u32 m0, s30, 36864
    s_bfe_u32 s54, s2, 0x30003
    buffer_load_dwordx4 v208, s[20:23], s72 offen offset:0 lds
    s_lshl_b32 s54, s54, 7
    s_add_u32 s7, s7, s54
    s_add_u32 s100, s98, F_LAST-F_PC0
    s_addc_u32 s101, s99, 0
    v_xor_b32 v6, v3, v4
    v_lshlrev_b32 v7, 8, v4
    v_add_u32 v24, 0, v1
    buffer_load_dwordx4 v209, s[20:23], s72 offen offset:1024 lds
    v_and_b32 v24, 3, v24
    v_lshlrev_b32 v21, 2, v24
    v_xor_b32 v21, v21, v6
    v_lshl_add_u32 v204, v21, 4, v7
    v_add_u32 v25, 1, v1
    v_and_b32 v25, 3, v25
    v_lshlrev_b32 v21, 2, v25
    v_xor_b32 v21, v21, v6
    buffer_load_dwordx4 v210, s[20:23], s72 offen offset:2048 lds
    v_lshl_add_u32 v205, v21, 4, v7
    v_add_u32 v26, 2, v1
    v_and_b32 v26, 3, v26
    v_lshlrev_b32 v21, 2, v26
    v_xor_b32 v21, v21, v6
    v_lshl_add_u32 v206, v21, 4, v7
    v_add_u32 v27, 3, v1
    v_and_b32 v27, 3, v27
    buffer_load_dwordx4 v211, s[20:23], s72 offen offset:3072 lds
    v_lshlrev_b32 v21, 2, v27
    v_xor_b32 v21, v21, v6
    v_lshl_add_u32 v207, v21, 4, v7
    v_lshlrev_b32 v7, 13, v1
    v_lshl_add_u32 v7, v3, 8, v7
    v_add_u32 v20, 0, v3
    v_xor_b32 v20, v20, v4
    v_lshl_add_u32 v216, v20, 4, v7
    s_mov_b32 s43, 524288
    s_add_u32 m0, s6, 114688
    v_add_u32 v20, 4, v3
    buffer_load_dwordx4 v212, s[16:19], s43 offen offset:0 lds
    v_xor_b32 v20, v20, v4
    v_lshl_add_u32 v217, v20, 4, v7
    v_add_u32 v20, 8, v3
    v_xor_b32 v20, v20, v4
    v_lshl_add_u32 v218, v20, 4, v7
    v_add_u32 v20, 12, v3
    v_xor_b32 v20, v20, v4
    buffer_load_dwordx4 v213, s[16:19], s43 offen offset:1024 lds
    v_lshl_add_u32 v219, v20, 4, v7
    v_add_u32 v20, 0, v3
    v_lshlrev_b32 v20, 1, v20
    v_xor_b32 v20, v20, v4
    v_lshl_add_u32 v220, v20, 4, v7
    v_add_u32 v20, 4, v3
    v_lshlrev_b32 v20, 1, v20
    v_xor_b32 v20, v20, v4
    buffer_load_dwordx4 v214, s[16:19], s43 offen offset:2048 lds
    v_lshl_add_u32 v221, v20, 4, v7
    v_bfe_u32 v6, v2, 2, 2
    v_and_b32 v20, 3, v2
    v_lshl_add_u32 v7, v3, 3, v6
    v_lshlrev_b32 v7, 8, v7
    v_lshl_add_u32 v7, v20, 4, v7
    v_add_u32 v7, 98304, v7
    v_xor_b32 v20, v24, v6
    buffer_load_dwordx4 v215, s[16:19], s43 offen offset:3072 lds
    v_lshl_add_u32 v196, v20, 6, v7
    v_xor_b32 v20, v25, v6
    v_lshl_add_u32 v197, v20, 6, v7
    v_xor_b32 v20, v26, v6
    v_lshl_add_u32 v198, v20, 6, v7
    v_xor_b32 v20, v27, v6
    v_lshl_add_u32 v199, v20, 6, v7
    v_lshrrev_b32 v6, 1, v4
    s_mov_b32 s72, 128
    s_add_u32 m0, s30, 65536
    v_xor_b32 v6, v6, v3
    buffer_load_dwordx4 v208, s[20:23], s72 offen offset:0 lds
    v_lshlrev_b32 v7, 13, v1
    v_lshl_add_u32 v7, v4, 7, v7
    v_lshl_add_u32 v200, v6, 4, v7
    v_xor_b32 v201, 64, v200
    v_add_u32 v202, 0x10000, v200
    v_add_u32 v203, 0x10000, v201
    v_mov_b32 v192, 0x3f803f80
    buffer_load_dwordx4 v209, s[20:23], s72 offen offset:1024 lds
    v_mov_b32 v193, 0x3f803f80
    v_mov_b32 v194, 0x3f803f80
    v_mov_b32 v195, 0x3f803f80
    s_mov_b32 s31, 0
    s_mov_b32 s32, 4096
    s_mov_b32 s33, 0
    s_mov_b32 s34, 4096
    s_lshl_b32 s57, s42, 3
    buffer_load_dwordx4 v210, s[20:23], s72 offen offset:2048 lds
    s_add_u32 s57, s57, 2097152
    s_lshl_b32 s56, s42, 10
    s_lshr_b32 s62, s53, 1
    s_lshl_b32 s62, s62, 10
    s_lshl_b32 s54, s28, 3
    s_and_b32 s55, s3, 1
    s_add_u32 s54, s54, s55
    s_lshl_b32 s54, s54, 2
    buffer_load_dwordx4 v211, s[20:23], s72 offen offset:3072 lds
    s_add_u32 s62, s62, s54
    s_add_u32 s62, s62, 3145728
    s_lshl_b32 s63, s2, 7
    s_add_u32 s63, s63, 3276800
    s_and_b32 s47, s2, 7
    s_mul_i32 s47, s47, 24
    s_lshr_b32 s54, s2, 3
    s_add_u32 s47, s47, s54
    s_cmp_lt_u32 s54, 24
    s_cselect_b32 s47, s47, 172
    s_min_u32 s47, s47, 172
    s_and_b32 s54, s2, 4
    s_lshl_b32 s54, s54, 1
    s_add_u32 s54, s54, s29
    s_and_b32 s55, s2, 3
    s_lshl_b32 s0, s54, 20
    s_lshl_b32 s58, s55, 18
    s_add_u32 s0, s0, s58
    s_lshl_b32 s58, s3, 10
    s_and_b32 s59, s54, 1
    s_lshl_b32 s59, s59, 11
    s_xor_b32 s58, s58, s59
    s_lshr_b32 s59, s55, 1
    s_lshl_b32 s59, s59, 10
    s_xor_b32 s58, s58, s59
    s_add_u32 s58, s58, 8388608
    s_add_u32 s0, s0, s58
    s_lshl_b32 s97, s54, 2
    s_add_u32 s97, s97, s55
    s_bfe_u32 s58, s2, 0x20003
    s_lshl_b32 s58, s58, 2
    s_add_u32 s58, s58, s3
    s_lshl_b32 s55, s58, 18
    s_add_u32 s1, s55, 4194304
    s_lshl_b32 s58, s58, 6
    s_lshl_b32 s97, s97, 15
    s_add_u32 s97, s97, s58
    s_lshl_b32 s54, s54, 10
    s_add_u32 s54, s54, 3145728
    s_add_u32 s70, s4, s54
    s_addc_u32 s71, s5, 0
    s_lshl_b32 s98, s2, 2
    s_add_u32 s98, s98, s3
    s_lshl_b32 s98, s98, 14
    s_add_u32 s98, s98, 25165824
    s_mul_i32 s99, s3, 6144
    s_sub_u32 s58, 0xffff, s42
    s_sub_u32 s59, s58, 1
    s_waitcnt vmcnt(21)
    v_lshlrev_b32 v168, 16, v160
    v_lshlrev_b32 v176, 16, v164
    v_and_b32 v169, 0xffff0000, v160
    v_and_b32 v177, 0xffff0000, v164
    v_lshlrev_b32 v170, 16, v161
    v_lshlrev_b32 v178, 16, v165
    v_and_b32 v171, 0xffff0000, v161
    v_and_b32 v179, 0xffff0000, v165
    v_lshlrev_b32 v172, 16, v162
    v_lshlrev_b32 v180, 16, v166
    v_and_b32 v173, 0xffff0000, v162
    v_and_b32 v181, 0xffff0000, v166
    v_lshlrev_b32 v174, 16, v163
    v_lshlrev_b32 v182, 16, v167
    v_and_b32 v175, 0xffff0000, v163
    v_and_b32 v183, 0xffff0000, v167
    s_waitcnt lgkmcnt(0)
    s_add_u32 s44, s44, 0x9e3779b1
    s_xor_b32 s45, s44, 0x5bd1e995
    s_mov_b32 s64, s44
    s_mov_b32 s65, s44
    s_waitcnt vmcnt(8)
    ds_read_b128 a[192:195], v200 offset:32768
    ds_read_b128 a[196:199], v201 offset:32768
    ds_read_b128 a[200:203], v200 offset:34816
    ds_read_b128 a[204:207], v201 offset:34816
    s_barrier
    ds_read_b64_tr_b16 v[224:225], v196 offset:0
    ds_read_b64_tr_b16 v[226:227], v196 offset:1024
    ds_read_b64_tr_b16 v[228:229], v196 offset:8192
    ds_read_b64_tr_b16 v[230:231], v196 offset:9216
    ds_read_b64_tr_b16 v[232:233], v196 offset:8
    ds_read_b64_tr_b16 v[234:235], v196 offset:1032
    ds_read_b64_tr_b16 v[236:237], v196 offset:8200
    ds_read_b64_tr_b16 v[238:239], v196 offset:9224
    s_waitcnt lgkmcnt(8)
    ds_read_b128 a[208:211], v200 offset:36864
    ds_read_b128 a[212:215], v201 offset:36864
    ds_read_b128 a[216:219], v200 offset:38912
    ds_read_b128 a[220:223], v201 offset:38912
    s_waitcnt lgkmcnt(0)
    v_mfma_f32_16x16x32_bf16 a[128:131], v[224:227], v[192:195], 0
    s_mov_b32 s72, 32896
    v_add_f32 v184, v168, v169
    v_add_f32 v185, v176, v177
    v_add_f32 v186, v170, v171
    v_mfma_f32_16x16x32_bf16 a[128:131], v[228:231], v[192:195], a[128:131]
    ds_read_b64_tr_b16 v[240:241], v197 offset:0
    ds_read_b64_tr_b16 v[242:243], v197 offset:1024
    v_add_f32 v187, v178, v179
    v_mfma_f32_16x16x32_bf16 a[132:135], v[232:235], v[192:195], 0
    s_add_u32 m0, s30, 69632
    v_add_f32 v188, v172, v173
    v_add_f32 v189, v180, v181
    v_add_f32 v190, v174, v175
    v_mfma_f32_16x16x32_bf16 a[132:135], v[236:239], v[192:195], a[132:135]
    ds_read_b64_tr_b16 v[244:245], v197 offset:8192
    ds_read_b64_tr_b16 v[246:247], v197 offset:9216
    v_add_f32 v191, v182, v183
    v_mfma_f32_16x16x32_bf16 v[0:3], v[224:227], a[192:195], 0
    buffer_load_dwordx4 v208, s[20:23], s72 offen offset:0 lds
    v_add_f32 v184, v184, v186
    v_mfma_f32_16x16x32_bf16 v[0:3], v[228:231], a[196:199], v[0:3]
    ds_read_b64_tr_b16 v[248:249], v197 offset:8
    ds_read_b64_tr_b16 v[250:251], v197 offset:1032
    v_add_f32 v185, v185, v187
    v_mfma_f32_16x16x32_bf16 v[4:7], v[224:227], a[200:203], 0
    v_add_f32 v188, v188, v190
    v_add_f32 v189, v189, v191
    v_add_f32 v184, v184, v188
    v_mfma_f32_16x16x32_bf16 v[4:7], v[228:231], a[204:207], v[4:7]
    ds_read_b64_tr_b16 v[252:253], v197 offset:8200
    ds_read_b64_tr_b16 v[254:255], v197 offset:9224
    v_add_f32 v185, v185, v189
    v_mfma_f32_16x16x32_bf16 v[8:11], v[224:227], a[208:211], 0
    buffer_load_dwordx4 v209, s[20:23], s72 offen offset:1024 lds
    v_add_f32_dpp v184, v184, v184 quad_perm:[1,0,3,2] row_mask:0xf bank_mask:0xf
    v_mfma_f32_16x16x32_bf16 v[8:11], v[228:231], a[212:215], v[8:11]
    v_add_f32_dpp v185, v185, v185 quad_perm:[1,0,3,2] row_mask:0xf bank_mask:0xf
    v_mfma_f32_16x16x32_bf16 v[12:15], v[224:227], a[216:219], 0
    v_add_f32_dpp v184, v184, v184 quad_perm:[2,3,0,1] row_mask:0xf bank_mask:0xf
    v_mfma_f32_16x16x32_bf16 v[12:15], v[228:231], a[220:223], v[12:15]
    buffer_load_dwordx4 v210, s[20:23], s72 offen offset:2048 lds
    v_add_f32_dpp v185, v185, v185 quad_perm:[2,3,0,1] row_mask:0xf bank_mask:0xf
    v_mfma_f32_16x16x32_bf16 v[16:19], v[232:235], a[192:195], 0
    v_add_f32_dpp v184, v184, v184 row_half_mirror row_mask:0xf bank_mask:0xf
    v_mfma_f32_16x16x32_bf16 v[16:19], v[236:239], a[196:199], v[16:19]
    v_add_f32_dpp v185, v185, v185 row_half_mirror row_mask:0xf bank_mask:0xf
    v_mfma_f32_16x16x32_bf16 v[20:23], v[232:235], a[200:203], 0
    v_add_f32_dpp v184, v184, v184 row_mirror row_mask:0xf bank_mask:0xf
    v_mfma_f32_16x16x32_bf16 v[20:23], v[236:239], a[204:207], v[20:23]
    buffer_load_dwordx4 v211, s[20:23], s72 offen offset:3072 lds
    v_add_f32_dpp v185, v185, v185 row_mirror row_mask:0xf bank_mask:0xf
    v_mfma_f32_16x16x32_bf16 v[24:27], v[232:235], a[208:211], 0
    s_mov_b32 s43, 1048576
    v_mov_b32 v186, v184
    v_mov_b32 v187, v185
    v_mfma_f32_16x16x32_bf16 v[24:27], v[236:239], a[212:215], v[24:27]
    s_add_u32 m0, s6, 131072
    v_mfma_f32_16x16x32_bf16 v[28:31], v[232:235], a[216:219], 0
    s_waitcnt lgkmcnt(0)
    v_permlane16_swap_b32 v184, v186
    v_permlane16_swap_b32 v185, v187
    v_add_f32 v184, v184, v186
    v_mfma_f32_16x16x32_bf16 v[28:31], v[236:239], a[220:223], v[28:31]
    v_add_f32 v185, v185, v187
    v_mov_b32 v186, v184
    v_mov_b32 v187, v185
    v_mfma_f32_16x16x32_bf16 v[32:35], v[240:243], a[192:195], 0
    buffer_load_dwordx4 v212, s[16:19], s43 offen offset:0 lds
    v_mfma_f32_16x16x32_bf16 v[32:35], v[244:247], a[196:199], v[32:35]
    ds_read_b64_tr_b16 v[224:225], v198 offset:0
    ds_read_b64_tr_b16 v[226:227], v198 offset:1024
    v_permlane32_swap_b32 v184, v186
    v_mfma_f32_16x16x32_bf16 v[36:39], v[240:243], a[200:203], 0
    v_permlane32_swap_b32 v185, v187
    v_add_f32 v184, v184, v186
    v_add_f32 v185, v185, v187
    v_mfma_f32_16x16x32_bf16 v[36:39], v[244:247], a[204:207], v[36:39]
    ds_read_b64_tr_b16 v[228:229], v198 offset:8192
    ds_read_b64_tr_b16 v[230:231], v198 offset:9216
    v_mul_f32 v184, 0x3b000000, v184
    v_mfma_f32_16x16x32_bf16 v[40:43], v[240:243], a[208:211], 0
    buffer_load_dwordx4 v213, s[16:19], s43 offen offset:1024 lds
    v_mul_f32 v185, 0x3b000000, v185
    v_mfma_f32_16x16x32_bf16 v[40:43], v[244:247], a[212:215], v[40:43]
    ds_read_b64_tr_b16 v[232:233], v198 offset:8
    ds_read_b64_tr_b16 v[234:235], v198 offset:1032
    v_sub_f32 v160, v168, v184
    v_mfma_f32_16x16x32_bf16 v[44:47], v[240:243], a[216:219], 0
    v_sub_f32 v164, v176, v185
    v_sub_f32 v161, v169, v184
    v_sub_f32 v165, v177, v185
    v_mfma_f32_16x16x32_bf16 v[44:47], v[244:247], a[220:223], v[44:47]
    ds_read_b64_tr_b16 v[236:237], v198 offset:8200
    ds_read_b64_tr_b16 v[238:239], v198 offset:9224
    v_sub_f32 v162, v170, v184
    v_mfma_f32_16x16x32_bf16 v[48:51], v[248:251], a[192:195], 0
    buffer_load_dwordx4 v214, s[16:19], s43 offen offset:2048 lds
    v_sub_f32 v166, v178, v185
    v_mfma_f32_16x16x32_bf16 v[48:51], v[252:255], a[196:199], v[48:51]
    v_sub_f32 v163, v171, v184
    v_sub_f32 v167, v179, v185
    v_mul_f32 v188, v160, v160
    v_mfma_f32_16x16x32_bf16 v[52:55], v[248:251], a[200:203], 0
    v_mul_f32 v189, v164, v164
    v_mul_f32 v190, v161, v161
    v_mul_f32 v191, v165, v165
    v_mfma_f32_16x16x32_bf16 v[52:55], v[252:255], a[204:207], v[52:55]
    buffer_load_dwordx4 v215, s[16:19], s43 offen offset:3072 lds
    v_fmac_f32 v188, v162, v162
    v_mfma_f32_16x16x32_bf16 v[56:59], v[248:251], a[208:211], 0
    s_mov_b32 s72, 256
    v_fmac_f32 v189, v166, v166
    v_fmac_f32 v190, v163, v163
    v_fmac_f32 v191, v167, v167
    v_mfma_f32_16x16x32_bf16 v[56:59], v[252:255], a[212:215], v[56:59]
    s_add_u32 m0, s30, 0
    v_sub_f32 v160, v172, v184
    v_sub_f32 v164, v180, v185
    v_sub_f32 v161, v173, v184
    v_mfma_f32_16x16x32_bf16 v[60:63], v[248:251], a[216:219], 0
    s_waitcnt lgkmcnt(0)
    v_sub_f32 v165, v181, v185
    v_sub_f32 v162, v174, v184
    v_sub_f32 v166, v182, v185
    v_mfma_f32_16x16x32_bf16 v[60:63], v[252:255], a[220:223], v[60:63]
    v_sub_f32 v163, v175, v184
    v_sub_f32 v167, v183, v185
    v_fmac_f32 v188, v160, v160
    v_mfma_f32_16x16x32_bf16 v[64:67], v[224:227], a[192:195], 0
    buffer_load_dwordx4 v208, s[20:23], s72 offen offset:0 lds
    v_fmac_f32 v189, v164, v164
    v_mfma_f32_16x16x32_bf16 v[64:67], v[228:231], a[196:199], v[64:67]
    ds_read_b64_tr_b16 v[240:241], v199 offset:0
    ds_read_b64_tr_b16 v[242:243], v199 offset:1024
    v_fmac_f32 v190, v161, v161
    v_mfma_f32_16x16x32_bf16 v[68:71], v[224:227], a[200:203], 0
    v_fmac_f32 v191, v165, v165
    v_fmac_f32 v188, v162, v162
    v_fmac_f32 v189, v166, v166
    v_mfma_f32_16x16x32_bf16 v[68:71], v[228:231], a[204:207], v[68:71]
    ds_read_b64_tr_b16 v[244:245], v199 offset:8192
    ds_read_b64_tr_b16 v[246:247], v199 offset:9216
    v_fmac_f32 v190, v163, v163
    v_mfma_f32_16x16x32_bf16 v[72:75], v[224:227], a[208:211], 0
    buffer_load_dwordx4 v209, s[20:23], s72 offen offset:1024 lds
    v_fmac_f32 v191, v167, v167
    v_mfma_f32_16x16x32_bf16 v[72:75], v[228:231], a[212:215], v[72:75]
    ds_read_b64_tr_b16 v[248:249], v199 offset:8
    ds_read_b64_tr_b16 v[250:251], v199 offset:1032
    v_add_f32 v188, v188, v190
    v_mfma_f32_16x16x32_bf16 v[76:79], v[224:227], a[216:219], 0
    v_add_f32 v189, v189, v191
    v_cvt_pk_bf16_f32 v184, v184, v184
    v_cvt_pk_bf16_f32 v185, v185, v185
    v_mfma_f32_16x16x32_bf16 v[76:79], v[228:231], a[220:223], v[76:79]
    ds_read_b64_tr_b16 v[252:253], v199 offset:8200
    ds_read_b64_tr_b16 v[254:255], v199 offset:9224
    v_lshlrev_b32 v184, 16, v184
    v_mfma_f32_16x16x32_bf16 v[80:83], v[232:235], a[192:195], 0
    buffer_load_dwordx4 v210, s[20:23], s72 offen offset:2048 lds
    v_lshlrev_b32 v185, 16, v185
    v_mfma_f32_16x16x32_bf16 v[80:83], v[236:239], a[196:199], v[80:83]
    v_add_f32_dpp v188, v188, v188 quad_perm:[1,0,3,2] row_mask:0xf bank_mask:0xf
    v_add_f32_dpp v189, v189, v189 quad_perm:[1,0,3,2] row_mask:0xf bank_mask:0xf
    v_mfma_f32_16x16x32_bf16 v[84:87], v[232:235], a[200:203], 0
    v_mfma_f32_16x16x32_bf16 v[84:87], v[236:239], a[204:207], v[84:87]
    buffer_load_dwordx4 v211, s[20:23], s72 offen offset:3072 lds
    v_add_f32_dpp v188, v188, v188 quad_perm:[2,3,0,1] row_mask:0xf bank_mask:0xf
    v_mfma_f32_16x16x32_bf16 v[88:91], v[232:235], a[208:211], 0
    s_mov_b32 s72, 33024
    v_add_f32_dpp v189, v189, v189 quad_perm:[2,3,0,1] row_mask:0xf bank_mask:0xf
    v_mfma_f32_16x16x32_bf16 v[88:91], v[236:239], a[212:215], v[88:91]
    s_add_u32 m0, s30, 4096
    v_add_f32_dpp v188, v188, v188 row_half_mirror row_mask:0xf bank_mask:0xf
    v_mfma_f32_16x16x32_bf16 v[92:95], v[232:235], a[216:219], 0
    s_waitcnt vmcnt(16) lgkmcnt(0)
    v_add_f32_dpp v189, v189, v189 row_half_mirror row_mask:0xf bank_mask:0xf
    v_mfma_f32_16x16x32_bf16 v[92:95], v[236:239], a[220:223], v[92:95]
    s_barrier
    v_add_f32_dpp v188, v188, v188 row_mirror row_mask:0xf bank_mask:0xf
    v_mfma_f32_16x16x32_bf16 v[96:99], v[240:243], a[192:195], 0
    buffer_load_dwordx4 v208, s[20:23], s72 offen offset:0 lds
    v_add_f32_dpp v189, v189, v189 row_mirror row_mask:0xf bank_mask:0xf
    v_mfma_f32_16x16x32_bf16 v[96:99], v[244:247], a[196:199], v[96:99]
    ds_read_b64_tr_b16 v[224:225], v196 offset:16384
    ds_read_b64_tr_b16 v[226:227], v196 offset:17408
    v_mov_b32 v186, v188
    v_mfma_f32_16x16x32_bf16 v[100:103], v[240:243], a[200:203], 0
    v_mov_b32 v187, v189
    v_mfma_f32_16x16x32_bf16 v[100:103], v[244:247], a[204:207], v[100:103]
    ds_read_b64_tr_b16 v[228:229], v196 offset:24576
    ds_read_b64_tr_b16 v[230:231], v196 offset:25600
    v_permlane16_swap_b32 v188, v186
    v_mfma_f32_16x16x32_bf16 v[104:107], v[240:243], a[208:211], 0
    buffer_load_dwordx4 v209, s[20:23], s72 offen offset:1024 lds
    v_permlane16_swap_b32 v189, v187
    v_mfma_f32_16x16x32_bf16 v[104:107], v[244:247], a[212:215], v[104:107]
    ds_read_b64_tr_b16 v[232:233], v196 offset:16392
    ds_read_b64_tr_b16 v[234:235], v196 offset:17416
    v_add_f32 v188, v188, v186
    v_mfma_f32_16x16x32_bf16 v[108:111], v[240:243], a[216:219], 0
    v_add_f32 v189, v189, v187
    v_mov_b32 v186, v188
    v_mov_b32 v187, v189
    v_mfma_f32_16x16x32_bf16 v[108:111], v[244:247], a[220:223], v[108:111]
    ds_read_b64_tr_b16 v[236:237], v196 offset:24584
    ds_read_b64_tr_b16 v[238:239], v196 offset:25608
    v_mfma_f32_16x16x32_bf16 v[112:115], v[248:251], a[192:195], 0
    s_waitcnt vmcnt(10) lgkmcnt(4)
    v_permlane32_swap_b32 v188, v186
    v_permlane32_swap_b32 v189, v187
    v_add_f32 v188, v188, v186
    v_mfma_f32_16x16x32_bf16 v[112:115], v[252:255], a[196:199], v[112:115]
    ds_read_b128 v[128:131], v202 offset:0
    ds_read_b128 v[132:135], v203 offset:0
    v_add_f32 v189, v189, v187
    v_mfma_f32_16x16x32_bf16 v[116:119], v[248:251], a[200:203], 0
    ds_read_b128 v[136:139], v202 offset:2048
    ds_read_b128 v[140:143], v203 offset:2048
    v_mul_f32 v188, 0x3b000000, v188
    v_mfma_f32_16x16x32_bf16 v[116:119], v[252:255], a[204:207], v[116:119]
    ds_read_b128 v[144:147], v202 offset:4096
    ds_read_b128 v[148:151], v203 offset:4096
    v_mul_f32 v189, 0x3b000000, v189
    v_mfma_f32_16x16x32_bf16 v[120:123], v[248:251], a[208:211], 0
    ds_read_b128 v[152:155], v202 offset:6144
    ds_read_b128 v[156:159], v203 offset:6144
    v_cvt_pk_bf16_f32 v188, v188, v188
    v_mfma_f32_16x16x32_bf16 v[120:123], v[252:255], a[212:215], v[120:123]
    buffer_load_dwordx4 v210, s[20:23], s72 offen offset:2048 lds
    v_cvt_pk_bf16_f32 v189, v189, v189
    v_mfma_f32_16x16x32_bf16 v[124:127], v[248:251], a[216:219], 0
    s_waitcnt lgkmcnt(0)
    v_lshlrev_b32 v188, 16, v188
    v_lshlrev_b32 v189, 16, v189
    v_add_f32 v188, 0x3727c5ac, v188
    v_mfma_f32_16x16x32_bf16 v[124:127], v[252:255], a[220:223], v[124:127]
    v_add_f32 v189, 0x3727c5ac, v189
    v_cvt_pk_bf16_f32 v188, v188, v188
    v_cvt_pk_bf16_f32 v189, v189, v189
    v_mfma_f32_16x16x32_bf16 a[128:131], v[224:227], v[192:195], a[128:131]
    buffer_load_dwordx4 v211, s[20:23], s72 offen offset:3072 lds
    v_lshlrev_b32 v188, 16, v188
    v_mfma_f32_16x16x32_bf16 a[128:131], v[228:231], v[192:195], a[128:131]
    ds_read_b64_tr_b16 v[240:241], v197 offset:16384
    ds_read_b64_tr_b16 v[242:243], v197 offset:17408
    v_lshlrev_b32 v189, 16, v189
    v_mfma_f32_16x16x32_bf16 a[132:135], v[232:235], v[192:195], a[132:135]
    s_mov_b32 s43, 1572864
    v_sqrt_f32 v188, v188
    v_mfma_f32_16x16x32_bf16 a[132:135], v[236:239], v[192:195], a[132:135]
    ds_read_b64_tr_b16 v[244:245], v197 offset:24576
    ds_read_b64_tr_b16 v[246:247], v197 offset:25600
    v_mfma_f32_16x16x32_bf16 v[0:3], v[224:227], v[128:131], v[0:3]
    s_add_u32 m0, s6, 147456
    v_sqrt_f32 v189, v189
    v_lshl_add_u32 v186, s57, 1, v222
    v_mfma_f32_16x16x32_bf16 v[0:3], v[228:231], v[132:135], v[0:3]
    ds_read_b64_tr_b16 v[248:249], v197 offset:16392
    ds_read_b64_tr_b16 v[250:251], v197 offset:17416
    v_mov_b32 v164, 0
    v_mfma_f32_16x16x32_bf16 v[4:7], v[224:227], v[136:139], v[4:7]
    buffer_load_dwordx4 v212, s[16:19], s43 offen offset:0 lds
    v_mov_b32 v165, 0
    v_mfma_f32_16x16x32_bf16 v[4:7], v[228:231], v[140:143], v[4:7]
    ds_read_b64_tr_b16 v[252:253], v197 offset:24584
    ds_read_b64_tr_b16 v[254:255], v197 offset:25608
    v_mov_b32 v166, 0
    v_mfma_f32_16x16x32_bf16 v[8:11], v[224:227], v[144:147], v[8:11]
    v_mov_b32 v167, 0
    v_add_u32 v186, 0xffe10000, v186
    v_lshrrev_b32 v160, 16, v184
    v_mfma_f32_16x16x32_bf16 v[8:11], v[228:231], v[148:151], v[8:11]
    buffer_load_dwordx4 v213, s[16:19], s43 offen offset:1024 lds
    v_lshrrev_b32 v162, 16, v185
    v_mfma_f32_16x16x32_bf16 v[12:15], v[224:227], v[152:155], v[12:15]
    v_cvt_pk_bf16_f32 v188, v188, v188
    v_cvt_pk_bf16_f32 v189, v189, v189
    v_lshlrev_b32 v188, 16, v188
    v_mfma_f32_16x16x32_bf16 v[12:15], v[228:231], v[156:159], v[12:15]
    v_lshlrev_b32 v189, 16, v189
    v_mov_b32 v161, s44
    v_mov_b32 v163, s44
    v_mfma_f32_16x16x32_bf16 v[16:19], v[232:235], v[128:131], v[16:19]
    v_or_b32 v160, v160, v188
    v_or_b32 v162, v162, v189
    v_mfma_f32_16x16x32_bf16 v[16:19], v[236:239], v[132:135], v[16:19]
    buffer_load_dwordx4 v214, s[16:19], s43 offen offset:2048 lds
    v_mfma_f32_16x16x32_bf16 v[20:23], v[232:235], v[136:139], v[20:23]
    s_mov_b64 exec, 1
    buffer_store_dwordx4 v[160:163], off, s[48:51], s57 sc1
    s_mov_b64 exec, 3
    buffer_store_dwordx4 v[164:167], v186, s[48:51], 0 offen sc1
    s_mov_b64 exec, -1
    v_mfma_f32_16x16x32_bf16 v[20:23], v[236:239], v[140:143], v[20:23]
    v_rcp_f32 v188, v188
    v_mfma_f32_16x16x32_bf16 v[24:27], v[232:235], v[144:147], v[24:27]
    v_rcp_f32 v189, v189
    v_sub_f32 v168, v168, v184
    v_mfma_f32_16x16x32_bf16 v[24:27], v[236:239], v[148:151], v[24:27]
    buffer_load_dwordx4 v215, s[16:19], s43 offen offset:3072 lds
    v_sub_f32 v176, v176, v185
    v_mfma_f32_16x16x32_bf16 v[28:31], v[232:235], v[152:155], v[28:31]
    s_waitcnt lgkmcnt(0)
    v_sub_f32 v169, v169, v184
    v_sub_f32 v177, v177, v185
    v_sub_f32 v170, v170, v184
    v_mfma_f32_16x16x32_bf16 v[28:31], v[236:239], v[156:159], v[28:31]
    v_sub_f32 v178, v178, v185
    v_sub_f32 v171, v171, v184
    v_sub_f32 v179, v179, v185
    v_mfma_f32_16x16x32_bf16 v[32:35], v[240:243], v[128:131], v[32:35]
    s_mov_b32 s72, 384
    v_sub_f32 v172, v172, v184
    v_sub_f32 v180, v180, v185
    v_sub_f32 v173, v173, v184
    v_mfma_f32_16x16x32_bf16 v[32:35], v[244:247], v[132:135], v[32:35]
    ds_read_b64_tr_b16 v[224:225], v198 offset:16384
    ds_read_b64_tr_b16 v[226:227], v198 offset:17408
    v_sub_f32 v181, v181, v185
    v_mfma_f32_16x16x32_bf16 v[36:39], v[240:243], v[136:139], v[36:39]
    s_add_u32 m0, s30, 32768
    v_sub_f32 v174, v174, v184
    v_sub_f32 v182, v182, v185
    v_sub_f32 v175, v175, v184
    v_mfma_f32_16x16x32_bf16 v[36:39], v[244:247], v[140:143], v[36:39]
    ds_read_b64_tr_b16 v[228:229], v198 offset:24576
    ds_read_b64_tr_b16 v[230:231], v198 offset:25600
    v_sub_f32 v183, v183, v185
    v_mfma_f32_16x16x32_bf16 v[40:43], v[240:243], v[144:147], v[40:43]
    buffer_load_dwordx4 v208, s[20:23], s72 offen offset:0 lds
    v_cvt_pk_bf16_f32 v160, v168, v169
    v_mfma_f32_16x16x32_bf16 v[40:43], v[244:247], v[148:151], v[40:43]
    ds_read_b64_tr_b16 v[232:233], v198 offset:16392
    ds_read_b64_tr_b16 v[234:235], v198 offset:17416
    v_cvt_pk_bf16_f32 v164, v176, v177
    v_mfma_f32_16x16x32_bf16 v[44:47], v[240:243], v[152:155], v[44:47]
    v_cvt_pk_bf16_f32 v161, v170, v171
    v_cvt_pk_bf16_f32 v165, v178, v179
    v_cvt_pk_bf16_f32 v162, v172, v173
    v_mfma_f32_16x16x32_bf16 v[44:47], v[244:247], v[156:159], v[44:47]
    ds_read_b64_tr_b16 v[236:237], v198 offset:24584
    ds_read_b64_tr_b16 v[238:239], v198 offset:25608
    v_cvt_pk_bf16_f32 v166, v180, v181
    v_mfma_f32_16x16x32_bf16 v[48:51], v[248:251], v[128:131], v[48:51]
    buffer_load_dwordx4 v209, s[20:23], s72 offen offset:1024 lds
    v_cvt_pk_bf16_f32 v163, v174, v175
    v_mfma_f32_16x16x32_bf16 v[48:51], v[252:255], v[132:135], v[48:51]
    v_cvt_pk_bf16_f32 v167, v182, v183
    v_lshlrev_b32 v168, 16, v160
    v_lshlrev_b32 v176, 16, v164
    v_mfma_f32_16x16x32_bf16 v[52:55], v[248:251], v[136:139], v[52:55]
    v_and_b32 v169, 0xffff0000, v160
    v_and_b32 v177, 0xffff0000, v164
    v_lshlrev_b32 v170, 16, v161
    v_mfma_f32_16x16x32_bf16 v[52:55], v[252:255], v[140:143], v[52:55]
    buffer_load_dwordx4 v210, s[20:23], s72 offen offset:2048 lds
    v_lshlrev_b32 v178, 16, v165
    v_mfma_f32_16x16x32_bf16 v[56:59], v[248:251], v[144:147], v[56:59]
    v_and_b32 v171, 0xffff0000, v161
    v_and_b32 v179, 0xffff0000, v165
    v_lshlrev_b32 v172, 16, v162
    v_mfma_f32_16x16x32_bf16 v[56:59], v[252:255], v[148:151], v[56:59]
    v_lshlrev_b32 v180, 16, v166
    v_and_b32 v173, 0xffff0000, v162
    v_and_b32 v181, 0xffff0000, v166
    v_mfma_f32_16x16x32_bf16 v[60:63], v[248:251], v[152:155], v[60:63]
    s_waitcnt lgkmcnt(0)
    v_lshlrev_b32 v174, 16, v163
    v_lshlrev_b32 v182, 16, v167
    v_and_b32 v175, 0xffff0000, v163
    v_mfma_f32_16x16x32_bf16 v[60:63], v[252:255], v[156:159], v[60:63]
    v_and_b32 v183, 0xffff0000, v167
    v_mul_f32 v168, v168, v188
    v_mul_f32 v176, v176, v189
    v_mfma_f32_16x16x32_bf16 v[64:67], v[224:227], v[128:131], v[64:67]
    buffer_load_dwordx4 v211, s[20:23], s72 offen offset:3072 lds
    v_mul_f32 v169, v169, v188
    v_mfma_f32_16x16x32_bf16 v[64:67], v[228:231], v[132:135], v[64:67]
    ds_read_b64_tr_b16 v[240:241], v199 offset:16384
    ds_read_b64_tr_b16 v[242:243], v199 offset:17408
    v_mul_f32 v177, v177, v189
    v_mfma_f32_16x16x32_bf16 v[68:71], v[224:227], v[136:139], v[68:71]
    s_mov_b32 s72, 33152
    v_mul_f32 v170, v170, v188
    v_mul_f32 v178, v178, v189
    v_mul_f32 v171, v171, v188
    v_mfma_f32_16x16x32_bf16 v[68:71], v[228:231], v[140:143], v[68:71]
    ds_read_b64_tr_b16 v[244:245], v199 offset:24576
    ds_read_b64_tr_b16 v[246:247], v199 offset:25600
    v_mul_f32 v179, v179, v189
    v_mfma_f32_16x16x32_bf16 v[72:75], v[224:227], v[144:147], v[72:75]
    s_add_u32 m0, s30, 36864
    v_mul_f32 v172, v172, v188
    v_mul_f32 v180, v180, v189
    v_mul_f32 v173, v173, v188
    v_mfma_f32_16x16x32_bf16 v[72:75], v[228:231], v[148:151], v[72:75]
    ds_read_b64_tr_b16 v[248:249], v199 offset:16392
    ds_read_b64_tr_b16 v[250:251], v199 offset:17416
    v_mul_f32 v181, v181, v189
    v_mfma_f32_16x16x32_bf16 v[76:79], v[224:227], v[152:155], v[76:79]
    buffer_load_dwordx4 v208, s[20:23], s72 offen offset:0 lds
    v_mul_f32 v174, v174, v188
    v_mfma_f32_16x16x32_bf16 v[76:79], v[228:231], v[156:159], v[76:79]
    ds_read_b64_tr_b16 v[252:253], v199 offset:24584
    ds_read_b64_tr_b16 v[254:255], v199 offset:25608
    v_mul_f32 v182, v182, v189
    v_mfma_f32_16x16x32_bf16 v[80:83], v[232:235], v[128:131], v[80:83]
    v_mul_f32 v175, v175, v188
    v_mul_f32 v183, v183, v189
    v_cvt_pk_bf16_f32 v160, v168, v169
    v_mfma_f32_16x16x32_bf16 v[80:83], v[236:239], v[132:135], v[80:83]
    buffer_load_dwordx4 v209, s[20:23], s72 offen offset:1024 lds
    v_cvt_pk_bf16_f32 v164, v176, v177
    v_mfma_f32_16x16x32_bf16 v[84:87], v[232:235], v[136:139], v[84:87]
    v_cvt_pk_bf16_f32 v161, v170, v171
    v_cvt_pk_bf16_f32 v165, v178, v179
    v_cvt_pk_bf16_f32 v162, v172, v173
    v_mfma_f32_16x16x32_bf16 v[84:87], v[236:239], v[140:143], v[84:87]
    v_cvt_pk_bf16_f32 v166, v180, v181
    v_cvt_pk_bf16_f32 v163, v174, v175
    v_cvt_pk_bf16_f32 v167, v182, v183
    v_mfma_f32_16x16x32_bf16 v[88:91], v[232:235], v[144:147], v[88:91]
    buffer_store_dwordx4 v[160:163], v222, s[48:51], s56 offen sc1
    v_mfma_f32_16x16x32_bf16 v[88:91], v[236:239], v[148:151], v[88:91]
    buffer_load_dwordx4 v210, s[20:23], s72 offen offset:2048 lds
    v_mfma_f32_16x16x32_bf16 v[92:95], v[232:235], v[152:155], v[92:95]
    s_waitcnt vmcnt(22) lgkmcnt(0)
    buffer_store_dwordx4 v[164:167], v222, s[48:51], s56 offen offset:1024 sc1
    v_accvgpr_read_b32 v186, a136
    v_mfma_f32_16x16x32_bf16 v[92:95], v[236:239], v[156:159], v[92:95]
    s_barrier
    v_accvgpr_read_b32 v187, a137
    v_accvgpr_read_b32 v188, a138
    v_accvgpr_read_b32 v189, a139
    v_mfma_f32_16x16x32_bf16 v[96:99], v[240:243], v[128:131], v[96:99]
    v_lshlrev_b32 v168, 16, v160
    v_lshlrev_b32 v176, 16, v164
    v_and_b32 v169, 0xffff0000, v160
    v_mfma_f32_16x16x32_bf16 v[96:99], v[244:247], v[132:135], v[96:99]
    ds_read_b64_tr_b16 v[224:225], v196 offset:32768
    ds_read_b64_tr_b16 v[226:227], v196 offset:33792
    v_and_b32 v177, 0xffff0000, v164
    v_mfma_f32_16x16x32_bf16 v[100:103], v[240:243], v[136:139], v[100:103]
    buffer_load_dwordx4 v211, s[20:23], s72 offen offset:3072 lds
    v_lshlrev_b32 v170, 16, v161
    v_mfma_f32_16x16x32_bf16 v[100:103], v[244:247], v[140:143], v[100:103]
    ds_read_b64_tr_b16 v[228:229], v196 offset:40960
    ds_read_b64_tr_b16 v[230:231], v196 offset:41984
    v_lshlrev_b32 v178, 16, v165
    v_mfma_f32_16x16x32_bf16 v[104:107], v[240:243], v[144:147], v[104:107]
    s_mov_b32 s43, 2097152
    v_and_b32 v171, 0xffff0000, v161
    v_and_b32 v179, 0xffff0000, v165
    v_lshlrev_b32 v172, 16, v162
    v_mfma_f32_16x16x32_bf16 v[104:107], v[244:247], v[148:151], v[104:107]
    ds_read_b64_tr_b16 v[232:233], v196 offset:32776
    ds_read_b64_tr_b16 v[234:235], v196 offset:33800
    v_lshlrev_b32 v180, 16, v166
    v_mfma_f32_16x16x32_bf16 v[108:111], v[240:243], v[152:155], v[108:111]
    s_add_u32 m0, s6, 98304
    v_and_b32 v173, 0xffff0000, v162
    v_and_b32 v181, 0xffff0000, v166
    v_lshlrev_b32 v174, 16, v163
    v_mfma_f32_16x16x32_bf16 v[108:111], v[244:247], v[156:159], v[108:111]
    ds_read_b64_tr_b16 v[236:237], v196 offset:40968
    ds_read_b64_tr_b16 v[238:239], v196 offset:41992
    v_lshlrev_b32 v182, 16, v167
    v_mfma_f32_16x16x32_bf16 v[112:115], v[248:251], v[128:131], v[112:115]
    s_waitcnt vmcnt(16) lgkmcnt(4)
    v_and_b32 v175, 0xffff0000, v163
    v_and_b32 v183, 0xffff0000, v167
    v_lshlrev_b32 v160, 16, v186
    v_mfma_f32_16x16x32_bf16 v[112:115], v[252:255], v[132:135], v[112:115]
    ds_read_b128 a[224:227], v200 offset:0
    ds_read_b128 a[228:231], v201 offset:0
    v_and_b32 v161, 0xffff0000, v186
    v_mfma_f32_16x16x32_bf16 v[116:119], v[248:251], v[136:139], v[116:119]
    ds_read_b128 a[232:235], v200 offset:2048
    ds_read_b128 a[236:239], v201 offset:2048
    v_lshlrev_b32 v162, 16, v187
    v_mfma_f32_16x16x32_bf16 v[116:119], v[252:255], v[140:143], v[116:119]
    ds_read_b128 a[240:243], v200 offset:4096
    ds_read_b128 a[244:247], v201 offset:4096
    v_and_b32 v163, 0xffff0000, v187
    v_mfma_f32_16x16x32_bf16 v[120:123], v[248:251], v[144:147], v[120:123]
    ds_read_b128 a[248:251], v200 offset:6144
    ds_read_b128 a[252:255], v201 offset:6144
    v_lshlrev_b32 v164, 16, v188
    v_mfma_f32_16x16x32_bf16 v[120:123], v[252:255], v[148:151], v[120:123]
    buffer_load_dwordx4 v212, s[16:19], s43 offen offset:0 lds
    v_and_b32 v165, 0xffff0000, v188
    v_mfma_f32_16x16x32_bf16 v[124:127], v[248:251], v[152:155], v[124:127]
    s_waitcnt lgkmcnt(0)
    v_lshlrev_b32 v166, 16, v189
    v_and_b32 v167, 0xffff0000, v189
    v_mul_f32 v184, v168, v160
    v_mfma_f32_16x16x32_bf16 v[124:127], v[252:255], v[156:159], v[124:127]
    v_mul_f32 v185, v176, v160
    v_mul_f32 v190, v169, v161
    v_mul_f32 v191, v177, v161
    v_mfma_f32_16x16x32_bf16 a[128:131], v[224:227], v[192:195], a[128:131]
    buffer_load_dwordx4 v213, s[16:19], s43 offen offset:1024 lds
    v_fmac_f32 v184, v170, v162
    v_mfma_f32_16x16x32_bf16 a[128:131], v[228:231], v[192:195], a[128:131]
    ds_read_b64_tr_b16 v[240:241], v197 offset:32768
    ds_read_b64_tr_b16 v[242:243], v197 offset:33792
    v_fmac_f32 v185, v178, v162
    v_mfma_f32_16x16x32_bf16 a[132:135], v[232:235], v[192:195], a[132:135]
    v_fmac_f32 v190, v171, v163
    v_fmac_f32 v191, v179, v163
    v_fmac_f32 v184, v172, v164
    v_mfma_f32_16x16x32_bf16 a[132:135], v[236:239], v[192:195], a[132:135]
    ds_read_b64_tr_b16 v[244:245], v197 offset:40960
    ds_read_b64_tr_b16 v[246:247], v197 offset:41984
    v_fmac_f32 v185, v180, v164
    v_mfma_f32_16x16x32_bf16 v[0:3], v[224:227], a[224:227], v[0:3]
    buffer_load_dwordx4 v214, s[16:19], s43 offen offset:2048 lds
    v_fmac_f32 v190, v173, v165
    v_mfma_f32_16x16x32_bf16 v[0:3], v[228:231], a[228:231], v[0:3]
    ds_read_b64_tr_b16 v[248:249], v197 offset:32776
    ds_read_b64_tr_b16 v[250:251], v197 offset:33800
    v_fmac_f32 v191, v181, v165
    v_mfma_f32_16x16x32_bf16 v[4:7], v[224:227], a[232:235], v[4:7]
    v_fmac_f32 v184, v174, v166
    v_fmac_f32 v185, v182, v166
    v_fmac_f32 v190, v175, v167
    v_mfma_f32_16x16x32_bf16 v[4:7], v[228:231], a[236:239], v[4:7]
    ds_read_b64_tr_b16 v[252:253], v197 offset:40968
    ds_read_b64_tr_b16 v[254:255], v197 offset:41992
    v_fmac_f32 v191, v183, v167
    v_mfma_f32_16x16x32_bf16 v[8:11], v[224:227], a[240:243], v[8:11]
    buffer_load_dwordx4 v215, s[16:19], s43 offen offset:3072 lds
    v_add_f32 v184, v184, v190
    v_mfma_f32_16x16x32_bf16 v[8:11], v[228:231], a[244:247], v[8:11]
    s_mov_b32 s72, 512
    v_add_f32 v185, v185, v191
    v_mfma_f32_16x16x32_bf16 v[12:15], v[224:227], a[248:251], v[12:15]
    s_add_u32 m0, s30, 65536
    v_add_f32_dpp v184, v184, v184 quad_perm:[1,0,3,2] row_mask:0xf bank_mask:0xf
    v_mfma_f32_16x16x32_bf16 v[12:15], v[228:231], a[252:255], v[12:15]
    v_add_f32_dpp v185, v185, v185 quad_perm:[1,0,3,2] row_mask:0xf bank_mask:0xf
    v_mfma_f32_16x16x32_bf16 v[16:19], v[232:235], a[224:227], v[16:19]
    buffer_load_dwordx4 v208, s[20:23], s72 offen offset:0 lds
    v_add_f32_dpp v184, v184, v184 quad_perm:[2,3,0,1] row_mask:0xf bank_mask:0xf
    v_mfma_f32_16x16x32_bf16 v[16:19], v[236:239], a[228:231], v[16:19]
    v_add_f32_dpp v185, v185, v185 quad_perm:[2,3,0,1] row_mask:0xf bank_mask:0xf
    v_mfma_f32_16x16x32_bf16 v[20:23], v[232:235], a[232:235], v[20:23]
    v_add_f32_dpp v184, v184, v184 row_half_mirror row_mask:0xf bank_mask:0xf
    v_mfma_f32_16x16x32_bf16 v[20:23], v[236:239], a[236:239], v[20:23]
    v_add_f32_dpp v185, v185, v185 row_half_mirror row_mask:0xf bank_mask:0xf
    v_mfma_f32_16x16x32_bf16 v[24:27], v[232:235], a[240:243], v[24:27]
    buffer_load_dwordx4 v209, s[20:23], s72 offen offset:1024 lds
    v_add_f32_dpp v184, v184, v184 row_mirror row_mask:0xf bank_mask:0xf
    v_mfma_f32_16x16x32_bf16 v[24:27], v[236:239], a[244:247], v[24:27]
    v_add_f32_dpp v185, v185, v185 row_mirror row_mask:0xf bank_mask:0xf
    v_mov_b32 v186, v184
    v_mov_b32 v187, v185
    v_mfma_f32_16x16x32_bf16 v[28:31], v[232:235], a[248:251], v[28:31]
    s_waitcnt lgkmcnt(0)
    v_mfma_f32_16x16x32_bf16 v[28:31], v[236:239], a[252:255], v[28:31]
    v_permlane16_swap_b32 v184, v186
    v_permlane16_swap_b32 v185, v187
    v_add_f32 v184, v184, v186
    v_mfma_f32_16x16x32_bf16 v[32:35], v[240:243], a[224:227], v[32:35]
    buffer_load_dwordx4 v210, s[20:23], s72 offen offset:2048 lds
    v_add_f32 v185, v185, v187
    v_mfma_f32_16x16x32_bf16 v[32:35], v[244:247], a[228:231], v[32:35]
    ds_read_b64_tr_b16 v[224:225], v198 offset:32768
    ds_read_b64_tr_b16 v[226:227], v198 offset:33792
    v_mov_b32 v186, v184
    v_mfma_f32_16x16x32_bf16 v[36:39], v[240:243], a[232:235], v[36:39]
    v_mov_b32 v187, v185
    v_mfma_f32_16x16x32_bf16 v[36:39], v[244:247], a[236:239], v[36:39]
    ds_read_b64_tr_b16 v[228:229], v198 offset:40960
    ds_read_b64_tr_b16 v[230:231], v198 offset:41984
    v_permlane32_swap_b32 v184, v186
    v_mfma_f32_16x16x32_bf16 v[40:43], v[240:243], a[240:243], v[40:43]
    buffer_load_dwordx4 v211, s[20:23], s72 offen offset:3072 lds
    v_permlane32_swap_b32 v185, v187
    v_mfma_f32_16x16x32_bf16 v[40:43], v[244:247], a[244:247], v[40:43]
    ds_read_b64_tr_b16 v[232:233], v198 offset:32776
    ds_read_b64_tr_b16 v[234:235], v198 offset:33800
    v_add_f32 v184, v184, v186
    v_mfma_f32_16x16x32_bf16 v[44:47], v[240:243], a[248:251], v[44:47]
    s_mov_b32 s72, 33280
    v_add_f32 v185, v185, v187
    v_cvt_pk_bf16_f32 v184, v184, v184
    v_cvt_pk_bf16_f32 v185, v185, v185
    v_mfma_f32_16x16x32_bf16 v[44:47], v[244:247], a[252:255], v[44:47]
    ds_read_b64_tr_b16 v[236:237], v198 offset:40968
    ds_read_b64_tr_b16 v[238:239], v198 offset:41992
    v_lshlrev_b32 v184, 16, v184
    v_mfma_f32_16x16x32_bf16 v[48:51], v[248:251], a[224:227], v[48:51]
    s_add_u32 m0, s30, 69632
    v_lshlrev_b32 v185, 16, v185
    v_ashrrev_i32 v186, 31, v184
    v_ashrrev_i32 v187, 31, v185
    v_mfma_f32_16x16x32_bf16 v[48:51], v[252:255], a[228:231], v[48:51]
    buffer_load_dwordx4 v208, s[20:23], s72 offen offset:0 lds
    v_or_b32 v186, 0x80000000, v186
    v_mfma_f32_16x16x32_bf16 v[52:55], v[248:251], a[232:235], v[52:55]
    v_or_b32 v187, 0x80000000, v187
    v_xor_b32 v184, v184, v186
    v_xor_b32 v185, v185, v187
    v_mfma_f32_16x16x32_bf16 v[52:55], v[252:255], a[236:239], v[52:55]
    v_and_b32 v184, 0xffff0000, v184
    v_and_b32 v185, 0xffff0000, v185
    v_or_b32 v184, s58, v184
    v_mfma_f32_16x16x32_bf16 v[56:59], v[248:251], a[240:243], v[56:59]
    buffer_load_dwordx4 v209, s[20:23], s72 offen offset:1024 lds
    v_or_b32 v185, s59, v185
    v_mfma_f32_16x16x32_bf16 v[56:59], v[252:255], a[244:247], v[56:59]
    v_max_u32 v184, v184, v185
    v_mfma_f32_16x16x32_bf16 v[60:63], v[248:251], a[248:251], v[60:63]
    s_waitcnt lgkmcnt(0)
    v_readfirstlane_b32 s46, v184
    v_accvgpr_write_b32 a0, 0
    v_mfma_f32_16x16x32_bf16 v[60:63], v[252:255], a[252:255], v[60:63]
    v_accvgpr_write_b32 a1, 0
    v_accvgpr_write_b32 a2, 0
    v_mfma_f32_16x16x32_bf16 v[64:67], v[224:227], a[224:227], v[64:67]
    buffer_load_dwordx4 v210, s[20:23], s72 offen offset:2048 lds
    v_mfma_f32_16x16x32_bf16 v[64:67], v[228:231], a[228:231], v[64:67]
    ds_read_b64_tr_b16 v[240:241], v199 offset:32768
    ds_read_b64_tr_b16 v[242:243], v199 offset:33792
    v_mfma_f32_16x16x32_bf16 v[68:71], v[224:227], a[232:235], v[68:71]
    v_accvgpr_write_b32 a3, 0
    v_accvgpr_write_b32 a4, 0
    v_mfma_f32_16x16x32_bf16 v[68:71], v[228:231], a[236:239], v[68:71]
    ds_read_b64_tr_b16 v[244:245], v199 offset:40960
    ds_read_b64_tr_b16 v[246:247], v199 offset:41984
    v_mfma_f32_16x16x32_bf16 v[72:75], v[224:227], a[240:243], v[72:75]
    buffer_load_dwordx4 v211, s[20:23], s72 offen offset:3072 lds
    v_mfma_f32_16x16x32_bf16 v[72:75], v[228:231], a[244:247], v[72:75]
    ds_read_b64_tr_b16 v[248:249], v199 offset:32776
    ds_read_b64_tr_b16 v[250:251], v199 offset:33800
    v_mfma_f32_16x16x32_bf16 v[76:79], v[224:227], a[248:251], v[76:79]
    s_mov_b32 s43, 2621440
    v_accvgpr_write_b32 a5, 0
    v_accvgpr_write_b32 a6, 0
    v_mfma_f32_16x16x32_bf16 v[76:79], v[228:231], a[252:255], v[76:79]
    ds_read_b64_tr_b16 v[252:253], v199 offset:40968
    ds_read_b64_tr_b16 v[254:255], v199 offset:41992
    v_mfma_f32_16x16x32_bf16 v[80:83], v[232:235], a[224:227], v[80:83]
    s_add_u32 m0, s6, 114688
    v_accvgpr_write_b32 a7, 0
    v_accvgpr_write_b32 a8, 0
    v_mfma_f32_16x16x32_bf16 v[80:83], v[236:239], a[228:231], v[80:83]
    buffer_load_dwordx4 v212, s[16:19], s43 offen offset:0 lds
    v_mfma_f32_16x16x32_bf16 v[84:87], v[232:235], a[232:235], v[84:87]
    v_accvgpr_write_b32 a9, 0
    v_accvgpr_write_b32 a10, 0
    v_mfma_f32_16x16x32_bf16 v[84:87], v[236:239], a[236:239], v[84:87]
    v_accvgpr_write_b32 a11, 0
    v_accvgpr_write_b32 a12, 0
    v_mfma_f32_16x16x32_bf16 v[88:91], v[232:235], a[240:243], v[88:91]
    buffer_load_dwordx4 v213, s[16:19], s43 offen offset:1024 lds
    v_mfma_f32_16x16x32_bf16 v[88:91], v[236:239], a[244:247], v[88:91]
    v_accvgpr_write_b32 a13, 0
    v_accvgpr_write_b32 a14, 0
    v_mfma_f32_16x16x32_bf16 v[92:95], v[232:235], a[248:251], v[92:95]
    s_waitcnt vmcnt(24) lgkmcnt(0)
    v_accvgpr_write_b32 a15, 0
    v_accvgpr_write_b32 a16, 0
    v_mfma_f32_16x16x32_bf16 v[92:95], v[236:239], a[252:255], v[92:95]
    s_barrier
    v_accvgpr_write_b32 a17, 0
    v_accvgpr_write_b32 a18, 0
    v_mfma_f32_16x16x32_bf16 v[96:99], v[240:243], a[224:227], v[96:99]
    buffer_load_dwordx4 v214, s[16:19], s43 offen offset:2048 lds
    v_mfma_f32_16x16x32_bf16 v[96:99], v[244:247], a[228:231], v[96:99]
    ds_read_b64_tr_b16 v[224:225], v196 offset:49152
    ds_read_b64_tr_b16 v[226:227], v196 offset:50176
    v_mfma_f32_16x16x32_bf16 v[100:103], v[240:243], a[232:235], v[100:103]
    v_accvgpr_write_b32 a19, 0
    v_accvgpr_write_b32 a20, 0
    v_mfma_f32_16x16x32_bf16 v[100:103], v[244:247], a[236:239], v[100:103]
    ds_read_b64_tr_b16 v[228:229], v196 offset:57344
    ds_read_b64_tr_b16 v[230:231], v196 offset:58368
    v_mfma_f32_16x16x32_bf16 v[104:107], v[240:243], a[240:243], v[104:107]
    buffer_load_dwordx4 v215, s[16:19], s43 offen offset:3072 lds
    v_mfma_f32_16x16x32_bf16 v[104:107], v[244:247], a[244:247], v[104:107]
    ds_read_b64_tr_b16 v[232:233], v196 offset:49160
    ds_read_b64_tr_b16 v[234:235], v196 offset:50184
    v_mfma_f32_16x16x32_bf16 v[108:111], v[240:243], a[248:251], v[108:111]
    s_mov_b32 s72, 640
    v_accvgpr_write_b32 a21, 0
    v_accvgpr_write_b32 a22, 0
    v_mfma_f32_16x16x32_bf16 v[108:111], v[244:247], a[252:255], v[108:111]
    ds_read_b64_tr_b16 v[236:237], v196 offset:57352
    ds_read_b64_tr_b16 v[238:239], v196 offset:58376
    v_mfma_f32_16x16x32_bf16 v[112:115], v[248:251], a[224:227], v[112:115]
    s_waitcnt vmcnt(16) lgkmcnt(4)
    v_accvgpr_write_b32 a23, 0
    v_accvgpr_write_b32 a24, 0
    v_mfma_f32_16x16x32_bf16 v[112:115], v[252:255], a[228:231], v[112:115]
    ds_read_b128 v[160:163], v200 offset:32768
    ds_read_b128 v[164:167], v201 offset:32768
    v_mfma_f32_16x16x32_bf16 v[116:119], v[248:251], a[232:235], v[116:119]
    ds_read_b128 v[168:171], v200 offset:34816
    ds_read_b128 v[172:175], v201 offset:34816
    v_mfma_f32_16x16x32_bf16 v[116:119], v[252:255], a[236:239], v[116:119]
    ds_read_b128 v[176:179], v200 offset:36864
    ds_read_b128 v[180:183], v201 offset:36864
    v_mfma_f32_16x16x32_bf16 v[120:123], v[248:251], a[240:243], v[120:123]
    ds_read_b128 v[184:187], v200 offset:38912
    ds_read_b128 v[188:191], v201 offset:38912
    v_mfma_f32_16x16x32_bf16 v[120:123], v[252:255], a[244:247], v[120:123]
    s_add_u32 m0, s30, 0
    v_accvgpr_write_b32 a25, 0
    v_accvgpr_write_b32 a26, 0
    v_mfma_f32_16x16x32_bf16 v[124:127], v[248:251], a[248:251], v[124:127]
    s_waitcnt lgkmcnt(0)
    v_accvgpr_write_b32 a27, 0
    v_accvgpr_write_b32 a28, 0
    v_mfma_f32_16x16x32_bf16 v[124:127], v[252:255], a[252:255], v[124:127]
    v_accvgpr_write_b32 a29, 0
    v_accvgpr_write_b32 a30, 0
    v_mfma_f32_16x16x32_bf16 a[128:131], v[224:227], v[192:195], a[128:131]
    buffer_load_dwordx4 v208, s[20:23], s72 offen offset:0 lds
    v_mfma_f32_16x16x32_bf16 a[128:131], v[228:231], v[192:195], a[128:131]
    ds_read_b64_tr_b16 v[240:241], v197 offset:49152
    ds_read_b64_tr_b16 v[242:243], v197 offset:50176
    v_mfma_f32_16x16x32_bf16 a[132:135], v[232:235], v[192:195], a[132:135]
    v_accvgpr_write_b32 a31, 0
    v_accvgpr_write_b32 a32, 0
    v_mfma_f32_16x16x32_bf16 a[132:135], v[236:239], v[192:195], a[132:135]
    ds_read_b64_tr_b16 v[244:245], v197 offset:57344
    ds_read_b64_tr_b16 v[246:247], v197 offset:58368
    v_mfma_f32_16x16x32_bf16 v[0:3], v[224:227], v[160:163], v[0:3]
    buffer_load_dwordx4 v209, s[20:23], s72 offen offset:1024 lds
    v_mfma_f32_16x16x32_bf16 v[0:3], v[228:231], v[164:167], v[0:3]
    ds_read_b64_tr_b16 v[248:249], v197 offset:49160
    ds_read_b64_tr_b16 v[250:251], v197 offset:50184
    v_mfma_f32_16x16x32_bf16 v[4:7], v[224:227], v[168:171], v[4:7]
    v_accvgpr_write_b32 a33, 0
    v_accvgpr_write_b32 a34, 0
    v_mfma_f32_16x16x32_bf16 v[4:7], v[228:231], v[172:175], v[4:7]
    ds_read_b64_tr_b16 v[252:253], v197 offset:57352
    ds_read_b64_tr_b16 v[254:255], v197 offset:58376
    v_mfma_f32_16x16x32_bf16 v[8:11], v[224:227], v[176:179], v[8:11]
    buffer_load_dwordx4 v210, s[20:23], s72 offen offset:2048 lds
    v_mfma_f32_16x16x32_bf16 v[8:11], v[228:231], v[180:183], v[8:11]
    v_accvgpr_write_b32 a35, 0
    v_accvgpr_write_b32 a36, 0
    v_mfma_f32_16x16x32_bf16 v[12:15], v[224:227], v[184:187], v[12:15]
    v_accvgpr_write_b32 a37, 0
    v_accvgpr_write_b32 a38, 0
    v_mfma_f32_16x16x32_bf16 v[12:15], v[228:231], v[188:191], v[12:15]
    buffer_load_dwordx4 v211, s[20:23], s72 offen offset:3072 lds
    v_mfma_f32_16x16x32_bf16 v[16:19], v[232:235], v[160:163], v[16:19]
    s_mov_b32 s72, 33408
    v_accvgpr_write_b32 a39, 0
    v_accvgpr_write_b32 a40, 0
    v_mfma_f32_16x16x32_bf16 v[16:19], v[236:239], v[164:167], v[16:19]
    s_add_u32 m0, s30, 4096
    v_accvgpr_write_b32 a41, 0
    v_accvgpr_write_b32 a42, 0
    v_mfma_f32_16x16x32_bf16 v[20:23], v[232:235], v[168:171], v[20:23]
    v_accvgpr_write_b32 a43, 0
    v_accvgpr_write_b32 a44, 0
    v_mfma_f32_16x16x32_bf16 v[20:23], v[236:239], v[172:175], v[20:23]
    buffer_load_dwordx4 v208, s[20:23], s72 offen offset:0 lds
    v_mfma_f32_16x16x32_bf16 v[24:27], v[232:235], v[176:179], v[24:27]
    v_accvgpr_write_b32 a45, 0
    v_accvgpr_write_b32 a46, 0
    v_mfma_f32_16x16x32_bf16 v[24:27], v[236:239], v[180:183], v[24:27]
    v_accvgpr_write_b32 a47, 0
    v_accvgpr_write_b32 a48, 0
    v_mfma_f32_16x16x32_bf16 v[28:31], v[232:235], v[184:187], v[28:31]
    s_waitcnt lgkmcnt(0)
    v_accvgpr_write_b32 a49, 0
    v_accvgpr_write_b32 a50, 0
    v_mfma_f32_16x16x32_bf16 v[28:31], v[236:239], v[188:191], v[28:31]
    v_accvgpr_write_b32 a51, 0
    v_accvgpr_write_b32 a52, 0
    v_mfma_f32_16x16x32_bf16 v[32:35], v[240:243], v[160:163], v[32:35]
    buffer_load_dwordx4 v209, s[20:23], s72 offen offset:1024 lds
    v_mfma_f32_16x16x32_bf16 v[32:35], v[244:247], v[164:167], v[32:35]
    ds_read_b64_tr_b16 v[224:225], v198 offset:49152
    ds_read_b64_tr_b16 v[226:227], v198 offset:50176
    v_mfma_f32_16x16x32_bf16 v[36:39], v[240:243], v[168:171], v[36:39]
    v_accvgpr_write_b32 a53, 0
    v_accvgpr_write_b32 a54, 0
    v_mfma_f32_16x16x32_bf16 v[36:39], v[244:247], v[172:175], v[36:39]
    ds_read_b64_tr_b16 v[228:229], v198 offset:57344
    ds_read_b64_tr_b16 v[230:231], v198 offset:58368
    v_mfma_f32_16x16x32_bf16 v[40:43], v[240:243], v[176:179], v[40:43]
    buffer_load_dwordx4 v210, s[20:23], s72 offen offset:2048 lds
    v_mfma_f32_16x16x32_bf16 v[40:43], v[244:247], v[180:183], v[40:43]
    ds_read_b64_tr_b16 v[232:233], v198 offset:49160
    ds_read_b64_tr_b16 v[234:235], v198 offset:50184
    v_mfma_f32_16x16x32_bf16 v[44:47], v[240:243], v[184:187], v[44:47]
    v_accvgpr_write_b32 a55, 0
    v_accvgpr_write_b32 a56, 0
    v_mfma_f32_16x16x32_bf16 v[44:47], v[244:247], v[188:191], v[44:47]
    ds_read_b64_tr_b16 v[236:237], v198 offset:57352
    ds_read_b64_tr_b16 v[238:239], v198 offset:58376
    v_mfma_f32_16x16x32_bf16 v[48:51], v[248:251], v[160:163], v[48:51]
    buffer_load_dwordx4 v211, s[20:23], s72 offen offset:3072 lds
    v_mfma_f32_16x16x32_bf16 v[48:51], v[252:255], v[164:167], v[48:51]
    s_mov_b32 s43, 3145728
    v_accvgpr_write_b32 a57, 0
    v_accvgpr_write_b32 a58, 0
    v_mfma_f32_16x16x32_bf16 v[52:55], v[248:251], v[168:171], v[52:55]
    s_add_u32 m0, s6, 131072
    v_accvgpr_write_b32 a59, 0
    v_accvgpr_write_b32 a60, 0
    v_mfma_f32_16x16x32_bf16 v[52:55], v[252:255], v[172:175], v[52:55]
    buffer_load_dwordx4 v212, s[16:19], s43 offen offset:0 lds
    v_mfma_f32_16x16x32_bf16 v[56:59], v[248:251], v[176:179], v[56:59]
    v_accvgpr_write_b32 a61, 0
    v_accvgpr_write_b32 a62, 0
    v_mfma_f32_16x16x32_bf16 v[56:59], v[252:255], v[180:183], v[56:59]
    v_accvgpr_write_b32 a63, 0
    v_accvgpr_write_b32 a64, 0
    v_mfma_f32_16x16x32_bf16 v[60:63], v[248:251], v[184:187], v[60:63]
    s_waitcnt lgkmcnt(0)
    v_accvgpr_write_b32 a65, 0
    v_accvgpr_write_b32 a66, 0
    v_mfma_f32_16x16x32_bf16 v[60:63], v[252:255], v[188:191], v[60:63]
    v_accvgpr_write_b32 a67, 0
    v_accvgpr_write_b32 a68, 0
    v_mfma_f32_16x16x32_bf16 v[64:67], v[224:227], v[160:163], v[64:67]
    buffer_load_dwordx4 v213, s[16:19], s43 offen offset:1024 lds
    v_mfma_f32_16x16x32_bf16 v[64:67], v[228:231], v[164:167], v[64:67]
    ds_read_b64_tr_b16 v[240:241], v199 offset:49152
    ds_read_b64_tr_b16 v[242:243], v199 offset:50176
    v_mfma_f32_16x16x32_bf16 v[68:71], v[224:227], v[168:171], v[68:71]
    v_accvgpr_write_b32 a69, 0
    v_accvgpr_write_b32 a70, 0
    v_mfma_f32_16x16x32_bf16 v[68:71], v[228:231], v[172:175], v[68:71]
    ds_read_b64_tr_b16 v[244:245], v199 offset:57344
    ds_read_b64_tr_b16 v[246:247], v199 offset:58368
    v_mfma_f32_16x16x32_bf16 v[72:75], v[224:227], v[176:179], v[72:75]
    buffer_load_dwordx4 v214, s[16:19], s43 offen offset:2048 lds
    v_mfma_f32_16x16x32_bf16 v[72:75], v[228:231], v[180:183], v[72:75]
    ds_read_b64_tr_b16 v[248:249], v199 offset:49160
    ds_read_b64_tr_b16 v[250:251], v199 offset:50184
    v_mfma_f32_16x16x32_bf16 v[76:79], v[224:227], v[184:187], v[76:79]
    v_accvgpr_write_b32 a71, 0
    v_accvgpr_write_b32 a72, 0
    v_mfma_f32_16x16x32_bf16 v[76:79], v[228:231], v[188:191], v[76:79]
    ds_read_b64_tr_b16 v[252:253], v199 offset:57352
    ds_read_b64_tr_b16 v[254:255], v199 offset:58376
    v_mfma_f32_16x16x32_bf16 v[80:83], v[232:235], v[160:163], v[80:83]
    s_waitcnt vmcnt(15) lgkmcnt(4)
    v_accvgpr_write_b32 a73, 0
    v_accvgpr_write_b32 a74, 0
    v_mfma_f32_16x16x32_bf16 v[80:83], v[236:239], v[164:167], v[80:83]
    ds_read_b128 a[192:195], v202 offset:0
    ds_read_b128 a[196:199], v203 offset:0
    v_mfma_f32_16x16x32_bf16 v[84:87], v[232:235], v[168:171], v[84:87]
    ds_read_b128 a[200:203], v202 offset:2048
    ds_read_b128 a[204:207], v203 offset:2048
    v_mfma_f32_16x16x32_bf16 v[84:87], v[236:239], v[172:175], v[84:87]
    ds_read_b128 a[208:211], v202 offset:4096
    ds_read_b128 a[212:215], v203 offset:4096
    v_mfma_f32_16x16x32_bf16 v[88:91], v[232:235], v[176:179], v[88:91]
    ds_read_b128 a[216:219], v202 offset:6144
    ds_read_b128 a[220:223], v203 offset:6144
    v_mfma_f32_16x16x32_bf16 v[88:91], v[236:239], v[180:183], v[88:91]
    buffer_load_dwordx4 v215, s[16:19], s43 offen offset:3072 lds
    v_mfma_f32_16x16x32_bf16 v[92:95], v[232:235], v[184:187], v[92:95]
    s_waitcnt vmcnt(24) lgkmcnt(0)
    v_accvgpr_write_b32 a75, 0
    v_accvgpr_write_b32 a76, 0
    v_mfma_f32_16x16x32_bf16 v[92:95], v[236:239], v[188:191], v[92:95]
    s_barrier
    v_accvgpr_write_b32 a77, 0
    v_accvgpr_write_b32 a78, 0
    v_mfma_f32_16x16x32_bf16 v[96:99], v[240:243], v[160:163], v[96:99]
    s_mov_b32 s72, 768
    v_accvgpr_write_b32 a79, 0
    v_accvgpr_write_b32 a80, 0
    v_mfma_f32_16x16x32_bf16 v[96:99], v[244:247], v[164:167], v[96:99]
    ds_read_b64_tr_b16 v[224:225], v196 offset:0
    ds_read_b64_tr_b16 v[226:227], v196 offset:1024
    v_mfma_f32_16x16x32_bf16 v[100:103], v[240:243], v[168:171], v[100:103]
    s_add_u32 m0, s30, 32768
    v_accvgpr_write_b32 a81, 0
    v_accvgpr_write_b32 a82, 0
    v_mfma_f32_16x16x32_bf16 v[100:103], v[244:247], v[172:175], v[100:103]
    ds_read_b64_tr_b16 v[228:229], v196 offset:8192
    ds_read_b64_tr_b16 v[230:231], v196 offset:9216
    v_mfma_f32_16x16x32_bf16 v[104:107], v[240:243], v[176:179], v[104:107]
    buffer_load_dwordx4 v208, s[20:23], s72 offen offset:0 lds
    v_mfma_f32_16x16x32_bf16 v[104:107], v[244:247], v[180:183], v[104:107]
    ds_read_b64_tr_b16 v[232:233], v196 offset:8
    ds_read_b64_tr_b16 v[234:235], v196 offset:1032
    v_mfma_f32_16x16x32_bf16 v[108:111], v[240:243], v[184:187], v[108:111]
    v_accvgpr_write_b32 a83, 0
    v_accvgpr_write_b32 a84, 0
    v_mfma_f32_16x16x32_bf16 v[108:111], v[244:247], v[188:191], v[108:111]
    ds_read_b64_tr_b16 v[236:237], v196 offset:8200
    ds_read_b64_tr_b16 v[238:239], v196 offset:9224
    v_mfma_f32_16x16x32_bf16 v[112:115], v[248:251], v[160:163], v[112:115]
    buffer_load_dwordx4 v209, s[20:23], s72 offen offset:1024 lds
    v_mfma_f32_16x16x32_bf16 v[112:115], v[252:255], v[164:167], v[112:115]
    v_accvgpr_write_b32 a85, 0
    v_accvgpr_write_b32 a86, 0
    v_mfma_f32_16x16x32_bf16 v[116:119], v[248:251], v[168:171], v[116:119]
    v_accvgpr_write_b32 a87, 0
    v_accvgpr_write_b32 a88, 0
    v_mfma_f32_16x16x32_bf16 v[116:119], v[252:255], v[172:175], v[116:119]
    buffer_load_dwordx4 v210, s[20:23], s72 offen offset:2048 lds
    v_mfma_f32_16x16x32_bf16 v[120:123], v[248:251], v[176:179], v[120:123]
    v_accvgpr_write_b32 a89, 0
    v_accvgpr_write_b32 a90, 0
    v_mfma_f32_16x16x32_bf16 v[120:123], v[252:255], v[180:183], v[120:123]
    v_accvgpr_write_b32 a91, 0
    v_accvgpr_write_b32 a92, 0
    v_mfma_f32_16x16x32_bf16 v[124:127], v[248:251], v[184:187], v[124:127]
    s_waitcnt lgkmcnt(0)
    v_accvgpr_write_b32 a93, 0
    v_accvgpr_write_b32 a94, 0
    v_mfma_f32_16x16x32_bf16 v[124:127], v[252:255], v[188:191], v[124:127]
    v_accvgpr_write_b32 a95, 0
    v_accvgpr_write_b32 a96, 0
    v_mfma_f32_16x16x32_bf16 a[128:131], v[224:227], v[192:195], a[128:131]
    buffer_load_dwordx4 v211, s[20:23], s72 offen offset:3072 lds
    v_mfma_f32_16x16x32_bf16 a[128:131], v[228:231], v[192:195], a[128:131]
    ds_read_b64_tr_b16 v[240:241], v197 offset:0
    ds_read_b64_tr_b16 v[242:243], v197 offset:1024
    v_mfma_f32_16x16x32_bf16 a[132:135], v[232:235], v[192:195], a[132:135]
    s_mov_b32 s72, 33536
    v_accvgpr_write_b32 a97, 0
    v_accvgpr_write_b32 a98, 0
    v_mfma_f32_16x16x32_bf16 a[132:135], v[236:239], v[192:195], a[132:135]
    ds_read_b64_tr_b16 v[244:245], v197 offset:8192
    ds_read_b64_tr_b16 v[246:247], v197 offset:9216
    v_mfma_f32_16x16x32_bf16 v[0:3], v[224:227], a[192:195], v[0:3]
    s_add_u32 m0, s30, 36864
    v_accvgpr_write_b32 a99, 0
    v_accvgpr_write_b32 a100, 0
    v_mfma_f32_16x16x32_bf16 v[0:3], v[228:231], a[196:199], v[0:3]
    ds_read_b64_tr_b16 v[248:249], v197 offset:8
    ds_read_b64_tr_b16 v[250:251], v197 offset:1032
    v_mfma_f32_16x16x32_bf16 v[4:7], v[224:227], a[200:203], v[4:7]
    buffer_load_dwordx4 v208, s[20:23], s72 offen offset:0 lds
    v_mfma_f32_16x16x32_bf16 v[4:7], v[228:231], a[204:207], v[4:7]
    ds_read_b64_tr_b16 v[252:253], v197 offset:8200
    ds_read_b64_tr_b16 v[254:255], v197 offset:9224
    v_mfma_f32_16x16x32_bf16 v[8:11], v[224:227], a[208:211], v[8:11]
    v_accvgpr_write_b32 a101, 0
    v_accvgpr_write_b32 a102, 0
    v_mfma_f32_16x16x32_bf16 v[8:11], v[228:231], a[212:215], v[8:11]
    buffer_load_dwordx4 v209, s[20:23], s72 offen offset:1024 lds
    v_mfma_f32_16x16x32_bf16 v[12:15], v[224:227], a[216:219], v[12:15]
    v_accvgpr_write_b32 a103, 0
    v_accvgpr_write_b32 a104, 0
    v_mfma_f32_16x16x32_bf16 v[12:15], v[228:231], a[220:223], v[12:15]
    v_accvgpr_write_b32 a105, 0
    v_accvgpr_write_b32 a106, 0
    v_mfma_f32_16x16x32_bf16 v[16:19], v[232:235], a[192:195], v[16:19]
    v_accvgpr_write_b32 a107, 0
    v_accvgpr_write_b32 a108, 0
    v_mfma_f32_16x16x32_bf16 v[16:19], v[236:239], a[196:199], v[16:19]
    buffer_load_dwordx4 v210, s[20:23], s72 offen offset:2048 lds
    v_mfma_f32_16x16x32_bf16 v[20:23], v[232:235], a[200:203], v[20:23]
    v_accvgpr_write_b32 a109, 0
    v_accvgpr_write_b32 a110, 0
    v_mfma_f32_16x16x32_bf16 v[20:23], v[236:239], a[204:207], v[20:23]
    v_accvgpr_write_b32 a111, 0
    v_accvgpr_write_b32 a112, 0
    v_mfma_f32_16x16x32_bf16 v[24:27], v[232:235], a[208:211], v[24:27]
    v_accvgpr_write_b32 a113, 0
    v_accvgpr_write_b32 a114, 0
    v_mfma_f32_16x16x32_bf16 v[24:27], v[236:239], a[212:215], v[24:27]
    buffer_load_dwordx4 v211, s[20:23], s72 offen offset:3072 lds
    v_mfma_f32_16x16x32_bf16 v[28:31], v[232:235], a[216:219], v[28:31]
    s_waitcnt lgkmcnt(0)
    v_accvgpr_write_b32 a115, 0
    v_accvgpr_write_b32 a116, 0
    v_mfma_f32_16x16x32_bf16 v[28:31], v[236:239], a[220:223], v[28:31]
    v_accvgpr_write_b32 a117, 0
    v_accvgpr_write_b32 a118, 0
    v_mfma_f32_16x16x32_bf16 v[32:35], v[240:243], a[192:195], v[32:35]
    s_mov_b32 s43, 3670016
    v_accvgpr_write_b32 a119, 0
    v_accvgpr_write_b32 a120, 0
    v_mfma_f32_16x16x32_bf16 v[32:35], v[244:247], a[196:199], v[32:35]
    ds_read_b64_tr_b16 v[224:225], v198 offset:0
    ds_read_b64_tr_b16 v[226:227], v198 offset:1024
    v_mfma_f32_16x16x32_bf16 v[36:39], v[240:243], a[200:203], v[36:39]
    s_add_u32 m0, s6, 147456
    v_accvgpr_write_b32 a121, 0
    v_accvgpr_write_b32 a122, 0
    v_mfma_f32_16x16x32_bf16 v[36:39], v[244:247], a[204:207], v[36:39]
    ds_read_b64_tr_b16 v[228:229], v198 offset:8192
    ds_read_b64_tr_b16 v[230:231], v198 offset:9216
    v_mfma_f32_16x16x32_bf16 v[40:43], v[240:243], a[208:211], v[40:43]
    buffer_load_dwordx4 v212, s[16:19], s43 offen offset:0 lds
    v_mfma_f32_16x16x32_bf16 v[40:43], v[244:247], a[212:215], v[40:43]
    ds_read_b64_tr_b16 v[232:233], v198 offset:8
    ds_read_b64_tr_b16 v[234:235], v198 offset:1032
    v_mfma_f32_16x16x32_bf16 v[44:47], v[240:243], a[216:219], v[44:47]
    v_accvgpr_write_b32 a123, 0
    v_accvgpr_write_b32 a124, 0
    v_mfma_f32_16x16x32_bf16 v[44:47], v[244:247], a[220:223], v[44:47]
    ds_read_b64_tr_b16 v[236:237], v198 offset:8200
    ds_read_b64_tr_b16 v[238:239], v198 offset:9224
    v_mfma_f32_16x16x32_bf16 v[48:51], v[248:251], a[192:195], v[48:51]
    s_waitcnt vmcnt(13) lgkmcnt(4)
    v_accvgpr_write_b32 a125, 0
    v_accvgpr_write_b32 a126, 0
    v_mfma_f32_16x16x32_bf16 v[48:51], v[252:255], a[196:199], v[48:51]
    ds_read_b128 v[128:131], v200 offset:0
    ds_read_b128 v[132:135], v201 offset:0
    v_mfma_f32_16x16x32_bf16 v[52:55], v[248:251], a[200:203], v[52:55]
    ds_read_b128 v[136:139], v200 offset:2048
    ds_read_b128 v[140:143], v201 offset:2048
    v_mfma_f32_16x16x32_bf16 v[52:55], v[252:255], a[204:207], v[52:55]
    ds_read_b128 v[144:147], v200 offset:4096
    ds_read_b128 v[148:151], v201 offset:4096
    v_mfma_f32_16x16x32_bf16 v[56:59], v[248:251], a[208:211], v[56:59]
    ds_read_b128 v[152:155], v200 offset:6144
    ds_read_b128 v[156:159], v201 offset:6144
    v_mfma_f32_16x16x32_bf16 v[56:59], v[252:255], a[212:215], v[56:59]
    buffer_load_dwordx4 v213, s[16:19], s43 offen offset:1024 lds
    v_mfma_f32_16x16x32_bf16 v[60:63], v[248:251], a[216:219], v[60:63]
    s_waitcnt lgkmcnt(0)
    v_accvgpr_write_b32 a127, 0
    v_mfma_f32_16x16x32_bf16 v[60:63], v[252:255], a[220:223], v[60:63]
    v_mfma_f32_16x16x32_bf16 v[64:67], v[224:227], a[192:195], v[64:67]
    buffer_load_dwordx4 v214, s[16:19], s43 offen offset:2048 lds
    v_mfma_f32_16x16x32_bf16 v[64:67], v[228:231], a[196:199], v[64:67]
    ds_read_b64_tr_b16 v[240:241], v199 offset:0
    ds_read_b64_tr_b16 v[242:243], v199 offset:1024
    v_mfma_f32_16x16x32_bf16 v[68:71], v[224:227], a[200:203], v[68:71]
    v_mfma_f32_16x16x32_bf16 v[68:71], v[228:231], a[204:207], v[68:71]
    ds_read_b64_tr_b16 v[244:245], v199 offset:8192
    ds_read_b64_tr_b16 v[246:247], v199 offset:9216
    v_mfma_f32_16x16x32_bf16 v[72:75], v[224:227], a[208:211], v[72:75]
    buffer_load_dwordx4 v215, s[16:19], s43 offen offset:3072 lds
    v_mfma_f32_16x16x32_bf16 v[72:75], v[228:231], a[212:215], v[72:75]
    ds_read_b64_tr_b16 v[248:249], v199 offset:8
    ds_read_b64_tr_b16 v[250:251], v199 offset:1032
    v_and_b32 v215, 0xf0, v222
    v_mfma_f32_16x16x32_bf16 v[76:79], v[224:227], a[216:219], v[76:79]
    s_lshl_b32 s42, s53, 9
    v_lshrrev_b32 v215, 1, v215
    v_mfma_f32_16x16x32_bf16 v[76:79], v[228:231], a[220:223], v[76:79]
    ds_read_b64_tr_b16 v[252:253], v199 offset:8200
    ds_read_b64_tr_b16 v[254:255], v199 offset:9224
    v_mfma_f32_16x16x32_bf16 v[80:83], v[232:235], a[192:195], v[80:83]
    s_add_u32 s42, s42, 2097152
    v_mfma_f32_16x16x32_bf16 v[80:83], v[236:239], a[196:199], v[80:83]
    s_mov_b32 s72, 896
    v_mfma_f32_16x16x32_bf16 v[84:87], v[232:235], a[200:203], v[84:87]
    s_add_u32 m0, s30, 65536
    v_mfma_f32_16x16x32_bf16 v[84:87], v[236:239], a[204:207], v[84:87]
    buffer_load_dwordx4 v208, s[20:23], s72 offen offset:0 lds
    v_mfma_f32_16x16x32_bf16 v[88:91], v[232:235], a[208:211], v[88:91]
    v_mfma_f32_16x16x32_bf16 v[88:91], v[236:239], a[212:215], v[88:91]
    v_mfma_f32_16x16x32_bf16 v[92:95], v[232:235], a[216:219], v[92:95]
    s_waitcnt vmcnt(25) lgkmcnt(0)
    v_mfma_f32_16x16x32_bf16 v[92:95], v[236:239], a[220:223], v[92:95]
    s_barrier
    v_mfma_f32_16x16x32_bf16 v[96:99], v[240:243], a[192:195], v[96:99]
    buffer_load_dwordx4 v209, s[20:23], s72 offen offset:1024 lds
    v_mfma_f32_16x16x32_bf16 v[96:99], v[244:247], a[196:199], v[96:99]
    ds_read_b64_tr_b16 v[224:225], v196 offset:16384
    ds_read_b64_tr_b16 v[226:227], v196 offset:17408
    v_mfma_f32_16x16x32_bf16 v[100:103], v[240:243], a[200:203], v[100:103]
    v_mfma_f32_16x16x32_bf16 v[100:103], v[244:247], a[204:207], v[100:103]
    ds_read_b64_tr_b16 v[228:229], v196 offset:24576
    ds_read_b64_tr_b16 v[230:231], v196 offset:25600
    v_mfma_f32_16x16x32_bf16 v[104:107], v[240:243], a[208:211], v[104:107]
    buffer_load_dwordx4 v210, s[20:23], s72 offen offset:2048 lds
    v_mfma_f32_16x16x32_bf16 v[104:107], v[244:247], a[212:215], v[104:107]
    ds_read_b64_tr_b16 v[232:233], v196 offset:16392
    ds_read_b64_tr_b16 v[234:235], v196 offset:17416
    v_mfma_f32_16x16x32_bf16 v[108:111], v[240:243], a[216:219], v[108:111]
    v_mfma_f32_16x16x32_bf16 v[108:111], v[244:247], a[220:223], v[108:111]
    ds_read_b64_tr_b16 v[236:237], v196 offset:24584
    ds_read_b64_tr_b16 v[238:239], v196 offset:25608
    v_mfma_f32_16x16x32_bf16 v[112:115], v[248:251], a[192:195], v[112:115]
    buffer_load_dwordx4 v211, s[20:23], s72 offen offset:3072 lds
    v_mfma_f32_16x16x32_bf16 v[112:115], v[252:255], a[196:199], v[112:115]
    s_mov_b32 s72, 33664
    v_mfma_f32_16x16x32_bf16 v[116:119], v[248:251], a[200:203], v[116:119]
    s_add_u32 m0, s30, 69632
    v_mfma_f32_16x16x32_bf16 v[116:119], v[252:255], a[204:207], v[116:119]
    buffer_load_dwordx4 v208, s[20:23], s72 offen offset:0 lds
    v_mfma_f32_16x16x32_bf16 v[120:123], v[248:251], a[208:211], v[120:123]
    v_mfma_f32_16x16x32_bf16 v[120:123], v[252:255], a[212:215], v[120:123]
    v_mfma_f32_16x16x32_bf16 v[124:127], v[248:251], a[216:219], v[124:127]
    s_waitcnt lgkmcnt(0)
    v_mfma_f32_16x16x32_bf16 v[124:127], v[252:255], a[220:223], v[124:127]
    v_mfma_f32_16x16x32_bf16 a[128:131], v[224:227], v[192:195], a[128:131]
    v_mfma_f32_16x16x32_bf16 a[128:131], v[228:231], v[192:195], a[128:131]
    ds_read_b64_tr_b16 v[240:241], v197 offset:16384
    ds_read_b64_tr_b16 v[242:243], v197 offset:17408
    v_mfma_f32_16x16x32_bf16 a[132:135], v[232:235], v[192:195], a[132:135]
    buffer_load_dwordx4 v209, s[20:23], s72 offen offset:1024 lds
    v_mfma_f32_16x16x32_bf16 a[132:135], v[236:239], v[192:195], a[132:135]
    ds_read_b64_tr_b16 v[244:245], v197 offset:24576
    ds_read_b64_tr_b16 v[246:247], v197 offset:25600
    v_mfma_f32_16x16x32_bf16 v[0:3], v[224:227], v[128:131], v[0:3]
    v_mfma_f32_16x16x32_bf16 v[0:3], v[228:231], v[132:135], v[0:3]
    ds_read_b64_tr_b16 v[248:249], v197 offset:16392
    ds_read_b64_tr_b16 v[250:251], v197 offset:17416
    v_mfma_f32_16x16x32_bf16 v[4:7], v[224:227], v[136:139], v[4:7]
    buffer_load_dwordx4 v210, s[20:23], s72 offen offset:2048 lds
    v_mfma_f32_16x16x32_bf16 v[4:7], v[228:231], v[140:143], v[4:7]
    ds_read_b64_tr_b16 v[252:253], v197 offset:24584
    ds_read_b64_tr_b16 v[254:255], v197 offset:25608
    v_mfma_f32_16x16x32_bf16 v[8:11], v[224:227], v[144:147], v[8:11]
    v_mfma_f32_16x16x32_bf16 v[8:11], v[228:231], v[148:151], v[8:11]
    buffer_load_dwordx4 v211, s[20:23], s72 offen offset:3072 lds
    v_mfma_f32_16x16x32_bf16 v[12:15], v[224:227], v[152:155], v[12:15]
    v_mfma_f32_16x16x32_bf16 v[12:15], v[228:231], v[156:159], v[12:15]
    v_mfma_f32_16x16x32_bf16 v[16:19], v[232:235], v[128:131], v[16:19]
    s_waitcnt vmcnt(12) lgkmcnt(4)
    v_mfma_f32_16x16x32_bf16 v[16:19], v[236:239], v[132:135], v[16:19]
    ds_read_b128 a[224:227], v200 offset:32768
    ds_read_b128 a[228:231], v201 offset:32768
    v_mfma_f32_16x16x32_bf16 v[20:23], v[232:235], v[136:139], v[20:23]
    ds_read_b128 a[232:235], v200 offset:34816
    ds_read_b128 a[236:239], v201 offset:34816
    v_mfma_f32_16x16x32_bf16 v[20:23], v[236:239], v[140:143], v[20:23]
    ds_read_b128 a[240:243], v200 offset:36864
    ds_read_b128 a[244:247], v201 offset:36864
    v_mfma_f32_16x16x32_bf16 v[24:27], v[232:235], v[144:147], v[24:27]
    ds_read_b128 a[248:251], v200 offset:38912
    ds_read_b128 a[252:255], v201 offset:38912
    v_mfma_f32_16x16x32_bf16 v[24:27], v[236:239], v[148:151], v[24:27]
    buffer_load_dwordx2 v[208:209], v215, s[48:51], s42 offen offset:0 sc1
    v_mfma_f32_16x16x32_bf16 v[28:31], v[232:235], v[152:155], v[28:31]
    s_waitcnt lgkmcnt(0)
    v_mfma_f32_16x16x32_bf16 v[28:31], v[236:239], v[156:159], v[28:31]
    v_mfma_f32_16x16x32_bf16 v[32:35], v[240:243], v[128:131], v[32:35]
    v_bfe_u32 v223, v222, 1, 8
    v_lshrrev_b32 v201, 6, v222
    v_mfma_f32_16x16x32_bf16 v[32:35], v[244:247], v[132:135], v[32:35]
    ds_read_b64_tr_b16 v[224:225], v198 offset:16384
    ds_read_b64_tr_b16 v[226:227], v198 offset:17408
    v_mfma_f32_16x16x32_bf16 v[36:39], v[240:243], v[136:139], v[36:39]
    buffer_load_dwordx2 v[210:211], v215, s[48:51], s42 offen offset:128 sc1
    v_mfma_f32_16x16x32_bf16 v[36:39], v[244:247], v[140:143], v[36:39]
    ds_read_b64_tr_b16 v[228:229], v198 offset:24576
    ds_read_b64_tr_b16 v[230:231], v198 offset:25600
    v_mfma_f32_16x16x32_bf16 v[40:43], v[240:243], v[144:147], v[40:43]
    s_lshl_b32 s54, s3, 7
    v_lshl_add_u32 v223, v201, 8, v223
    v_add_u32 v223, 65536, v223
    v_mfma_f32_16x16x32_bf16 v[40:43], v[244:247], v[148:151], v[40:43]
    ds_read_b64_tr_b16 v[232:233], v198 offset:16392
    ds_read_b64_tr_b16 v[234:235], v198 offset:17416
    v_mfma_f32_16x16x32_bf16 v[44:47], v[240:243], v[152:155], v[44:47]
    buffer_load_dwordx2 v[212:213], v215, s[48:51], s42 offen offset:256 sc1
    v_mfma_f32_16x16x32_bf16 v[44:47], v[244:247], v[156:159], v[44:47]
    ds_read_b64_tr_b16 v[236:237], v198 offset:24584
    ds_read_b64_tr_b16 v[238:239], v198 offset:25608
    v_mfma_f32_16x16x32_bf16 v[48:51], v[248:251], v[128:131], v[48:51]
    s_add_u32 s54, s54, 98304
    v_lshrrev_b32 v200, 8, v222
    v_lshl_add_u32 v200, v200, 5, s54
    v_mfma_f32_16x16x32_bf16 v[48:51], v[252:255], v[132:135], v[48:51]
    buffer_load_dwordx2 v[214:215], v215, s[48:51], s42 offen offset:384 sc1
    v_mfma_f32_16x16x32_bf16 v[52:55], v[248:251], v[136:139], v[52:55]
    s_add_u32 m0, s30, 0
    v_mfma_f32_16x16x32_bf16 v[52:55], v[252:255], v[140:143], v[52:55]
    s_mov_b32 s54, 0x00010001
    v_mfma_f32_16x16x32_bf16 v[56:59], v[248:251], v[144:147], v[56:59]
    s_mov_b32 s55, 0x00010001
    v_mfma_f32_16x16x32_bf16 v[56:59], v[252:255], v[148:151], v[56:59]
    buffer_load_dwordx4 v216, s[8:11], s31 offen offset:0 lds
    v_mfma_f32_16x16x32_bf16 v[60:63], v[248:251], v[152:155], v[60:63]
    s_waitcnt lgkmcnt(0)
    v_mfma_f32_16x16x32_bf16 v[60:63], v[252:255], v[156:159], v[60:63]
    v_mfma_f32_16x16x32_bf16 v[64:67], v[224:227], v[128:131], v[64:67]
    v_mfma_f32_16x16x32_bf16 v[64:67], v[228:231], v[132:135], v[64:67]
    ds_read_b64_tr_b16 v[240:241], v199 offset:16384
    ds_read_b64_tr_b16 v[242:243], v199 offset:17408
    v_mfma_f32_16x16x32_bf16 v[68:71], v[224:227], v[136:139], v[68:71]
    buffer_load_dwordx4 v217, s[8:11], s31 offen offset:1024 lds
    v_mfma_f32_16x16x32_bf16 v[68:71], v[228:231], v[140:143], v[68:71]
    ds_read_b64_tr_b16 v[244:245], v199 offset:24576
    ds_read_b64_tr_b16 v[246:247], v199 offset:25600
    v_mfma_f32_16x16x32_bf16 v[72:75], v[224:227], v[144:147], v[72:75]
    v_mfma_f32_16x16x32_bf16 v[72:75], v[228:231], v[148:151], v[72:75]
    ds_read_b64_tr_b16 v[248:249], v199 offset:16392
    ds_read_b64_tr_b16 v[250:251], v199 offset:17416
    v_mfma_f32_16x16x32_bf16 v[76:79], v[224:227], v[152:155], v[76:79]
    buffer_load_dwordx4 v218, s[8:11], s31 offen offset:2048 lds
    v_mfma_f32_16x16x32_bf16 v[76:79], v[228:231], v[156:159], v[76:79]
    ds_read_b64_tr_b16 v[252:253], v199 offset:24584
    ds_read_b64_tr_b16 v[254:255], v199 offset:25608
    v_mfma_f32_16x16x32_bf16 v[80:83], v[232:235], v[128:131], v[80:83]
    s_waitcnt vmcnt(7) lgkmcnt(4)
    v_mfma_f32_16x16x32_bf16 v[80:83], v[236:239], v[132:135], v[80:83]
    ds_read_b128 v[160:163], v202 offset:0
    ds_read_b128 v[164:167], v203 offset:0
    v_mfma_f32_16x16x32_bf16 v[84:87], v[232:235], v[136:139], v[84:87]
    ds_read_b128 v[168:171], v202 offset:2048
    ds_read_b128 v[172:175], v203 offset:2048
    v_mfma_f32_16x16x32_bf16 v[84:87], v[236:239], v[140:143], v[84:87]
    ds_read_b128 v[176:179], v202 offset:4096
    ds_read_b128 v[180:183], v203 offset:4096
    v_mfma_f32_16x16x32_bf16 v[88:91], v[232:235], v[144:147], v[88:91]
    ds_read_b128 v[184:187], v202 offset:6144
    ds_read_b128 v[188:191], v203 offset:6144
    v_mfma_f32_16x16x32_bf16 v[88:91], v[236:239], v[148:151], v[88:91]
    buffer_load_dwordx4 v219, s[8:11], s31 offen offset:3072 lds
    v_mfma_f32_16x16x32_bf16 v[92:95], v[232:235], v[152:155], v[92:95]
    s_waitcnt vmcnt(16) lgkmcnt(0)
    v_mfma_f32_16x16x32_bf16 v[92:95], v[236:239], v[156:159], v[92:95]
    s_barrier
    v_mfma_f32_16x16x32_bf16 v[96:99], v[240:243], v[128:131], v[96:99]
    s_add_u32 s31, s31, 32768
    v_mfma_f32_16x16x32_bf16 v[96:99], v[244:247], v[132:135], v[96:99]
    ds_read_b64_tr_b16 v[224:225], v196 offset:32768
    ds_read_b64_tr_b16 v[226:227], v196 offset:33792
    v_mfma_f32_16x16x32_bf16 v[100:103], v[240:243], v[136:139], v[100:103]
    s_add_u32 m0, s30, 4096
    v_mfma_f32_16x16x32_bf16 v[100:103], v[244:247], v[140:143], v[100:103]
    ds_read_b64_tr_b16 v[228:229], v196 offset:40960
    ds_read_b64_tr_b16 v[230:231], v196 offset:41984
    v_mfma_f32_16x16x32_bf16 v[104:107], v[240:243], v[144:147], v[104:107]
    buffer_load_dwordx4 v216, s[8:11], s32 offen offset:0 lds
    v_mfma_f32_16x16x32_bf16 v[104:107], v[244:247], v[148:151], v[104:107]
    ds_read_b64_tr_b16 v[232:233], v196 offset:49152
    ds_read_b64_tr_b16 v[234:235], v196 offset:50176
    v_mfma_f32_16x16x32_bf16 v[108:111], v[240:243], v[152:155], v[108:111]
    v_mfma_f32_16x16x32_bf16 v[108:111], v[244:247], v[156:159], v[108:111]
    ds_read_b64_tr_b16 v[236:237], v196 offset:57344
    ds_read_b64_tr_b16 v[238:239], v196 offset:58368
    v_mfma_f32_16x16x32_bf16 v[112:115], v[248:251], v[128:131], v[112:115]
    s_waitcnt lgkmcnt(4)
    v_mfma_f32_16x16x32_bf16 v[112:115], v[252:255], v[132:135], v[112:115]
    ds_read_b64_tr_b16 a[192:193], v196 offset:32776
    ds_read_b64_tr_b16 a[194:195], v196 offset:33800
    v_mfma_f32_16x16x32_bf16 v[116:119], v[248:251], v[136:139], v[116:119]
    ds_read_b64_tr_b16 a[196:197], v196 offset:40968
    ds_read_b64_tr_b16 a[198:199], v196 offset:41992
    v_mfma_f32_16x16x32_bf16 v[116:119], v[252:255], v[140:143], v[116:119]
    ds_read_b64_tr_b16 a[200:201], v196 offset:49160
    ds_read_b64_tr_b16 a[202:203], v196 offset:50184
    v_mfma_f32_16x16x32_bf16 v[120:123], v[248:251], v[144:147], v[120:123]
    ds_read_b64_tr_b16 a[204:205], v196 offset:57352
    ds_read_b64_tr_b16 a[206:207], v196 offset:58376
    v_mfma_f32_16x16x32_bf16 v[120:123], v[252:255], v[148:151], v[120:123]
    buffer_load_dwordx4 v217, s[8:11], s32 offen offset:1024 lds
    v_mfma_f32_16x16x32_bf16 v[124:127], v[248:251], v[152:155], v[124:127]
    s_waitcnt lgkmcnt(0)
    v_mfma_f32_16x16x32_bf16 v[124:127], v[252:255], v[156:159], v[124:127]
    v_mfma_f32_16x16x32_bf16 a[128:131], v[224:227], v[192:195], a[128:131]
    v_mfma_f32_16x16x32_bf16 a[128:131], v[228:231], v[192:195], a[128:131]
    ds_read_b64_tr_b16 v[240:241], v196 offset:32776
    ds_read_b64_tr_b16 v[242:243], v196 offset:33800
    v_mfma_f32_16x16x32_bf16 a[128:131], v[232:235], v[192:195], a[128:131]
    buffer_load_dwordx4 v218, s[8:11], s32 offen offset:2048 lds
    v_mfma_f32_16x16x32_bf16 a[128:131], v[236:239], v[192:195], a[128:131]
    ds_read_b64_tr_b16 v[244:245], v196 offset:40968
    ds_read_b64_tr_b16 v[246:247], v196 offset:41992
    v_mfma_f32_16x16x32_bf16 a[132:135], a[192:195], v[192:195], a[132:135]
    s_waitcnt vmcnt(7)
    v_cmp_eq_u32 s[56:57], s44, v209
    v_cmp_eq_u32 s[58:59], s44, v211
    v_mfma_f32_16x16x32_bf16 a[132:135], a[196:199], v[192:195], a[132:135]
    ds_read_b64_tr_b16 v[248:249], v196 offset:49160
    ds_read_b64_tr_b16 v[250:251], v196 offset:50184
    v_mfma_f32_16x16x32_bf16 a[132:135], a[200:203], v[192:195], a[132:135]
    buffer_load_dwordx4 v219, s[8:11], s32 offen offset:3072 lds
    v_mfma_f32_16x16x32_bf16 a[132:135], a[204:207], v[192:195], a[132:135]
    ds_read_b64_tr_b16 v[252:253], v196 offset:57352
    ds_read_b64_tr_b16 v[254:255], v196 offset:58376
    v_mfma_f32_16x16x32_bf16 v[0:3], v[224:227], a[224:227], v[0:3]
    s_add_u32 s32, s32, 32768
    v_cmp_eq_u32 s[72:73], s44, v213
    v_cmp_eq_u32 vcc, s44, v215
    v_mfma_f32_16x16x32_bf16 v[0:3], v[228:231], a[228:231], v[0:3]
    s_add_u32 m0, s30, 32768
    v_mfma_f32_16x16x32_bf16 v[0:3], v[232:235], v[160:163], v[0:3]
    buffer_load_dwordx4 v216, s[8:11], s31 offen offset:0 lds
    v_mfma_f32_16x16x32_bf16 v[0:3], v[236:239], v[164:167], v[0:3]
    s_mov_b64 exec, s[54:55]
    ds_write_b128 v200, a[128:131] offset:0
    ds_write_b128 v200, a[128:131] offset:512
    ds_write_b128 v200, a[132:135] offset:16
    ds_write_b128 v200, a[132:135] offset:528
    s_mov_b64 exec, -1
    v_mfma_f32_16x16x32_bf16 v[4:7], v[224:227], a[232:235], v[4:7]
    s_and_b64 s[56:57], s[56:57], s[58:59]
    s_and_b64 vcc, vcc, s[72:73]
    s_and_b64 vcc, vcc, s[56:57]
    s_cmp_eq_u64 vcc, -1
    s_cbranch_scc0 F_SPIN1
F_BACK1:
    v_and_b32 v209, 0xffff0000, v208
    v_and_b32 v211, 0xffff0000, v210
    v_mfma_f32_16x16x32_bf16 v[4:7], v[228:231], a[236:239], v[4:7]
    v_and_b32 v213, 0xffff0000, v212
    v_and_b32 v215, 0xffff0000, v214
    v_mfma_f32_16x16x32_bf16 v[4:7], v[232:235], v[168:171], v[4:7]
    v_rcp_f32 v209, v209
    v_mfma_f32_16x16x32_bf16 v[4:7], v[236:239], v[172:175], v[4:7]
    s_waitcnt lgkmcnt(0)
    v_rcp_f32 v211, v211
    v_mfma_f32_16x16x32_bf16 v[8:11], v[224:227], a[240:243], v[8:11]
    s_barrier
    v_rcp_f32 v213, v213
    v_mfma_f32_16x16x32_bf16 v[8:11], v[228:231], a[244:247], v[8:11]
    ds_read_b128 v[128:131], v200 offset:0
    ds_read_b128 v[132:135], v200 offset:16
    v_mfma_f32_16x16x32_bf16 v[8:11], v[232:235], v[176:179], v[8:11]
    ds_read_b128 v[136:139], v200 offset:128
    ds_read_b128 v[140:143], v200 offset:144
    v_mfma_f32_16x16x32_bf16 v[8:11], v[236:239], v[180:183], v[8:11]
    ds_read_b128 v[144:147], v200 offset:256
    ds_read_b128 v[148:151], v200 offset:272
    v_mfma_f32_16x16x32_bf16 v[12:15], v[224:227], a[248:251], v[12:15]
    ds_read_b128 v[152:155], v200 offset:384
    ds_read_b128 v[156:159], v200 offset:400
    v_mfma_f32_16x16x32_bf16 v[12:15], v[228:231], a[252:255], v[12:15]
    buffer_load_dwordx4 v217, s[8:11], s31 offen offset:1024 lds
    v_mfma_f32_16x16x32_bf16 v[12:15], v[232:235], v[184:187], v[12:15]
    s_waitcnt lgkmcnt(0)
    v_rcp_f32 v215, v215
    v_mfma_f32_16x16x32_bf16 v[12:15], v[236:239], v[188:191], v[12:15]
    v_lshlrev_b32 v208, 16, v208
    v_lshlrev_b32 v210, 16, v210
    v_mfma_f32_16x16x32_bf16 v[16:19], v[240:243], a[224:227], v[16:19]
    s_waitcnt lgkmcnt(0)
    v_lshlrev_b32 v212, 16, v212
    v_lshlrev_b32 v214, 16, v214
    v_mfma_f32_16x16x32_bf16 v[16:19], v[244:247], a[228:231], v[16:19]
    ds_read_b64_tr_b16 v[224:225], v197 offset:32768
    ds_read_b64_tr_b16 v[226:227], v197 offset:33792
    v_mfma_f32_16x16x32_bf16 v[16:19], v[248:251], v[160:163], v[16:19]
    buffer_load_dwordx4 v218, s[8:11], s31 offen offset:2048 lds
    v_mfma_f32_16x16x32_bf16 v[16:19], v[252:255], v[164:167], v[16:19]
    ds_read_b64_tr_b16 v[228:229], v197 offset:40960
    ds_read_b64_tr_b16 v[230:231], v197 offset:41984
    v_mfma_f32_16x16x32_bf16 v[20:23], v[240:243], a[232:235], v[20:23]
    v_mul_f32 v209, 0x3e0293ee, v209
    v_mul_f32 v211, 0x3e0293ee, v211
    v_mfma_f32_16x16x32_bf16 v[20:23], v[244:247], a[236:239], v[20:23]
    ds_read_b64_tr_b16 v[232:233], v197 offset:49152
    ds_read_b64_tr_b16 v[234:235], v197 offset:50176
    v_mfma_f32_16x16x32_bf16 v[20:23], v[248:251], v[168:171], v[20:23]
    buffer_load_dwordx4 v219, s[8:11], s31 offen offset:3072 lds
    v_mfma_f32_16x16x32_bf16 v[20:23], v[252:255], v[172:175], v[20:23]
    ds_read_b64_tr_b16 v[236:237], v197 offset:57344
    ds_read_b64_tr_b16 v[238:239], v197 offset:58368
    v_mfma_f32_16x16x32_bf16 v[24:27], v[240:243], a[240:243], v[24:27]
    s_add_u32 s31, s31, 32768
    v_mul_f32 v213, 0x3e0293ee, v213
    v_mul_f32 v215, 0x3e0293ee, v215
    v_mfma_f32_16x16x32_bf16 v[24:27], v[244:247], a[244:247], v[24:27]
    s_add_u32 m0, s30, 36864
    v_xor_b32 v208, 0x80000000, v208
    v_xor_b32 v210, 0x80000000, v210
    v_mfma_f32_16x16x32_bf16 v[24:27], v[248:251], v[176:179], v[24:27]
    buffer_load_dwordx4 v216, s[8:11], s32 offen offset:0 lds
    v_mfma_f32_16x16x32_bf16 v[24:27], v[252:255], v[180:183], v[24:27]
    v_xor_b32 v212, 0x80000000, v212
    v_xor_b32 v214, 0x80000000, v214
    v_mfma_f32_16x16x32_bf16 v[28:31], v[240:243], a[248:251], v[28:31]
    v_fma_f32 v0, v208, v128, v0
    v_fma_f32 v1, v208, v129, v1
    v_mfma_f32_16x16x32_bf16 v[28:31], v[244:247], a[252:255], v[28:31]
    buffer_load_dwordx4 v217, s[8:11], s32 offen offset:1024 lds
    v_mfma_f32_16x16x32_bf16 v[28:31], v[248:251], v[184:187], v[28:31]
    s_waitcnt lgkmcnt(0)
    v_fma_f32 v2, v208, v130, v2
    v_fma_f32 v3, v208, v131, v3
    v_mfma_f32_16x16x32_bf16 v[28:31], v[252:255], v[188:191], v[28:31]
    v_mul_f32 v0, v209, v0
    v_mul_f32 v1, v209, v1
    v_mfma_f32_16x16x32_bf16 v[32:35], v[224:227], a[224:227], v[32:35]
    v_mul_f32 v2, v209, v2
    v_mul_f32 v3, v209, v3
    v_mfma_f32_16x16x32_bf16 v[32:35], v[228:231], a[228:231], v[32:35]
    ds_read_b64_tr_b16 v[240:241], v197 offset:32776
    ds_read_b64_tr_b16 v[242:243], v197 offset:33800
    v_mfma_f32_16x16x32_bf16 v[32:35], v[232:235], v[160:163], v[32:35]
    buffer_load_dwordx4 v218, s[8:11], s32 offen offset:2048 lds
    v_mfma_f32_16x16x32_bf16 v[32:35], v[236:239], v[164:167], v[32:35]
    ds_read_b64_tr_b16 v[244:245], v197 offset:40968
    ds_read_b64_tr_b16 v[246:247], v197 offset:41992
    v_mfma_f32_16x16x32_bf16 v[36:39], v[224:227], a[232:235], v[36:39]
    v_cvt_pk_bf16_f32 v0, v0, v1
    v_cvt_pk_bf16_f32 v2, v2, v3
    v_mfma_f32_16x16x32_bf16 v[36:39], v[228:231], a[236:239], v[36:39]
    ds_read_b64_tr_b16 v[248:249], v197 offset:49160
    ds_read_b64_tr_b16 v[250:251], v197 offset:50184
    v_mfma_f32_16x16x32_bf16 v[36:39], v[232:235], v[168:171], v[36:39]
    buffer_load_dwordx4 v219, s[8:11], s32 offen offset:3072 lds
    v_mfma_f32_16x16x32_bf16 v[36:39], v[236:239], v[172:175], v[36:39]
    ds_read_b64_tr_b16 v[252:253], v197 offset:57352
    ds_read_b64_tr_b16 v[254:255], v197 offset:58376
    v_mfma_f32_16x16x32_bf16 v[40:43], v[224:227], a[240:243], v[40:43]
    s_add_u32 s32, s32, 32768
    v_accvgpr_write_b32 a128, v0
    v_accvgpr_write_b32 a129, v2
    v_mfma_f32_16x16x32_bf16 v[40:43], v[228:231], a[244:247], v[40:43]
    s_add_u32 m0, s30, 65536
    v_fma_f32 v4, v210, v128, v4
    v_fma_f32 v5, v210, v129, v5
    v_mfma_f32_16x16x32_bf16 v[40:43], v[232:235], v[176:179], v[40:43]
    buffer_load_dwordx4 v220, s[12:15], s33 offen offset:0 lds
    v_mfma_f32_16x16x32_bf16 v[40:43], v[236:239], v[180:183], v[40:43]
    v_fma_f32 v6, v210, v130, v6
    v_fma_f32 v7, v210, v131, v7
    v_mfma_f32_16x16x32_bf16 v[44:47], v[224:227], a[248:251], v[44:47]
    v_mul_f32 v4, v211, v4
    v_mul_f32 v5, v211, v5
    v_mfma_f32_16x16x32_bf16 v[44:47], v[228:231], a[252:255], v[44:47]
    buffer_load_dwordx4 v221, s[12:15], s33 offen offset:1024 lds
    v_mfma_f32_16x16x32_bf16 v[44:47], v[232:235], v[184:187], v[44:47]
    s_waitcnt lgkmcnt(0)
    v_mul_f32 v6, v211, v6
    v_mul_f32 v7, v211, v7
    v_mfma_f32_16x16x32_bf16 v[44:47], v[236:239], v[188:191], v[44:47]
    v_cvt_pk_bf16_f32 v4, v4, v5
    v_cvt_pk_bf16_f32 v6, v6, v7
    v_mfma_f32_16x16x32_bf16 v[48:51], v[240:243], a[224:227], v[48:51]
    v_accvgpr_write_b32 a144, v4
    v_accvgpr_write_b32 a145, v6
    v_mfma_f32_16x16x32_bf16 v[48:51], v[244:247], a[228:231], v[48:51]
    ds_read_b64_tr_b16 v[224:225], v198 offset:32768
    ds_read_b64_tr_b16 v[226:227], v198 offset:33792
    v_mfma_f32_16x16x32_bf16 v[48:51], v[248:251], v[160:163], v[48:51]
    buffer_load_dwordx4 v220, s[12:15], s33 offen offset:2048 lds
    v_mfma_f32_16x16x32_bf16 v[48:51], v[252:255], v[164:167], v[48:51]
    ds_read_b64_tr_b16 v[228:229], v198 offset:40960
    ds_read_b64_tr_b16 v[230:231], v198 offset:41984
    v_mfma_f32_16x16x32_bf16 v[52:55], v[240:243], a[232:235], v[52:55]
    v_fma_f32 v8, v212, v128, v8
    v_fma_f32 v9, v212, v129, v9
    v_mfma_f32_16x16x32_bf16 v[52:55], v[244:247], a[236:239], v[52:55]
    ds_read_b64_tr_b16 v[232:233], v198 offset:49152
    ds_read_b64_tr_b16 v[234:235], v198 offset:50176
    v_mfma_f32_16x16x32_bf16 v[52:55], v[248:251], v[168:171], v[52:55]
    buffer_load_dwordx4 v221, s[12:15], s33 offen offset:3072 lds
    v_mfma_f32_16x16x32_bf16 v[52:55], v[252:255], v[172:175], v[52:55]
    ds_read_b64_tr_b16 v[236:237], v198 offset:57344
    ds_read_b64_tr_b16 v[238:239], v198 offset:58368
    v_mfma_f32_16x16x32_bf16 v[56:59], v[240:243], a[240:243], v[56:59]
    s_add_u32 s33, s33, 32768
    v_fma_f32 v10, v212, v130, v10
    v_fma_f32 v11, v212, v131, v11
    v_mfma_f32_16x16x32_bf16 v[56:59], v[244:247], a[244:247], v[56:59]
    s_add_u32 m0, s30, 69632
    v_mul_f32 v8, v213, v8
    v_mul_f32 v9, v213, v9
    v_mfma_f32_16x16x32_bf16 v[56:59], v[248:251], v[176:179], v[56:59]
    buffer_load_dwordx4 v220, s[12:15], s34 offen offset:0 lds
    v_mfma_f32_16x16x32_bf16 v[56:59], v[252:255], v[180:183], v[56:59]
    v_mul_f32 v10, v213, v10
    v_mul_f32 v11, v213, v11
    v_mfma_f32_16x16x32_bf16 v[60:63], v[240:243], a[248:251], v[60:63]
    v_cvt_pk_bf16_f32 v8, v8, v9
    v_cvt_pk_bf16_f32 v10, v10, v11
    v_mfma_f32_16x16x32_bf16 v[60:63], v[244:247], a[252:255], v[60:63]
    buffer_load_dwordx4 v221, s[12:15], s34 offen offset:1024 lds
    v_mfma_f32_16x16x32_bf16 v[60:63], v[248:251], v[184:187], v[60:63]
    s_waitcnt lgkmcnt(0)
    v_accvgpr_write_b32 a160, v8
    v_accvgpr_write_b32 a161, v10
    v_mfma_f32_16x16x32_bf16 v[60:63], v[252:255], v[188:191], v[60:63]
    v_fma_f32 v12, v214, v128, v12
    v_fma_f32 v13, v214, v129, v13
    v_mfma_f32_16x16x32_bf16 v[64:67], v[224:227], a[224:227], v[64:67]
    v_fma_f32 v14, v214, v130, v14
    v_fma_f32 v15, v214, v131, v15
    v_mfma_f32_16x16x32_bf16 v[64:67], v[228:231], a[228:231], v[64:67]
    ds_read_b64_tr_b16 v[240:241], v198 offset:32776
    ds_read_b64_tr_b16 v[242:243], v198 offset:33800
    v_mfma_f32_16x16x32_bf16 v[64:67], v[232:235], v[160:163], v[64:67]
    buffer_load_dwordx4 v220, s[12:15], s34 offen offset:2048 lds
    v_mfma_f32_16x16x32_bf16 v[64:67], v[236:239], v[164:167], v[64:67]
    ds_read_b64_tr_b16 v[244:245], v198 offset:40968
    ds_read_b64_tr_b16 v[246:247], v198 offset:41992
    v_mfma_f32_16x16x32_bf16 v[68:71], v[224:227], a[232:235], v[68:71]
    v_mul_f32 v12, v215, v12
    v_mul_f32 v13, v215, v13
    v_mfma_f32_16x16x32_bf16 v[68:71], v[228:231], a[236:239], v[68:71]
    ds_read_b64_tr_b16 v[248:249], v198 offset:49160
    ds_read_b64_tr_b16 v[250:251], v198 offset:50184
    v_mfma_f32_16x16x32_bf16 v[68:71], v[232:235], v[168:171], v[68:71]
    buffer_load_dwordx4 v221, s[12:15], s34 offen offset:3072 lds
    v_mfma_f32_16x16x32_bf16 v[68:71], v[236:239], v[172:175], v[68:71]
    ds_read_b64_tr_b16 v[252:253], v198 offset:57352
    ds_read_b64_tr_b16 v[254:255], v198 offset:58376
    v_mfma_f32_16x16x32_bf16 v[72:75], v[224:227], a[240:243], v[72:75]
    s_add_u32 s34, s34, 32768
    v_mul_f32 v14, v215, v14
    v_mul_f32 v15, v215, v15
    v_mfma_f32_16x16x32_bf16 v[72:75], v[228:231], a[244:247], v[72:75]
    v_cvt_pk_bf16_f32 v12, v12, v13
    v_cvt_pk_bf16_f32 v14, v14, v15
    v_mfma_f32_16x16x32_bf16 v[72:75], v[232:235], v[176:179], v[72:75]
    v_accvgpr_write_b32 a176, v12
    v_accvgpr_write_b32 a177, v14
    v_mfma_f32_16x16x32_bf16 v[72:75], v[236:239], v[180:183], v[72:75]
    v_fma_f32 v16, v208, v132, v16
    v_fma_f32 v17, v208, v133, v17
    v_mfma_f32_16x16x32_bf16 v[76:79], v[224:227], a[248:251], v[76:79]
    v_fma_f32 v18, v208, v134, v18
    v_fma_f32 v19, v208, v135, v19
    v_mfma_f32_16x16x32_bf16 v[76:79], v[228:231], a[252:255], v[76:79]
    v_mul_f32 v16, v209, v16
    v_mul_f32 v17, v209, v17
    v_mfma_f32_16x16x32_bf16 v[76:79], v[232:235], v[184:187], v[76:79]
    s_waitcnt lgkmcnt(0)
    v_mul_f32 v18, v209, v18
    v_mul_f32 v19, v209, v19
    v_mfma_f32_16x16x32_bf16 v[76:79], v[236:239], v[188:191], v[76:79]
    v_cvt_pk_bf16_f32 v16, v16, v17
    v_cvt_pk_bf16_f32 v18, v18, v19
    v_mfma_f32_16x16x32_bf16 v[80:83], v[240:243], a[224:227], v[80:83]
    v_accvgpr_write_b32 a130, v16
    v_accvgpr_write_b32 a131, v18
    v_mfma_f32_16x16x32_bf16 v[80:83], v[244:247], a[228:231], v[80:83]
    ds_read_b64_tr_b16 v[224:225], v199 offset:32768
    ds_read_b64_tr_b16 v[226:227], v199 offset:33792
    v_mfma_f32_16x16x32_bf16 v[80:83], v[248:251], v[160:163], v[80:83]
    v_fma_f32 v20, v210, v132, v20
    v_fma_f32 v21, v210, v133, v21
    v_mfma_f32_16x16x32_bf16 v[80:83], v[252:255], v[164:167], v[80:83]
    ds_read_b64_tr_b16 v[228:229], v199 offset:40960
    ds_read_b64_tr_b16 v[230:231], v199 offset:41984
    v_mfma_f32_16x16x32_bf16 v[84:87], v[240:243], a[232:235], v[84:87]
    v_fma_f32 v22, v210, v134, v22
    v_fma_f32 v23, v210, v135, v23
    v_mfma_f32_16x16x32_bf16 v[84:87], v[244:247], a[236:239], v[84:87]
    ds_read_b64_tr_b16 v[232:233], v199 offset:49152
    ds_read_b64_tr_b16 v[234:235], v199 offset:50176
    v_mfma_f32_16x16x32_bf16 v[84:87], v[248:251], v[168:171], v[84:87]
    v_mul_f32 v20, v211, v20
    v_mul_f32 v21, v211, v21
    v_mfma_f32_16x16x32_bf16 v[84:87], v[252:255], v[172:175], v[84:87]
    ds_read_b64_tr_b16 v[236:237], v199 offset:57344
    ds_read_b64_tr_b16 v[238:239], v199 offset:58368
    v_mfma_f32_16x16x32_bf16 v[88:91], v[240:243], a[240:243], v[88:91]
    v_mul_f32 v22, v211, v22
    v_mul_f32 v23, v211, v23
    v_mfma_f32_16x16x32_bf16 v[88:91], v[244:247], a[244:247], v[88:91]
    v_cvt_pk_bf16_f32 v20, v20, v21
    v_cvt_pk_bf16_f32 v22, v22, v23
    v_mfma_f32_16x16x32_bf16 v[88:91], v[248:251], v[176:179], v[88:91]
    v_accvgpr_write_b32 a146, v20
    v_accvgpr_write_b32 a147, v22
    v_mfma_f32_16x16x32_bf16 v[88:91], v[252:255], v[180:183], v[88:91]
    v_fma_f32 v24, v212, v132, v24
    v_fma_f32 v25, v212, v133, v25
    v_mfma_f32_16x16x32_bf16 v[92:95], v[240:243], a[248:251], v[92:95]
    v_fma_f32 v26, v212, v134, v26
    v_fma_f32 v27, v212, v135, v27
    v_mfma_f32_16x16x32_bf16 v[92:95], v[244:247], a[252:255], v[92:95]
    v_mul_f32 v24, v213, v24
    v_mul_f32 v25, v213, v25
    v_mfma_f32_16x16x32_bf16 v[92:95], v[248:251], v[184:187], v[92:95]
    s_waitcnt lgkmcnt(0)
    v_mul_f32 v26, v213, v26
    v_mul_f32 v27, v213, v27
    v_mfma_f32_16x16x32_bf16 v[92:95], v[252:255], v[188:191], v[92:95]
    v_cvt_pk_bf16_f32 v24, v24, v25
    v_cvt_pk_bf16_f32 v26, v26, v27
    v_mfma_f32_16x16x32_bf16 v[96:99], v[224:227], a[224:227], v[96:99]
    v_accvgpr_write_b32 a162, v24
    v_accvgpr_write_b32 a163, v26
    v_mfma_f32_16x16x32_bf16 v[96:99], v[228:231], a[228:231], v[96:99]
    ds_read_b64_tr_b16 v[240:241], v199 offset:32776
    ds_read_b64_tr_b16 v[242:243], v199 offset:33800
    v_mfma_f32_16x16x32_bf16 v[96:99], v[232:235], v[160:163], v[96:99]
    v_fma_f32 v28, v214, v132, v28
    v_fma_f32 v29, v214, v133, v29
    v_mfma_f32_16x16x32_bf16 v[96:99], v[236:239], v[164:167], v[96:99]
    ds_read_b64_tr_b16 v[244:245], v199 offset:40968
    ds_read_b64_tr_b16 v[246:247], v199 offset:41992
    v_mfma_f32_16x16x32_bf16 v[100:103], v[224:227], a[232:235], v[100:103]
    v_fma_f32 v30, v214, v134, v30
    v_fma_f32 v31, v214, v135, v31
    v_mfma_f32_16x16x32_bf16 v[100:103], v[228:231], a[236:239], v[100:103]
    ds_read_b64_tr_b16 v[248:249], v199 offset:49160
    ds_read_b64_tr_b16 v[250:251], v199 offset:50184
    v_mfma_f32_16x16x32_bf16 v[100:103], v[232:235], v[168:171], v[100:103]
    v_mul_f32 v28, v215, v28
    v_mul_f32 v29, v215, v29
    v_mfma_f32_16x16x32_bf16 v[100:103], v[236:239], v[172:175], v[100:103]
    ds_read_b64_tr_b16 v[252:253], v199 offset:57352
    ds_read_b64_tr_b16 v[254:255], v199 offset:58376
    v_mfma_f32_16x16x32_bf16 v[104:107], v[224:227], a[240:243], v[104:107]
    v_mul_f32 v30, v215, v30
    v_mul_f32 v31, v215, v31
    v_mfma_f32_16x16x32_bf16 v[104:107], v[228:231], a[244:247], v[104:107]
    v_cvt_pk_bf16_f32 v28, v28, v29
    v_cvt_pk_bf16_f32 v30, v30, v31
    v_mfma_f32_16x16x32_bf16 v[104:107], v[232:235], v[176:179], v[104:107]
    v_accvgpr_write_b32 a178, v28
    v_accvgpr_write_b32 a179, v30
    v_mfma_f32_16x16x32_bf16 v[104:107], v[236:239], v[180:183], v[104:107]
    v_fma_f32 v32, v208, v136, v32
    v_fma_f32 v33, v208, v137, v33
    v_mfma_f32_16x16x32_bf16 v[108:111], v[224:227], a[248:251], v[108:111]
    v_fma_f32 v34, v208, v138, v34
    v_fma_f32 v35, v208, v139, v35
    v_mfma_f32_16x16x32_bf16 v[108:111], v[228:231], a[252:255], v[108:111]
    v_mul_f32 v32, v209, v32
    v_mul_f32 v33, v209, v33
    v_mfma_f32_16x16x32_bf16 v[108:111], v[232:235], v[184:187], v[108:111]
    s_waitcnt vmcnt(16) lgkmcnt(0)
    v_mul_f32 v34, v209, v34
    v_mul_f32 v35, v209, v35
    v_mfma_f32_16x16x32_bf16 v[108:111], v[236:239], v[188:191], v[108:111]
    s_barrier
    v_cvt_pk_bf16_f32 v32, v32, v33
    v_cvt_pk_bf16_f32 v34, v34, v35
    v_mfma_f32_16x16x32_bf16 v[112:115], v[240:243], a[224:227], v[112:115]
    v_accvgpr_write_b32 a132, v32
    v_accvgpr_write_b32 a133, v34
    v_mfma_f32_16x16x32_bf16 v[112:115], v[244:247], a[228:231], v[112:115]
    ds_read_b128 a[192:195], v204 offset:0
    ds_read_b128 a[196:199], v205 offset:0
    v_mfma_f32_16x16x32_bf16 v[112:115], v[248:251], v[160:163], v[112:115]
    v_fma_f32 v36, v210, v136, v36
    v_fma_f32 v37, v210, v137, v37
    v_mfma_f32_16x16x32_bf16 v[112:115], v[252:255], v[164:167], v[112:115]
    ds_read_b128 a[200:203], v206 offset:0
    ds_read_b128 a[204:207], v207 offset:0
    v_mfma_f32_16x16x32_bf16 v[116:119], v[240:243], a[232:235], v[116:119]
    v_fma_f32 v38, v210, v138, v38
    v_fma_f32 v39, v210, v139, v39
    v_mfma_f32_16x16x32_bf16 v[116:119], v[244:247], a[236:239], v[116:119]
    v_mul_f32 v36, v211, v36
    v_mul_f32 v37, v211, v37
    v_mfma_f32_16x16x32_bf16 v[116:119], v[248:251], v[168:171], v[116:119]
    v_mul_f32 v38, v211, v38
    v_mul_f32 v39, v211, v39
    v_mfma_f32_16x16x32_bf16 v[116:119], v[252:255], v[172:175], v[116:119]
    v_cvt_pk_bf16_f32 v36, v36, v37
    v_cvt_pk_bf16_f32 v38, v38, v39
    v_mfma_f32_16x16x32_bf16 v[120:123], v[240:243], a[240:243], v[120:123]
    v_accvgpr_write_b32 a148, v36
    v_accvgpr_write_b32 a149, v38
    v_mfma_f32_16x16x32_bf16 v[120:123], v[244:247], a[244:247], v[120:123]
    v_fma_f32 v40, v212, v136, v40
    v_fma_f32 v41, v212, v137, v41
    v_mfma_f32_16x16x32_bf16 v[120:123], v[248:251], v[176:179], v[120:123]
    v_fma_f32 v42, v212, v138, v42
    v_fma_f32 v43, v212, v139, v43
    v_mfma_f32_16x16x32_bf16 v[120:123], v[252:255], v[180:183], v[120:123]
    v_mul_f32 v40, v213, v40
    v_mul_f32 v41, v213, v41
    v_mfma_f32_16x16x32_bf16 v[124:127], v[240:243], a[248:251], v[124:127]
    v_mul_f32 v42, v213, v42
    v_mul_f32 v43, v213, v43
    v_mfma_f32_16x16x32_bf16 v[124:127], v[244:247], a[252:255], v[124:127]
    v_cvt_pk_bf16_f32 v40, v40, v41
    v_cvt_pk_bf16_f32 v42, v42, v43
    v_mfma_f32_16x16x32_bf16 v[124:127], v[248:251], v[184:187], v[124:127]
    v_accvgpr_write_b32 a164, v40
    v_accvgpr_write_b32 a165, v42
    v_mfma_f32_16x16x32_bf16 v[124:127], v[252:255], v[188:191], v[124:127]
    v_fma_f32 v44, v214, v136, v44
    v_fma_f32 v45, v214, v137, v45
    v_pk_fma_f32 v[46:47], v[214:215], v[138:139], v[46:47] op_sel:[0,0,0] op_sel_hi:[0,1,1]
    v_pk_mul_f32 v[44:45], v[214:215], v[44:45] op_sel:[1,0] op_sel_hi:[1,1]
    v_pk_mul_f32 v[46:47], v[214:215], v[46:47] op_sel:[1,0] op_sel_hi:[1,1]
    v_cvt_pk_bf16_f32 v44, v44, v45
    v_cvt_pk_bf16_f32 v46, v46, v47
    v_accvgpr_write_b32 a180, v44
    v_accvgpr_write_b32 a181, v46
    v_pk_fma_f32 v[48:49], v[208:209], v[140:141], v[48:49] op_sel:[0,0,0] op_sel_hi:[0,1,1]
    v_pk_fma_f32 v[50:51], v[208:209], v[142:143], v[50:51] op_sel:[0,0,0] op_sel_hi:[0,1,1]
    v_pk_mul_f32 v[48:49], v[208:209], v[48:49] op_sel:[1,0] op_sel_hi:[1,1]
    v_pk_mul_f32 v[50:51], v[208:209], v[50:51] op_sel:[1,0] op_sel_hi:[1,1]
    v_cvt_pk_bf16_f32 v48, v48, v49
    v_cvt_pk_bf16_f32 v50, v50, v51
    v_accvgpr_write_b32 a134, v48
    v_accvgpr_write_b32 a135, v50
    v_pk_fma_f32 v[52:53], v[210:211], v[140:141], v[52:53] op_sel:[0,0,0] op_sel_hi:[0,1,1]
    v_pk_fma_f32 v[54:55], v[210:211], v[142:143], v[54:55] op_sel:[0,0,0] op_sel_hi:[0,1,1]
    v_pk_mul_f32 v[52:53], v[210:211], v[52:53] op_sel:[1,0] op_sel_hi:[1,1]
    v_pk_mul_f32 v[54:55], v[210:211], v[54:55] op_sel:[1,0] op_sel_hi:[1,1]
    v_cvt_pk_bf16_f32 v52, v52, v53
    v_cvt_pk_bf16_f32 v54, v54, v55
    v_accvgpr_write_b32 a150, v52
    v_accvgpr_write_b32 a151, v54
    v_pk_fma_f32 v[56:57], v[212:213], v[140:141], v[56:57] op_sel:[0,0,0] op_sel_hi:[0,1,1]
    v_pk_fma_f32 v[58:59], v[212:213], v[142:143], v[58:59] op_sel:[0,0,0] op_sel_hi:[0,1,1]
    v_pk_mul_f32 v[56:57], v[212:213], v[56:57] op_sel:[1,0] op_sel_hi:[1,1]
    v_pk_mul_f32 v[58:59], v[212:213], v[58:59] op_sel:[1,0] op_sel_hi:[1,1]
    v_cvt_pk_bf16_f32 v56, v56, v57
    v_cvt_pk_bf16_f32 v58, v58, v59
    v_accvgpr_write_b32 a166, v56
    v_accvgpr_write_b32 a167, v58
    v_pk_fma_f32 v[60:61], v[214:215], v[140:141], v[60:61] op_sel:[0,0,0] op_sel_hi:[0,1,1]
    v_pk_fma_f32 v[62:63], v[214:215], v[142:143], v[62:63] op_sel:[0,0,0] op_sel_hi:[0,1,1]
    v_pk_mul_f32 v[60:61], v[214:215], v[60:61] op_sel:[1,0] op_sel_hi:[1,1]
    v_pk_mul_f32 v[62:63], v[214:215], v[62:63] op_sel:[1,0] op_sel_hi:[1,1]
    v_cvt_pk_bf16_f32 v60, v60, v61
    v_cvt_pk_bf16_f32 v62, v62, v63
    v_accvgpr_write_b32 a182, v60
    v_accvgpr_write_b32 a183, v62
    v_pk_fma_f32 v[64:65], v[208:209], v[144:145], v[64:65] op_sel:[0,0,0] op_sel_hi:[0,1,1]
    v_pk_fma_f32 v[66:67], v[208:209], v[146:147], v[66:67] op_sel:[0,0,0] op_sel_hi:[0,1,1]
    v_pk_mul_f32 v[64:65], v[208:209], v[64:65] op_sel:[1,0] op_sel_hi:[1,1]
    v_pk_mul_f32 v[66:67], v[208:209], v[66:67] op_sel:[1,0] op_sel_hi:[1,1]
    v_cvt_pk_bf16_f32 v64, v64, v65
    v_cvt_pk_bf16_f32 v66, v66, v67
    v_accvgpr_write_b32 a136, v64
    v_accvgpr_write_b32 a137, v66
    v_pk_fma_f32 v[68:69], v[210:211], v[144:145], v[68:69] op_sel:[0,0,0] op_sel_hi:[0,1,1]
    v_pk_fma_f32 v[70:71], v[210:211], v[146:147], v[70:71] op_sel:[0,0,0] op_sel_hi:[0,1,1]
    v_pk_mul_f32 v[68:69], v[210:211], v[68:69] op_sel:[1,0] op_sel_hi:[1,1]
    v_pk_mul_f32 v[70:71], v[210:211], v[70:71] op_sel:[1,0] op_sel_hi:[1,1]
    v_cvt_pk_bf16_f32 v68, v68, v69
    v_cvt_pk_bf16_f32 v70, v70, v71
    v_accvgpr_write_b32 a152, v68
    v_accvgpr_write_b32 a153, v70
    v_pk_fma_f32 v[72:73], v[212:213], v[144:145], v[72:73] op_sel:[0,0,0] op_sel_hi:[0,1,1]
    v_pk_fma_f32 v[74:75], v[212:213], v[146:147], v[74:75] op_sel:[0,0,0] op_sel_hi:[0,1,1]
    v_pk_mul_f32 v[72:73], v[212:213], v[72:73] op_sel:[1,0] op_sel_hi:[1,1]
    v_pk_mul_f32 v[74:75], v[212:213], v[74:75] op_sel:[1,0] op_sel_hi:[1,1]
    v_cvt_pk_bf16_f32 v72, v72, v73
    v_cvt_pk_bf16_f32 v74, v74, v75
    v_accvgpr_write_b32 a168, v72
    v_accvgpr_write_b32 a169, v74
    v_pk_fma_f32 v[76:77], v[214:215], v[144:145], v[76:77] op_sel:[0,0,0] op_sel_hi:[0,1,1]
    v_pk_fma_f32 v[78:79], v[214:215], v[146:147], v[78:79] op_sel:[0,0,0] op_sel_hi:[0,1,1]
    v_pk_mul_f32 v[76:77], v[214:215], v[76:77] op_sel:[1,0] op_sel_hi:[1,1]
    v_pk_mul_f32 v[78:79], v[214:215], v[78:79] op_sel:[1,0] op_sel_hi:[1,1]
    v_cvt_pk_bf16_f32 v76, v76, v77
    v_cvt_pk_bf16_f32 v78, v78, v79
    v_accvgpr_write_b32 a184, v76
    v_accvgpr_write_b32 a185, v78
    v_pk_fma_f32 v[80:81], v[208:209], v[148:149], v[80:81] op_sel:[0,0,0] op_sel_hi:[0,1,1]
    v_pk_fma_f32 v[82:83], v[208:209], v[150:151], v[82:83] op_sel:[0,0,0] op_sel_hi:[0,1,1]
    v_pk_mul_f32 v[80:81], v[208:209], v[80:81] op_sel:[1,0] op_sel_hi:[1,1]
    v_pk_mul_f32 v[82:83], v[208:209], v[82:83] op_sel:[1,0] op_sel_hi:[1,1]
    v_cvt_pk_bf16_f32 v80, v80, v81
    v_cvt_pk_bf16_f32 v82, v82, v83
    v_accvgpr_write_b32 a138, v80
    v_accvgpr_write_b32 a139, v82
    v_pk_fma_f32 v[84:85], v[210:211], v[148:149], v[84:85] op_sel:[0,0,0] op_sel_hi:[0,1,1]
    v_pk_fma_f32 v[86:87], v[210:211], v[150:151], v[86:87] op_sel:[0,0,0] op_sel_hi:[0,1,1]
    v_pk_mul_f32 v[84:85], v[210:211], v[84:85] op_sel:[1,0] op_sel_hi:[1,1]
    v_pk_mul_f32 v[86:87], v[210:211], v[86:87] op_sel:[1,0] op_sel_hi:[1,1]
    v_cvt_pk_bf16_f32 v84, v84, v85
    v_cvt_pk_bf16_f32 v86, v86, v87
    v_accvgpr_write_b32 a154, v84
    v_accvgpr_write_b32 a155, v86
    v_pk_fma_f32 v[88:89], v[212:213], v[148:149], v[88:89] op_sel:[0,0,0] op_sel_hi:[0,1,1]
    v_pk_fma_f32 v[90:91], v[212:213], v[150:151], v[90:91] op_sel:[0,0,0] op_sel_hi:[0,1,1]
    v_pk_mul_f32 v[88:89], v[212:213], v[88:89] op_sel:[1,0] op_sel_hi:[1,1]
    v_pk_mul_f32 v[90:91], v[212:213], v[90:91] op_sel:[1,0] op_sel_hi:[1,1]
    v_cvt_pk_bf16_f32 v88, v88, v89
    v_cvt_pk_bf16_f32 v90, v90, v91
    v_accvgpr_write_b32 a170, v88
    v_accvgpr_write_b32 a171, v90
    v_pk_fma_f32 v[92:93], v[214:215], v[148:149], v[92:93] op_sel:[0,0,0] op_sel_hi:[0,1,1]
    v_pk_fma_f32 v[94:95], v[214:215], v[150:151], v[94:95] op_sel:[0,0,0] op_sel_hi:[0,1,1]
    v_pk_mul_f32 v[92:93], v[214:215], v[92:93] op_sel:[1,0] op_sel_hi:[1,1]
    v_pk_mul_f32 v[94:95], v[214:215], v[94:95] op_sel:[1,0] op_sel_hi:[1,1]
    v_cvt_pk_bf16_f32 v92, v92, v93
    v_cvt_pk_bf16_f32 v94, v94, v95
    v_accvgpr_write_b32 a186, v92
    v_accvgpr_write_b32 a187, v94
    v_pk_fma_f32 v[96:97], v[208:209], v[152:153], v[96:97] op_sel:[0,0,0] op_sel_hi:[0,1,1]
    v_pk_fma_f32 v[98:99], v[208:209], v[154:155], v[98:99] op_sel:[0,0,0] op_sel_hi:[0,1,1]
    v_pk_mul_f32 v[96:97], v[208:209], v[96:97] op_sel:[1,0] op_sel_hi:[1,1]
    v_pk_mul_f32 v[98:99], v[208:209], v[98:99] op_sel:[1,0] op_sel_hi:[1,1]
    v_cvt_pk_bf16_f32 v96, v96, v97
    v_cvt_pk_bf16_f32 v98, v98, v99
    v_accvgpr_write_b32 a140, v96
    v_accvgpr_write_b32 a141, v98
    v_pk_fma_f32 v[100:101], v[210:211], v[152:153], v[100:101] op_sel:[0,0,0] op_sel_hi:[0,1,1]
    v_pk_fma_f32 v[102:103], v[210:211], v[154:155], v[102:103] op_sel:[0,0,0] op_sel_hi:[0,1,1]
    v_pk_mul_f32 v[100:101], v[210:211], v[100:101] op_sel:[1,0] op_sel_hi:[1,1]
    v_pk_mul_f32 v[102:103], v[210:211], v[102:103] op_sel:[1,0] op_sel_hi:[1,1]
    v_cvt_pk_bf16_f32 v100, v100, v101
    v_cvt_pk_bf16_f32 v102, v102, v103
    v_accvgpr_write_b32 a156, v100
    v_accvgpr_write_b32 a157, v102
    v_pk_fma_f32 v[104:105], v[212:213], v[152:153], v[104:105] op_sel:[0,0,0] op_sel_hi:[0,1,1]
    v_pk_fma_f32 v[106:107], v[212:213], v[154:155], v[106:107] op_sel:[0,0,0] op_sel_hi:[0,1,1]
    v_pk_mul_f32 v[104:105], v[212:213], v[104:105] op_sel:[1,0] op_sel_hi:[1,1]
    v_pk_mul_f32 v[106:107], v[212:213], v[106:107] op_sel:[1,0] op_sel_hi:[1,1]
    v_cvt_pk_bf16_f32 v104, v104, v105
    v_cvt_pk_bf16_f32 v106, v106, v107
    v_accvgpr_write_b32 a172, v104
    v_accvgpr_write_b32 a173, v106
    v_pk_fma_f32 v[108:109], v[214:215], v[152:153], v[108:109] op_sel:[0,0,0] op_sel_hi:[0,1,1]
    v_pk_fma_f32 v[110:111], v[214:215], v[154:155], v[110:111] op_sel:[0,0,0] op_sel_hi:[0,1,1]
    v_pk_mul_f32 v[108:109], v[214:215], v[108:109] op_sel:[1,0] op_sel_hi:[1,1]
    v_pk_mul_f32 v[110:111], v[214:215], v[110:111] op_sel:[1,0] op_sel_hi:[1,1]
    v_cvt_pk_bf16_f32 v108, v108, v109
    v_cvt_pk_bf16_f32 v110, v110, v111
    v_accvgpr_write_b32 a188, v108
    v_accvgpr_write_b32 a189, v110
    v_pk_fma_f32 v[112:113], v[208:209], v[156:157], v[112:113] op_sel:[0,0,0] op_sel_hi:[0,1,1]
    v_pk_fma_f32 v[114:115], v[208:209], v[158:159], v[114:115] op_sel:[0,0,0] op_sel_hi:[0,1,1]
    v_pk_mul_f32 v[112:113], v[208:209], v[112:113] op_sel:[1,0] op_sel_hi:[1,1]
    v_pk_mul_f32 v[114:115], v[208:209], v[114:115] op_sel:[1,0] op_sel_hi:[1,1]
    v_cvt_pk_bf16_f32 v112, v112, v113
    v_cvt_pk_bf16_f32 v114, v114, v115
    v_accvgpr_write_b32 a142, v112
    v_accvgpr_write_b32 a143, v114
    v_pk_fma_f32 v[116:117], v[210:211], v[156:157], v[116:117] op_sel:[0,0,0] op_sel_hi:[0,1,1]
    v_pk_fma_f32 v[118:119], v[210:211], v[158:159], v[118:119] op_sel:[0,0,0] op_sel_hi:[0,1,1]
    v_pk_mul_f32 v[116:117], v[210:211], v[116:117] op_sel:[1,0] op_sel_hi:[1,1]
    v_pk_mul_f32 v[118:119], v[210:211], v[118:119] op_sel:[1,0] op_sel_hi:[1,1]
    v_cvt_pk_bf16_f32 v116, v116, v117
    v_cvt_pk_bf16_f32 v118, v118, v119
    v_accvgpr_write_b32 a158, v116
    v_accvgpr_write_b32 a159, v118
    v_pk_fma_f32 v[120:121], v[212:213], v[156:157], v[120:121] op_sel:[0,0,0] op_sel_hi:[0,1,1]
    v_pk_fma_f32 v[122:123], v[212:213], v[158:159], v[122:123] op_sel:[0,0,0] op_sel_hi:[0,1,1]
    v_pk_mul_f32 v[120:121], v[212:213], v[120:121] op_sel:[1,0] op_sel_hi:[1,1]
    v_pk_mul_f32 v[122:123], v[212:213], v[122:123] op_sel:[1,0] op_sel_hi:[1,1]
    v_cvt_pk_bf16_f32 v120, v120, v121
    v_cvt_pk_bf16_f32 v122, v122, v123
    v_accvgpr_write_b32 a174, v120
    v_accvgpr_write_b32 a175, v122
    v_pk_fma_f32 v[124:125], v[214:215], v[156:157], v[124:125] op_sel:[0,0,0] op_sel_hi:[0,1,1]
    v_pk_fma_f32 v[126:127], v[214:215], v[158:159], v[126:127] op_sel:[0,0,0] op_sel_hi:[0,1,1]
    v_pk_mul_f32 v[124:125], v[214:215], v[124:125] op_sel:[1,0] op_sel_hi:[1,1]
    v_pk_mul_f32 v[126:127], v[214:215], v[126:127] op_sel:[1,0] op_sel_hi:[1,1]
    v_cvt_pk_bf16_f32 v124, v124, v125
    v_cvt_pk_bf16_f32 v126, v126, v127
    v_accvgpr_write_b32 a190, v124
    v_accvgpr_write_b32 a191, v126
F_QK0:
    s_mov_b32 s35, 0
    s_waitcnt lgkmcnt(0)
    v_mfma_f32_16x16x32_bf16 v[128:131], a[192:195], a[128:131], 0
    ds_read_b128 a[208:211], v204 offset:4096
    v_mov_b32 v196, 0
    v_mfma_f32_16x16x32_bf16 v[128:131], a[196:199], a[132:135], v[128:131]
    ds_read_b128 a[212:215], v205 offset:4096
    v_mov_b32 v197, 0
    v_mfma_f32_16x16x32_bf16 v[128:131], a[200:203], a[136:139], v[128:131]
    ds_read_b128 a[216:219], v206 offset:4096
    v_mov_b32 v198, 0
    v_mfma_f32_16x16x32_bf16 v[128:131], a[204:207], a[140:143], v[128:131]
    ds_read_b128 a[220:223], v207 offset:4096
    v_mov_b32 v199, 0
    v_mfma_f32_16x16x32_bf16 v[132:135], a[192:195], a[144:147], 0
    v_mov_b32 v200, 0
    v_mov_b32 v201, 0
    v_mfma_f32_16x16x32_bf16 v[132:135], a[196:199], a[148:151], v[132:135]
    v_mov_b32 v202, 0
    v_mov_b32 v203, 0
    v_mfma_f32_16x16x32_bf16 v[132:135], a[200:203], a[152:155], v[132:135]
    v_mov_b32 v176, 0
    v_mov_b32 v177, 0
    v_mfma_f32_16x16x32_bf16 v[132:135], a[204:207], a[156:159], v[132:135]
    v_mov_b32 v178, 0
    v_mov_b32 v179, 0
    v_mfma_f32_16x16x32_bf16 v[136:139], a[192:195], a[160:163], 0
    v_mov_b32 v180, 0
    v_mov_b32 v181, 0
    v_mfma_f32_16x16x32_bf16 v[136:139], a[196:199], a[164:167], v[136:139]
    v_mov_b32 v182, 0
    v_mov_b32 v183, 0
    v_mfma_f32_16x16x32_bf16 v[136:139], a[200:203], a[168:171], v[136:139]
    v_mov_b32 v184, 0
    v_mov_b32 v185, 0
    v_mfma_f32_16x16x32_bf16 v[136:139], a[204:207], a[172:175], v[136:139]
    v_mov_b32 v186, 0
    v_mov_b32 v187, 0
    v_mfma_f32_16x16x32_bf16 v[140:143], a[192:195], a[176:179], 0
    v_mov_b32 v188, 0
    v_mov_b32 v189, 0
    v_mfma_f32_16x16x32_bf16 v[140:143], a[196:199], a[180:183], v[140:143]
    v_mov_b32 v190, 0
    v_mov_b32 v191, 0
    v_mfma_f32_16x16x32_bf16 v[140:143], a[200:203], a[184:187], v[140:143]
    v_xor_b32 v208, 0, v223
    v_xor_b32 v209, 32, v223
    v_mfma_f32_16x16x32_bf16 v[140:143], a[204:207], a[188:191], v[140:143]
    v_xor_b32 v210, 64, v223
    v_xor_b32 v211, 96, v223
    v_xor_b32 v212, 128, v223
    v_xor_b32 v213, 160, v223
    v_xor_b32 v214, 192, v223
    v_xor_b32 v215, 224, v223
    s_cmp_lg_u32 s37, 0
    s_cbranch_scc1 F_HAVEM
    v_max3_f32 v224, v128, v129, v130
    v_max_f32 v224, v224, v131
    v_max3_f32 v225, v132, v133, v134
    v_max_f32 v225, v225, v135
    v_max3_f32 v226, v136, v137, v138
    v_max_f32 v226, v226, v139
    v_max3_f32 v227, v140, v141, v142
    v_max_f32 v227, v227, v143
    v_mov_b32 v228, v224
    v_mov_b32 v229, v225
    v_mov_b32 v230, v226
    v_mov_b32 v231, v227
    v_permlane16_swap_b32 v224, v228
    v_permlane16_swap_b32 v225, v229
    v_permlane16_swap_b32 v226, v230
    v_permlane16_swap_b32 v227, v231
    v_max_f32 v224, v224, v228
    v_max_f32 v225, v225, v229
    v_max_f32 v226, v226, v230
    v_max_f32 v227, v227, v231
    v_mov_b32 v228, v224
    v_mov_b32 v229, v225
    v_mov_b32 v230, v226
    v_mov_b32 v231, v227
    v_permlane32_swap_b32 v224, v228
    v_permlane32_swap_b32 v225, v229
    v_permlane32_swap_b32 v226, v230
    v_permlane32_swap_b32 v227, v231
    v_max_f32 v224, v224, v228
    v_max_f32 v225, v225, v229
    v_max_f32 v226, v226, v230
    v_max_f32 v227, v227, v231
    v_sub_f32 v160, 0, v224
    v_sub_f32 v161, 0, v224
    v_sub_f32 v162, 0, v224
    v_sub_f32 v163, 0, v224
    v_sub_f32 v164, 0, v225
    v_sub_f32 v165, 0, v225
    v_sub_f32 v166, 0, v225
    v_sub_f32 v167, 0, v225
    v_sub_f32 v168, 0, v226
    v_sub_f32 v169, 0, v226
    v_sub_f32 v170, 0, v226
    v_sub_f32 v171, 0, v226
    v_sub_f32 v172, 0, v227
    v_sub_f32 v173, 0, v227
    v_sub_f32 v174, 0, v227
    v_sub_f32 v175, 0, v227
F_HAVEM:
    v_add_f32 v128, v128, v160
    v_add_f32 v129, v129, v161
    v_add_f32 v130, v130, v162
    v_add_f32 v131, v131, v163
    v_add_f32 v132, v132, v164
    v_add_f32 v133, v133, v165
    v_add_f32 v134, v134, v166
    v_add_f32 v135, v135, v167
    v_add_f32 v136, v136, v168
    v_add_f32 v137, v137, v169
    v_add_f32 v138, v138, v170
    v_add_f32 v139, v139, v171
    v_add_f32 v140, v140, v172
    v_add_f32 v141, v141, v173
    v_add_f32 v142, v142, v174
    v_add_f32 v143, v143, v175
    s_waitcnt lgkmcnt(0)
    v_mfma_f32_16x16x32_bf16 v[144:147], a[208:211], a[128:131], v[160:163]
    v_exp_f32 v128, v128
    v_exp_f32 v129, v129
    v_mfma_f32_16x16x32_bf16 v[144:147], a[212:215], a[132:135], v[144:147]
    ds_read_b128 a[192:195], v204 offset:8192
    ds_read_b128 a[196:199], v205 offset:8192
    v_cvt_pk_bf16_f32 v0, v128, v129
    v_mfma_f32_16x16x32_bf16 v[144:147], a[216:219], a[136:139], v[144:147]
    s_lshl_b32 s42, s3, 2
    s_add_u32 s42, s42, 138240
    s_lshl_b32 s43, s2, 3
    s_add_u32 s43, s43, 2113536
    v_mov_b32 v64, s46
    v_mov_b32 v65, s42
    v_mov_b32 v66, 138240
    v_mov_b32 v73, s44
    v_mfma_f32_16x16x32_bf16 v[144:147], a[220:223], a[140:143], v[144:147]
    ds_read_b128 a[200:203], v206 offset:8192
    ds_read_b128 a[204:207], v207 offset:8192
    ds_write_b32 v65, v64
    v_mfma_f32_16x16x32_bf16 v[148:151], a[208:211], a[144:147], v[164:167]
    v_exp_f32 v130, v130
    v_exp_f32 v131, v131
    v_mfma_f32_16x16x32_bf16 v[148:151], a[212:215], a[148:151], v[148:151]
    v_cvt_pk_bf16_f32 v1, v130, v131
    v_exp_f32 v132, v132
    v_mfma_f32_16x16x32_bf16 v[148:151], a[216:219], a[152:155], v[148:151]
    v_exp_f32 v133, v133
    v_exp_f32 v134, v134
    v_mfma_f32_16x16x32_bf16 v[148:151], a[220:223], a[156:159], v[148:151]
    v_cvt_pk_bf16_f32 v4, v132, v133
    v_exp_f32 v135, v135
    v_mfma_f32_16x16x32_bf16 v[152:155], a[208:211], a[160:163], v[168:171]
    v_cvt_pk_bf16_f32 v5, v134, v135
    v_exp_f32 v136, v136
    v_mfma_f32_16x16x32_bf16 v[152:155], a[212:215], a[164:167], v[152:155]
    v_exp_f32 v137, v137
    v_exp_f32 v138, v138
    v_mfma_f32_16x16x32_bf16 v[152:155], a[216:219], a[168:171], v[152:155]
    v_cvt_pk_bf16_f32 v8, v136, v137
    v_exp_f32 v139, v139
    v_mfma_f32_16x16x32_bf16 v[152:155], a[220:223], a[172:175], v[152:155]
    v_cvt_pk_bf16_f32 v9, v138, v139
    v_exp_f32 v140, v140
    v_mfma_f32_16x16x32_bf16 v[156:159], a[208:211], a[176:179], v[172:175]
    v_exp_f32 v141, v141
    v_exp_f32 v142, v142
    v_mfma_f32_16x16x32_bf16 v[156:159], a[212:215], a[180:183], v[156:159]
    v_cvt_pk_bf16_f32 v12, v140, v141
    v_exp_f32 v143, v143
    v_mfma_f32_16x16x32_bf16 v[156:159], a[216:219], a[184:187], v[156:159]
    s_waitcnt lgkmcnt(1)
    v_cvt_pk_bf16_f32 v13, v142, v143
    v_exp_f32 v144, v144
    v_mfma_f32_16x16x32_bf16 v[156:159], a[220:223], a[188:191], v[156:159]
    v_exp_f32 v145, v145
    v_exp_f32 v146, v146
    v_mfma_f32_16x16x32_bf16 v[128:131], a[192:195], a[128:131], v[160:163]
    v_cvt_pk_bf16_f32 v2, v144, v145
    v_exp_f32 v147, v147
    v_mfma_f32_16x16x32_bf16 v[128:131], a[196:199], a[132:135], v[128:131]
    ds_read_b128 a[208:211], v204 offset:12288
    ds_read_b128 a[212:215], v205 offset:12288
    v_cvt_pk_bf16_f32 v3, v146, v147
    v_mfma_f32_16x16x32_bf16 v[128:131], a[200:203], a[136:139], v[128:131]
    v_exp_f32 v148, v148
    v_exp_f32 v149, v149
    v_mfma_f32_16x16x32_bf16 v[128:131], a[204:207], a[140:143], v[128:131]
    ds_read_b128 a[216:219], v206 offset:12288
    ds_read_b128 a[220:223], v207 offset:12288
    v_cvt_pk_bf16_f32 v6, v148, v149
    v_mfma_f32_16x16x32_bf16 v[132:135], a[192:195], a[144:147], v[164:167]
    v_exp_f32 v150, v150
    v_exp_f32 v151, v151
    v_mfma_f32_16x16x32_bf16 v[132:135], a[196:199], a[148:151], v[132:135]
    v_cvt_pk_bf16_f32 v7, v150, v151
    v_exp_f32 v152, v152
    v_mfma_f32_16x16x32_bf16 v[132:135], a[200:203], a[152:155], v[132:135]
    v_exp_f32 v153, v153
    v_exp_f32 v154, v154
    v_mfma_f32_16x16x32_bf16 v[132:135], a[204:207], a[156:159], v[132:135]
    v_cvt_pk_bf16_f32 v10, v152, v153
    v_exp_f32 v155, v155
    v_mfma_f32_16x16x32_bf16 v[136:139], a[192:195], a[160:163], v[168:171]
    v_cvt_pk_bf16_f32 v11, v154, v155
    v_exp_f32 v156, v156
    v_mfma_f32_16x16x32_bf16 v[136:139], a[196:199], a[164:167], v[136:139]
    v_exp_f32 v157, v157
    v_exp_f32 v158, v158
    v_mfma_f32_16x16x32_bf16 v[136:139], a[200:203], a[168:171], v[136:139]
    v_cvt_pk_bf16_f32 v14, v156, v157
    v_exp_f32 v159, v159
    v_mfma_f32_16x16x32_bf16 v[136:139], a[204:207], a[172:175], v[136:139]
    v_cvt_pk_bf16_f32 v15, v158, v159
    v_exp_f32 v128, v128
    v_mfma_f32_16x16x32_bf16 v[140:143], a[192:195], a[176:179], v[172:175]
    v_exp_f32 v129, v129
    v_exp_f32 v130, v130
    v_mfma_f32_16x16x32_bf16 v[140:143], a[196:199], a[180:183], v[140:143]
    v_cvt_pk_bf16_f32 v16, v128, v129
    v_exp_f32 v131, v131
    v_mfma_f32_16x16x32_bf16 v[140:143], a[200:203], a[184:187], v[140:143]
    s_waitcnt lgkmcnt(0)
    v_cvt_pk_bf16_f32 v17, v130, v131
    v_exp_f32 v132, v132
    v_mfma_f32_16x16x32_bf16 v[140:143], a[204:207], a[188:191], v[140:143]
    v_exp_f32 v133, v133
    v_exp_f32 v134, v134
    v_mfma_f32_16x16x32_bf16 v[144:147], a[208:211], a[128:131], v[160:163]
    v_cvt_pk_bf16_f32 v20, v132, v133
    v_exp_f32 v135, v135
    v_mfma_f32_16x16x32_bf16 v[144:147], a[212:215], a[132:135], v[144:147]
    ds_read_b128 a[192:195], v204 offset:16384
    ds_read_b128 a[196:199], v205 offset:16384
    v_cvt_pk_bf16_f32 v21, v134, v135
    v_mfma_f32_16x16x32_bf16 v[144:147], a[216:219], a[136:139], v[144:147]
    v_exp_f32 v136, v136
    v_exp_f32 v137, v137
    v_mfma_f32_16x16x32_bf16 v[144:147], a[220:223], a[140:143], v[144:147]
    ds_read_b128 a[200:203], v206 offset:16384
    ds_read_b128 a[204:207], v207 offset:16384
    v_cvt_pk_bf16_f32 v24, v136, v137
    v_mfma_f32_16x16x32_bf16 v[148:151], a[208:211], a[144:147], v[164:167]
    v_exp_f32 v138, v138
    v_exp_f32 v139, v139
    v_mfma_f32_16x16x32_bf16 v[148:151], a[212:215], a[148:151], v[148:151]
    v_cvt_pk_bf16_f32 v25, v138, v139
    v_exp_f32 v140, v140
    v_mfma_f32_16x16x32_bf16 v[148:151], a[216:219], a[152:155], v[148:151]
    v_exp_f32 v141, v141
    v_exp_f32 v142, v142
    v_mfma_f32_16x16x32_bf16 v[148:151], a[220:223], a[156:159], v[148:151]
    v_cvt_pk_bf16_f32 v28, v140, v141
    v_exp_f32 v143, v143
    v_mfma_f32_16x16x32_bf16 v[152:155], a[208:211], a[160:163], v[168:171]
    v_cvt_pk_bf16_f32 v29, v142, v143
    v_exp_f32 v144, v144
    v_mfma_f32_16x16x32_bf16 v[152:155], a[212:215], a[164:167], v[152:155]
    v_exp_f32 v145, v145
    v_exp_f32 v146, v146
    v_mfma_f32_16x16x32_bf16 v[152:155], a[216:219], a[168:171], v[152:155]
    v_cvt_pk_bf16_f32 v18, v144, v145
    v_exp_f32 v147, v147
    v_mfma_f32_16x16x32_bf16 v[152:155], a[220:223], a[172:175], v[152:155]
    v_cvt_pk_bf16_f32 v19, v146, v147
    v_exp_f32 v148, v148
    v_mfma_f32_16x16x32_bf16 v[156:159], a[208:211], a[176:179], v[172:175]
    v_exp_f32 v149, v149
    v_exp_f32 v150, v150
    v_mfma_f32_16x16x32_bf16 v[156:159], a[212:215], a[180:183], v[156:159]
    v_cvt_pk_bf16_f32 v22, v148, v149
    v_exp_f32 v151, v151
    v_mfma_f32_16x16x32_bf16 v[156:159], a[216:219], a[184:187], v[156:159]
    s_waitcnt lgkmcnt(0)
    v_cvt_pk_bf16_f32 v23, v150, v151
    v_mfma_f32_16x16x32_bf16 v[156:159], a[220:223], a[188:191], v[156:159]
    v_exp_f32 v152, v152
    v_exp_f32 v153, v153
    v_mfma_f32_16x16x32_bf16 v[128:131], a[192:195], a[128:131], v[160:163]
    v_cvt_pk_bf16_f32 v26, v152, v153
    v_exp_f32 v154, v154
    v_mfma_f32_16x16x32_bf16 v[128:131], a[196:199], a[132:135], v[128:131]
    ds_read_b128 a[208:211], v204 offset:20480
    ds_read_b128 a[212:215], v205 offset:20480
    v_exp_f32 v155, v155
    v_mfma_f32_16x16x32_bf16 v[128:131], a[200:203], a[136:139], v[128:131]
    v_cvt_pk_bf16_f32 v27, v154, v155
    v_mfma_f32_16x16x32_bf16 v[128:131], a[204:207], a[140:143], v[128:131]
    ds_read_b128 a[216:219], v206 offset:20480
    ds_read_b128 a[220:223], v207 offset:20480
    v_exp_f32 v156, v156
    v_mfma_f32_16x16x32_bf16 v[132:135], a[192:195], a[144:147], v[164:167]
    v_exp_f32 v157, v157
    v_exp_f32 v158, v158
    v_mfma_f32_16x16x32_bf16 v[132:135], a[196:199], a[148:151], v[132:135]
    v_cvt_pk_bf16_f32 v30, v156, v157
    v_exp_f32 v159, v159
    v_mfma_f32_16x16x32_bf16 v[132:135], a[200:203], a[152:155], v[132:135]
    v_cvt_pk_bf16_f32 v31, v158, v159
    v_mfma_f32_16x16x32_bf16 v[132:135], a[204:207], a[156:159], v[132:135]
    v_exp_f32 v128, v128
    v_exp_f32 v129, v129
    v_mfma_f32_16x16x32_bf16 v[136:139], a[192:195], a[160:163], v[168:171]
    v_add_f32 v196, v196, v128
    v_add_f32 v197, v197, v129
    v_cvt_pk_bf16_f32 v32, v128, v129
    v_mfma_f32_16x16x32_bf16 v[136:139], a[196:199], a[164:167], v[136:139]
    v_exp_f32 v130, v130
    v_exp_f32 v131, v131
    v_mfma_f32_16x16x32_bf16 v[136:139], a[200:203], a[168:171], v[136:139]
    v_add_f32 v196, v196, v130
    v_add_f32 v197, v197, v131
    v_cvt_pk_bf16_f32 v33, v130, v131
    v_mfma_f32_16x16x32_bf16 v[136:139], a[204:207], a[172:175], v[136:139]
    v_exp_f32 v132, v132
    v_exp_f32 v133, v133
    v_mfma_f32_16x16x32_bf16 v[140:143], a[192:195], a[176:179], v[172:175]
    v_add_f32 v198, v198, v132
    v_add_f32 v199, v199, v133
    v_cvt_pk_bf16_f32 v36, v132, v133
    v_mfma_f32_16x16x32_bf16 v[140:143], a[196:199], a[180:183], v[140:143]
    v_exp_f32 v134, v134
    v_exp_f32 v135, v135
    v_mfma_f32_16x16x32_bf16 v[140:143], a[200:203], a[184:187], v[140:143]
    s_waitcnt lgkmcnt(0)
    v_add_f32 v198, v198, v134
    v_add_f32 v199, v199, v135
    v_cvt_pk_bf16_f32 v37, v134, v135
    v_mfma_f32_16x16x32_bf16 v[140:143], a[204:207], a[188:191], v[140:143]
    v_exp_f32 v136, v136
    v_exp_f32 v137, v137
    v_mfma_f32_16x16x32_bf16 v[144:147], a[208:211], a[128:131], v[160:163]
    v_add_f32 v200, v200, v136
    v_add_f32 v201, v201, v137
    v_cvt_pk_bf16_f32 v40, v136, v137
    v_mfma_f32_16x16x32_bf16 v[144:147], a[212:215], a[132:135], v[144:147]
    ds_read_b128 a[192:195], v204 offset:24576
    ds_read_b128 a[196:199], v205 offset:24576
    v_exp_f32 v138, v138
    v_mfma_f32_16x16x32_bf16 v[144:147], a[216:219], a[136:139], v[144:147]
    v_add_f32 v200, v200, v138
    v_exp_f32 v139, v139
    v_mfma_f32_16x16x32_bf16 v[144:147], a[220:223], a[140:143], v[144:147]
    ds_read_b128 a[200:203], v206 offset:24576
    ds_read_b128 a[204:207], v207 offset:24576
    v_add_f32 v201, v201, v139
    v_cvt_pk_bf16_f32 v41, v138, v139
    v_mfma_f32_16x16x32_bf16 v[148:151], a[208:211], a[144:147], v[164:167]
    v_exp_f32 v140, v140
    v_exp_f32 v141, v141
    v_mfma_f32_16x16x32_bf16 v[148:151], a[212:215], a[148:151], v[148:151]
    v_add_f32 v202, v202, v140
    v_add_f32 v203, v203, v141
    v_cvt_pk_bf16_f32 v44, v140, v141
    v_mfma_f32_16x16x32_bf16 v[148:151], a[216:219], a[152:155], v[148:151]
    v_exp_f32 v142, v142
    v_exp_f32 v143, v143
    v_mfma_f32_16x16x32_bf16 v[148:151], a[220:223], a[156:159], v[148:151]
    v_add_f32 v202, v202, v142
    v_add_f32 v203, v203, v143
    v_cvt_pk_bf16_f32 v45, v142, v143
    v_mfma_f32_16x16x32_bf16 v[152:155], a[208:211], a[160:163], v[168:171]
    v_exp_f32 v144, v144
    v_exp_f32 v145, v145
    v_mfma_f32_16x16x32_bf16 v[152:155], a[212:215], a[164:167], v[152:155]
    v_add_f32 v196, v196, v144
    v_add_f32 v197, v197, v145
    v_cvt_pk_bf16_f32 v34, v144, v145
    v_mfma_f32_16x16x32_bf16 v[152:155], a[216:219], a[168:171], v[152:155]
    v_exp_f32 v146, v146
    v_exp_f32 v147, v147
    v_mfma_f32_16x16x32_bf16 v[152:155], a[220:223], a[172:175], v[152:155]
    v_add_f32 v196, v196, v146
    v_add_f32 v197, v197, v147
    v_cvt_pk_bf16_f32 v35, v146, v147
    v_mfma_f32_16x16x32_bf16 v[156:159], a[208:211], a[176:179], v[172:175]
    v_exp_f32 v148, v148
    v_exp_f32 v149, v149
    v_mfma_f32_16x16x32_bf16 v[156:159], a[212:215], a[180:183], v[156:159]
    v_add_f32 v198, v198, v148
    v_add_f32 v199, v199, v149
    v_cvt_pk_bf16_f32 v38, v148, v149
    v_mfma_f32_16x16x32_bf16 v[156:159], a[216:219], a[184:187], v[156:159]
    s_waitcnt lgkmcnt(0)
    v_exp_f32 v150, v150
    v_exp_f32 v151, v151
    v_mfma_f32_16x16x32_bf16 v[156:159], a[220:223], a[188:191], v[156:159]
    v_add_f32 v198, v198, v150
    v_add_f32 v199, v199, v151
    v_cvt_pk_bf16_f32 v39, v150, v151
    v_mfma_f32_16x16x32_bf16 v[128:131], a[192:195], a[128:131], v[160:163]
    v_exp_f32 v152, v152
    v_exp_f32 v153, v153
    v_mfma_f32_16x16x32_bf16 v[128:131], a[196:199], a[132:135], v[128:131]
    ds_read_b128 a[208:211], v204 offset:28672
    ds_read_b128 a[212:215], v205 offset:28672
    v_add_f32 v200, v200, v152
    v_add_f32 v201, v201, v153
    v_mfma_f32_16x16x32_bf16 v[128:131], a[200:203], a[136:139], v[128:131]
    v_cvt_pk_bf16_f32 v42, v152, v153
    v_exp_f32 v154, v154
    v_mfma_f32_16x16x32_bf16 v[128:131], a[204:207], a[140:143], v[128:131]
    ds_read_b128 a[216:219], v206 offset:28672
    ds_read_b128 a[220:223], v207 offset:28672
    v_add_f32 v200, v200, v154
    v_mfma_f32_16x16x32_bf16 v[132:135], a[192:195], a[144:147], v[164:167]
    v_exp_f32 v155, v155
    v_exp_f32 v156, v156
    v_mfma_f32_16x16x32_bf16 v[132:135], a[196:199], a[148:151], v[132:135]
    v_add_f32 v201, v201, v155
    v_cvt_pk_bf16_f32 v43, v154, v155
    v_add_f32 v202, v202, v156
    v_mfma_f32_16x16x32_bf16 v[132:135], a[200:203], a[152:155], v[132:135]
    v_exp_f32 v157, v157
    v_exp_f32 v158, v158
    v_mfma_f32_16x16x32_bf16 v[132:135], a[204:207], a[156:159], v[132:135]
    v_add_f32 v203, v203, v157
    v_cvt_pk_bf16_f32 v46, v156, v157
    v_add_f32 v202, v202, v158
    v_mfma_f32_16x16x32_bf16 v[136:139], a[192:195], a[160:163], v[168:171]
    v_exp_f32 v159, v159
    v_exp_f32 v128, v128
    v_mfma_f32_16x16x32_bf16 v[136:139], a[196:199], a[164:167], v[136:139]
    v_add_f32 v203, v203, v159
    v_cvt_pk_bf16_f32 v47, v158, v159
    v_add_f32 v196, v196, v128
    v_mfma_f32_16x16x32_bf16 v[136:139], a[200:203], a[168:171], v[136:139]
    v_exp_f32 v129, v129
    v_exp_f32 v130, v130
    v_mfma_f32_16x16x32_bf16 v[136:139], a[204:207], a[172:175], v[136:139]
    v_add_f32 v197, v197, v129
    v_cvt_pk_bf16_f32 v48, v128, v129
    v_add_f32 v196, v196, v130
    v_mfma_f32_16x16x32_bf16 v[140:143], a[192:195], a[176:179], v[172:175]
    v_exp_f32 v131, v131
    v_exp_f32 v132, v132
    v_mfma_f32_16x16x32_bf16 v[140:143], a[196:199], a[180:183], v[140:143]
    v_add_f32 v197, v197, v131
    v_cvt_pk_bf16_f32 v49, v130, v131
    v_add_f32 v198, v198, v132
    v_mfma_f32_16x16x32_bf16 v[140:143], a[200:203], a[184:187], v[140:143]
    s_waitcnt vmcnt(0) lgkmcnt(0)
    v_exp_f32 v133, v133
    v_exp_f32 v134, v134
    v_mfma_f32_16x16x32_bf16 v[140:143], a[204:207], a[188:191], v[140:143]
    s_barrier
    v_add_f32 v199, v199, v133
    v_cvt_pk_bf16_f32 v52, v132, v133
    v_add_f32 v198, v198, v134
    v_mfma_f32_16x16x32_bf16 v[144:147], a[208:211], a[128:131], v[160:163]
    ds_read_b128 v[68:71], v66
    v_exp_f32 v135, v135
    v_mfma_f32_16x16x32_bf16 v[144:147], a[212:215], a[132:135], v[144:147]
    ds_read_b128 a[192:195], v204 offset:32768
    ds_read_b128 a[196:199], v205 offset:32768
    v_add_f32 v199, v199, v135
    v_cvt_pk_bf16_f32 v53, v134, v135
    v_mfma_f32_16x16x32_bf16 v[144:147], a[216:219], a[136:139], v[144:147]
    v_exp_f32 v136, v136
    v_exp_f32 v137, v137
    v_mfma_f32_16x16x32_bf16 v[144:147], a[220:223], a[140:143], v[144:147]
    ds_read_b128 a[200:203], v206 offset:32768
    ds_read_b128 a[204:207], v207 offset:32768
    v_add_f32 v200, v200, v136
    v_add_f32 v201, v201, v137
    v_mfma_f32_16x16x32_bf16 v[148:151], a[208:211], a[144:147], v[164:167]
    v_cvt_pk_bf16_f32 v56, v136, v137
    v_exp_f32 v138, v138
    v_mfma_f32_16x16x32_bf16 v[148:151], a[212:215], a[148:151], v[148:151]
    ds_read_b64_tr_b16 a[224:225], v208 offset:0
    ds_read_b64_tr_b16 a[226:227], v208 offset:4096
    v_add_f32 v200, v200, v138
    v_mfma_f32_16x16x32_bf16 v[148:151], a[216:219], a[152:155], v[148:151]
    v_exp_f32 v139, v139
    v_exp_f32 v140, v140
    v_mfma_f32_16x16x32_bf16 v[148:151], a[220:223], a[156:159], v[148:151]
    ds_read_b64_tr_b16 a[228:229], v208 offset:8192
    ds_read_b64_tr_b16 a[230:231], v208 offset:12288
    v_add_f32 v201, v201, v139
    v_cvt_pk_bf16_f32 v57, v138, v139
    v_mfma_f32_16x16x32_bf16 v[152:155], a[208:211], a[160:163], v[168:171]
    v_add_f32 v202, v202, v140
    v_exp_f32 v141, v141
    v_mfma_f32_16x16x32_bf16 v[152:155], a[212:215], a[164:167], v[152:155]
    s_waitcnt lgkmcnt(8)
    v_max3_u32 v72, v68, v69, v70
    v_max_u32 v72, v72, v71
    v_add_f32 v203, v203, v141
    v_cvt_pk_bf16_f32 v60, v140, v141
    v_mfma_f32_16x16x32_bf16 v[152:155], a[216:219], a[168:171], v[152:155]
    s_mov_b64 exec, s[84:85]
    buffer_store_dwordx2 v[72:73], off, s[48:51], s43 sc1
    s_mov_b64 exec, -1
    v_exp_f32 v142, v142
    v_mfma_f32_16x16x32_bf16 v[152:155], a[220:223], a[172:175], v[152:155]
    v_add_f32 v202, v202, v142
    v_exp_f32 v143, v143
    v_mfma_f32_16x16x32_bf16 v[156:159], a[208:211], a[176:179], v[172:175]
    v_add_f32 v203, v203, v143
    v_cvt_pk_bf16_f32 v61, v142, v143
    v_exp_f32 v144, v144
    v_mfma_f32_16x16x32_bf16 v[156:159], a[212:215], a[180:183], v[156:159]
    v_add_f32 v196, v196, v144
    v_exp_f32 v145, v145
    v_mfma_f32_16x16x32_bf16 v[156:159], a[216:219], a[184:187], v[156:159]
    v_add_f32 v197, v197, v145
    v_cvt_pk_bf16_f32 v50, v144, v145
    v_exp_f32 v146, v146
    v_mfma_f32_16x16x32_bf16 v[156:159], a[220:223], a[188:191], v[156:159]
    v_add_f32 v196, v196, v146
    v_exp_f32 v147, v147
    s_nop 4
    v_exp_f32 v148, v148
    v_exp_f32 v149, v149
    v_exp_f32 v150, v150
    v_exp_f32 v151, v151
    v_exp_f32 v152, v152
    v_exp_f32 v153, v153
    v_exp_f32 v154, v154
    v_exp_f32 v155, v155
    s_nop 0
    v_add_f32 v197, v197, v147
    v_cvt_pk_bf16_f32 v51, v146, v147
    v_add_f32 v198, v198, v148
    v_add_f32 v199, v199, v149
    v_cvt_pk_bf16_f32 v54, v148, v149
    v_add_f32 v198, v198, v150
    v_add_f32 v199, v199, v151
    v_cvt_pk_bf16_f32 v55, v150, v151
    v_add_f32 v200, v200, v152
    v_add_f32 v201, v201, v153
    s_waitcnt lgkmcnt(4)
F_LOOP:
    v_mfma_f32_16x16x32_bf16 v[128:131], a[192:195], a[128:131], v[160:163]
    v_exp_f32 v156, v156
    v_mfma_f32_16x16x32_bf16 v[128:131], a[196:199], a[132:135], v[128:131]
    ds_read_b64_tr_b16 a[232:233], v208 offset:16384
    ds_read_b64_tr_b16 a[234:235], v208 offset:20480
    v_mfma_f32_16x16x32_bf16 v[128:131], a[200:203], a[136:139], v[128:131]
    v_exp_f32 v157, v157
    v_mfma_f32_16x16x32_bf16 v[128:131], a[204:207], a[140:143], v[128:131]
    ds_read_b64_tr_b16 a[236:237], v208 offset:24576
    ds_read_b64_tr_b16 a[238:239], v208 offset:28672
    v_mfma_f32_16x16x32_bf16 v[132:135], a[204:207], a[156:159], v[164:167]
    s_add_u32 m0, s30, 0
    v_exp_f32 v158, v158
    v_mfma_f32_16x16x32_bf16 v[132:135], a[200:203], a[152:155], v[132:135]
    buffer_load_dwordx4 v216, s[8:11], s31 offen offset:0 lds
    v_mfma_f32_16x16x32_bf16 v[132:135], a[196:199], a[148:151], v[132:135]
    v_exp_f32 v159, v159
    v_mfma_f32_16x16x32_bf16 v[132:135], a[192:195], a[144:147], v[132:135]
    v_cvt_pk_bf16_f32 v58, v152, v153
    v_add_f32 v200, v200, v154
    v_mfma_f32_16x16x32_bf16 v[136:139], a[192:195], a[160:163], v[168:171]
    v_exp_f32 v128, v128
    v_mfma_f32_16x16x32_bf16 v[136:139], a[196:199], a[164:167], v[136:139]
    buffer_load_dwordx4 v217, s[8:11], s31 offen offset:1024 lds
    v_mfma_f32_16x16x32_bf16 v[136:139], a[200:203], a[168:171], v[136:139]
    v_exp_f32 v129, v129
    v_mfma_f32_16x16x32_bf16 v[136:139], a[204:207], a[172:175], v[136:139]
    v_add_f32 v201, v201, v155
    v_cvt_pk_bf16_f32 v59, v154, v155
    v_mfma_f32_16x16x32_bf16 v[140:143], a[204:207], a[188:191], v[172:175]
    v_exp_f32 v130, v130
    v_mfma_f32_16x16x32_bf16 v[140:143], a[200:203], a[184:187], v[140:143]
    v_add_f32 v202, v202, v156
    v_add_f32 v203, v203, v157
    v_mfma_f32_16x16x32_bf16 v[140:143], a[196:199], a[180:183], v[140:143]
    s_waitcnt lgkmcnt(0)
    v_exp_f32 v131, v131
    v_mfma_f32_16x16x32_bf16 v[140:143], a[192:195], a[176:179], v[140:143]
    v_cvt_pk_bf16_f32 v62, v156, v157
    v_add_f32 v202, v202, v158
    v_mfma_f32_16x16x32_bf16 a[0:3], a[236:239], v[48:51], a[0:3]
    v_exp_f32 v132, v132
    v_mfma_f32_16x16x32_bf16 a[0:3], a[232:235], v[32:35], a[0:3]
    ds_read_b128 a[208:211], v204 offset:36864
    ds_read_b128 a[212:215], v205 offset:36864
    v_mfma_f32_16x16x32_bf16 a[0:3], a[228:231], v[16:19], a[0:3]
    v_exp_f32 v133, v133
    v_mfma_f32_16x16x32_bf16 a[0:3], a[224:227], v[0:3], a[0:3]
    ds_read_b128 a[216:219], v206 offset:36864
    ds_read_b128 a[220:223], v207 offset:36864
    v_mfma_f32_16x16x32_bf16 a[4:7], a[224:227], v[4:7], a[4:7]
    v_exp_f32 v134, v134
    v_mfma_f32_16x16x32_bf16 a[4:7], a[228:231], v[20:23], a[4:7]
    ds_read_b64_tr_b16 a[240:241], v209 offset:0
    ds_read_b64_tr_b16 a[242:243], v209 offset:4096
    v_mfma_f32_16x16x32_bf16 a[4:7], a[232:235], v[36:39], a[4:7]
    v_exp_f32 v135, v135
    v_mfma_f32_16x16x32_bf16 a[4:7], a[236:239], v[52:55], a[4:7]
    ds_read_b64_tr_b16 a[244:245], v209 offset:8192
    ds_read_b64_tr_b16 a[246:247], v209 offset:12288
    v_mfma_f32_16x16x32_bf16 a[8:11], a[236:239], v[56:59], a[8:11]
    v_exp_f32 v136, v136
    v_mfma_f32_16x16x32_bf16 a[8:11], a[232:235], v[40:43], a[8:11]
    buffer_load_dwordx4 v218, s[8:11], s31 offen offset:2048 lds
    v_mfma_f32_16x16x32_bf16 a[8:11], a[228:231], v[24:27], a[8:11]
    v_exp_f32 v137, v137
    v_mfma_f32_16x16x32_bf16 a[8:11], a[224:227], v[8:11], a[8:11]
    v_add_f32 v203, v203, v159
    v_cvt_pk_bf16_f32 v63, v158, v159
    v_mfma_f32_16x16x32_bf16 a[12:15], a[224:227], v[12:15], a[12:15]
    v_exp_f32 v138, v138
    v_mfma_f32_16x16x32_bf16 a[12:15], a[228:231], v[28:31], a[12:15]
    buffer_load_dwordx4 v219, s[8:11], s31 offen offset:3072 lds
    v_mfma_f32_16x16x32_bf16 a[12:15], a[232:235], v[44:47], a[12:15]
    s_waitcnt lgkmcnt(4)
    v_exp_f32 v139, v139
    v_mfma_f32_16x16x32_bf16 a[12:15], a[236:239], v[60:63], a[12:15]
    v_cvt_pk_bf16_f32 v64, v128, v129
    v_cvt_pk_bf16_f32 v65, v130, v131
    v_mfma_f32_16x16x32_bf16 v[144:147], a[208:211], a[128:131], v[160:163]
    v_exp_f32 v140, v140
    v_mfma_f32_16x16x32_bf16 v[144:147], a[212:215], a[132:135], v[144:147]
    ds_read_b64_tr_b16 a[248:249], v209 offset:16384
    ds_read_b64_tr_b16 a[250:251], v209 offset:20480
    v_mfma_f32_16x16x32_bf16 v[144:147], a[216:219], a[136:139], v[144:147]
    v_exp_f32 v141, v141
    v_mfma_f32_16x16x32_bf16 v[144:147], a[220:223], a[140:143], v[144:147]
    ds_read_b64_tr_b16 a[252:253], v209 offset:24576
    ds_read_b64_tr_b16 a[254:255], v209 offset:28672
    v_mfma_f32_16x16x32_bf16 v[148:151], a[220:223], a[156:159], v[164:167]
    s_add_u32 m0, s30, 4096
    v_exp_f32 v142, v142
    v_mfma_f32_16x16x32_bf16 v[148:151], a[216:219], a[152:155], v[148:151]
    buffer_load_dwordx4 v216, s[8:11], s32 offen offset:0 lds
    v_mfma_f32_16x16x32_bf16 v[148:151], a[212:215], a[148:151], v[148:151]
    v_exp_f32 v143, v143
    v_mfma_f32_16x16x32_bf16 v[148:151], a[208:211], a[144:147], v[148:151]
    v_cvt_pk_bf16_f32 v68, v132, v133
    v_cvt_pk_bf16_f32 v69, v134, v135
    v_mfma_f32_16x16x32_bf16 v[152:155], a[208:211], a[160:163], v[168:171]
    v_exp_f32 v144, v144
    v_mfma_f32_16x16x32_bf16 v[152:155], a[212:215], a[164:167], v[152:155]
    buffer_load_dwordx4 v217, s[8:11], s32 offen offset:1024 lds
    v_mfma_f32_16x16x32_bf16 v[152:155], a[216:219], a[168:171], v[152:155]
    v_exp_f32 v145, v145
    v_mfma_f32_16x16x32_bf16 v[152:155], a[220:223], a[172:175], v[152:155]
    v_cvt_pk_bf16_f32 v72, v136, v137
    v_cvt_pk_bf16_f32 v73, v138, v139
    v_mfma_f32_16x16x32_bf16 v[156:159], a[220:223], a[188:191], v[172:175]
    v_exp_f32 v146, v146
    v_mfma_f32_16x16x32_bf16 v[156:159], a[216:219], a[184:187], v[156:159]
    v_cvt_pk_bf16_f32 v76, v140, v141
    v_cvt_pk_bf16_f32 v77, v142, v143
    v_mfma_f32_16x16x32_bf16 v[156:159], a[212:215], a[180:183], v[156:159]
    s_waitcnt lgkmcnt(0)
    v_exp_f32 v147, v147
    v_mfma_f32_16x16x32_bf16 v[156:159], a[208:211], a[176:179], v[156:159]
    v_cvt_pk_bf16_f32 v66, v144, v145
    v_cvt_pk_bf16_f32 v67, v146, v147
    v_mfma_f32_16x16x32_bf16 a[16:19], a[252:255], v[48:51], a[16:19]
    v_exp_f32 v148, v148
    v_mfma_f32_16x16x32_bf16 a[16:19], a[248:251], v[32:35], a[16:19]
    ds_read_b128 a[192:195], v204 offset:40960
    ds_read_b128 a[196:199], v205 offset:40960
    v_mfma_f32_16x16x32_bf16 a[16:19], a[244:247], v[16:19], a[16:19]
    v_exp_f32 v149, v149
    v_mfma_f32_16x16x32_bf16 a[16:19], a[240:243], v[0:3], a[16:19]
    ds_read_b128 a[200:203], v206 offset:40960
    ds_read_b128 a[204:207], v207 offset:40960
    v_mfma_f32_16x16x32_bf16 a[20:23], a[240:243], v[4:7], a[20:23]
    v_exp_f32 v150, v150
    v_mfma_f32_16x16x32_bf16 a[20:23], a[244:247], v[20:23], a[20:23]
    ds_read_b64_tr_b16 a[224:225], v210 offset:0
    ds_read_b64_tr_b16 a[226:227], v210 offset:4096
    v_mfma_f32_16x16x32_bf16 a[20:23], a[248:251], v[36:39], a[20:23]
    v_exp_f32 v151, v151
    v_mfma_f32_16x16x32_bf16 a[20:23], a[252:255], v[52:55], a[20:23]
    ds_read_b64_tr_b16 a[228:229], v210 offset:8192
    ds_read_b64_tr_b16 a[230:231], v210 offset:12288
    v_mfma_f32_16x16x32_bf16 a[24:27], a[252:255], v[56:59], a[24:27]
    v_exp_f32 v152, v152
    v_mfma_f32_16x16x32_bf16 a[24:27], a[248:251], v[40:43], a[24:27]
    buffer_load_dwordx4 v218, s[8:11], s32 offen offset:2048 lds
    v_mfma_f32_16x16x32_bf16 a[24:27], a[244:247], v[24:27], a[24:27]
    v_exp_f32 v153, v153
    v_mfma_f32_16x16x32_bf16 a[24:27], a[240:243], v[8:11], a[24:27]
    v_cvt_pk_bf16_f32 v70, v148, v149
    v_cvt_pk_bf16_f32 v71, v150, v151
    v_mfma_f32_16x16x32_bf16 a[28:31], a[240:243], v[12:15], a[28:31]
    v_exp_f32 v154, v154
    v_mfma_f32_16x16x32_bf16 a[28:31], a[244:247], v[28:31], a[28:31]
    buffer_load_dwordx4 v219, s[8:11], s32 offen offset:3072 lds
    v_mfma_f32_16x16x32_bf16 a[28:31], a[248:251], v[44:47], a[28:31]
    s_add_u32 s31, s31, 32768
    s_waitcnt lgkmcnt(4)
    v_exp_f32 v155, v155
    v_mfma_f32_16x16x32_bf16 a[28:31], a[252:255], v[60:63], a[28:31]
    v_cvt_pk_bf16_f32 v74, v152, v153
    v_cvt_pk_bf16_f32 v75, v154, v155
    v_mfma_f32_16x16x32_bf16 v[128:131], a[192:195], a[128:131], v[160:163]
    s_add_u32 s32, s32, 32768
    v_exp_f32 v156, v156
    v_mfma_f32_16x16x32_bf16 v[128:131], a[196:199], a[132:135], v[128:131]
    ds_read_b64_tr_b16 a[232:233], v210 offset:16384
    ds_read_b64_tr_b16 a[234:235], v210 offset:20480
    v_mfma_f32_16x16x32_bf16 v[128:131], a[200:203], a[136:139], v[128:131]
    v_exp_f32 v157, v157
    v_mfma_f32_16x16x32_bf16 v[128:131], a[204:207], a[140:143], v[128:131]
    ds_read_b64_tr_b16 a[236:237], v210 offset:24576
    ds_read_b64_tr_b16 a[238:239], v210 offset:28672
    v_mfma_f32_16x16x32_bf16 v[132:135], a[204:207], a[156:159], v[164:167]
    s_add_u32 m0, s30, 98304
    v_exp_f32 v158, v158
    v_mfma_f32_16x16x32_bf16 v[132:135], a[200:203], a[152:155], v[132:135]
    buffer_load_dwordx4 v220, s[12:15], s33 offen offset:0 lds
    v_mfma_f32_16x16x32_bf16 v[132:135], a[196:199], a[148:151], v[132:135]
    v_exp_f32 v159, v159
    v_mfma_f32_16x16x32_bf16 v[132:135], a[192:195], a[144:147], v[132:135]
    v_cvt_pk_bf16_f32 v78, v156, v157
    v_cvt_pk_bf16_f32 v79, v158, v159
    v_mfma_f32_16x16x32_bf16 v[136:139], a[192:195], a[160:163], v[168:171]
    v_exp_f32 v128, v128
    v_mfma_f32_16x16x32_bf16 v[136:139], a[196:199], a[164:167], v[136:139]
    buffer_load_dwordx4 v221, s[12:15], s33 offen offset:1024 lds
    v_mfma_f32_16x16x32_bf16 v[136:139], a[200:203], a[168:171], v[136:139]
    v_exp_f32 v129, v129
    v_mfma_f32_16x16x32_bf16 v[136:139], a[204:207], a[172:175], v[136:139]
    v_cvt_pk_bf16_f32 v80, v128, v129
    v_mfma_f32_16x16x32_bf16 v[140:143], a[204:207], a[188:191], v[172:175]
    v_exp_f32 v130, v130
    v_mfma_f32_16x16x32_bf16 v[140:143], a[200:203], a[184:187], v[140:143]
    v_mfma_f32_16x16x32_bf16 v[140:143], a[196:199], a[180:183], v[140:143]
    s_waitcnt lgkmcnt(0)
    v_exp_f32 v131, v131
    v_mfma_f32_16x16x32_bf16 v[140:143], a[192:195], a[176:179], v[140:143]
    v_cvt_pk_bf16_f32 v81, v130, v131
    v_mfma_f32_16x16x32_bf16 a[32:35], a[236:239], v[48:51], a[32:35]
    v_exp_f32 v132, v132
    v_mfma_f32_16x16x32_bf16 a[32:35], a[232:235], v[32:35], a[32:35]
    ds_read_b128 a[208:211], v204 offset:45056
    ds_read_b128 a[212:215], v205 offset:45056
    v_mfma_f32_16x16x32_bf16 a[32:35], a[228:231], v[16:19], a[32:35]
    v_exp_f32 v133, v133
    v_mfma_f32_16x16x32_bf16 a[32:35], a[224:227], v[0:3], a[32:35]
    ds_read_b128 a[216:219], v206 offset:45056
    ds_read_b128 a[220:223], v207 offset:45056
    v_mfma_f32_16x16x32_bf16 a[36:39], a[224:227], v[4:7], a[36:39]
    v_exp_f32 v134, v134
    v_mfma_f32_16x16x32_bf16 a[36:39], a[228:231], v[20:23], a[36:39]
    ds_read_b64_tr_b16 a[240:241], v211 offset:0
    ds_read_b64_tr_b16 a[242:243], v211 offset:4096
    v_mfma_f32_16x16x32_bf16 a[36:39], a[232:235], v[36:39], a[36:39]
    v_exp_f32 v135, v135
    v_mfma_f32_16x16x32_bf16 a[36:39], a[236:239], v[52:55], a[36:39]
    ds_read_b64_tr_b16 a[244:245], v211 offset:8192
    ds_read_b64_tr_b16 a[246:247], v211 offset:12288
    v_mfma_f32_16x16x32_bf16 a[40:43], a[236:239], v[56:59], a[40:43]
    v_exp_f32 v136, v136
    v_mfma_f32_16x16x32_bf16 a[40:43], a[232:235], v[40:43], a[40:43]
    buffer_load_dwordx4 v220, s[12:15], s33 offen offset:2048 lds
    v_mfma_f32_16x16x32_bf16 a[40:43], a[228:231], v[24:27], a[40:43]
    v_exp_f32 v137, v137
    v_mfma_f32_16x16x32_bf16 a[40:43], a[224:227], v[8:11], a[40:43]
    v_cvt_pk_bf16_f32 v84, v132, v133
    v_cvt_pk_bf16_f32 v85, v134, v135
    v_mfma_f32_16x16x32_bf16 a[44:47], a[224:227], v[12:15], a[44:47]
    v_exp_f32 v138, v138
    v_mfma_f32_16x16x32_bf16 a[44:47], a[228:231], v[28:31], a[44:47]
    buffer_load_dwordx4 v221, s[12:15], s33 offen offset:3072 lds
    v_mfma_f32_16x16x32_bf16 a[44:47], a[232:235], v[44:47], a[44:47]
    s_waitcnt lgkmcnt(4)
    v_exp_f32 v139, v139
    v_mfma_f32_16x16x32_bf16 a[44:47], a[236:239], v[60:63], a[44:47]
    v_cvt_pk_bf16_f32 v88, v136, v137
    v_cvt_pk_bf16_f32 v89, v138, v139
    v_mfma_f32_16x16x32_bf16 v[144:147], a[208:211], a[128:131], v[160:163]
    v_exp_f32 v140, v140
    v_mfma_f32_16x16x32_bf16 v[144:147], a[212:215], a[132:135], v[144:147]
    ds_read_b64_tr_b16 a[248:249], v211 offset:16384
    ds_read_b64_tr_b16 a[250:251], v211 offset:20480
    v_mfma_f32_16x16x32_bf16 v[144:147], a[216:219], a[136:139], v[144:147]
    v_exp_f32 v141, v141
    v_mfma_f32_16x16x32_bf16 v[144:147], a[220:223], a[140:143], v[144:147]
    ds_read_b64_tr_b16 a[252:253], v211 offset:24576
    ds_read_b64_tr_b16 a[254:255], v211 offset:28672
    v_mfma_f32_16x16x32_bf16 v[148:151], a[220:223], a[156:159], v[164:167]
    s_add_u32 m0, s30, 102400
    v_exp_f32 v142, v142
    v_mfma_f32_16x16x32_bf16 v[148:151], a[216:219], a[152:155], v[148:151]
    buffer_load_dwordx4 v220, s[12:15], s34 offen offset:0 lds
    v_mfma_f32_16x16x32_bf16 v[148:151], a[212:215], a[148:151], v[148:151]
    v_exp_f32 v143, v143
    v_mfma_f32_16x16x32_bf16 v[148:151], a[208:211], a[144:147], v[148:151]
    v_cvt_pk_bf16_f32 v92, v140, v141
    v_cvt_pk_bf16_f32 v93, v142, v143
    v_mfma_f32_16x16x32_bf16 v[152:155], a[208:211], a[160:163], v[168:171]
    v_exp_f32 v144, v144
    v_mfma_f32_16x16x32_bf16 v[152:155], a[212:215], a[164:167], v[152:155]
    buffer_load_dwordx4 v221, s[12:15], s34 offen offset:1024 lds
    v_mfma_f32_16x16x32_bf16 v[152:155], a[216:219], a[168:171], v[152:155]
    v_exp_f32 v145, v145
    v_mfma_f32_16x16x32_bf16 v[152:155], a[220:223], a[172:175], v[152:155]
    v_cvt_pk_bf16_f32 v82, v144, v145
    v_mfma_f32_16x16x32_bf16 v[156:159], a[220:223], a[188:191], v[172:175]
    v_exp_f32 v146, v146
    v_mfma_f32_16x16x32_bf16 v[156:159], a[216:219], a[184:187], v[156:159]
    v_mfma_f32_16x16x32_bf16 v[156:159], a[212:215], a[180:183], v[156:159]
    s_waitcnt lgkmcnt(0)
    v_exp_f32 v147, v147
    v_mfma_f32_16x16x32_bf16 v[156:159], a[208:211], a[176:179], v[156:159]
    v_cvt_pk_bf16_f32 v83, v146, v147
    v_mfma_f32_16x16x32_bf16 a[48:51], a[252:255], v[48:51], a[48:51]
    v_exp_f32 v148, v148
    v_mfma_f32_16x16x32_bf16 a[48:51], a[248:251], v[32:35], a[48:51]
    ds_read_b128 a[192:195], v204 offset:49152
    ds_read_b128 a[196:199], v205 offset:49152
    v_mfma_f32_16x16x32_bf16 a[48:51], a[244:247], v[16:19], a[48:51]
    v_exp_f32 v149, v149
    v_mfma_f32_16x16x32_bf16 a[48:51], a[240:243], v[0:3], a[48:51]
    ds_read_b128 a[200:203], v206 offset:49152
    ds_read_b128 a[204:207], v207 offset:49152
    v_mfma_f32_16x16x32_bf16 a[52:55], a[240:243], v[4:7], a[52:55]
    v_exp_f32 v150, v150
    v_mfma_f32_16x16x32_bf16 a[52:55], a[244:247], v[20:23], a[52:55]
    ds_read_b64_tr_b16 a[224:225], v212 offset:0
    ds_read_b64_tr_b16 a[226:227], v212 offset:4096
    v_mfma_f32_16x16x32_bf16 a[52:55], a[248:251], v[36:39], a[52:55]
    v_exp_f32 v151, v151
    v_mfma_f32_16x16x32_bf16 a[52:55], a[252:255], v[52:55], a[52:55]
    ds_read_b64_tr_b16 a[228:229], v212 offset:8192
    ds_read_b64_tr_b16 a[230:231], v212 offset:12288
    v_mfma_f32_16x16x32_bf16 a[56:59], a[252:255], v[56:59], a[56:59]
    v_exp_f32 v152, v152
    v_mfma_f32_16x16x32_bf16 a[56:59], a[248:251], v[40:43], a[56:59]
    buffer_load_dwordx4 v220, s[12:15], s34 offen offset:2048 lds
    v_mfma_f32_16x16x32_bf16 a[56:59], a[244:247], v[24:27], a[56:59]
    v_exp_f32 v153, v153
    v_mfma_f32_16x16x32_bf16 a[56:59], a[240:243], v[8:11], a[56:59]
    v_cvt_pk_bf16_f32 v86, v148, v149
    v_cvt_pk_bf16_f32 v87, v150, v151
    v_mfma_f32_16x16x32_bf16 a[60:63], a[240:243], v[12:15], a[60:63]
    v_exp_f32 v154, v154
    v_mfma_f32_16x16x32_bf16 a[60:63], a[244:247], v[28:31], a[60:63]
    buffer_load_dwordx4 v221, s[12:15], s34 offen offset:3072 lds
    v_mfma_f32_16x16x32_bf16 a[60:63], a[248:251], v[44:47], a[60:63]
    s_add_u32 s33, s33, 32768
    s_waitcnt lgkmcnt(4)
    v_exp_f32 v155, v155
    v_mfma_f32_16x16x32_bf16 a[60:63], a[252:255], v[60:63], a[60:63]
    v_cvt_pk_bf16_f32 v90, v152, v153
    v_cvt_pk_bf16_f32 v91, v154, v155
    v_mfma_f32_16x16x32_bf16 v[176:179], v[192:195], v[0:3], v[176:179]
    s_add_u32 s34, s34, 32768
    v_mfma_f32_16x16x32_bf16 v[176:179], v[192:195], v[16:19], v[176:179]
    v_mfma_f32_16x16x32_bf16 v[128:131], a[192:195], a[128:131], v[160:163]
    v_exp_f32 v156, v156
    v_mfma_f32_16x16x32_bf16 v[128:131], a[196:199], a[132:135], v[128:131]
    ds_read_b64_tr_b16 a[232:233], v212 offset:16384
    ds_read_b64_tr_b16 a[234:235], v212 offset:20480
    v_mfma_f32_16x16x32_bf16 v[128:131], a[200:203], a[136:139], v[128:131]
    v_exp_f32 v157, v157
    v_mfma_f32_16x16x32_bf16 v[128:131], a[204:207], a[140:143], v[128:131]
    ds_read_b64_tr_b16 a[236:237], v212 offset:24576
    ds_read_b64_tr_b16 a[238:239], v212 offset:28672
    v_mfma_f32_16x16x32_bf16 v[132:135], a[204:207], a[156:159], v[164:167]
    v_exp_f32 v158, v158
    v_mfma_f32_16x16x32_bf16 v[132:135], a[200:203], a[152:155], v[132:135]
    v_cvt_pk_bf16_f32 v94, v156, v157
    v_mfma_f32_16x16x32_bf16 v[132:135], a[196:199], a[148:151], v[132:135]
    v_exp_f32 v159, v159
    v_mfma_f32_16x16x32_bf16 v[132:135], a[192:195], a[144:147], v[132:135]
    v_cvt_pk_bf16_f32 v95, v158, v159
    v_mfma_f32_16x16x32_bf16 v[136:139], a[192:195], a[160:163], v[168:171]
    v_exp_f32 v128, v128
    v_mfma_f32_16x16x32_bf16 v[136:139], a[196:199], a[164:167], v[136:139]
    v_add_f32 v196, v196, v128
    v_mfma_f32_16x16x32_bf16 v[136:139], a[200:203], a[168:171], v[136:139]
    v_exp_f32 v129, v129
    v_mfma_f32_16x16x32_bf16 v[136:139], a[204:207], a[172:175], v[136:139]
    v_add_f32 v197, v197, v129
    v_cvt_pk_bf16_f32 v96, v128, v129
    v_mfma_f32_16x16x32_bf16 v[140:143], a[204:207], a[188:191], v[172:175]
    v_exp_f32 v130, v130
    v_mfma_f32_16x16x32_bf16 v[140:143], a[200:203], a[184:187], v[140:143]
    v_add_f32 v196, v196, v130
    v_mfma_f32_16x16x32_bf16 v[140:143], a[196:199], a[180:183], v[140:143]
    s_waitcnt lgkmcnt(0)
    v_exp_f32 v131, v131
    v_mfma_f32_16x16x32_bf16 v[140:143], a[192:195], a[176:179], v[140:143]
    v_add_f32 v197, v197, v131
    v_cvt_pk_bf16_f32 v97, v130, v131
    v_mfma_f32_16x16x32_bf16 a[64:67], a[236:239], v[48:51], a[64:67]
    v_exp_f32 v132, v132
    v_mfma_f32_16x16x32_bf16 a[64:67], a[232:235], v[32:35], a[64:67]
    ds_read_b128 a[208:211], v204 offset:53248
    ds_read_b128 a[212:215], v205 offset:53248
    v_mfma_f32_16x16x32_bf16 a[64:67], a[228:231], v[16:19], a[64:67]
    v_exp_f32 v133, v133
    v_mfma_f32_16x16x32_bf16 a[64:67], a[224:227], v[0:3], a[64:67]
    ds_read_b128 a[216:219], v206 offset:53248
    ds_read_b128 a[220:223], v207 offset:53248
    v_mfma_f32_16x16x32_bf16 a[68:71], a[224:227], v[4:7], a[68:71]
    v_exp_f32 v134, v134
    v_mfma_f32_16x16x32_bf16 a[68:71], a[228:231], v[20:23], a[68:71]
    ds_read_b64_tr_b16 a[240:241], v213 offset:0
    ds_read_b64_tr_b16 a[242:243], v213 offset:4096
    v_mfma_f32_16x16x32_bf16 a[68:71], a[232:235], v[36:39], a[68:71]
    v_exp_f32 v135, v135
    v_mfma_f32_16x16x32_bf16 a[68:71], a[236:239], v[52:55], a[68:71]
    ds_read_b64_tr_b16 a[244:245], v213 offset:8192
    ds_read_b64_tr_b16 a[246:247], v213 offset:12288
    v_mfma_f32_16x16x32_bf16 a[72:75], a[236:239], v[56:59], a[72:75]
    v_exp_f32 v136, v136
    v_mfma_f32_16x16x32_bf16 a[72:75], a[232:235], v[40:43], a[72:75]
    v_add_f32 v198, v198, v132
    v_add_f32 v199, v199, v133
    v_mfma_f32_16x16x32_bf16 a[72:75], a[228:231], v[24:27], a[72:75]
    v_exp_f32 v137, v137
    v_mfma_f32_16x16x32_bf16 a[72:75], a[224:227], v[8:11], a[72:75]
    v_cvt_pk_bf16_f32 v100, v132, v133
    v_add_f32 v198, v198, v134
    v_mfma_f32_16x16x32_bf16 a[76:79], a[224:227], v[12:15], a[76:79]
    v_exp_f32 v138, v138
    v_mfma_f32_16x16x32_bf16 a[76:79], a[228:231], v[28:31], a[76:79]
    v_add_f32 v199, v199, v135
    v_cvt_pk_bf16_f32 v101, v134, v135
    v_mfma_f32_16x16x32_bf16 a[76:79], a[232:235], v[44:47], a[76:79]
    s_waitcnt lgkmcnt(4)
    v_exp_f32 v139, v139
    v_mfma_f32_16x16x32_bf16 a[76:79], a[236:239], v[60:63], a[76:79]
    v_add_f32 v200, v200, v136
    v_add_f32 v201, v201, v137
    v_mfma_f32_16x16x32_bf16 v[180:183], v[192:195], v[4:7], v[180:183]
    v_cvt_pk_bf16_f32 v104, v136, v137
    v_add_f32 v200, v200, v138
    v_mfma_f32_16x16x32_bf16 v[180:183], v[192:195], v[20:23], v[180:183]
    v_add_f32 v201, v201, v139
    v_cvt_pk_bf16_f32 v105, v138, v139
    v_mfma_f32_16x16x32_bf16 v[144:147], a[208:211], a[128:131], v[160:163]
    v_exp_f32 v140, v140
    v_mfma_f32_16x16x32_bf16 v[144:147], a[212:215], a[132:135], v[144:147]
    ds_read_b64_tr_b16 a[248:249], v213 offset:16384
    ds_read_b64_tr_b16 a[250:251], v213 offset:20480
    v_mfma_f32_16x16x32_bf16 v[144:147], a[216:219], a[136:139], v[144:147]
    v_exp_f32 v141, v141
    v_mfma_f32_16x16x32_bf16 v[144:147], a[220:223], a[140:143], v[144:147]
    ds_read_b64_tr_b16 a[252:253], v213 offset:24576
    ds_read_b64_tr_b16 a[254:255], v213 offset:28672
    v_mfma_f32_16x16x32_bf16 v[148:151], a[220:223], a[156:159], v[164:167]
    v_exp_f32 v142, v142
    v_mfma_f32_16x16x32_bf16 v[148:151], a[216:219], a[152:155], v[148:151]
    v_add_f32 v202, v202, v140
    v_add_f32 v203, v203, v141
    v_mfma_f32_16x16x32_bf16 v[148:151], a[212:215], a[148:151], v[148:151]
    v_exp_f32 v143, v143
    v_mfma_f32_16x16x32_bf16 v[148:151], a[208:211], a[144:147], v[148:151]
    v_cvt_pk_bf16_f32 v108, v140, v141
    v_add_f32 v202, v202, v142
    v_mfma_f32_16x16x32_bf16 v[152:155], a[208:211], a[160:163], v[168:171]
    v_exp_f32 v144, v144
    v_mfma_f32_16x16x32_bf16 v[152:155], a[212:215], a[164:167], v[152:155]
    v_add_f32 v203, v203, v143
    v_cvt_pk_bf16_f32 v109, v142, v143
    v_mfma_f32_16x16x32_bf16 v[152:155], a[216:219], a[168:171], v[152:155]
    v_exp_f32 v145, v145
    v_mfma_f32_16x16x32_bf16 v[152:155], a[220:223], a[172:175], v[152:155]
    v_add_f32 v196, v196, v144
    v_add_f32 v197, v197, v145
    v_mfma_f32_16x16x32_bf16 v[156:159], a[220:223], a[188:191], v[172:175]
    v_exp_f32 v146, v146
    v_mfma_f32_16x16x32_bf16 v[156:159], a[216:219], a[184:187], v[156:159]
    v_cvt_pk_bf16_f32 v98, v144, v145
    v_add_f32 v196, v196, v146
    v_mfma_f32_16x16x32_bf16 v[156:159], a[212:215], a[180:183], v[156:159]
    s_waitcnt lgkmcnt(0)
    v_exp_f32 v147, v147
    v_mfma_f32_16x16x32_bf16 v[156:159], a[208:211], a[176:179], v[156:159]
    v_add_f32 v197, v197, v147
    v_cvt_pk_bf16_f32 v99, v146, v147
    v_mfma_f32_16x16x32_bf16 a[80:83], a[252:255], v[48:51], a[80:83]
    v_exp_f32 v148, v148
    v_mfma_f32_16x16x32_bf16 a[80:83], a[248:251], v[32:35], a[80:83]
    ds_read_b128 a[192:195], v204 offset:57344
    ds_read_b128 a[196:199], v205 offset:57344
    v_mfma_f32_16x16x32_bf16 a[80:83], a[244:247], v[16:19], a[80:83]
    v_exp_f32 v149, v149
    v_mfma_f32_16x16x32_bf16 a[80:83], a[240:243], v[0:3], a[80:83]
    ds_read_b128 a[200:203], v206 offset:57344
    ds_read_b128 a[204:207], v207 offset:57344
    v_mfma_f32_16x16x32_bf16 a[84:87], a[240:243], v[4:7], a[84:87]
    v_exp_f32 v150, v150
    v_mfma_f32_16x16x32_bf16 a[84:87], a[244:247], v[20:23], a[84:87]
    ds_read_b64_tr_b16 a[224:225], v214 offset:0
    ds_read_b64_tr_b16 a[226:227], v214 offset:4096
    v_mfma_f32_16x16x32_bf16 a[84:87], a[248:251], v[36:39], a[84:87]
    v_exp_f32 v151, v151
    v_mfma_f32_16x16x32_bf16 a[84:87], a[252:255], v[52:55], a[84:87]
    ds_read_b64_tr_b16 a[228:229], v214 offset:8192
    ds_read_b64_tr_b16 a[230:231], v214 offset:12288
    v_mfma_f32_16x16x32_bf16 a[88:91], a[252:255], v[56:59], a[88:91]
    v_exp_f32 v152, v152
    v_mfma_f32_16x16x32_bf16 a[88:91], a[248:251], v[40:43], a[88:91]
    v_add_f32 v198, v198, v148
    v_add_f32 v199, v199, v149
    v_mfma_f32_16x16x32_bf16 a[88:91], a[244:247], v[24:27], a[88:91]
    v_exp_f32 v153, v153
    v_mfma_f32_16x16x32_bf16 a[88:91], a[240:243], v[8:11], a[88:91]
    v_cvt_pk_bf16_f32 v102, v148, v149
    v_add_f32 v198, v198, v150
    v_mfma_f32_16x16x32_bf16 a[92:95], a[240:243], v[12:15], a[92:95]
    v_exp_f32 v154, v154
    v_mfma_f32_16x16x32_bf16 a[92:95], a[244:247], v[28:31], a[92:95]
    v_add_f32 v199, v199, v151
    v_cvt_pk_bf16_f32 v103, v150, v151
    v_mfma_f32_16x16x32_bf16 a[92:95], a[248:251], v[44:47], a[92:95]
    s_waitcnt lgkmcnt(4)
    v_exp_f32 v155, v155
    v_mfma_f32_16x16x32_bf16 a[92:95], a[252:255], v[60:63], a[92:95]
    v_add_f32 v200, v200, v152
    v_add_f32 v201, v201, v153
    v_mfma_f32_16x16x32_bf16 v[184:187], v[192:195], v[8:11], v[184:187]
    v_cvt_pk_bf16_f32 v106, v152, v153
    v_add_f32 v200, v200, v154
    v_mfma_f32_16x16x32_bf16 v[184:187], v[192:195], v[24:27], v[184:187]
    v_add_f32 v201, v201, v155
    v_cvt_pk_bf16_f32 v107, v154, v155
    v_mfma_f32_16x16x32_bf16 v[128:131], a[192:195], a[128:131], v[160:163]
    v_exp_f32 v156, v156
    v_mfma_f32_16x16x32_bf16 v[128:131], a[196:199], a[132:135], v[128:131]
    ds_read_b64_tr_b16 a[232:233], v214 offset:16384
    ds_read_b64_tr_b16 a[234:235], v214 offset:20480
    v_mfma_f32_16x16x32_bf16 v[128:131], a[200:203], a[136:139], v[128:131]
    v_exp_f32 v157, v157
    v_mfma_f32_16x16x32_bf16 v[128:131], a[204:207], a[140:143], v[128:131]
    ds_read_b64_tr_b16 a[236:237], v214 offset:24576
    ds_read_b64_tr_b16 a[238:239], v214 offset:28672
    v_mfma_f32_16x16x32_bf16 v[132:135], a[204:207], a[156:159], v[164:167]
    v_exp_f32 v158, v158
    v_mfma_f32_16x16x32_bf16 v[132:135], a[200:203], a[152:155], v[132:135]
    v_add_f32 v202, v202, v156
    v_add_f32 v203, v203, v157
    v_mfma_f32_16x16x32_bf16 v[132:135], a[196:199], a[148:151], v[132:135]
    v_exp_f32 v159, v159
    v_mfma_f32_16x16x32_bf16 v[132:135], a[192:195], a[144:147], v[132:135]
    v_cvt_pk_bf16_f32 v110, v156, v157
    v_add_f32 v202, v202, v158
    v_mfma_f32_16x16x32_bf16 v[136:139], a[192:195], a[160:163], v[168:171]
    v_exp_f32 v128, v128
    v_mfma_f32_16x16x32_bf16 v[136:139], a[196:199], a[164:167], v[136:139]
    v_add_f32 v196, v196, v128
    v_add_f32 v203, v203, v159
    v_mfma_f32_16x16x32_bf16 v[136:139], a[200:203], a[168:171], v[136:139]
    v_exp_f32 v129, v129
    v_mfma_f32_16x16x32_bf16 v[136:139], a[204:207], a[172:175], v[136:139]
    v_add_f32 v197, v197, v129
    v_cvt_pk_bf16_f32 v112, v128, v129
    v_mfma_f32_16x16x32_bf16 v[140:143], a[204:207], a[188:191], v[172:175]
    v_exp_f32 v130, v130
    v_mfma_f32_16x16x32_bf16 v[140:143], a[200:203], a[184:187], v[140:143]
    v_add_f32 v196, v196, v130
    v_cvt_pk_bf16_f32 v111, v158, v159
    v_mfma_f32_16x16x32_bf16 v[140:143], a[196:199], a[180:183], v[140:143]
    s_waitcnt lgkmcnt(0)
    v_exp_f32 v131, v131
    v_mfma_f32_16x16x32_bf16 v[140:143], a[192:195], a[176:179], v[140:143]
    v_add_f32 v197, v197, v131
    v_cvt_pk_bf16_f32 v113, v130, v131
    v_mfma_f32_16x16x32_bf16 a[96:99], a[236:239], v[48:51], a[96:99]
    v_exp_f32 v132, v132
    v_mfma_f32_16x16x32_bf16 a[96:99], a[232:235], v[32:35], a[96:99]
    ds_read_b128 a[208:211], v204 offset:61440
    ds_read_b128 a[212:215], v205 offset:61440
    v_mfma_f32_16x16x32_bf16 a[96:99], a[228:231], v[16:19], a[96:99]
    v_exp_f32 v133, v133
    v_mfma_f32_16x16x32_bf16 a[96:99], a[224:227], v[0:3], a[96:99]
    ds_read_b128 a[216:219], v206 offset:61440
    ds_read_b128 a[220:223], v207 offset:61440
    v_mfma_f32_16x16x32_bf16 a[100:103], a[224:227], v[4:7], a[100:103]
    v_exp_f32 v134, v134
    v_mfma_f32_16x16x32_bf16 a[100:103], a[228:231], v[20:23], a[100:103]
    ds_read_b64_tr_b16 a[240:241], v215 offset:0
    ds_read_b64_tr_b16 a[242:243], v215 offset:4096
    v_mfma_f32_16x16x32_bf16 a[100:103], a[232:235], v[36:39], a[100:103]
    v_exp_f32 v135, v135
    v_mfma_f32_16x16x32_bf16 a[100:103], a[236:239], v[52:55], a[100:103]
    ds_read_b64_tr_b16 a[244:245], v215 offset:8192
    ds_read_b64_tr_b16 a[246:247], v215 offset:12288
    v_mfma_f32_16x16x32_bf16 a[104:107], a[236:239], v[56:59], a[104:107]
    v_exp_f32 v136, v136
    v_mfma_f32_16x16x32_bf16 a[104:107], a[232:235], v[40:43], a[104:107]
    v_add_f32 v198, v198, v132
    v_add_f32 v199, v199, v133
    v_mfma_f32_16x16x32_bf16 a[104:107], a[228:231], v[24:27], a[104:107]
    v_exp_f32 v137, v137
    v_mfma_f32_16x16x32_bf16 a[104:107], a[224:227], v[8:11], a[104:107]
    v_cvt_pk_bf16_f32 v116, v132, v133
    v_add_f32 v198, v198, v134
    v_mfma_f32_16x16x32_bf16 a[108:111], a[224:227], v[12:15], a[108:111]
    v_exp_f32 v138, v138
    v_mfma_f32_16x16x32_bf16 a[108:111], a[228:231], v[28:31], a[108:111]
    v_add_f32 v199, v199, v135
    v_cvt_pk_bf16_f32 v117, v134, v135
    v_mfma_f32_16x16x32_bf16 a[108:111], a[232:235], v[44:47], a[108:111]
    s_waitcnt lgkmcnt(4)
    v_exp_f32 v139, v139
    v_mfma_f32_16x16x32_bf16 a[108:111], a[236:239], v[60:63], a[108:111]
    v_add_f32 v200, v200, v136
    v_add_f32 v201, v201, v137
    v_mfma_f32_16x16x32_bf16 v[188:191], v[192:195], v[12:15], v[188:191]
    v_cvt_pk_bf16_f32 v120, v136, v137
    v_add_f32 v200, v200, v138
    v_mfma_f32_16x16x32_bf16 v[188:191], v[192:195], v[28:31], v[188:191]
    v_add_f32 v201, v201, v139
    v_cvt_pk_bf16_f32 v121, v138, v139
    v_mfma_f32_16x16x32_bf16 v[144:147], a[208:211], a[128:131], v[160:163]
    v_exp_f32 v140, v140
    v_mfma_f32_16x16x32_bf16 v[144:147], a[212:215], a[132:135], v[144:147]
    ds_read_b64_tr_b16 a[248:249], v215 offset:16384
    ds_read_b64_tr_b16 a[250:251], v215 offset:20480
    v_mfma_f32_16x16x32_bf16 v[144:147], a[216:219], a[136:139], v[144:147]
    v_exp_f32 v141, v141
    v_mfma_f32_16x16x32_bf16 v[144:147], a[220:223], a[140:143], v[144:147]
    ds_read_b64_tr_b16 a[252:253], v215 offset:24576
    ds_read_b64_tr_b16 a[254:255], v215 offset:28672
    v_mfma_f32_16x16x32_bf16 v[148:151], a[220:223], a[156:159], v[164:167]
    v_exp_f32 v142, v142
    v_mfma_f32_16x16x32_bf16 v[148:151], a[216:219], a[152:155], v[148:151]
    v_add_f32 v202, v202, v140
    v_add_f32 v203, v203, v141
    v_mfma_f32_16x16x32_bf16 v[148:151], a[212:215], a[148:151], v[148:151]
    v_exp_f32 v143, v143
    v_mfma_f32_16x16x32_bf16 v[148:151], a[208:211], a[144:147], v[148:151]
    v_cvt_pk_bf16_f32 v124, v140, v141
    v_add_f32 v202, v202, v142
    v_mfma_f32_16x16x32_bf16 v[152:155], a[208:211], a[160:163], v[168:171]
    v_exp_f32 v144, v144
    v_mfma_f32_16x16x32_bf16 v[152:155], a[212:215], a[164:167], v[152:155]
    v_add_f32 v203, v203, v143
    v_cvt_pk_bf16_f32 v125, v142, v143
    v_mfma_f32_16x16x32_bf16 v[152:155], a[216:219], a[168:171], v[152:155]
    v_exp_f32 v145, v145
    v_mfma_f32_16x16x32_bf16 v[152:155], a[220:223], a[172:175], v[152:155]
    v_add_f32 v196, v196, v144
    v_add_f32 v197, v197, v145
    v_mfma_f32_16x16x32_bf16 v[156:159], a[220:223], a[188:191], v[172:175]
    s_waitcnt vmcnt(0) lgkmcnt(0)
    v_exp_f32 v146, v146
    v_mfma_f32_16x16x32_bf16 v[156:159], a[216:219], a[184:187], v[156:159]
    v_cvt_pk_bf16_f32 v114, v144, v145
    v_add_f32 v196, v196, v146
    v_mfma_f32_16x16x32_bf16 v[156:159], a[212:215], a[180:183], v[156:159]
    s_barrier
    v_exp_f32 v147, v147
    v_mfma_f32_16x16x32_bf16 v[156:159], a[208:211], a[176:179], v[156:159]
    v_add_f32 v197, v197, v147
    v_cvt_pk_bf16_f32 v115, v146, v147
    v_mfma_f32_16x16x32_bf16 a[112:115], a[252:255], v[48:51], a[112:115]
    v_exp_f32 v148, v148
    v_mfma_f32_16x16x32_bf16 a[112:115], a[248:251], v[32:35], a[112:115]
    ds_read_b128 a[192:195], v204 offset:0
    ds_read_b128 a[196:199], v205 offset:0
    v_mfma_f32_16x16x32_bf16 a[112:115], a[244:247], v[16:19], a[112:115]
    v_exp_f32 v149, v149
    v_mfma_f32_16x16x32_bf16 a[112:115], a[240:243], v[0:3], a[112:115]
    ds_read_b128 a[200:203], v206 offset:0
    ds_read_b128 a[204:207], v207 offset:0
    v_mfma_f32_16x16x32_bf16 a[116:119], a[240:243], v[4:7], a[116:119]
    v_exp_f32 v150, v150
    v_mfma_f32_16x16x32_bf16 a[116:119], a[244:247], v[20:23], a[116:119]
    ds_read_b64_tr_b16 a[224:225], v208 offset:32768
    ds_read_b64_tr_b16 a[226:227], v208 offset:36864
    v_mfma_f32_16x16x32_bf16 a[116:119], a[248:251], v[36:39], a[116:119]
    v_exp_f32 v151, v151
    v_mfma_f32_16x16x32_bf16 a[116:119], a[252:255], v[52:55], a[116:119]
    ds_read_b64_tr_b16 a[228:229], v208 offset:40960
    ds_read_b64_tr_b16 a[230:231], v208 offset:45056
    v_mfma_f32_16x16x32_bf16 a[120:123], a[252:255], v[56:59], a[120:123]
    v_exp_f32 v152, v152
    v_mfma_f32_16x16x32_bf16 a[120:123], a[248:251], v[40:43], a[120:123]
    v_add_f32 v198, v198, v148
    v_add_f32 v199, v199, v149
    v_mfma_f32_16x16x32_bf16 a[120:123], a[244:247], v[24:27], a[120:123]
    v_exp_f32 v153, v153
    v_mfma_f32_16x16x32_bf16 a[120:123], a[240:243], v[8:11], a[120:123]
    v_cvt_pk_bf16_f32 v118, v148, v149
    v_add_f32 v198, v198, v150
    v_mfma_f32_16x16x32_bf16 a[124:127], a[240:243], v[12:15], a[124:127]
    v_exp_f32 v154, v154
    v_mfma_f32_16x16x32_bf16 a[124:127], a[244:247], v[28:31], a[124:127]
    v_add_f32 v199, v199, v151
    v_cvt_pk_bf16_f32 v119, v150, v151
    v_mfma_f32_16x16x32_bf16 a[124:127], a[248:251], v[44:47], a[124:127]
    s_waitcnt lgkmcnt(4)
    v_exp_f32 v155, v155
    v_mfma_f32_16x16x32_bf16 a[124:127], a[252:255], v[60:63], a[124:127]
    v_add_f32 v200, v200, v152
    v_add_f32 v201, v201, v153
    v_mfma_f32_16x16x32_bf16 v[128:131], a[192:195], a[128:131], v[160:163]
    v_exp_f32 v156, v156
    v_mfma_f32_16x16x32_bf16 v[128:131], a[196:199], a[132:135], v[128:131]
    ds_read_b64_tr_b16 a[232:233], v208 offset:49152
    ds_read_b64_tr_b16 a[234:235], v208 offset:53248
    v_mfma_f32_16x16x32_bf16 v[128:131], a[200:203], a[136:139], v[128:131]
    v_exp_f32 v157, v157
    v_mfma_f32_16x16x32_bf16 v[128:131], a[204:207], a[140:143], v[128:131]
    ds_read_b64_tr_b16 a[236:237], v208 offset:57344
    ds_read_b64_tr_b16 a[238:239], v208 offset:61440
    v_mfma_f32_16x16x32_bf16 v[132:135], a[204:207], a[156:159], v[164:167]
    s_add_u32 m0, s30, 32768
    v_exp_f32 v158, v158
    v_mfma_f32_16x16x32_bf16 v[132:135], a[200:203], a[152:155], v[132:135]
    buffer_load_dwordx4 v216, s[8:11], s31 offen offset:0 lds
    v_mfma_f32_16x16x32_bf16 v[132:135], a[196:199], a[148:151], v[132:135]
    v_exp_f32 v159, v159
    v_mfma_f32_16x16x32_bf16 v[132:135], a[192:195], a[144:147], v[132:135]
    v_cvt_pk_bf16_f32 v122, v152, v153
    v_add_f32 v200, v200, v154
    v_mfma_f32_16x16x32_bf16 v[136:139], a[192:195], a[160:163], v[168:171]
    v_exp_f32 v128, v128
    v_mfma_f32_16x16x32_bf16 v[136:139], a[196:199], a[164:167], v[136:139]
    buffer_load_dwordx4 v217, s[8:11], s31 offen offset:1024 lds
    v_mfma_f32_16x16x32_bf16 v[136:139], a[200:203], a[168:171], v[136:139]
    v_exp_f32 v129, v129
    v_mfma_f32_16x16x32_bf16 v[136:139], a[204:207], a[172:175], v[136:139]
    v_add_f32 v201, v201, v155
    v_cvt_pk_bf16_f32 v123, v154, v155
    v_mfma_f32_16x16x32_bf16 v[140:143], a[204:207], a[188:191], v[172:175]
    v_exp_f32 v130, v130
    v_mfma_f32_16x16x32_bf16 v[140:143], a[200:203], a[184:187], v[140:143]
    v_add_f32 v202, v202, v156
    v_add_f32 v203, v203, v157
    v_mfma_f32_16x16x32_bf16 v[140:143], a[196:199], a[180:183], v[140:143]
    s_waitcnt lgkmcnt(0)
    v_exp_f32 v131, v131
    v_mfma_f32_16x16x32_bf16 v[140:143], a[192:195], a[176:179], v[140:143]
    v_cvt_pk_bf16_f32 v126, v156, v157
    v_add_f32 v202, v202, v158
    v_mfma_f32_16x16x32_bf16 a[0:3], a[236:239], v[112:115], a[0:3]
    v_exp_f32 v132, v132
    v_mfma_f32_16x16x32_bf16 a[0:3], a[232:235], v[96:99], a[0:3]
    ds_read_b128 a[208:211], v204 offset:4096
    ds_read_b128 a[212:215], v205 offset:4096
    v_mfma_f32_16x16x32_bf16 a[0:3], a[228:231], v[80:83], a[0:3]
    v_exp_f32 v133, v133
    v_mfma_f32_16x16x32_bf16 a[0:3], a[224:227], v[64:67], a[0:3]
    ds_read_b128 a[216:219], v206 offset:4096
    ds_read_b128 a[220:223], v207 offset:4096
    v_mfma_f32_16x16x32_bf16 a[4:7], a[224:227], v[68:71], a[4:7]
    v_exp_f32 v134, v134
    v_mfma_f32_16x16x32_bf16 a[4:7], a[228:231], v[84:87], a[4:7]
    ds_read_b64_tr_b16 a[240:241], v209 offset:32768
    ds_read_b64_tr_b16 a[242:243], v209 offset:36864
    v_mfma_f32_16x16x32_bf16 a[4:7], a[232:235], v[100:103], a[4:7]
    v_exp_f32 v135, v135
    v_mfma_f32_16x16x32_bf16 a[4:7], a[236:239], v[116:119], a[4:7]
    ds_read_b64_tr_b16 a[244:245], v209 offset:40960
    ds_read_b64_tr_b16 a[246:247], v209 offset:45056
    v_mfma_f32_16x16x32_bf16 a[8:11], a[236:239], v[120:123], a[8:11]
    v_exp_f32 v136, v136
    v_mfma_f32_16x16x32_bf16 a[8:11], a[232:235], v[104:107], a[8:11]
    buffer_load_dwordx4 v218, s[8:11], s31 offen offset:2048 lds
    v_mfma_f32_16x16x32_bf16 a[8:11], a[228:231], v[88:91], a[8:11]
    v_exp_f32 v137, v137
    v_mfma_f32_16x16x32_bf16 a[8:11], a[224:227], v[72:75], a[8:11]
    v_add_f32 v203, v203, v159
    v_cvt_pk_bf16_f32 v127, v158, v159
    v_mfma_f32_16x16x32_bf16 a[12:15], a[224:227], v[76:79], a[12:15]
    v_exp_f32 v138, v138
    v_mfma_f32_16x16x32_bf16 a[12:15], a[228:231], v[92:95], a[12:15]
    buffer_load_dwordx4 v219, s[8:11], s31 offen offset:3072 lds
    v_mfma_f32_16x16x32_bf16 a[12:15], a[232:235], v[108:111], a[12:15]
    s_waitcnt lgkmcnt(4)
    v_exp_f32 v139, v139
    v_mfma_f32_16x16x32_bf16 a[12:15], a[236:239], v[124:127], a[12:15]
    v_cvt_pk_bf16_f32 v0, v128, v129
    v_cvt_pk_bf16_f32 v1, v130, v131
    v_mfma_f32_16x16x32_bf16 v[144:147], a[208:211], a[128:131], v[160:163]
    v_exp_f32 v140, v140
    v_mfma_f32_16x16x32_bf16 v[144:147], a[212:215], a[132:135], v[144:147]
    ds_read_b64_tr_b16 a[248:249], v209 offset:49152
    ds_read_b64_tr_b16 a[250:251], v209 offset:53248
    v_mfma_f32_16x16x32_bf16 v[144:147], a[216:219], a[136:139], v[144:147]
    v_exp_f32 v141, v141
    v_mfma_f32_16x16x32_bf16 v[144:147], a[220:223], a[140:143], v[144:147]
    ds_read_b64_tr_b16 a[252:253], v209 offset:57344
    ds_read_b64_tr_b16 a[254:255], v209 offset:61440
    v_mfma_f32_16x16x32_bf16 v[148:151], a[220:223], a[156:159], v[164:167]
    s_add_u32 m0, s30, 36864
    v_exp_f32 v142, v142
    v_mfma_f32_16x16x32_bf16 v[148:151], a[216:219], a[152:155], v[148:151]
    buffer_load_dwordx4 v216, s[8:11], s32 offen offset:0 lds
    v_mfma_f32_16x16x32_bf16 v[148:151], a[212:215], a[148:151], v[148:151]
    v_exp_f32 v143, v143
    v_mfma_f32_16x16x32_bf16 v[148:151], a[208:211], a[144:147], v[148:151]
    v_cvt_pk_bf16_f32 v4, v132, v133
    v_cvt_pk_bf16_f32 v5, v134, v135
    v_mfma_f32_16x16x32_bf16 v[152:155], a[208:211], a[160:163], v[168:171]
    v_exp_f32 v144, v144
    v_mfma_f32_16x16x32_bf16 v[152:155], a[212:215], a[164:167], v[152:155]
    buffer_load_dwordx4 v217, s[8:11], s32 offen offset:1024 lds
    v_mfma_f32_16x16x32_bf16 v[152:155], a[216:219], a[168:171], v[152:155]
    v_exp_f32 v145, v145
    v_mfma_f32_16x16x32_bf16 v[152:155], a[220:223], a[172:175], v[152:155]
    v_cvt_pk_bf16_f32 v8, v136, v137
    v_cvt_pk_bf16_f32 v9, v138, v139
    v_mfma_f32_16x16x32_bf16 v[156:159], a[220:223], a[188:191], v[172:175]
    v_exp_f32 v146, v146
    v_mfma_f32_16x16x32_bf16 v[156:159], a[216:219], a[184:187], v[156:159]
    v_cvt_pk_bf16_f32 v12, v140, v141
    v_cvt_pk_bf16_f32 v13, v142, v143
    v_mfma_f32_16x16x32_bf16 v[156:159], a[212:215], a[180:183], v[156:159]
    s_waitcnt lgkmcnt(0)
    v_exp_f32 v147, v147
    v_mfma_f32_16x16x32_bf16 v[156:159], a[208:211], a[176:179], v[156:159]
    v_cvt_pk_bf16_f32 v2, v144, v145
    v_cvt_pk_bf16_f32 v3, v146, v147
    v_mfma_f32_16x16x32_bf16 a[16:19], a[252:255], v[112:115], a[16:19]
    v_exp_f32 v148, v148
    v_mfma_f32_16x16x32_bf16 a[16:19], a[248:251], v[96:99], a[16:19]
    ds_read_b128 a[192:195], v204 offset:8192
    ds_read_b128 a[196:199], v205 offset:8192
    v_mfma_f32_16x16x32_bf16 a[16:19], a[244:247], v[80:83], a[16:19]
    v_exp_f32 v149, v149
    v_mfma_f32_16x16x32_bf16 a[16:19], a[240:243], v[64:67], a[16:19]
    ds_read_b128 a[200:203], v206 offset:8192
    ds_read_b128 a[204:207], v207 offset:8192
    v_mfma_f32_16x16x32_bf16 a[20:23], a[240:243], v[68:71], a[20:23]
    v_exp_f32 v150, v150
    v_mfma_f32_16x16x32_bf16 a[20:23], a[244:247], v[84:87], a[20:23]
    ds_read_b64_tr_b16 a[224:225], v210 offset:32768
    ds_read_b64_tr_b16 a[226:227], v210 offset:36864
    v_mfma_f32_16x16x32_bf16 a[20:23], a[248:251], v[100:103], a[20:23]
    v_exp_f32 v151, v151
    v_mfma_f32_16x16x32_bf16 a[20:23], a[252:255], v[116:119], a[20:23]
    ds_read_b64_tr_b16 a[228:229], v210 offset:40960
    ds_read_b64_tr_b16 a[230:231], v210 offset:45056
    v_mfma_f32_16x16x32_bf16 a[24:27], a[252:255], v[120:123], a[24:27]
    v_exp_f32 v152, v152
    v_mfma_f32_16x16x32_bf16 a[24:27], a[248:251], v[104:107], a[24:27]
    buffer_load_dwordx4 v218, s[8:11], s32 offen offset:2048 lds
    v_mfma_f32_16x16x32_bf16 a[24:27], a[244:247], v[88:91], a[24:27]
    v_exp_f32 v153, v153
    v_mfma_f32_16x16x32_bf16 a[24:27], a[240:243], v[72:75], a[24:27]
    v_cvt_pk_bf16_f32 v6, v148, v149
    v_cvt_pk_bf16_f32 v7, v150, v151
    v_mfma_f32_16x16x32_bf16 a[28:31], a[240:243], v[76:79], a[28:31]
    v_exp_f32 v154, v154
    v_mfma_f32_16x16x32_bf16 a[28:31], a[244:247], v[92:95], a[28:31]
    buffer_load_dwordx4 v219, s[8:11], s32 offen offset:3072 lds
    v_mfma_f32_16x16x32_bf16 a[28:31], a[248:251], v[108:111], a[28:31]
    s_add_u32 s31, s31, 32768
    s_waitcnt lgkmcnt(4)
    v_exp_f32 v155, v155
    v_mfma_f32_16x16x32_bf16 a[28:31], a[252:255], v[124:127], a[28:31]
    v_cvt_pk_bf16_f32 v10, v152, v153
    v_cvt_pk_bf16_f32 v11, v154, v155
    v_mfma_f32_16x16x32_bf16 v[128:131], a[192:195], a[128:131], v[160:163]
    s_add_u32 s32, s32, 32768
    v_exp_f32 v156, v156
    v_mfma_f32_16x16x32_bf16 v[128:131], a[196:199], a[132:135], v[128:131]
    ds_read_b64_tr_b16 a[232:233], v210 offset:49152
    ds_read_b64_tr_b16 a[234:235], v210 offset:53248
    v_mfma_f32_16x16x32_bf16 v[128:131], a[200:203], a[136:139], v[128:131]
    v_exp_f32 v157, v157
    v_mfma_f32_16x16x32_bf16 v[128:131], a[204:207], a[140:143], v[128:131]
    ds_read_b64_tr_b16 a[236:237], v210 offset:57344
    ds_read_b64_tr_b16 a[238:239], v210 offset:61440
    v_mfma_f32_16x16x32_bf16 v[132:135], a[204:207], a[156:159], v[164:167]
    s_add_u32 m0, s30, 65536
    v_exp_f32 v158, v158
    v_mfma_f32_16x16x32_bf16 v[132:135], a[200:203], a[152:155], v[132:135]
    buffer_load_dwordx4 v220, s[12:15], s33 offen offset:0 lds
    v_mfma_f32_16x16x32_bf16 v[132:135], a[196:199], a[148:151], v[132:135]
    v_exp_f32 v159, v159
    v_mfma_f32_16x16x32_bf16 v[132:135], a[192:195], a[144:147], v[132:135]
    v_cvt_pk_bf16_f32 v14, v156, v157
    v_cvt_pk_bf16_f32 v15, v158, v159
    v_mfma_f32_16x16x32_bf16 v[136:139], a[192:195], a[160:163], v[168:171]
    v_exp_f32 v128, v128
    v_mfma_f32_16x16x32_bf16 v[136:139], a[196:199], a[164:167], v[136:139]
    buffer_load_dwordx4 v221, s[12:15], s33 offen offset:1024 lds
    v_mfma_f32_16x16x32_bf16 v[136:139], a[200:203], a[168:171], v[136:139]
    v_exp_f32 v129, v129
    v_mfma_f32_16x16x32_bf16 v[136:139], a[204:207], a[172:175], v[136:139]
    v_cvt_pk_bf16_f32 v16, v128, v129
    v_mfma_f32_16x16x32_bf16 v[140:143], a[204:207], a[188:191], v[172:175]
    v_exp_f32 v130, v130
    v_mfma_f32_16x16x32_bf16 v[140:143], a[200:203], a[184:187], v[140:143]
    v_mfma_f32_16x16x32_bf16 v[140:143], a[196:199], a[180:183], v[140:143]
    s_waitcnt lgkmcnt(0)
    v_exp_f32 v131, v131
    v_mfma_f32_16x16x32_bf16 v[140:143], a[192:195], a[176:179], v[140:143]
    v_cvt_pk_bf16_f32 v17, v130, v131
    v_mfma_f32_16x16x32_bf16 a[32:35], a[236:239], v[112:115], a[32:35]
    v_exp_f32 v132, v132
    v_mfma_f32_16x16x32_bf16 a[32:35], a[232:235], v[96:99], a[32:35]
    ds_read_b128 a[208:211], v204 offset:12288
    ds_read_b128 a[212:215], v205 offset:12288
    v_mfma_f32_16x16x32_bf16 a[32:35], a[228:231], v[80:83], a[32:35]
    v_exp_f32 v133, v133
    v_mfma_f32_16x16x32_bf16 a[32:35], a[224:227], v[64:67], a[32:35]
    ds_read_b128 a[216:219], v206 offset:12288
    ds_read_b128 a[220:223], v207 offset:12288
    v_mfma_f32_16x16x32_bf16 a[36:39], a[224:227], v[68:71], a[36:39]
    v_exp_f32 v134, v134
    v_mfma_f32_16x16x32_bf16 a[36:39], a[228:231], v[84:87], a[36:39]
    ds_read_b64_tr_b16 a[240:241], v211 offset:32768
    ds_read_b64_tr_b16 a[242:243], v211 offset:36864
    v_mfma_f32_16x16x32_bf16 a[36:39], a[232:235], v[100:103], a[36:39]
    v_exp_f32 v135, v135
    v_mfma_f32_16x16x32_bf16 a[36:39], a[236:239], v[116:119], a[36:39]
    ds_read_b64_tr_b16 a[244:245], v211 offset:40960
    ds_read_b64_tr_b16 a[246:247], v211 offset:45056
    v_mfma_f32_16x16x32_bf16 a[40:43], a[236:239], v[120:123], a[40:43]
    v_exp_f32 v136, v136
    v_mfma_f32_16x16x32_bf16 a[40:43], a[232:235], v[104:107], a[40:43]
    buffer_load_dwordx4 v220, s[12:15], s33 offen offset:2048 lds
    v_mfma_f32_16x16x32_bf16 a[40:43], a[228:231], v[88:91], a[40:43]
    v_exp_f32 v137, v137
    v_mfma_f32_16x16x32_bf16 a[40:43], a[224:227], v[72:75], a[40:43]
    v_cvt_pk_bf16_f32 v20, v132, v133
    v_cvt_pk_bf16_f32 v21, v134, v135
    v_mfma_f32_16x16x32_bf16 a[44:47], a[224:227], v[76:79], a[44:47]
    v_exp_f32 v138, v138
    v_mfma_f32_16x16x32_bf16 a[44:47], a[228:231], v[92:95], a[44:47]
    buffer_load_dwordx4 v221, s[12:15], s33 offen offset:3072 lds
    v_mfma_f32_16x16x32_bf16 a[44:47], a[232:235], v[108:111], a[44:47]
    s_waitcnt lgkmcnt(4)
    v_exp_f32 v139, v139
    v_mfma_f32_16x16x32_bf16 a[44:47], a[236:239], v[124:127], a[44:47]
    v_cvt_pk_bf16_f32 v24, v136, v137
    v_cvt_pk_bf16_f32 v25, v138, v139
    v_mfma_f32_16x16x32_bf16 v[144:147], a[208:211], a[128:131], v[160:163]
    v_exp_f32 v140, v140
    v_mfma_f32_16x16x32_bf16 v[144:147], a[212:215], a[132:135], v[144:147]
    ds_read_b64_tr_b16 a[248:249], v211 offset:49152
    ds_read_b64_tr_b16 a[250:251], v211 offset:53248
    v_mfma_f32_16x16x32_bf16 v[144:147], a[216:219], a[136:139], v[144:147]
    v_exp_f32 v141, v141
    v_mfma_f32_16x16x32_bf16 v[144:147], a[220:223], a[140:143], v[144:147]
    ds_read_b64_tr_b16 a[252:253], v211 offset:57344
    ds_read_b64_tr_b16 a[254:255], v211 offset:61440
    v_mfma_f32_16x16x32_bf16 v[148:151], a[220:223], a[156:159], v[164:167]
    s_add_u32 m0, s30, 69632
    v_exp_f32 v142, v142
    v_mfma_f32_16x16x32_bf16 v[148:151], a[216:219], a[152:155], v[148:151]
    buffer_load_dwordx4 v220, s[12:15], s34 offen offset:0 lds
    v_mfma_f32_16x16x32_bf16 v[148:151], a[212:215], a[148:151], v[148:151]
    v_exp_f32 v143, v143
    v_mfma_f32_16x16x32_bf16 v[148:151], a[208:211], a[144:147], v[148:151]
    v_cvt_pk_bf16_f32 v28, v140, v141
    v_cvt_pk_bf16_f32 v29, v142, v143
    v_mfma_f32_16x16x32_bf16 v[152:155], a[208:211], a[160:163], v[168:171]
    v_exp_f32 v144, v144
    v_mfma_f32_16x16x32_bf16 v[152:155], a[212:215], a[164:167], v[152:155]
    buffer_load_dwordx4 v221, s[12:15], s34 offen offset:1024 lds
    v_mfma_f32_16x16x32_bf16 v[152:155], a[216:219], a[168:171], v[152:155]
    v_exp_f32 v145, v145
    v_mfma_f32_16x16x32_bf16 v[152:155], a[220:223], a[172:175], v[152:155]
    v_cvt_pk_bf16_f32 v18, v144, v145
    v_mfma_f32_16x16x32_bf16 v[156:159], a[220:223], a[188:191], v[172:175]
    v_exp_f32 v146, v146
    v_mfma_f32_16x16x32_bf16 v[156:159], a[216:219], a[184:187], v[156:159]
    v_mfma_f32_16x16x32_bf16 v[156:159], a[212:215], a[180:183], v[156:159]
    s_waitcnt lgkmcnt(0)
    v_exp_f32 v147, v147
    v_mfma_f32_16x16x32_bf16 v[156:159], a[208:211], a[176:179], v[156:159]
    v_cvt_pk_bf16_f32 v19, v146, v147
    v_mfma_f32_16x16x32_bf16 a[48:51], a[252:255], v[112:115], a[48:51]
    v_exp_f32 v148, v148
    v_mfma_f32_16x16x32_bf16 a[48:51], a[248:251], v[96:99], a[48:51]
    ds_read_b128 a[192:195], v204 offset:16384
    ds_read_b128 a[196:199], v205 offset:16384
    v_mfma_f32_16x16x32_bf16 a[48:51], a[244:247], v[80:83], a[48:51]
    v_exp_f32 v149, v149
    v_mfma_f32_16x16x32_bf16 a[48:51], a[240:243], v[64:67], a[48:51]
    ds_read_b128 a[200:203], v206 offset:16384
    ds_read_b128 a[204:207], v207 offset:16384
    v_mfma_f32_16x16x32_bf16 a[52:55], a[240:243], v[68:71], a[52:55]
    v_exp_f32 v150, v150
    v_mfma_f32_16x16x32_bf16 a[52:55], a[244:247], v[84:87], a[52:55]
    ds_read_b64_tr_b16 a[224:225], v212 offset:32768
    ds_read_b64_tr_b16 a[226:227], v212 offset:36864
    v_mfma_f32_16x16x32_bf16 a[52:55], a[248:251], v[100:103], a[52:55]
    v_exp_f32 v151, v151
    v_mfma_f32_16x16x32_bf16 a[52:55], a[252:255], v[116:119], a[52:55]
    ds_read_b64_tr_b16 a[228:229], v212 offset:40960
    ds_read_b64_tr_b16 a[230:231], v212 offset:45056
    v_mfma_f32_16x16x32_bf16 a[56:59], a[252:255], v[120:123], a[56:59]
    v_exp_f32 v152, v152
    v_mfma_f32_16x16x32_bf16 a[56:59], a[248:251], v[104:107], a[56:59]
    buffer_load_dwordx4 v220, s[12:15], s34 offen offset:2048 lds
    v_mfma_f32_16x16x32_bf16 a[56:59], a[244:247], v[88:91], a[56:59]
    v_exp_f32 v153, v153
    v_mfma_f32_16x16x32_bf16 a[56:59], a[240:243], v[72:75], a[56:59]
    v_cvt_pk_bf16_f32 v22, v148, v149
    v_cvt_pk_bf16_f32 v23, v150, v151
    v_mfma_f32_16x16x32_bf16 a[60:63], a[240:243], v[76:79], a[60:63]
    v_exp_f32 v154, v154
    v_mfma_f32_16x16x32_bf16 a[60:63], a[244:247], v[92:95], a[60:63]
    buffer_load_dwordx4 v221, s[12:15], s34 offen offset:3072 lds
    v_mfma_f32_16x16x32_bf16 a[60:63], a[248:251], v[108:111], a[60:63]
    s_add_u32 s33, s33, 32768
    s_waitcnt lgkmcnt(4)
    v_exp_f32 v155, v155
    v_mfma_f32_16x16x32_bf16 a[60:63], a[252:255], v[124:127], a[60:63]
    v_cvt_pk_bf16_f32 v26, v152, v153
    v_cvt_pk_bf16_f32 v27, v154, v155
    v_mfma_f32_16x16x32_bf16 v[176:179], v[192:195], v[64:67], v[176:179]
    s_add_u32 s34, s34, 32768
    v_mfma_f32_16x16x32_bf16 v[176:179], v[192:195], v[80:83], v[176:179]
    s_add_u32 s35, s35, 1
    v_mfma_f32_16x16x32_bf16 v[128:131], a[192:195], a[128:131], v[160:163]
    s_branch F_JOBS
F_JRET:
    v_exp_f32 v156, v156
    v_mfma_f32_16x16x32_bf16 v[128:131], a[196:199], a[132:135], v[128:131]
    ds_read_b64_tr_b16 a[232:233], v212 offset:49152
    ds_read_b64_tr_b16 a[234:235], v212 offset:53248
    v_mfma_f32_16x16x32_bf16 v[128:131], a[200:203], a[136:139], v[128:131]
    v_exp_f32 v157, v157
    v_mfma_f32_16x16x32_bf16 v[128:131], a[204:207], a[140:143], v[128:131]
    ds_read_b64_tr_b16 a[236:237], v212 offset:57344
    ds_read_b64_tr_b16 a[238:239], v212 offset:61440
    v_mfma_f32_16x16x32_bf16 v[132:135], a[204:207], a[156:159], v[164:167]
    v_exp_f32 v158, v158
    v_mfma_f32_16x16x32_bf16 v[132:135], a[200:203], a[152:155], v[132:135]
    v_cvt_pk_bf16_f32 v30, v156, v157
    v_mfma_f32_16x16x32_bf16 v[132:135], a[196:199], a[148:151], v[132:135]
    v_exp_f32 v159, v159
    v_mfma_f32_16x16x32_bf16 v[132:135], a[192:195], a[144:147], v[132:135]
    v_cvt_pk_bf16_f32 v31, v158, v159
    v_mfma_f32_16x16x32_bf16 v[136:139], a[192:195], a[160:163], v[168:171]
    v_exp_f32 v128, v128
    v_mfma_f32_16x16x32_bf16 v[136:139], a[196:199], a[164:167], v[136:139]
    v_add_f32 v196, v196, v128
    v_mfma_f32_16x16x32_bf16 v[136:139], a[200:203], a[168:171], v[136:139]
    v_exp_f32 v129, v129
    v_mfma_f32_16x16x32_bf16 v[136:139], a[204:207], a[172:175], v[136:139]
    v_add_f32 v197, v197, v129
    v_cvt_pk_bf16_f32 v32, v128, v129
    v_mfma_f32_16x16x32_bf16 v[140:143], a[204:207], a[188:191], v[172:175]
    v_exp_f32 v130, v130
    v_mfma_f32_16x16x32_bf16 v[140:143], a[200:203], a[184:187], v[140:143]
    v_add_f32 v196, v196, v130
    v_mfma_f32_16x16x32_bf16 v[140:143], a[196:199], a[180:183], v[140:143]
    s_waitcnt lgkmcnt(0)
    v_exp_f32 v131, v131
    v_mfma_f32_16x16x32_bf16 v[140:143], a[192:195], a[176:179], v[140:143]
    v_add_f32 v197, v197, v131
    v_cvt_pk_bf16_f32 v33, v130, v131
    v_mfma_f32_16x16x32_bf16 a[64:67], a[236:239], v[112:115], a[64:67]
    v_exp_f32 v132, v132
    v_mfma_f32_16x16x32_bf16 a[64:67], a[232:235], v[96:99], a[64:67]
    ds_read_b128 a[208:211], v204 offset:20480
    ds_read_b128 a[212:215], v205 offset:20480
    v_mfma_f32_16x16x32_bf16 a[64:67], a[228:231], v[80:83], a[64:67]
    v_exp_f32 v133, v133
    v_mfma_f32_16x16x32_bf16 a[64:67], a[224:227], v[64:67], a[64:67]
    ds_read_b128 a[216:219], v206 offset:20480
    ds_read_b128 a[220:223], v207 offset:20480
    v_mfma_f32_16x16x32_bf16 a[68:71], a[224:227], v[68:71], a[68:71]
    v_exp_f32 v134, v134
    v_mfma_f32_16x16x32_bf16 a[68:71], a[228:231], v[84:87], a[68:71]
    ds_read_b64_tr_b16 a[240:241], v213 offset:32768
    ds_read_b64_tr_b16 a[242:243], v213 offset:36864
    v_mfma_f32_16x16x32_bf16 a[68:71], a[232:235], v[100:103], a[68:71]
    v_exp_f32 v135, v135
    v_mfma_f32_16x16x32_bf16 a[68:71], a[236:239], v[116:119], a[68:71]
    ds_read_b64_tr_b16 a[244:245], v213 offset:40960
    ds_read_b64_tr_b16 a[246:247], v213 offset:45056
    v_mfma_f32_16x16x32_bf16 a[72:75], a[236:239], v[120:123], a[72:75]
    v_exp_f32 v136, v136
    v_mfma_f32_16x16x32_bf16 a[72:75], a[232:235], v[104:107], a[72:75]
    v_add_f32 v198, v198, v132
    v_add_f32 v199, v199, v133
    v_mfma_f32_16x16x32_bf16 a[72:75], a[228:231], v[88:91], a[72:75]
    v_exp_f32 v137, v137
    v_mfma_f32_16x16x32_bf16 a[72:75], a[224:227], v[72:75], a[72:75]
    v_cvt_pk_bf16_f32 v36, v132, v133
    v_add_f32 v198, v198, v134
    v_mfma_f32_16x16x32_bf16 a[76:79], a[224:227], v[76:79], a[76:79]
    v_exp_f32 v138, v138
    v_mfma_f32_16x16x32_bf16 a[76:79], a[228:231], v[92:95], a[76:79]
    v_add_f32 v199, v199, v135
    v_cvt_pk_bf16_f32 v37, v134, v135
    v_mfma_f32_16x16x32_bf16 a[76:79], a[232:235], v[108:111], a[76:79]
    s_waitcnt lgkmcnt(4)
    v_exp_f32 v139, v139
    v_mfma_f32_16x16x32_bf16 a[76:79], a[236:239], v[124:127], a[76:79]
    v_add_f32 v200, v200, v136
    v_add_f32 v201, v201, v137
    v_mfma_f32_16x16x32_bf16 v[180:183], v[192:195], v[68:71], v[180:183]
    v_cvt_pk_bf16_f32 v40, v136, v137
    v_add_f32 v200, v200, v138
    v_mfma_f32_16x16x32_bf16 v[180:183], v[192:195], v[84:87], v[180:183]
    v_add_f32 v201, v201, v139
    v_cvt_pk_bf16_f32 v41, v138, v139
    v_mfma_f32_16x16x32_bf16 v[144:147], a[208:211], a[128:131], v[160:163]
    v_exp_f32 v140, v140
    v_mfma_f32_16x16x32_bf16 v[144:147], a[212:215], a[132:135], v[144:147]
    ds_read_b64_tr_b16 a[248:249], v213 offset:49152
    ds_read_b64_tr_b16 a[250:251], v213 offset:53248
    v_mfma_f32_16x16x32_bf16 v[144:147], a[216:219], a[136:139], v[144:147]
    v_exp_f32 v141, v141
    v_mfma_f32_16x16x32_bf16 v[144:147], a[220:223], a[140:143], v[144:147]
    ds_read_b64_tr_b16 a[252:253], v213 offset:57344
    ds_read_b64_tr_b16 a[254:255], v213 offset:61440
    v_mfma_f32_16x16x32_bf16 v[148:151], a[220:223], a[156:159], v[164:167]
    v_exp_f32 v142, v142
    v_mfma_f32_16x16x32_bf16 v[148:151], a[216:219], a[152:155], v[148:151]
    v_add_f32 v202, v202, v140
    v_add_f32 v203, v203, v141
    v_mfma_f32_16x16x32_bf16 v[148:151], a[212:215], a[148:151], v[148:151]
    v_exp_f32 v143, v143
    v_mfma_f32_16x16x32_bf16 v[148:151], a[208:211], a[144:147], v[148:151]
    v_cvt_pk_bf16_f32 v44, v140, v141
    v_add_f32 v202, v202, v142
    v_mfma_f32_16x16x32_bf16 v[152:155], a[208:211], a[160:163], v[168:171]
    v_exp_f32 v144, v144
    v_mfma_f32_16x16x32_bf16 v[152:155], a[212:215], a[164:167], v[152:155]
    v_add_f32 v203, v203, v143
    v_cvt_pk_bf16_f32 v45, v142, v143
    v_mfma_f32_16x16x32_bf16 v[152:155], a[216:219], a[168:171], v[152:155]
    v_exp_f32 v145, v145
    v_mfma_f32_16x16x32_bf16 v[152:155], a[220:223], a[172:175], v[152:155]
    v_add_f32 v196, v196, v144
    v_add_f32 v197, v197, v145
    v_mfma_f32_16x16x32_bf16 v[156:159], a[220:223], a[188:191], v[172:175]
    v_exp_f32 v146, v146
    v_mfma_f32_16x16x32_bf16 v[156:159], a[216:219], a[184:187], v[156:159]
    v_cvt_pk_bf16_f32 v34, v144, v145
    v_add_f32 v196, v196, v146
    v_mfma_f32_16x16x32_bf16 v[156:159], a[212:215], a[180:183], v[156:159]
    s_waitcnt lgkmcnt(0)
    v_exp_f32 v147, v147
    v_mfma_f32_16x16x32_bf16 v[156:159], a[208:211], a[176:179], v[156:159]
    v_add_f32 v197, v197, v147
    v_cvt_pk_bf16_f32 v35, v146, v147
    v_mfma_f32_16x16x32_bf16 a[80:83], a[252:255], v[112:115], a[80:83]
    v_exp_f32 v148, v148
    v_mfma_f32_16x16x32_bf16 a[80:83], a[248:251], v[96:99], a[80:83]
    ds_read_b128 a[192:195], v204 offset:24576
    ds_read_b128 a[196:199], v205 offset:24576
    v_mfma_f32_16x16x32_bf16 a[80:83], a[244:247], v[80:83], a[80:83]
    v_exp_f32 v149, v149
    v_mfma_f32_16x16x32_bf16 a[80:83], a[240:243], v[64:67], a[80:83]
    ds_read_b128 a[200:203], v206 offset:24576
    ds_read_b128 a[204:207], v207 offset:24576
    v_mfma_f32_16x16x32_bf16 a[84:87], a[240:243], v[68:71], a[84:87]
    v_exp_f32 v150, v150
    v_mfma_f32_16x16x32_bf16 a[84:87], a[244:247], v[84:87], a[84:87]
    ds_read_b64_tr_b16 a[224:225], v214 offset:32768
    ds_read_b64_tr_b16 a[226:227], v214 offset:36864
    v_mfma_f32_16x16x32_bf16 a[84:87], a[248:251], v[100:103], a[84:87]
    v_exp_f32 v151, v151
    v_mfma_f32_16x16x32_bf16 a[84:87], a[252:255], v[116:119], a[84:87]
    ds_read_b64_tr_b16 a[228:229], v214 offset:40960
    ds_read_b64_tr_b16 a[230:231], v214 offset:45056
    v_mfma_f32_16x16x32_bf16 a[88:91], a[252:255], v[120:123], a[88:91]
    v_exp_f32 v152, v152
    v_mfma_f32_16x16x32_bf16 a[88:91], a[248:251], v[104:107], a[88:91]
    v_add_f32 v198, v198, v148
    v_add_f32 v199, v199, v149
    v_mfma_f32_16x16x32_bf16 a[88:91], a[244:247], v[88:91], a[88:91]
    v_exp_f32 v153, v153
    v_mfma_f32_16x16x32_bf16 a[88:91], a[240:243], v[72:75], a[88:91]
    v_cvt_pk_bf16_f32 v38, v148, v149
    v_add_f32 v198, v198, v150
    v_mfma_f32_16x16x32_bf16 a[92:95], a[240:243], v[76:79], a[92:95]
    v_exp_f32 v154, v154
    v_mfma_f32_16x16x32_bf16 a[92:95], a[244:247], v[92:95], a[92:95]
    v_add_f32 v199, v199, v151
    v_cvt_pk_bf16_f32 v39, v150, v151
    v_mfma_f32_16x16x32_bf16 a[92:95], a[248:251], v[108:111], a[92:95]
    s_waitcnt lgkmcnt(4)
    v_exp_f32 v155, v155
    v_mfma_f32_16x16x32_bf16 a[92:95], a[252:255], v[124:127], a[92:95]
    v_add_f32 v200, v200, v152
    v_add_f32 v201, v201, v153
    v_mfma_f32_16x16x32_bf16 v[184:187], v[192:195], v[72:75], v[184:187]
    v_cvt_pk_bf16_f32 v42, v152, v153
    v_add_f32 v200, v200, v154
    v_mfma_f32_16x16x32_bf16 v[184:187], v[192:195], v[88:91], v[184:187]
    v_add_f32 v201, v201, v155
    v_cvt_pk_bf16_f32 v43, v154, v155
    v_mfma_f32_16x16x32_bf16 v[128:131], a[192:195], a[128:131], v[160:163]
    v_exp_f32 v156, v156
    v_mfma_f32_16x16x32_bf16 v[128:131], a[196:199], a[132:135], v[128:131]
    ds_read_b64_tr_b16 a[232:233], v214 offset:49152
    ds_read_b64_tr_b16 a[234:235], v214 offset:53248
    v_mfma_f32_16x16x32_bf16 v[128:131], a[200:203], a[136:139], v[128:131]
    v_exp_f32 v157, v157
    v_mfma_f32_16x16x32_bf16 v[128:131], a[204:207], a[140:143], v[128:131]
    ds_read_b64_tr_b16 a[236:237], v214 offset:57344
    ds_read_b64_tr_b16 a[238:239], v214 offset:61440
    v_mfma_f32_16x16x32_bf16 v[132:135], a[204:207], a[156:159], v[164:167]
    v_exp_f32 v158, v158
    v_mfma_f32_16x16x32_bf16 v[132:135], a[200:203], a[152:155], v[132:135]
    v_add_f32 v202, v202, v156
    v_add_f32 v203, v203, v157
    v_mfma_f32_16x16x32_bf16 v[132:135], a[196:199], a[148:151], v[132:135]
    v_exp_f32 v159, v159
    v_mfma_f32_16x16x32_bf16 v[132:135], a[192:195], a[144:147], v[132:135]
    v_cvt_pk_bf16_f32 v46, v156, v157
    v_add_f32 v202, v202, v158
    v_mfma_f32_16x16x32_bf16 v[136:139], a[192:195], a[160:163], v[168:171]
    v_exp_f32 v128, v128
    v_mfma_f32_16x16x32_bf16 v[136:139], a[196:199], a[164:167], v[136:139]
    v_add_f32 v196, v196, v128
    v_add_f32 v203, v203, v159
    v_mfma_f32_16x16x32_bf16 v[136:139], a[200:203], a[168:171], v[136:139]
    v_exp_f32 v129, v129
    v_mfma_f32_16x16x32_bf16 v[136:139], a[204:207], a[172:175], v[136:139]
    v_add_f32 v197, v197, v129
    v_cvt_pk_bf16_f32 v48, v128, v129
    v_mfma_f32_16x16x32_bf16 v[140:143], a[204:207], a[188:191], v[172:175]
    v_exp_f32 v130, v130
    v_mfma_f32_16x16x32_bf16 v[140:143], a[200:203], a[184:187], v[140:143]
    v_add_f32 v196, v196, v130
    v_cvt_pk_bf16_f32 v47, v158, v159
    v_mfma_f32_16x16x32_bf16 v[140:143], a[196:199], a[180:183], v[140:143]
    s_waitcnt lgkmcnt(0)
    v_exp_f32 v131, v131
    v_mfma_f32_16x16x32_bf16 v[140:143], a[192:195], a[176:179], v[140:143]
    v_add_f32 v197, v197, v131
    v_cvt_pk_bf16_f32 v49, v130, v131
    v_mfma_f32_16x16x32_bf16 a[96:99], a[236:239], v[112:115], a[96:99]
    v_exp_f32 v132, v132
    v_mfma_f32_16x16x32_bf16 a[96:99], a[232:235], v[96:99], a[96:99]
    ds_read_b128 a[208:211], v204 offset:28672
    ds_read_b128 a[212:215], v205 offset:28672
    v_mfma_f32_16x16x32_bf16 a[96:99], a[228:231], v[80:83], a[96:99]
    v_exp_f32 v133, v133
    v_mfma_f32_16x16x32_bf16 a[96:99], a[224:227], v[64:67], a[96:99]
    ds_read_b128 a[216:219], v206 offset:28672
    ds_read_b128 a[220:223], v207 offset:28672
    v_mfma_f32_16x16x32_bf16 a[100:103], a[224:227], v[68:71], a[100:103]
    v_exp_f32 v134, v134
    v_mfma_f32_16x16x32_bf16 a[100:103], a[228:231], v[84:87], a[100:103]
    ds_read_b64_tr_b16 a[240:241], v215 offset:32768
    ds_read_b64_tr_b16 a[242:243], v215 offset:36864
    v_mfma_f32_16x16x32_bf16 a[100:103], a[232:235], v[100:103], a[100:103]
    v_exp_f32 v135, v135
    v_mfma_f32_16x16x32_bf16 a[100:103], a[236:239], v[116:119], a[100:103]
    ds_read_b64_tr_b16 a[244:245], v215 offset:40960
    ds_read_b64_tr_b16 a[246:247], v215 offset:45056
    v_mfma_f32_16x16x32_bf16 a[104:107], a[236:239], v[120:123], a[104:107]
    v_exp_f32 v136, v136
    v_mfma_f32_16x16x32_bf16 a[104:107], a[232:235], v[104:107], a[104:107]
    v_add_f32 v198, v198, v132
    v_add_f32 v199, v199, v133
    v_mfma_f32_16x16x32_bf16 a[104:107], a[228:231], v[88:91], a[104:107]
    v_exp_f32 v137, v137
    v_mfma_f32_16x16x32_bf16 a[104:107], a[224:227], v[72:75], a[104:107]
    v_cvt_pk_bf16_f32 v52, v132, v133
    v_add_f32 v198, v198, v134
    v_mfma_f32_16x16x32_bf16 a[108:111], a[224:227], v[76:79], a[108:111]
    v_exp_f32 v138, v138
    v_mfma_f32_16x16x32_bf16 a[108:111], a[228:231], v[92:95], a[108:111]
    v_add_f32 v199, v199, v135
    v_cvt_pk_bf16_f32 v53, v134, v135
    v_mfma_f32_16x16x32_bf16 a[108:111], a[232:235], v[108:111], a[108:111]
    s_waitcnt lgkmcnt(4)
    v_exp_f32 v139, v139
    v_mfma_f32_16x16x32_bf16 a[108:111], a[236:239], v[124:127], a[108:111]
    v_add_f32 v200, v200, v136
    v_add_f32 v201, v201, v137
    v_mfma_f32_16x16x32_bf16 v[188:191], v[192:195], v[76:79], v[188:191]
    v_cvt_pk_bf16_f32 v56, v136, v137
    v_add_f32 v200, v200, v138
    v_mfma_f32_16x16x32_bf16 v[188:191], v[192:195], v[92:95], v[188:191]
    v_add_f32 v201, v201, v139
    v_cvt_pk_bf16_f32 v57, v138, v139
    v_mfma_f32_16x16x32_bf16 v[144:147], a[208:211], a[128:131], v[160:163]
    v_exp_f32 v140, v140
    v_mfma_f32_16x16x32_bf16 v[144:147], a[212:215], a[132:135], v[144:147]
    ds_read_b64_tr_b16 a[248:249], v215 offset:49152
    ds_read_b64_tr_b16 a[250:251], v215 offset:53248
    v_mfma_f32_16x16x32_bf16 v[144:147], a[216:219], a[136:139], v[144:147]
    s_cmp_eq_u32 s35, 7
    v_exp_f32 v141, v141
    v_mfma_f32_16x16x32_bf16 v[144:147], a[220:223], a[140:143], v[144:147]
    ds_read_b64_tr_b16 a[252:253], v215 offset:57344
    ds_read_b64_tr_b16 a[254:255], v215 offset:61440
    v_mfma_f32_16x16x32_bf16 v[148:151], a[220:223], a[156:159], v[164:167]
    v_exp_f32 v142, v142
    v_mfma_f32_16x16x32_bf16 v[148:151], a[216:219], a[152:155], v[148:151]
    v_add_f32 v202, v202, v140
    v_add_f32 v203, v203, v141
    v_mfma_f32_16x16x32_bf16 v[148:151], a[212:215], a[148:151], v[148:151]
    v_exp_f32 v143, v143
    v_mfma_f32_16x16x32_bf16 v[148:151], a[208:211], a[144:147], v[148:151]
    v_cvt_pk_bf16_f32 v60, v140, v141
    v_add_f32 v202, v202, v142
    v_mfma_f32_16x16x32_bf16 v[152:155], a[208:211], a[160:163], v[168:171]
    v_exp_f32 v144, v144
    v_mfma_f32_16x16x32_bf16 v[152:155], a[212:215], a[164:167], v[152:155]
    v_add_f32 v203, v203, v143
    v_cvt_pk_bf16_f32 v61, v142, v143
    v_mfma_f32_16x16x32_bf16 v[152:155], a[216:219], a[168:171], v[152:155]
    v_exp_f32 v145, v145
    v_mfma_f32_16x16x32_bf16 v[152:155], a[220:223], a[172:175], v[152:155]
    v_add_f32 v196, v196, v144
    v_add_f32 v197, v197, v145
    v_mfma_f32_16x16x32_bf16 v[156:159], a[220:223], a[188:191], v[172:175]
    s_waitcnt vmcnt(0) lgkmcnt(0)
    v_exp_f32 v146, v146
    v_mfma_f32_16x16x32_bf16 v[156:159], a[216:219], a[184:187], v[156:159]
    v_cvt_pk_bf16_f32 v50, v144, v145
    v_add_f32 v196, v196, v146
    v_mfma_f32_16x16x32_bf16 v[156:159], a[212:215], a[180:183], v[156:159]
    s_barrier
    v_exp_f32 v147, v147
    v_mfma_f32_16x16x32_bf16 v[156:159], a[208:211], a[176:179], v[156:159]
    v_add_f32 v197, v197, v147
    v_cvt_pk_bf16_f32 v51, v146, v147
    v_mfma_f32_16x16x32_bf16 a[112:115], a[252:255], v[112:115], a[112:115]
    v_exp_f32 v148, v148
    v_mfma_f32_16x16x32_bf16 a[112:115], a[248:251], v[96:99], a[112:115]
    ds_read_b128 a[192:195], v204 offset:32768
    ds_read_b128 a[196:199], v205 offset:32768
    v_mfma_f32_16x16x32_bf16 a[112:115], a[244:247], v[80:83], a[112:115]
    v_exp_f32 v149, v149
    v_mfma_f32_16x16x32_bf16 a[112:115], a[240:243], v[64:67], a[112:115]
    ds_read_b128 a[200:203], v206 offset:32768
    ds_read_b128 a[204:207], v207 offset:32768
    v_mfma_f32_16x16x32_bf16 a[116:119], a[240:243], v[68:71], a[116:119]
    v_exp_f32 v150, v150
    v_mfma_f32_16x16x32_bf16 a[116:119], a[244:247], v[84:87], a[116:119]
    ds_read_b64_tr_b16 a[224:225], v208 offset:0
    ds_read_b64_tr_b16 a[226:227], v208 offset:4096
    v_mfma_f32_16x16x32_bf16 a[116:119], a[248:251], v[100:103], a[116:119]
    v_exp_f32 v151, v151
    v_mfma_f32_16x16x32_bf16 a[116:119], a[252:255], v[116:119], a[116:119]
    ds_read_b64_tr_b16 a[228:229], v208 offset:8192
    ds_read_b64_tr_b16 a[230:231], v208 offset:12288
    v_mfma_f32_16x16x32_bf16 a[120:123], a[252:255], v[120:123], a[120:123]
    v_exp_f32 v152, v152
    v_mfma_f32_16x16x32_bf16 a[120:123], a[248:251], v[104:107], a[120:123]
    v_add_f32 v198, v198, v148
    v_add_f32 v199, v199, v149
    v_mfma_f32_16x16x32_bf16 a[120:123], a[244:247], v[88:91], a[120:123]
    v_exp_f32 v153, v153
    v_mfma_f32_16x16x32_bf16 a[120:123], a[240:243], v[72:75], a[120:123]
    v_cvt_pk_bf16_f32 v54, v148, v149
    v_add_f32 v198, v198, v150
    v_mfma_f32_16x16x32_bf16 a[124:127], a[240:243], v[76:79], a[124:127]
    v_exp_f32 v154, v154
    v_mfma_f32_16x16x32_bf16 a[124:127], a[244:247], v[92:95], a[124:127]
    v_add_f32 v199, v199, v151
    v_cvt_pk_bf16_f32 v55, v150, v151
    v_mfma_f32_16x16x32_bf16 a[124:127], a[248:251], v[108:111], a[124:127]
    s_waitcnt lgkmcnt(4)
    v_exp_f32 v155, v155
    v_mfma_f32_16x16x32_bf16 a[124:127], a[252:255], v[124:127], a[124:127]
    v_add_f32 v200, v200, v152
    v_add_f32 v201, v201, v153
    s_cbranch_scc0 F_LOOP
F_LAST:
    v_mfma_f32_16x16x32_bf16 v[128:131], a[192:195], a[128:131], v[160:163]
    v_exp_f32 v156, v156
    v_mfma_f32_16x16x32_bf16 v[128:131], a[196:199], a[132:135], v[128:131]
    ds_read_b64_tr_b16 a[232:233], v208 offset:16384
    ds_read_b64_tr_b16 a[234:235], v208 offset:20480
    v_mfma_f32_16x16x32_bf16 v[128:131], a[200:203], a[136:139], v[128:131]
    v_exp_f32 v157, v157
    v_mfma_f32_16x16x32_bf16 v[128:131], a[204:207], a[140:143], v[128:131]
    ds_read_b64_tr_b16 a[238:239], v208 offset:28672
    ds_read_b64_tr_b16 a[236:237], v208 offset:24576
    v_mfma_f32_16x16x32_bf16 v[132:135], a[204:207], a[156:159], v[164:167]
    s_add_u32 m0, s30, 98304
    v_exp_f32 v158, v158
    v_mfma_f32_16x16x32_bf16 v[132:135], a[200:203], a[152:155], v[132:135]
    buffer_load_dwordx4 v220, s[12:15], s33 offen offset:0 lds
    v_mfma_f32_16x16x32_bf16 v[132:135], a[196:199], a[148:151], v[132:135]
    v_exp_f32 v159, v159
    v_mfma_f32_16x16x32_bf16 v[132:135], a[192:195], a[144:147], v[132:135]
    v_add_f32 v200, v200, v154
    v_cvt_pk_bf16_f32 v58, v152, v153
    v_mfma_f32_16x16x32_bf16 v[136:139], a[192:195], a[160:163], v[168:171]
    v_cvt_pk_bf16_f32 v59, v154, v155
    v_add_f32 v201, v201, v155
    v_mfma_f32_16x16x32_bf16 v[136:139], a[196:199], a[164:167], v[136:139]
    v_add_f32 v202, v202, v156
    v_add_f32 v203, v203, v157
    v_mfma_f32_16x16x32_bf16 v[136:139], a[200:203], a[168:171], v[136:139]
    v_add_f32 v202, v202, v158
    v_cvt_pk_bf16_f32 v62, v156, v157
    v_mfma_f32_16x16x32_bf16 v[136:139], a[204:207], a[172:175], v[136:139]
    buffer_load_dwordx4 v221, s[12:15], s33 offen offset:1024 lds
    v_mfma_f32_16x16x32_bf16 v[140:143], a[204:207], a[188:191], v[172:175]
    v_cvt_pk_bf16_f32 v63, v158, v159
    v_add_f32 v203, v203, v159
    v_mfma_f32_16x16x32_bf16 v[140:143], a[200:203], a[184:187], v[140:143]
    v_exp_f32 v128, v128
    v_mfma_f32_16x16x32_bf16 v[140:143], a[196:199], a[180:183], v[140:143]
    s_waitcnt lgkmcnt(0)
    v_exp_f32 v129, v129
    v_mfma_f32_16x16x32_bf16 v[140:143], a[192:195], a[176:179], v[140:143]
    v_exp_f32 v130, v130
    v_mfma_f32_16x16x32_bf16 a[0:3], a[236:239], v[48:51], a[0:3]
    v_exp_f32 v131, v131
    v_mfma_f32_16x16x32_bf16 a[0:3], a[232:235], v[32:35], a[0:3]
    ds_read_b128 a[208:211], v204 offset:36864
    ds_read_b128 a[212:215], v205 offset:36864
    v_mfma_f32_16x16x32_bf16 a[0:3], a[228:231], v[16:19], a[0:3]
    buffer_load_dwordx4 v220, s[12:15], s33 offen offset:2048 lds
    v_mfma_f32_16x16x32_bf16 a[0:3], a[224:227], v[0:3], a[0:3]
    ds_read_b128 a[216:219], v206 offset:36864
    ds_read_b128 a[220:223], v207 offset:36864
    v_mfma_f32_16x16x32_bf16 a[4:7], a[224:227], v[4:7], a[4:7]
    v_cvt_pk_bf16_f32 v64, v128, v129
    v_cvt_pk_bf16_f32 v65, v130, v131
    v_add_f32 v196, v196, v197
    v_mfma_f32_16x16x32_bf16 a[4:7], a[228:231], v[20:23], a[4:7]
    v_exp_f32 v132, v132
    v_mfma_f32_16x16x32_bf16 a[4:7], a[232:235], v[36:39], a[4:7]
    v_exp_f32 v133, v133
    v_mfma_f32_16x16x32_bf16 a[4:7], a[236:239], v[52:55], a[4:7]
    v_exp_f32 v134, v134
    v_mfma_f32_16x16x32_bf16 a[8:11], a[236:239], v[56:59], a[8:11]
    buffer_load_dwordx4 v221, s[12:15], s33 offen offset:3072 lds
    v_mfma_f32_16x16x32_bf16 a[8:11], a[232:235], v[40:43], a[8:11]
    v_exp_f32 v135, v135
    v_mfma_f32_16x16x32_bf16 a[8:11], a[228:231], v[24:27], a[8:11]
    v_cvt_pk_bf16_f32 v68, v132, v133
    v_cvt_pk_bf16_f32 v69, v134, v135
    v_add_f32 v197, v198, v199
    v_mfma_f32_16x16x32_bf16 a[8:11], a[224:227], v[8:11], a[8:11]
    s_waitcnt lgkmcnt(0)
    v_exp_f32 v136, v136
    v_mfma_f32_16x16x32_bf16 a[12:15], a[224:227], v[12:15], a[12:15]
    ds_read_b64_tr_b16 a[240:241], v209 offset:0
    ds_read_b64_tr_b16 a[242:243], v209 offset:4096
    v_mfma_f32_16x16x32_bf16 v[144:147], a[208:211], a[128:131], v[160:163]
    v_exp_f32 v137, v137
    v_mfma_f32_16x16x32_bf16 v[144:147], a[212:215], a[132:135], v[144:147]
    ds_read_b64_tr_b16 a[244:245], v209 offset:8192
    ds_read_b64_tr_b16 a[246:247], v209 offset:12288
    v_mfma_f32_16x16x32_bf16 v[144:147], a[216:219], a[136:139], v[144:147]
    v_exp_f32 v138, v138
    v_mfma_f32_16x16x32_bf16 v[144:147], a[220:223], a[140:143], v[144:147]
    ds_read_b64_tr_b16 a[248:249], v209 offset:16384
    ds_read_b64_tr_b16 a[250:251], v209 offset:20480
    v_mfma_f32_16x16x32_bf16 v[148:151], a[220:223], a[156:159], v[164:167]
    v_exp_f32 v139, v139
    v_mfma_f32_16x16x32_bf16 v[148:151], a[216:219], a[152:155], v[148:151]
    ds_read_b64_tr_b16 a[252:253], v209 offset:24576
    ds_read_b64_tr_b16 a[254:255], v209 offset:28672
    v_mfma_f32_16x16x32_bf16 v[148:151], a[212:215], a[148:151], v[148:151]
    s_add_u32 m0, s30, 102400
    v_cvt_pk_bf16_f32 v72, v136, v137
    v_cvt_pk_bf16_f32 v73, v138, v139
    v_add_f32 v198, v200, v201
    v_mfma_f32_16x16x32_bf16 v[148:151], a[208:211], a[144:147], v[148:151]
    buffer_load_dwordx4 v220, s[12:15], s34 offen offset:0 lds
    v_mfma_f32_16x16x32_bf16 v[152:155], a[208:211], a[160:163], v[168:171]
    v_exp_f32 v140, v140
    v_mfma_f32_16x16x32_bf16 v[152:155], a[212:215], a[164:167], v[152:155]
    v_exp_f32 v141, v141
    v_mfma_f32_16x16x32_bf16 v[152:155], a[216:219], a[168:171], v[152:155]
    v_exp_f32 v142, v142
    v_mfma_f32_16x16x32_bf16 v[152:155], a[220:223], a[172:175], v[152:155]
    v_exp_f32 v143, v143
    v_mfma_f32_16x16x32_bf16 v[156:159], a[220:223], a[188:191], v[172:175]
    v_cvt_pk_bf16_f32 v76, v140, v141
    v_cvt_pk_bf16_f32 v77, v142, v143
    v_add_f32 v199, v202, v203
    v_mfma_f32_16x16x32_bf16 v[156:159], a[216:219], a[184:187], v[156:159]
    buffer_load_dwordx4 v221, s[12:15], s34 offen offset:1024 lds
    v_mfma_f32_16x16x32_bf16 v[156:159], a[212:215], a[180:183], v[156:159]
    v_exp_f32 v144, v144
    v_mfma_f32_16x16x32_bf16 v[156:159], a[208:211], a[176:179], v[156:159]
    v_exp_f32 v145, v145
    v_mfma_f32_16x16x32_bf16 a[12:15], a[228:231], v[28:31], a[12:15]
    v_exp_f32 v146, v146
    v_mfma_f32_16x16x32_bf16 a[12:15], a[232:235], v[44:47], a[12:15]
    ds_read_b128 a[192:195], v204 offset:40960
    ds_read_b128 a[196:199], v205 offset:40960
    v_mfma_f32_16x16x32_bf16 a[12:15], a[236:239], v[60:63], a[12:15]
    s_waitcnt lgkmcnt(2)
    v_exp_f32 v147, v147
    v_mfma_f32_16x16x32_bf16 a[16:19], a[252:255], v[48:51], a[16:19]
    ds_read_b128 a[200:203], v206 offset:40960
    ds_read_b128 a[204:207], v207 offset:40960
    v_mfma_f32_16x16x32_bf16 a[16:19], a[248:251], v[32:35], a[16:19]
    buffer_load_dwordx4 v220, s[12:15], s34 offen offset:2048 lds
    v_mfma_f32_16x16x32_bf16 a[16:19], a[244:247], v[16:19], a[16:19]
    v_cvt_pk_bf16_f32 v66, v144, v145
    v_cvt_pk_bf16_f32 v67, v146, v147
    v_mov_b32 v200, v196
    v_mfma_f32_16x16x32_bf16 a[16:19], a[240:243], v[0:3], a[16:19]
    v_exp_f32 v148, v148
    v_mfma_f32_16x16x32_bf16 a[20:23], a[240:243], v[4:7], a[20:23]
    v_exp_f32 v149, v149
    v_mfma_f32_16x16x32_bf16 a[20:23], a[244:247], v[20:23], a[20:23]
    v_exp_f32 v150, v150
    v_mfma_f32_16x16x32_bf16 a[20:23], a[248:251], v[36:39], a[20:23]
    v_exp_f32 v151, v151
    v_mfma_f32_16x16x32_bf16 a[20:23], a[252:255], v[52:55], a[20:23]
    buffer_load_dwordx4 v221, s[12:15], s34 offen offset:3072 lds
    v_mfma_f32_16x16x32_bf16 a[24:27], a[252:255], v[56:59], a[24:27]
    s_waitcnt lgkmcnt(0)
    v_cvt_pk_bf16_f32 v70, v148, v149
    v_cvt_pk_bf16_f32 v71, v150, v151
    v_mov_b32 v201, v197
    v_mfma_f32_16x16x32_bf16 a[24:27], a[248:251], v[40:43], a[24:27]
    v_exp_f32 v152, v152
    v_mfma_f32_16x16x32_bf16 v[128:131], a[192:195], a[128:131], v[160:163]
    v_exp_f32 v153, v153
    v_mfma_f32_16x16x32_bf16 v[128:131], a[196:199], a[132:135], v[128:131]
    v_exp_f32 v154, v154
    v_mfma_f32_16x16x32_bf16 v[128:131], a[200:203], a[136:139], v[128:131]
    s_lshl1_add_u32 s31, s79, s1
    s_add_u32 m0, s30, 0
    v_exp_f32 v155, v155
    v_mfma_f32_16x16x32_bf16 v[128:131], a[204:207], a[140:143], v[128:131]
    buffer_load_dwordx4 v222, s[48:51], s31 offen offset:0 sc1 lds
    v_mfma_f32_16x16x32_bf16 v[132:135], a[204:207], a[156:159], v[164:167]
    v_cvt_pk_bf16_f32 v74, v152, v153
    v_cvt_pk_bf16_f32 v75, v154, v155
    v_mov_b32 v202, v198
    v_mfma_f32_16x16x32_bf16 v[132:135], a[200:203], a[152:155], v[132:135]
    v_exp_f32 v156, v156
    v_mfma_f32_16x16x32_bf16 v[132:135], a[196:199], a[148:151], v[132:135]
    v_exp_f32 v157, v157
    v_mfma_f32_16x16x32_bf16 v[132:135], a[192:195], a[144:147], v[132:135]
    v_exp_f32 v158, v158
    v_mfma_f32_16x16x32_bf16 v[136:139], a[192:195], a[160:163], v[168:171]
    v_exp_f32 v159, v159
    v_mfma_f32_16x16x32_bf16 v[136:139], a[196:199], a[164:167], v[136:139]
    buffer_load_dwordx4 v222, s[48:51], s31 offen offset:1024 sc1 lds
    v_mfma_f32_16x16x32_bf16 v[136:139], a[200:203], a[168:171], v[136:139]
    v_cvt_pk_bf16_f32 v78, v156, v157
    v_cvt_pk_bf16_f32 v79, v158, v159
    v_mov_b32 v203, v199
    v_mfma_f32_16x16x32_bf16 v[136:139], a[204:207], a[172:175], v[136:139]
    v_exp_f32 v128, v128
    v_mfma_f32_16x16x32_bf16 v[140:143], a[204:207], a[188:191], v[172:175]
    v_exp_f32 v129, v129
    v_mfma_f32_16x16x32_bf16 v[140:143], a[200:203], a[184:187], v[140:143]
    v_exp_f32 v130, v130
    v_mfma_f32_16x16x32_bf16 v[140:143], a[196:199], a[180:183], v[140:143]
    v_exp_f32 v131, v131
    v_mfma_f32_16x16x32_bf16 v[140:143], a[192:195], a[176:179], v[140:143]
    buffer_load_dwordx4 v222, s[48:51], s31 offen offset:2048 sc1 lds
    v_mfma_f32_16x16x32_bf16 a[24:27], a[244:247], v[24:27], a[24:27]
    v_cvt_pk_bf16_f32 v80, v128, v129
    v_cvt_pk_bf16_f32 v81, v130, v131
    v_permlane16_swap_b32 v196, v200
    v_mfma_f32_16x16x32_bf16 a[24:27], a[240:243], v[8:11], a[24:27]
    ds_read_b128 a[208:211], v204 offset:45056
    ds_read_b128 a[212:215], v205 offset:45056
    v_mfma_f32_16x16x32_bf16 a[28:31], a[240:243], v[12:15], a[28:31]
    v_exp_f32 v132, v132
    v_mfma_f32_16x16x32_bf16 a[28:31], a[244:247], v[28:31], a[28:31]
    ds_read_b128 a[216:219], v206 offset:45056
    ds_read_b128 a[220:223], v207 offset:45056
    v_mfma_f32_16x16x32_bf16 a[28:31], a[248:251], v[44:47], a[28:31]
    v_exp_f32 v133, v133
    v_mfma_f32_16x16x32_bf16 a[28:31], a[252:255], v[60:63], a[28:31]
    buffer_load_dwordx4 v222, s[48:51], s31 offen offset:3072 sc1 lds
    v_mfma_f32_16x16x32_bf16 v[176:179], v[192:195], v[0:3], v[176:179]
    v_exp_f32 v134, v134
    v_mfma_f32_16x16x32_bf16 v[180:183], v[192:195], v[4:7], v[180:183]
    v_exp_f32 v135, v135
    v_mfma_f32_16x16x32_bf16 v[184:187], v[192:195], v[8:11], v[184:187]
    v_cvt_pk_bf16_f32 v84, v132, v133
    v_cvt_pk_bf16_f32 v85, v134, v135
    v_permlane16_swap_b32 v197, v201
    v_mfma_f32_16x16x32_bf16 v[188:191], v[192:195], v[12:15], v[188:191]
    v_exp_f32 v136, v136
    v_mfma_f32_16x16x32_bf16 v[176:179], v[192:195], v[16:19], v[176:179]
    ds_read_b64_tr_b16 a[224:225], v210 offset:0
    ds_read_b64_tr_b16 a[226:227], v210 offset:4096
    v_mfma_f32_16x16x32_bf16 v[180:183], v[192:195], v[20:23], v[180:183]
    s_waitcnt lgkmcnt(2)
    v_exp_f32 v137, v137
    v_mfma_f32_16x16x32_bf16 v[184:187], v[192:195], v[24:27], v[184:187]
    ds_read_b64_tr_b16 a[228:229], v210 offset:8192
    ds_read_b64_tr_b16 a[230:231], v210 offset:12288
    v_mfma_f32_16x16x32_bf16 v[144:147], a[208:211], a[128:131], v[160:163]
    v_exp_f32 v138, v138
    v_mfma_f32_16x16x32_bf16 v[144:147], a[212:215], a[132:135], v[144:147]
    ds_read_b64_tr_b16 a[232:233], v210 offset:16384
    ds_read_b64_tr_b16 a[234:235], v210 offset:20480
    v_mfma_f32_16x16x32_bf16 v[144:147], a[216:219], a[136:139], v[144:147]
    v_exp_f32 v139, v139
    v_mfma_f32_16x16x32_bf16 v[144:147], a[220:223], a[140:143], v[144:147]
    ds_read_b64_tr_b16 a[236:237], v210 offset:24576
    ds_read_b64_tr_b16 a[238:239], v210 offset:28672
    v_mfma_f32_16x16x32_bf16 v[148:151], a[220:223], a[156:159], v[164:167]
    s_add_u32 s32, s31, 4096
    s_add_u32 m0, s30, 4096
    v_cvt_pk_bf16_f32 v88, v136, v137
    v_cvt_pk_bf16_f32 v89, v138, v139
    v_permlane16_swap_b32 v198, v202
    v_mfma_f32_16x16x32_bf16 v[148:151], a[216:219], a[152:155], v[148:151]
    buffer_load_dwordx4 v222, s[48:51], s32 offen offset:0 sc1 lds
    v_mfma_f32_16x16x32_bf16 v[148:151], a[212:215], a[148:151], v[148:151]
    v_exp_f32 v140, v140
    v_mfma_f32_16x16x32_bf16 v[148:151], a[208:211], a[144:147], v[148:151]
    v_exp_f32 v141, v141
    v_mfma_f32_16x16x32_bf16 v[152:155], a[208:211], a[160:163], v[168:171]
    v_exp_f32 v142, v142
    v_mfma_f32_16x16x32_bf16 v[152:155], a[212:215], a[164:167], v[152:155]
    v_exp_f32 v143, v143
    v_mfma_f32_16x16x32_bf16 v[152:155], a[216:219], a[168:171], v[152:155]
    v_cvt_pk_bf16_f32 v92, v140, v141
    v_cvt_pk_bf16_f32 v93, v142, v143
    v_permlane16_swap_b32 v199, v203
    v_mfma_f32_16x16x32_bf16 v[152:155], a[220:223], a[172:175], v[152:155]
    buffer_load_dwordx4 v222, s[48:51], s32 offen offset:1024 sc1 lds
    v_mfma_f32_16x16x32_bf16 v[156:159], a[220:223], a[188:191], v[172:175]
    v_exp_f32 v144, v144
    v_mfma_f32_16x16x32_bf16 v[156:159], a[216:219], a[184:187], v[156:159]
    v_exp_f32 v145, v145
    v_mfma_f32_16x16x32_bf16 v[156:159], a[212:215], a[180:183], v[156:159]
    v_exp_f32 v146, v146
    v_mfma_f32_16x16x32_bf16 v[156:159], a[208:211], a[176:179], v[156:159]
    v_exp_f32 v147, v147
    v_mfma_f32_16x16x32_bf16 v[188:191], v[192:195], v[28:31], v[188:191]
    s_waitcnt lgkmcnt(0)
    v_cvt_pk_bf16_f32 v82, v144, v145
    v_cvt_pk_bf16_f32 v83, v146, v147
    v_add_f32 v196, v196, v200
    v_mfma_f32_16x16x32_bf16 a[32:35], a[236:239], v[48:51], a[32:35]
    ds_read_b128 a[192:195], v204 offset:49152
    ds_read_b128 a[196:199], v205 offset:49152
    v_mfma_f32_16x16x32_bf16 a[32:35], a[232:235], v[32:35], a[32:35]
    buffer_load_dwordx4 v222, s[48:51], s32 offen offset:2048 sc1 lds
    v_mfma_f32_16x16x32_bf16 a[32:35], a[228:231], v[16:19], a[32:35]
    ds_read_b128 a[200:203], v206 offset:49152
    ds_read_b128 a[204:207], v207 offset:49152
    v_mfma_f32_16x16x32_bf16 a[32:35], a[224:227], v[0:3], a[32:35]
    v_exp_f32 v148, v148
    v_mfma_f32_16x16x32_bf16 a[36:39], a[224:227], v[4:7], a[36:39]
    v_exp_f32 v149, v149
    v_mfma_f32_16x16x32_bf16 a[36:39], a[228:231], v[20:23], a[36:39]
    v_exp_f32 v150, v150
    v_mfma_f32_16x16x32_bf16 a[36:39], a[232:235], v[36:39], a[36:39]
    v_exp_f32 v151, v151
    v_mfma_f32_16x16x32_bf16 a[36:39], a[236:239], v[52:55], a[36:39]
    buffer_load_dwordx4 v222, s[48:51], s32 offen offset:3072 sc1 lds
    v_mfma_f32_16x16x32_bf16 a[40:43], a[236:239], v[56:59], a[40:43]
    v_cvt_pk_bf16_f32 v86, v148, v149
    v_cvt_pk_bf16_f32 v87, v150, v151
    v_add_f32 v197, v197, v201
    v_mfma_f32_16x16x32_bf16 a[40:43], a[232:235], v[40:43], a[40:43]
    v_exp_f32 v152, v152
    v_mfma_f32_16x16x32_bf16 a[40:43], a[228:231], v[24:27], a[40:43]
    s_waitcnt lgkmcnt(0)
    v_exp_f32 v153, v153
    v_mfma_f32_16x16x32_bf16 a[40:43], a[224:227], v[8:11], a[40:43]
    v_exp_f32 v154, v154
    v_mfma_f32_16x16x32_bf16 v[128:131], a[192:195], a[128:131], v[160:163]
    s_lshl1_add_u32 s31, s82, s1
    s_add_u32 m0, s30, 131072
    v_exp_f32 v155, v155
    v_mfma_f32_16x16x32_bf16 v[128:131], a[196:199], a[132:135], v[128:131]
    buffer_load_dwordx4 v222, s[48:51], s31 offen offset:0 sc1 lds
    v_mfma_f32_16x16x32_bf16 v[128:131], a[200:203], a[136:139], v[128:131]
    v_cvt_pk_bf16_f32 v90, v152, v153
    v_cvt_pk_bf16_f32 v91, v154, v155
    v_add_f32 v198, v198, v202
    v_mfma_f32_16x16x32_bf16 v[128:131], a[204:207], a[140:143], v[128:131]
    v_exp_f32 v156, v156
    v_mfma_f32_16x16x32_bf16 v[132:135], a[204:207], a[156:159], v[164:167]
    ds_read_b64_tr_b16 a[240:241], v211 offset:0
    ds_read_b64_tr_b16 a[242:243], v211 offset:4096
    v_mfma_f32_16x16x32_bf16 v[132:135], a[200:203], a[152:155], v[132:135]
    v_exp_f32 v157, v157
    v_mfma_f32_16x16x32_bf16 v[132:135], a[196:199], a[148:151], v[132:135]
    ds_read_b64_tr_b16 a[244:245], v211 offset:8192
    ds_read_b64_tr_b16 a[246:247], v211 offset:12288
    v_mfma_f32_16x16x32_bf16 v[132:135], a[192:195], a[144:147], v[132:135]
    buffer_load_dwordx4 v222, s[48:51], s31 offen offset:1024 sc1 lds
    v_mfma_f32_16x16x32_bf16 v[136:139], a[192:195], a[160:163], v[168:171]
    ds_read_b64_tr_b16 a[248:249], v211 offset:16384
    ds_read_b64_tr_b16 a[250:251], v211 offset:20480
    v_mfma_f32_16x16x32_bf16 v[136:139], a[196:199], a[164:167], v[136:139]
    v_exp_f32 v158, v158
    v_mfma_f32_16x16x32_bf16 v[136:139], a[200:203], a[168:171], v[136:139]
    ds_read_b64_tr_b16 a[252:253], v211 offset:24576
    ds_read_b64_tr_b16 a[254:255], v211 offset:28672
    v_mfma_f32_16x16x32_bf16 v[136:139], a[204:207], a[172:175], v[136:139]
    v_exp_f32 v159, v159
    v_mfma_f32_16x16x32_bf16 v[140:143], a[204:207], a[188:191], v[172:175]
    v_cvt_pk_bf16_f32 v94, v156, v157
    v_cvt_pk_bf16_f32 v95, v158, v159
    v_add_f32 v199, v199, v203
    v_mfma_f32_16x16x32_bf16 v[140:143], a[200:203], a[184:187], v[140:143]
    buffer_load_dwordx4 v222, s[48:51], s31 offen offset:2048 sc1 lds
    v_mfma_f32_16x16x32_bf16 v[140:143], a[196:199], a[180:183], v[140:143]
    v_exp_f32 v128, v128
    v_mfma_f32_16x16x32_bf16 v[140:143], a[192:195], a[176:179], v[140:143]
    v_exp_f32 v129, v129
    v_mfma_f32_16x16x32_bf16 a[44:47], a[224:227], v[12:15], a[44:47]
    v_exp_f32 v130, v130
    v_mfma_f32_16x16x32_bf16 a[44:47], a[228:231], v[28:31], a[44:47]
    ds_read_b128 a[208:211], v204 offset:53248
    ds_read_b128 a[212:215], v205 offset:53248
    v_mfma_f32_16x16x32_bf16 a[44:47], a[232:235], v[44:47], a[44:47]
    v_exp_f32 v131, v131
    v_mfma_f32_16x16x32_bf16 a[44:47], a[236:239], v[60:63], a[44:47]
    ds_read_b128 a[216:219], v206 offset:53248
    ds_read_b128 a[220:223], v207 offset:53248
    v_mfma_f32_16x16x32_bf16 v[176:179], v[192:195], v[64:67], v[176:179]
    s_waitcnt vmcnt(11)
    v_cvt_pk_bf16_f32 v96, v128, v129
    v_cvt_pk_bf16_f32 v97, v130, v131
    v_mov_b32 v200, v196
    v_mfma_f32_16x16x32_bf16 v[180:183], v[192:195], v[68:71], v[180:183]
    s_barrier
    v_exp_f32 v132, v132
    v_mfma_f32_16x16x32_bf16 v[184:187], v[192:195], v[72:75], v[184:187]
    buffer_load_dwordx4 v222, s[48:51], s31 offen offset:3072 sc1 lds
    v_mfma_f32_16x16x32_bf16 v[188:191], v[192:195], v[76:79], v[188:191]
    s_waitcnt lgkmcnt(4)
    v_exp_f32 v133, v133
    v_mfma_f32_16x16x32_bf16 a[48:51], a[252:255], v[48:51], a[48:51]
    v_exp_f32 v134, v134
    v_mfma_f32_16x16x32_bf16 a[48:51], a[248:251], v[32:35], a[48:51]
    v_exp_f32 v135, v135
    v_mfma_f32_16x16x32_bf16 a[48:51], a[244:247], v[16:19], a[48:51]
    v_cvt_pk_bf16_f32 v100, v132, v133
    v_cvt_pk_bf16_f32 v101, v134, v135
    v_mov_b32 v201, v197
    v_mfma_f32_16x16x32_bf16 a[48:51], a[240:243], v[0:3], a[48:51]
    v_exp_f32 v136, v136
    v_mfma_f32_16x16x32_bf16 a[52:55], a[240:243], v[4:7], a[52:55]
    s_waitcnt lgkmcnt(0)
    v_exp_f32 v137, v137
    v_mfma_f32_16x16x32_bf16 a[52:55], a[244:247], v[20:23], a[52:55]
    s_add_u32 s32, s31, 4096
    s_add_u32 m0, s30, 135168
    v_exp_f32 v138, v138
    v_mfma_f32_16x16x32_bf16 v[144:147], a[208:211], a[128:131], v[160:163]
    buffer_load_dwordx4 v222, s[48:51], s32 offen offset:0 sc1 lds
    v_mfma_f32_16x16x32_bf16 v[144:147], a[212:215], a[132:135], v[144:147]
    v_exp_f32 v139, v139
    v_mfma_f32_16x16x32_bf16 v[144:147], a[216:219], a[136:139], v[144:147]
    v_cvt_pk_bf16_f32 v104, v136, v137
    v_cvt_pk_bf16_f32 v105, v138, v139
    v_mov_b32 v202, v198
    v_mfma_f32_16x16x32_bf16 v[144:147], a[220:223], a[140:143], v[144:147]
    v_exp_f32 v140, v140
    v_mfma_f32_16x16x32_bf16 v[148:151], a[220:223], a[156:159], v[164:167]
    v_exp_f32 v141, v141
    v_mfma_f32_16x16x32_bf16 v[148:151], a[216:219], a[152:155], v[148:151]
    v_exp_f32 v142, v142
    v_mfma_f32_16x16x32_bf16 v[148:151], a[212:215], a[148:151], v[148:151]
    buffer_load_dwordx4 v222, s[48:51], s32 offen offset:1024 sc1 lds
    v_mfma_f32_16x16x32_bf16 v[148:151], a[208:211], a[144:147], v[148:151]
    v_exp_f32 v143, v143
    v_mfma_f32_16x16x32_bf16 v[152:155], a[208:211], a[160:163], v[168:171]
    v_cvt_pk_bf16_f32 v108, v140, v141
    v_cvt_pk_bf16_f32 v109, v142, v143
    v_mov_b32 v203, v199
    v_mfma_f32_16x16x32_bf16 v[152:155], a[212:215], a[164:167], v[152:155]
    v_exp_f32 v144, v144
    v_mfma_f32_16x16x32_bf16 v[152:155], a[216:219], a[168:171], v[152:155]
    v_exp_f32 v145, v145
    v_mfma_f32_16x16x32_bf16 v[152:155], a[220:223], a[172:175], v[152:155]
    v_exp_f32 v146, v146
    v_mfma_f32_16x16x32_bf16 v[156:159], a[220:223], a[188:191], v[172:175]
    buffer_load_dwordx4 v222, s[48:51], s32 offen offset:2048 sc1 lds
    v_mfma_f32_16x16x32_bf16 v[156:159], a[216:219], a[184:187], v[156:159]
    v_exp_f32 v147, v147
    v_mfma_f32_16x16x32_bf16 v[156:159], a[212:215], a[180:183], v[156:159]
    v_cvt_pk_bf16_f32 v98, v144, v145
    v_cvt_pk_bf16_f32 v99, v146, v147
    v_permlane32_swap_b32 v196, v200
    v_mfma_f32_16x16x32_bf16 v[156:159], a[208:211], a[176:179], v[156:159]
    v_exp_f32 v148, v148
    v_mfma_f32_16x16x32_bf16 a[52:55], a[248:251], v[36:39], a[52:55]
    v_exp_f32 v149, v149
    v_mfma_f32_16x16x32_bf16 a[52:55], a[252:255], v[52:55], a[52:55]
    ds_read_b128 a[192:195], v204 offset:57344
    ds_read_b128 a[196:199], v205 offset:57344
    v_mfma_f32_16x16x32_bf16 a[56:59], a[252:255], v[56:59], a[56:59]
    buffer_load_dwordx4 v222, s[48:51], s32 offen offset:3072 sc1 lds
    v_mfma_f32_16x16x32_bf16 a[56:59], a[248:251], v[40:43], a[56:59]
    ds_read_b128 a[200:203], v206 offset:57344
    ds_read_b128 a[204:207], v207 offset:57344
    v_mfma_f32_16x16x32_bf16 a[56:59], a[244:247], v[24:27], a[56:59]
    v_exp_f32 v150, v150
    v_mfma_f32_16x16x32_bf16 a[56:59], a[240:243], v[8:11], a[56:59]
    v_exp_f32 v151, v151
    v_mfma_f32_16x16x32_bf16 a[60:63], a[240:243], v[12:15], a[60:63]
    v_cvt_pk_bf16_f32 v102, v148, v149
    v_cvt_pk_bf16_f32 v103, v150, v151
    v_permlane32_swap_b32 v197, v201
    v_mfma_f32_16x16x32_bf16 a[60:63], a[244:247], v[28:31], a[60:63]
    s_lshl1_add_u32 s31, s74, s1
    v_exp_f32 v152, v152
    v_mfma_f32_16x16x32_bf16 a[60:63], a[248:251], v[44:47], a[60:63]
    buffer_load_dwordx4 v[224:227], v222, s[48:51], s31 offen offset:0 sc1
    v_mfma_f32_16x16x32_bf16 a[60:63], a[252:255], v[60:63], a[60:63]
    v_exp_f32 v153, v153
    v_mfma_f32_16x16x32_bf16 v[176:179], v[192:195], v[80:83], v[176:179]
    v_exp_f32 v154, v154
    v_mfma_f32_16x16x32_bf16 v[180:183], v[192:195], v[84:87], v[180:183]
    s_waitcnt lgkmcnt(0)
    v_exp_f32 v155, v155
    v_mfma_f32_16x16x32_bf16 v[184:187], v[192:195], v[88:91], v[184:187]
    v_cvt_pk_bf16_f32 v106, v152, v153
    v_cvt_pk_bf16_f32 v107, v154, v155
    v_permlane32_swap_b32 v198, v202
    v_mfma_f32_16x16x32_bf16 v[128:131], a[192:195], a[128:131], v[160:163]
    v_exp_f32 v156, v156
    v_mfma_f32_16x16x32_bf16 v[128:131], a[196:199], a[132:135], v[128:131]
    buffer_load_dwordx4 v[228:231], v222, s[48:51], s31 offen offset:1024 sc1
    v_mfma_f32_16x16x32_bf16 v[128:131], a[200:203], a[136:139], v[128:131]
    v_exp_f32 v157, v157
    v_mfma_f32_16x16x32_bf16 v[128:131], a[204:207], a[140:143], v[128:131]
    v_exp_f32 v158, v158
    v_mfma_f32_16x16x32_bf16 v[132:135], a[204:207], a[156:159], v[164:167]
    ds_read_b64_tr_b16 a[224:225], v208 offset:32768
    ds_read_b64_tr_b16 a[226:227], v208 offset:36864
    v_mfma_f32_16x16x32_bf16 v[132:135], a[200:203], a[152:155], v[132:135]
    v_exp_f32 v159, v159
    v_mfma_f32_16x16x32_bf16 v[132:135], a[196:199], a[148:151], v[132:135]
    ds_read_b64_tr_b16 a[228:229], v208 offset:40960
    ds_read_b64_tr_b16 a[230:231], v208 offset:45056
    v_mfma_f32_16x16x32_bf16 v[132:135], a[192:195], a[144:147], v[132:135]
    buffer_load_dwordx4 v[232:235], v222, s[48:51], s31 offen offset:2048 sc1
    v_mfma_f32_16x16x32_bf16 v[136:139], a[192:195], a[160:163], v[168:171]
    v_cvt_pk_bf16_f32 v110, v156, v157
    v_cvt_pk_bf16_f32 v111, v158, v159
    v_permlane32_swap_b32 v199, v203
    v_mfma_f32_16x16x32_bf16 v[136:139], a[196:199], a[164:167], v[136:139]
    v_exp_f32 v128, v128
    v_mfma_f32_16x16x32_bf16 v[136:139], a[200:203], a[168:171], v[136:139]
    v_exp_f32 v129, v129
    v_mfma_f32_16x16x32_bf16 v[136:139], a[204:207], a[172:175], v[136:139]
    v_exp_f32 v130, v130
    v_mfma_f32_16x16x32_bf16 v[140:143], a[204:207], a[188:191], v[172:175]
    ds_read_b64_tr_b16 a[240:241], v209 offset:32768
    ds_read_b64_tr_b16 a[242:243], v209 offset:36864
    v_mfma_f32_16x16x32_bf16 v[140:143], a[200:203], a[184:187], v[140:143]
    buffer_load_dwordx4 v[236:239], v222, s[48:51], s31 offen offset:3072 sc1
    v_mfma_f32_16x16x32_bf16 v[140:143], a[196:199], a[180:183], v[140:143]
    ds_read_b64_tr_b16 a[244:245], v209 offset:40960
    ds_read_b64_tr_b16 a[246:247], v209 offset:45056
    v_mfma_f32_16x16x32_bf16 v[140:143], a[192:195], a[176:179], v[140:143]
    v_exp_f32 v131, v131
    v_mfma_f32_16x16x32_bf16 v[188:191], v[192:195], v[92:95], v[188:191]
    s_waitcnt lgkmcnt(4)
    v_cvt_pk_bf16_f32 v112, v128, v129
    v_cvt_pk_bf16_f32 v113, v130, v131
    v_add_f32 v196, v196, v200
    v_mfma_f32_16x16x32_bf16 a[0:3], a[224:227], v[64:67], a[0:3]
    ds_read_b128 a[208:211], v204 offset:61440
    ds_read_b128 a[212:215], v205 offset:61440
    v_mfma_f32_16x16x32_bf16 a[4:7], a[224:227], v[68:71], a[4:7]
    v_exp_f32 v132, v132
    v_mfma_f32_16x16x32_bf16 a[8:11], a[224:227], v[72:75], a[8:11]
    ds_read_b128 a[216:219], v206 offset:61440
    ds_read_b128 a[220:223], v207 offset:61440
    v_mfma_f32_16x16x32_bf16 a[12:15], a[224:227], v[76:79], a[12:15]
    s_add_u32 s32, s31, 4096
    v_exp_f32 v133, v133
    v_mfma_f32_16x16x32_bf16 a[0:3], a[228:231], v[80:83], a[0:3]
    buffer_load_dwordx4 v[240:243], v222, s[48:51], s32 offen offset:0 sc1
    v_mfma_f32_16x16x32_bf16 a[4:7], a[228:231], v[84:87], a[4:7]
    v_exp_f32 v134, v134
    v_mfma_f32_16x16x32_bf16 a[8:11], a[228:231], v[88:91], a[8:11]
    v_exp_f32 v135, v135
    v_mfma_f32_16x16x32_bf16 a[12:15], a[228:231], v[92:95], a[12:15]
    s_waitcnt lgkmcnt(4)
    v_cvt_pk_bf16_f32 v116, v132, v133
    v_cvt_pk_bf16_f32 v117, v134, v135
    v_add_f32 v197, v197, v201
    v_mfma_f32_16x16x32_bf16 a[16:19], a[240:243], v[64:67], a[16:19]
    v_exp_f32 v136, v136
    v_mfma_f32_16x16x32_bf16 a[20:23], a[240:243], v[68:71], a[20:23]
    v_exp_f32 v137, v137
    v_mfma_f32_16x16x32_bf16 a[24:27], a[240:243], v[72:75], a[24:27]
    s_waitcnt lgkmcnt(0)
    v_exp_f32 v138, v138
    v_mfma_f32_16x16x32_bf16 a[28:31], a[240:243], v[76:79], a[28:31]
    buffer_load_dwordx4 v[244:247], v222, s[48:51], s32 offen offset:1024 sc1
    v_mfma_f32_16x16x32_bf16 v[144:147], a[208:211], a[128:131], v[160:163]
    v_exp_f32 v139, v139
    v_mfma_f32_16x16x32_bf16 v[144:147], a[212:215], a[132:135], v[144:147]
    v_cvt_pk_bf16_f32 v120, v136, v137
    v_cvt_pk_bf16_f32 v121, v138, v139
    v_add_f32 v198, v198, v202
    v_mfma_f32_16x16x32_bf16 v[144:147], a[216:219], a[136:139], v[144:147]
    v_exp_f32 v140, v140
    v_mfma_f32_16x16x32_bf16 v[144:147], a[220:223], a[140:143], v[144:147]
    v_exp_f32 v141, v141
    v_mfma_f32_16x16x32_bf16 v[148:151], a[220:223], a[156:159], v[164:167]
    v_exp_f32 v142, v142
    v_mfma_f32_16x16x32_bf16 v[148:151], a[216:219], a[152:155], v[148:151]
    buffer_load_dwordx4 v[248:251], v222, s[48:51], s32 offen offset:2048 sc1
    v_mfma_f32_16x16x32_bf16 v[148:151], a[212:215], a[148:151], v[148:151]
    v_exp_f32 v143, v143
    v_mfma_f32_16x16x32_bf16 v[148:151], a[208:211], a[144:147], v[148:151]
    v_cvt_pk_bf16_f32 v124, v140, v141
    v_cvt_pk_bf16_f32 v125, v142, v143
    v_add_f32 v199, v199, v203
    v_mfma_f32_16x16x32_bf16 v[152:155], a[208:211], a[160:163], v[168:171]
    s_mov_b32 s53, 0x4e800000
    v_exp_f32 v144, v144
    v_mfma_f32_16x16x32_bf16 v[152:155], a[212:215], a[164:167], v[152:155]
    s_lshl_b32 s38, s3, 10
    v_exp_f32 v145, v145
    v_mfma_f32_16x16x32_bf16 v[152:155], a[216:219], a[168:171], v[152:155]
    s_add_u32 s39, s38, 131072
    v_exp_f32 v146, v146
    v_mfma_f32_16x16x32_bf16 v[152:155], a[220:223], a[172:175], v[152:155]
    s_add_u32 s40, s38, 262144
    ds_read_b64_tr_b16 a[232:233], v208 offset:49152
    ds_read_b64_tr_b16 a[234:235], v208 offset:53248
    v_mfma_f32_16x16x32_bf16 v[156:159], a[220:223], a[188:191], v[172:175]
    s_add_u32 s41, s38, 393216
    buffer_load_dwordx4 v[252:255], v222, s[48:51], s32 offen offset:3072 sc1
    v_mfma_f32_16x16x32_bf16 v[156:159], a[216:219], a[184:187], v[156:159]
    v_exp_f32 v147, v147
    v_mfma_f32_16x16x32_bf16 v[156:159], a[212:215], a[180:183], v[156:159]
    v_cvt_pk_bf16_f32 v114, v144, v145
    v_cvt_pk_bf16_f32 v115, v146, v147
    v_mfma_f32_16x16x32_bf16 v[156:159], a[208:211], a[176:179], v[156:159]
    ds_read_b64_tr_b16 a[248:249], v209 offset:49152
    ds_read_b64_tr_b16 a[250:251], v209 offset:53248
    v_mfma_f32_16x16x32_bf16 a[16:19], a[244:247], v[80:83], a[16:19]
    v_exp_f32 v148, v148
    v_mfma_f32_16x16x32_bf16 a[20:23], a[244:247], v[84:87], a[20:23]
    s_lshl1_add_u32 s31, s75, s1
    v_exp_f32 v149, v149
    v_mfma_f32_16x16x32_bf16 a[24:27], a[244:247], v[88:91], a[24:27]
    buffer_load_dwordx4 a[192:195], v222, s[48:51], s31 offen offset:0 sc1
    v_mfma_f32_16x16x32_bf16 a[28:31], a[244:247], v[92:95], a[28:31]
    v_exp_f32 v150, v150
    v_mfma_f32_16x16x32_bf16 v[176:179], v[192:195], v[96:99], v[176:179]
    ds_read_b64_tr_b16 a[236:237], v208 offset:57344
    ds_read_b64_tr_b16 a[238:239], v208 offset:61440
    v_mfma_f32_16x16x32_bf16 v[180:183], v[192:195], v[100:103], v[180:183]
    ds_read_b64_tr_b16 a[252:253], v209 offset:57344
    ds_read_b64_tr_b16 a[254:255], v209 offset:61440
    v_mfma_f32_16x16x32_bf16 v[184:187], v[192:195], v[104:107], v[184:187]
    buffer_load_dwordx4 a[196:199], v222, s[48:51], s31 offen offset:1024 sc1
    v_mfma_f32_16x16x32_bf16 v[188:191], v[192:195], v[108:111], v[188:191]
    s_waitcnt lgkmcnt(6)
    v_exp_f32 v151, v151
    v_mfma_f32_16x16x32_bf16 a[0:3], a[232:235], v[96:99], a[0:3]
    v_cvt_pk_bf16_f32 v118, v148, v149
    v_cvt_pk_bf16_f32 v119, v150, v151
    v_mfma_f32_16x16x32_bf16 a[4:7], a[232:235], v[100:103], a[4:7]
    v_exp_f32 v152, v152
    v_mfma_f32_16x16x32_bf16 a[8:11], a[232:235], v[104:107], a[8:11]
    buffer_load_dwordx4 a[200:203], v222, s[48:51], s31 offen offset:2048 sc1
    v_mfma_f32_16x16x32_bf16 a[12:15], a[232:235], v[108:111], a[12:15]
    s_waitcnt lgkmcnt(4)
    v_exp_f32 v153, v153
    v_mfma_f32_16x16x32_bf16 a[16:19], a[248:251], v[96:99], a[16:19]
    v_exp_f32 v154, v154
    v_mfma_f32_16x16x32_bf16 a[20:23], a[248:251], v[100:103], a[20:23]
    v_exp_f32 v155, v155
    v_mfma_f32_16x16x32_bf16 a[24:27], a[248:251], v[104:107], a[24:27]
    buffer_load_dwordx4 a[204:207], v222, s[48:51], s31 offen offset:3072 sc1
    v_mfma_f32_16x16x32_bf16 a[28:31], a[248:251], v[108:111], a[28:31]
    ds_read_b64_tr_b16 a[224:225], v210 offset:32768
    ds_read_b64_tr_b16 a[226:227], v210 offset:36864
    v_mfma_f32_16x16x32_bf16 v[176:179], v[192:195], v[112:115], v[176:179]
    s_waitcnt lgkmcnt(4)
    v_cvt_pk_bf16_f32 v122, v152, v153
    v_cvt_pk_bf16_f32 v123, v154, v155
    v_mfma_f32_16x16x32_bf16 a[0:3], a[236:239], v[112:115], a[0:3]
    s_waitcnt lgkmcnt(2)
    ds_read_b64_tr_b16 a[228:229], v210 offset:40960
    ds_read_b64_tr_b16 a[230:231], v210 offset:45056
    v_mfma_f32_16x16x32_bf16 a[16:19], a[252:255], v[112:115], a[16:19]
    s_add_u32 s32, s31, 4096
    v_exp_f32 v156, v156
    v_mfma_f32_16x16x32_bf16 v[180:183], v[192:195], v[116:119], v[180:183]
    buffer_load_dwordx4 a[208:211], v222, s[48:51], s32 offen offset:0 sc1
    v_mfma_f32_16x16x32_bf16 a[4:7], a[236:239], v[116:119], a[4:7]
    v_exp_f32 v157, v157
    v_mfma_f32_16x16x32_bf16 a[20:23], a[252:255], v[116:119], a[20:23]
    v_exp_f32 v158, v158
    v_cvt_pk_bf16_f32 v126, v156, v157
    v_mfma_f32_16x16x32_bf16 v[184:187], v[192:195], v[120:123], v[184:187]
    v_exp_f32 v159, v159
    v_mfma_f32_16x16x32_bf16 a[8:11], a[236:239], v[120:123], a[8:11]
    ds_read_b64_tr_b16 a[232:233], v210 offset:49152
    ds_read_b64_tr_b16 a[234:235], v210 offset:53248
    v_cvt_pk_bf16_f32 v127, v158, v159
    v_mfma_f32_16x16x32_bf16 a[24:27], a[252:255], v[120:123], a[24:27]
    buffer_load_dwordx4 a[212:215], v222, s[48:51], s32 offen offset:1024 sc1
    v_mfma_f32_16x16x32_bf16 v[188:191], v[192:195], v[124:127], v[188:191]
    v_mfma_f32_16x16x32_bf16 a[12:15], a[236:239], v[124:127], a[12:15]
    v_mfma_f32_16x16x32_bf16 a[28:31], a[252:255], v[124:127], a[28:31]
    s_waitcnt lgkmcnt(2)
    ds_read_b64_tr_b16 a[236:237], v210 offset:57344
    ds_read_b64_tr_b16 a[238:239], v210 offset:61440
    v_mfma_f32_16x16x32_bf16 a[32:35], a[224:227], v[64:67], a[32:35]
    buffer_load_dwordx4 a[216:219], v222, s[48:51], s32 offen offset:2048 sc1
    v_mfma_f32_16x16x32_bf16 a[36:39], a[224:227], v[68:71], a[36:39]
    v_mfma_f32_16x16x32_bf16 a[40:43], a[224:227], v[72:75], a[40:43]
    v_add_f32 v196, v196, v176
    v_add_f32 v197, v197, v180
    v_add_f32 v198, v198, v184
    v_mfma_f32_16x16x32_bf16 a[44:47], a[224:227], v[76:79], a[44:47]
    ds_read_b64_tr_b16 a[240:241], v211 offset:32768
    ds_read_b64_tr_b16 a[242:243], v211 offset:36864
    v_add_f32 v199, v199, v188
    v_mfma_f32_16x16x32_bf16 a[32:35], a[228:231], v[80:83], a[32:35]
    buffer_load_dwordx4 a[220:223], v222, s[48:51], s32 offen offset:3072 sc1
    v_cmp_nle_f32 vcc, v196, s53
    v_mfma_f32_16x16x32_bf16 a[36:39], a[228:231], v[84:87], a[36:39]
    ds_read_b64_tr_b16 a[244:245], v211 offset:40960
    ds_read_b64_tr_b16 a[246:247], v211 offset:45056
    v_cmp_nle_f32 s[54:55], v197, s53
    v_mfma_f32_16x16x32_bf16 a[40:43], a[228:231], v[88:91], a[40:43]
    v_cmp_nle_f32 s[56:57], v198, s53
    v_cmp_nle_f32 s[58:59], v199, s53
    v_mfma_f32_16x16x32_bf16 a[44:47], a[228:231], v[92:95], a[44:47]
    s_waitcnt lgkmcnt(6)
    v_rcp_f32 v196, v196
    v_mfma_f32_16x16x32_bf16 a[32:35], a[232:235], v[96:99], a[32:35]
    v_rcp_f32 v197, v197
    v_mfma_f32_16x16x32_bf16 a[36:39], a[232:235], v[100:103], a[36:39]
    v_rcp_f32 v198, v198
    v_mfma_f32_16x16x32_bf16 a[40:43], a[232:235], v[104:107], a[40:43]
    v_rcp_f32 v199, v199
    v_mfma_f32_16x16x32_bf16 a[44:47], a[232:235], v[108:111], a[44:47]
    s_waitcnt lgkmcnt(4)
    ds_read_b64_tr_b16 a[248:249], v211 offset:49152
    ds_read_b64_tr_b16 a[250:251], v211 offset:53248
    v_mfma_f32_16x16x32_bf16 a[32:35], a[236:239], v[112:115], a[32:35]
    s_or_b64 s[52:53], vcc, s[54:55]
    s_or_b64 s[56:57], s[56:57], s[58:59]
    v_accvgpr_read_b32 v128, a0
    v_accvgpr_read_b32 v129, a1
    v_accvgpr_read_b32 v130, a2
    v_mfma_f32_16x16x32_bf16 a[36:39], a[236:239], v[116:119], a[36:39]
    s_or_b64 s[52:53], s[52:53], s[56:57]
    s_or_b32 s52, s52, s53
    v_accvgpr_read_b32 v131, a3
    v_accvgpr_read_b32 v132, a16
    v_accvgpr_read_b32 v133, a17
    v_mfma_f32_16x16x32_bf16 a[40:43], a[236:239], v[120:123], a[40:43]
    s_lshl_b32 s53, s3, 2
    s_add_u32 s53, s53, 57344
    v_mov_b32 v200, s52
    v_mov_b32 v201, s53
    v_mov_b32 v202, 57344
    v_mfma_f32_16x16x32_bf16 a[44:47], a[236:239], v[124:127], a[44:47]
    s_waitcnt lgkmcnt(2)
    ds_read_b64_tr_b16 a[252:253], v211 offset:57344
    ds_read_b64_tr_b16 a[254:255], v211 offset:61440
    ds_write_b32 v201, v200
    v_mfma_f32_16x16x32_bf16 a[48:51], a[240:243], v[64:67], a[48:51]
    v_accvgpr_read_b32 v134, a18
    v_accvgpr_read_b32 v135, a19
    v_mul_f32 v128, v128, v196
    v_mfma_f32_16x16x32_bf16 a[52:55], a[240:243], v[68:71], a[52:55]
    v_mul_f32 v129, v129, v196
    v_mul_f32 v130, v130, v196
    v_mul_f32 v131, v131, v196
    v_mfma_f32_16x16x32_bf16 a[56:59], a[240:243], v[72:75], a[56:59]
    v_mul_f32 v132, v132, v196
    v_mul_f32 v133, v133, v196
    v_mul_f32 v134, v134, v196
    v_mfma_f32_16x16x32_bf16 a[60:63], a[240:243], v[76:79], a[60:63]
    s_waitcnt lgkmcnt(0)
    ds_read_b64_tr_b16 a[224:225], v212 offset:0
    ds_read_b64_tr_b16 a[226:227], v212 offset:4096
    v_mul_f32 v135, v135, v196
    v_mfma_f32_16x16x32_bf16 a[48:51], a[244:247], v[80:83], a[48:51]
    s_barrier
    ds_read_b128 v[176:179], v202
    v_cvt_pk_bf16_f32 v128, v128, v129
    v_cvt_pk_bf16_f32 v129, v130, v131
    v_mfma_f32_16x16x32_bf16 a[52:55], a[244:247], v[84:87], a[52:55]
    ds_read_b64_tr_b16 a[228:229], v212 offset:8192
    ds_read_b64_tr_b16 a[230:231], v212 offset:12288
    v_cvt_pk_bf16_f32 v130, v132, v133
    v_mfma_f32_16x16x32_bf16 a[56:59], a[244:247], v[88:91], a[56:59]
    v_cvt_pk_bf16_f32 v131, v134, v135
    v_accvgpr_read_b32 v136, a4
    v_accvgpr_read_b32 v137, a5
    v_mfma_f32_16x16x32_bf16 a[60:63], a[244:247], v[92:95], a[60:63]
    s_waitcnt lgkmcnt(8)
    buffer_store_dwordx4 v[128:131], v222, s[24:27], s38 offen offset:0 sc1
    s_xor_b32 s38, s38, 1024
    v_accvgpr_read_b32 v138, a6
    v_mfma_f32_16x16x32_bf16 a[48:51], a[248:251], v[96:99], a[48:51]
    v_accvgpr_read_b32 v139, a7
    v_accvgpr_read_b32 v140, a20
    v_accvgpr_read_b32 v141, a21
    v_mfma_f32_16x16x32_bf16 a[52:55], a[248:251], v[100:103], a[52:55]
    s_waitcnt lgkmcnt(2)
    v_or3_b32 v176, v176, v177, v178
    v_or_b32 v176, v176, v179
    v_accvgpr_read_b32 v142, a22
    v_mfma_f32_16x16x32_bf16 a[56:59], a[248:251], v[104:107], a[56:59]
    v_readfirstlane_b32 s52, v176
    v_accvgpr_read_b32 v143, a23
    v_mul_f32 v136, v136, v197
    v_mfma_f32_16x16x32_bf16 a[60:63], a[248:251], v[108:111], a[60:63]
    s_waitcnt lgkmcnt(6)
    ds_read_b64_tr_b16 a[232:233], v212 offset:16384
    ds_read_b64_tr_b16 a[234:235], v212 offset:20480
    v_mul_f32 v137, v137, v197
    v_mfma_f32_16x16x32_bf16 a[48:51], a[252:255], v[112:115], a[48:51]
    v_mul_f32 v138, v138, v197
    v_mul_f32 v139, v139, v197
    v_mul_f32 v140, v140, v197
    v_mfma_f32_16x16x32_bf16 a[52:55], a[252:255], v[116:119], a[52:55]
    ds_read_b64_tr_b16 a[236:237], v212 offset:24576
    ds_read_b64_tr_b16 a[238:239], v212 offset:28672
    v_mul_f32 v141, v141, v197
    v_mfma_f32_16x16x32_bf16 a[56:59], a[252:255], v[120:123], a[56:59]
    s_andn2_b32 s52, s52, s37
    s_cmp_lg_u32 s52, 0
    s_cbranch_scc1 F_FB
    v_mul_f32 v142, v142, v197
    v_mul_f32 v143, v143, v197
    v_cvt_pk_bf16_f32 v136, v136, v137
    v_mfma_f32_16x16x32_bf16 a[60:63], a[252:255], v[124:127], a[60:63]
    s_waitcnt lgkmcnt(4)
    v_cvt_pk_bf16_f32 v137, v138, v139
    v_cvt_pk_bf16_f32 v138, v140, v141
    v_cvt_pk_bf16_f32 v139, v142, v143
    v_mfma_f32_16x16x32_bf16 a[64:67], a[224:227], v[0:3], a[64:67]
    s_add_u32 s6, s97, 16384
    v_and_b32 v194, 0xf0, v222
    v_lshrrev_b32 v195, 8, v222
    v_lshlrev_b32 v194, 6, v194
    v_mfma_f32_16x16x32_bf16 a[68:71], a[224:227], v[4:7], a[68:71]
    v_lshl_add_u32 v194, v195, 4, v194
    v_add_u32 v204, s30, v222
    v_add_u32 v205, 131072, v204
    v_mfma_f32_16x16x32_bf16 a[72:75], a[224:227], v[8:11], a[72:75]
    buffer_load_dwordx4 v[184:187], v194, s[48:51], s97 offen sc1
    v_accvgpr_read_b32 v144, a8
    v_mfma_f32_16x16x32_bf16 a[76:79], a[224:227], v[12:15], a[76:79]
    ds_read_b64_tr_b16 a[240:241], v212 offset:32768
    ds_read_b64_tr_b16 a[242:243], v212 offset:36864
    v_accvgpr_read_b32 v145, a9
    v_mfma_f32_16x16x32_bf16 a[64:67], a[228:231], v[16:19], a[64:67]
    buffer_load_dwordx4 v[188:191], v194, s[48:51], s6 offen sc1
    v_add_u32 v192, 32768, v222
    v_mfma_f32_16x16x32_bf16 a[68:71], a[228:231], v[20:23], a[68:71]
    ds_read_b64_tr_b16 a[244:245], v212 offset:40960
    ds_read_b64_tr_b16 a[246:247], v212 offset:45056
    v_add_u32 v193, 98304, v222
    v_mfma_f32_16x16x32_bf16 a[72:75], a[228:231], v[24:27], a[72:75]
    buffer_store_dwordx4 v[136:139], v222, s[24:27], s39 offen offset:0 sc1
    s_xor_b32 s39, s39, 1024
    v_mov_b32 v200, s44
    v_mfma_f32_16x16x32_bf16 a[76:79], a[228:231], v[28:31], a[76:79]
    s_waitcnt lgkmcnt(4)
    v_accvgpr_read_b32 v146, a10
    v_accvgpr_read_b32 v147, a11
    v_accvgpr_read_b32 v148, a24
    v_mfma_f32_16x16x32_bf16 a[64:67], a[232:235], v[32:35], a[64:67]
    s_lshr_b32 s58, s87, 15
    v_accvgpr_read_b32 v149, a25
    v_accvgpr_read_b32 v150, a26
    v_accvgpr_read_b32 v151, a27
    v_mfma_f32_16x16x32_bf16 a[68:71], a[232:235], v[36:39], a[68:71]
    s_lshr_b32 s52, s97, 15
    v_mul_f32 v144, v144, v198
    v_mul_f32 v145, v145, v198
    v_mul_f32 v146, v146, v198
    v_mfma_f32_16x16x32_bf16 a[72:75], a[232:235], v[40:43], a[72:75]
    s_xor_b32 s7, s58, s52
    v_mul_f32 v147, v147, v198
    v_mul_f32 v148, v148, v198
    v_mul_f32 v149, v149, v198
    v_mfma_f32_16x16x32_bf16 a[76:79], a[232:235], v[44:47], a[76:79]
    ds_read_b64_tr_b16 a[248:249], v212 offset:49152
    ds_read_b64_tr_b16 a[250:251], v212 offset:53248
    v_mul_f32 v150, v150, v198
    v_mfma_f32_16x16x32_bf16 a[64:67], a[236:239], v[48:51], a[64:67]
    v_mul_f32 v151, v151, v198
    v_cvt_pk_bf16_f32 v144, v144, v145
    v_cvt_pk_bf16_f32 v145, v146, v147
    v_mfma_f32_16x16x32_bf16 a[68:71], a[236:239], v[52:55], a[68:71]
    ds_read_b64_tr_b16 a[252:253], v212 offset:57344
    ds_read_b64_tr_b16 a[254:255], v212 offset:61440
    v_cvt_pk_bf16_f32 v146, v148, v149
    v_mfma_f32_16x16x32_bf16 a[72:75], a[236:239], v[56:59], a[72:75]
    v_cvt_pk_bf16_f32 v147, v150, v151
    v_accvgpr_read_b32 v152, a12
    v_accvgpr_read_b32 v153, a13
    v_mfma_f32_16x16x32_bf16 a[76:79], a[236:239], v[60:63], a[76:79]
    s_waitcnt lgkmcnt(4)
    v_accvgpr_read_b32 v154, a14
    v_accvgpr_read_b32 v155, a15
    v_accvgpr_read_b32 v156, a28
    v_mfma_f32_16x16x32_bf16 a[64:67], a[240:243], v[64:67], a[64:67]
    v_accvgpr_read_b32 v157, a29
    v_accvgpr_read_b32 v158, a30
    v_accvgpr_read_b32 v159, a31
    v_mfma_f32_16x16x32_bf16 a[68:71], a[240:243], v[68:71], a[68:71]
    s_waitcnt vmcnt(20)
    buffer_store_dwordx4 v[144:147], v222, s[24:27], s40 offen offset:0 sc1
    s_xor_b32 s40, s40, 1024
    v_mul_f32 v152, v152, v199
    v_mfma_f32_16x16x32_bf16 a[72:75], a[240:243], v[72:75], a[72:75]
    v_mul_f32 v153, v153, v199
    v_mul_f32 v154, v154, v199
    v_mul_f32 v155, v155, v199
    v_mfma_f32_16x16x32_bf16 a[76:79], a[240:243], v[76:79], a[76:79]
    ds_read_b64_tr_b16 a[224:225], v213 offset:0
    ds_read_b64_tr_b16 a[226:227], v213 offset:4096
    v_mul_f32 v156, v156, v199
    v_mfma_f32_16x16x32_bf16 a[64:67], a[244:247], v[80:83], a[64:67]
    v_mul_f32 v157, v157, v199
    v_mul_f32 v158, v158, v199
    v_mul_f32 v159, v159, v199
    v_mfma_f32_16x16x32_bf16 a[68:71], a[244:247], v[84:87], a[68:71]
    ds_read_b64_tr_b16 a[228:229], v213 offset:8192
    ds_read_b64_tr_b16 a[230:231], v213 offset:12288
    v_cvt_pk_bf16_f32 v152, v152, v153
    v_mfma_f32_16x16x32_bf16 a[72:75], a[244:247], v[88:91], a[72:75]
    v_cvt_pk_bf16_f32 v153, v154, v155
    v_cvt_pk_bf16_f32 v154, v156, v157
    v_cvt_pk_bf16_f32 v155, v158, v159
    v_mfma_f32_16x16x32_bf16 a[76:79], a[244:247], v[92:95], a[76:79]
    s_waitcnt lgkmcnt(4)
    v_accvgpr_read_b32 v160, a32
    v_accvgpr_read_b32 v161, a33
    v_accvgpr_read_b32 v162, a34
    v_mfma_f32_16x16x32_bf16 a[64:67], a[248:251], v[96:99], a[64:67]
    v_accvgpr_read_b32 v163, a35
    v_accvgpr_read_b32 v164, a48
    v_accvgpr_read_b32 v165, a49
    v_mfma_f32_16x16x32_bf16 a[68:71], a[248:251], v[100:103], a[68:71]
    v_accvgpr_read_b32 v166, a50
    v_accvgpr_read_b32 v167, a51
    v_mul_f32 v160, v160, v196
    v_mfma_f32_16x16x32_bf16 a[72:75], a[248:251], v[104:107], a[72:75]
    v_mul_f32 v161, v161, v196
    v_mul_f32 v162, v162, v196
    v_mul_f32 v163, v163, v196
    v_mfma_f32_16x16x32_bf16 a[76:79], a[248:251], v[108:111], a[76:79]
    ds_read_b64_tr_b16 a[232:233], v213 offset:16384
    ds_read_b64_tr_b16 a[234:235], v213 offset:20480
    v_mul_f32 v164, v164, v196
    v_mfma_f32_16x16x32_bf16 a[64:67], a[252:255], v[112:115], a[64:67]
    buffer_store_dwordx4 v[152:155], v222, s[24:27], s41 offen offset:0 sc1
    s_xor_b32 s41, s41, 1024
    v_mul_f32 v165, v165, v196
    v_mfma_f32_16x16x32_bf16 a[68:71], a[252:255], v[116:119], a[68:71]
    ds_read_b64_tr_b16 a[236:237], v213 offset:24576
    ds_read_b64_tr_b16 a[238:239], v213 offset:28672
    v_mul_f32 v166, v166, v196
    v_mfma_f32_16x16x32_bf16 a[72:75], a[252:255], v[120:123], a[72:75]
    v_mul_f32 v167, v167, v196
    v_cvt_pk_bf16_f32 v160, v160, v161
    v_cvt_pk_bf16_f32 v161, v162, v163
    v_mfma_f32_16x16x32_bf16 a[76:79], a[252:255], v[124:127], a[76:79]
    s_waitcnt lgkmcnt(4)
    v_cvt_pk_bf16_f32 v162, v164, v165
    v_cvt_pk_bf16_f32 v163, v166, v167
    v_accvgpr_read_b32 v168, a36
    v_mfma_f32_16x16x32_bf16 a[80:83], a[224:227], v[0:3], a[80:83]
    v_accvgpr_read_b32 v169, a37
    v_accvgpr_read_b32 v170, a38
    v_accvgpr_read_b32 v171, a39
    v_mfma_f32_16x16x32_bf16 a[84:87], a[224:227], v[4:7], a[84:87]
    v_accvgpr_read_b32 v172, a52
    v_accvgpr_read_b32 v173, a53
    v_accvgpr_read_b32 v174, a54
    v_mfma_f32_16x16x32_bf16 a[88:91], a[224:227], v[8:11], a[88:91]
    v_accvgpr_read_b32 v175, a55
    v_mul_f32 v168, v168, v197
    v_mul_f32 v169, v169, v197
    v_mfma_f32_16x16x32_bf16 a[92:95], a[224:227], v[12:15], a[92:95]
    ds_read_b64_tr_b16 a[240:241], v213 offset:32768
    ds_read_b64_tr_b16 a[242:243], v213 offset:36864
    v_mul_f32 v170, v170, v197
    v_mfma_f32_16x16x32_bf16 a[80:83], a[228:231], v[16:19], a[80:83]
    v_mul_f32 v171, v171, v197
    v_mul_f32 v172, v172, v197
    v_mul_f32 v173, v173, v197
    v_mfma_f32_16x16x32_bf16 a[84:87], a[228:231], v[20:23], a[84:87]
    ds_read_b64_tr_b16 a[244:245], v213 offset:40960
    ds_read_b64_tr_b16 a[246:247], v213 offset:45056
    v_mul_f32 v174, v174, v197
    v_mfma_f32_16x16x32_bf16 a[88:91], a[228:231], v[24:27], a[88:91]
    v_mul_f32 v175, v175, v197
    v_cvt_pk_bf16_f32 v168, v168, v169
    v_cvt_pk_bf16_f32 v169, v170, v171
    v_mfma_f32_16x16x32_bf16 a[92:95], a[228:231], v[28:31], a[92:95]
    s_waitcnt lgkmcnt(4)
    buffer_store_dwordx4 v[160:163], v222, s[24:27], s38 offen offset:0 sc1
    s_xor_b32 s38, s38, 3072
    v_cvt_pk_bf16_f32 v170, v172, v173
    v_mfma_f32_16x16x32_bf16 a[80:83], a[232:235], v[32:35], a[80:83]
    v_cvt_pk_bf16_f32 v171, v174, v175
    v_accvgpr_read_b32 v128, a40
    v_accvgpr_read_b32 v129, a41
    v_mfma_f32_16x16x32_bf16 a[84:87], a[232:235], v[36:39], a[84:87]
    v_accvgpr_read_b32 v130, a42
    v_accvgpr_read_b32 v131, a43
    v_accvgpr_read_b32 v132, a56
    v_mfma_f32_16x16x32_bf16 a[88:91], a[232:235], v[40:43], a[88:91]
    v_accvgpr_read_b32 v133, a57
    v_accvgpr_read_b32 v134, a58
    v_accvgpr_read_b32 v135, a59
    v_mfma_f32_16x16x32_bf16 a[92:95], a[232:235], v[44:47], a[92:95]
    ds_read_b64_tr_b16 a[248:249], v213 offset:49152
    ds_read_b64_tr_b16 a[250:251], v213 offset:53248
    v_mul_f32 v128, v128, v198
    v_mfma_f32_16x16x32_bf16 a[80:83], a[236:239], v[48:51], a[80:83]
    v_mul_f32 v129, v129, v198
    v_mul_f32 v130, v130, v198
    v_mul_f32 v131, v131, v198
    v_mfma_f32_16x16x32_bf16 a[84:87], a[236:239], v[52:55], a[84:87]
    ds_read_b64_tr_b16 a[252:253], v213 offset:57344
    ds_read_b64_tr_b16 a[254:255], v213 offset:61440
    v_mul_f32 v132, v132, v198
    v_mfma_f32_16x16x32_bf16 a[88:91], a[236:239], v[56:59], a[88:91]
    v_mul_f32 v133, v133, v198
    v_mul_f32 v134, v134, v198
    v_mul_f32 v135, v135, v198
    v_mfma_f32_16x16x32_bf16 a[92:95], a[236:239], v[60:63], a[92:95]
    s_waitcnt lgkmcnt(4)
    v_cvt_pk_bf16_f32 v128, v128, v129
    v_cvt_pk_bf16_f32 v129, v130, v131
    v_cvt_pk_bf16_f32 v130, v132, v133
    v_mfma_f32_16x16x32_bf16 a[80:83], a[240:243], v[64:67], a[80:83]
    v_cvt_pk_bf16_f32 v131, v134, v135
    v_accvgpr_read_b32 v136, a44
    v_accvgpr_read_b32 v137, a45
    v_mfma_f32_16x16x32_bf16 a[84:87], a[240:243], v[68:71], a[84:87]
    v_accvgpr_read_b32 v138, a46
    v_accvgpr_read_b32 v139, a47
    v_accvgpr_read_b32 v140, a60
    v_mfma_f32_16x16x32_bf16 a[88:91], a[240:243], v[72:75], a[88:91]
    buffer_store_dwordx4 v[168:171], v222, s[24:27], s39 offen offset:0 sc1
    s_xor_b32 s39, s39, 3072
    v_accvgpr_read_b32 v141, a61
    v_mfma_f32_16x16x32_bf16 a[92:95], a[240:243], v[76:79], a[92:95]
    ds_read_b64_tr_b16 a[224:225], v214 offset:0
    ds_read_b64_tr_b16 a[226:227], v214 offset:4096
    v_accvgpr_read_b32 v142, a62
    v_mfma_f32_16x16x32_bf16 a[80:83], a[244:247], v[80:83], a[80:83]
    v_accvgpr_read_b32 v143, a63
    v_mul_f32 v136, v136, v199
    v_mul_f32 v137, v137, v199
    v_mfma_f32_16x16x32_bf16 a[84:87], a[244:247], v[84:87], a[84:87]
    ds_read_b64_tr_b16 a[228:229], v214 offset:8192
    ds_read_b64_tr_b16 a[230:231], v214 offset:12288
    v_mul_f32 v138, v138, v199
    v_mfma_f32_16x16x32_bf16 a[88:91], a[244:247], v[88:91], a[88:91]
    v_mul_f32 v139, v139, v199
    v_mul_f32 v140, v140, v199
    v_mul_f32 v141, v141, v199
    v_mfma_f32_16x16x32_bf16 a[92:95], a[244:247], v[92:95], a[92:95]
    s_waitcnt lgkmcnt(4)
    v_mul_f32 v142, v142, v199
    v_mul_f32 v143, v143, v199
    v_cvt_pk_bf16_f32 v136, v136, v137
    v_mfma_f32_16x16x32_bf16 a[80:83], a[248:251], v[96:99], a[80:83]
    v_cvt_pk_bf16_f32 v137, v138, v139
    v_cvt_pk_bf16_f32 v138, v140, v141
    v_cvt_pk_bf16_f32 v139, v142, v143
    v_mfma_f32_16x16x32_bf16 a[84:87], a[248:251], v[100:103], a[84:87]
    ds_read_b128 a[0:3], v204 offset:0
    v_mfma_f32_16x16x32_bf16 a[88:91], a[248:251], v[104:107], a[88:91]
    v_mfma_f32_16x16x32_bf16 a[92:95], a[248:251], v[108:111], a[92:95]
    ds_read_b64_tr_b16 a[232:233], v214 offset:16384
    ds_read_b64_tr_b16 a[234:235], v214 offset:20480
    ds_read_b128 a[4:7], v204 offset:1024
    v_mfma_f32_16x16x32_bf16 a[80:83], a[252:255], v[112:115], a[80:83]
    v_mfma_f32_16x16x32_bf16 a[84:87], a[252:255], v[116:119], a[84:87]
    ds_read_b64_tr_b16 a[236:237], v214 offset:24576
    ds_read_b64_tr_b16 a[238:239], v214 offset:28672
    ds_read_b128 a[8:11], v204 offset:2048
    v_mfma_f32_16x16x32_bf16 a[88:91], a[252:255], v[120:123], a[88:91]
    buffer_store_dwordx4 v[128:131], v222, s[24:27], s40 offen offset:0 sc1
    s_xor_b32 s40, s40, 3072
    v_mfma_f32_16x16x32_bf16 a[92:95], a[252:255], v[124:127], a[92:95]
    s_waitcnt lgkmcnt(7)
    ds_read_b128 a[12:15], v204 offset:3072
    v_mfma_f32_16x16x32_bf16 a[96:99], a[224:227], v[0:3], a[96:99]
    v_mfma_f32_16x16x32_bf16 a[100:103], a[224:227], v[4:7], a[100:103]
    v_accvgpr_read_b32 v144, a64
    v_accvgpr_read_b32 v145, a65
    v_accvgpr_read_b32 v146, a66
    v_mfma_f32_16x16x32_bf16 a[104:107], a[224:227], v[8:11], a[104:107]
    v_accvgpr_read_b32 v147, a67
    v_accvgpr_read_b32 v148, a80
    v_accvgpr_read_b32 v149, a81
    v_mfma_f32_16x16x32_bf16 a[108:111], a[224:227], v[12:15], a[108:111]
    ds_read_b64_tr_b16 a[240:241], v214 offset:32768
    ds_read_b64_tr_b16 a[242:243], v214 offset:36864
    v_accvgpr_read_b32 v150, a82
    v_mfma_f32_16x16x32_bf16 a[96:99], a[228:231], v[16:19], a[96:99]
    v_accvgpr_read_b32 v151, a83
    v_mul_f32 v144, v144, v196
    v_mul_f32 v145, v145, v196
    v_mfma_f32_16x16x32_bf16 a[100:103], a[228:231], v[20:23], a[100:103]
    ds_read_b64_tr_b16 a[244:245], v214 offset:40960
    ds_read_b64_tr_b16 a[246:247], v214 offset:45056
    v_mul_f32 v146, v146, v196
    v_mfma_f32_16x16x32_bf16 a[104:107], a[228:231], v[24:27], a[104:107]
    v_mul_f32 v147, v147, v196
    v_mul_f32 v148, v148, v196
    v_mul_f32 v149, v149, v196
    v_mfma_f32_16x16x32_bf16 a[108:111], a[228:231], v[28:31], a[108:111]
    s_waitcnt lgkmcnt(6)
    v_mul_f32 v150, v150, v196
    v_mul_f32 v151, v151, v196
    v_cvt_pk_bf16_f32 v144, v144, v145
    v_mfma_f32_16x16x32_bf16 a[96:99], a[232:235], v[32:35], a[96:99]
    v_cvt_pk_bf16_f32 v145, v146, v147
    v_cvt_pk_bf16_f32 v146, v148, v149
    v_cvt_pk_bf16_f32 v147, v150, v151
    v_mfma_f32_16x16x32_bf16 a[100:103], a[232:235], v[36:39], a[100:103]
    buffer_store_dwordx4 v[136:139], v222, s[24:27], s41 offen offset:0 sc1
    s_xor_b32 s41, s41, 3072
    v_accvgpr_read_b32 v152, a68
    v_mfma_f32_16x16x32_bf16 a[104:107], a[232:235], v[40:43], a[104:107]
    v_accvgpr_read_b32 v153, a69
    v_accvgpr_read_b32 v154, a70
    v_accvgpr_read_b32 v155, a71
    v_mfma_f32_16x16x32_bf16 a[108:111], a[232:235], v[44:47], a[108:111]
    ds_read_b64_tr_b16 a[248:249], v214 offset:49152
    ds_read_b64_tr_b16 a[250:251], v214 offset:53248
    v_accvgpr_read_b32 v156, a84
    v_mfma_f32_16x16x32_bf16 a[96:99], a[236:239], v[48:51], a[96:99]
    v_accvgpr_read_b32 v157, a85
    v_accvgpr_read_b32 v158, a86
    v_accvgpr_read_b32 v159, a87
    v_mfma_f32_16x16x32_bf16 a[100:103], a[236:239], v[52:55], a[100:103]
    ds_read_b64_tr_b16 a[252:253], v214 offset:57344
    ds_read_b64_tr_b16 a[254:255], v214 offset:61440
    v_mul_f32 v152, v152, v197
    v_mfma_f32_16x16x32_bf16 a[104:107], a[236:239], v[56:59], a[104:107]
    v_mul_f32 v153, v153, v197
    v_mul_f32 v154, v154, v197
    v_mul_f32 v155, v155, v197
    v_mfma_f32_16x16x32_bf16 a[108:111], a[236:239], v[60:63], a[108:111]
    s_waitcnt lgkmcnt(4)
    v_mul_f32 v156, v156, v197
    v_mul_f32 v157, v157, v197
    v_mul_f32 v158, v158, v197
    v_mfma_f32_16x16x32_bf16 a[96:99], a[240:243], v[64:67], a[96:99]
    v_mul_f32 v159, v159, v197
    v_cvt_pk_bf16_f32 v152, v152, v153
    v_cvt_pk_bf16_f32 v153, v154, v155
    v_mfma_f32_16x16x32_bf16 a[100:103], a[240:243], v[68:71], a[100:103]
    v_cvt_pk_bf16_f32 v154, v156, v157
    v_cvt_pk_bf16_f32 v155, v158, v159
    v_accvgpr_read_b32 v160, a72
    v_mfma_f32_16x16x32_bf16 a[104:107], a[240:243], v[72:75], a[104:107]
    v_accvgpr_read_b32 v161, a73
    v_accvgpr_read_b32 v162, a74
    v_accvgpr_read_b32 v163, a75
    v_mfma_f32_16x16x32_bf16 a[108:111], a[240:243], v[76:79], a[108:111]
    ds_read_b64_tr_b16 a[224:225], v215 offset:0
    ds_read_b64_tr_b16 a[226:227], v215 offset:4096
    v_accvgpr_read_b32 v164, a88
    v_mfma_f32_16x16x32_bf16 a[96:99], a[244:247], v[80:83], a[96:99]
    buffer_store_dwordx4 v[144:147], v222, s[24:27], s38 offen offset:0 sc1
    s_xor_b32 s38, s38, 1024
    v_accvgpr_read_b32 v165, a89
    v_mfma_f32_16x16x32_bf16 a[100:103], a[244:247], v[84:87], a[100:103]
    ds_read_b64_tr_b16 a[228:229], v215 offset:8192
    ds_read_b64_tr_b16 a[230:231], v215 offset:12288
    v_accvgpr_read_b32 v166, a90
    v_mfma_f32_16x16x32_bf16 a[104:107], a[244:247], v[88:91], a[104:107]
    v_accvgpr_read_b32 v167, a91
    v_mul_f32 v160, v160, v198
    v_mul_f32 v161, v161, v198
    v_mfma_f32_16x16x32_bf16 a[108:111], a[244:247], v[92:95], a[108:111]
    s_waitcnt lgkmcnt(4)
    v_mul_f32 v162, v162, v198
    v_mul_f32 v163, v163, v198
    v_mul_f32 v164, v164, v198
    v_mfma_f32_16x16x32_bf16 a[96:99], a[248:251], v[96:99], a[96:99]
    v_mul_f32 v165, v165, v198
    v_mul_f32 v166, v166, v198
    v_mul_f32 v167, v167, v198
    v_mfma_f32_16x16x32_bf16 a[100:103], a[248:251], v[100:103], a[100:103]
    v_cvt_pk_bf16_f32 v160, v160, v161
    v_cvt_pk_bf16_f32 v161, v162, v163
    v_cvt_pk_bf16_f32 v162, v164, v165
    v_mfma_f32_16x16x32_bf16 a[104:107], a[248:251], v[104:107], a[104:107]
    v_cvt_pk_bf16_f32 v163, v166, v167
    v_accvgpr_read_b32 v168, a76
    v_accvgpr_read_b32 v169, a77
    v_mfma_f32_16x16x32_bf16 a[108:111], a[248:251], v[108:111], a[108:111]
    ds_read_b64_tr_b16 a[232:233], v215 offset:16384
    ds_read_b64_tr_b16 a[234:235], v215 offset:20480
    v_accvgpr_read_b32 v170, a78
    v_mfma_f32_16x16x32_bf16 a[96:99], a[252:255], v[112:115], a[96:99]
    v_accvgpr_read_b32 v171, a79
    v_accvgpr_read_b32 v172, a92
    v_accvgpr_read_b32 v173, a93
    v_mfma_f32_16x16x32_bf16 a[100:103], a[252:255], v[116:119], a[100:103]
    ds_read_b64_tr_b16 a[236:237], v215 offset:24576
    ds_read_b64_tr_b16 a[238:239], v215 offset:28672
    v_accvgpr_read_b32 v174, a94
    v_mfma_f32_16x16x32_bf16 a[104:107], a[252:255], v[120:123], a[104:107]
    v_accvgpr_read_b32 v175, a95
    v_mul_f32 v168, v168, v199
    v_mul_f32 v169, v169, v199
    v_mfma_f32_16x16x32_bf16 a[108:111], a[252:255], v[124:127], a[108:111]
    s_waitcnt lgkmcnt(4)
    buffer_store_dwordx4 v[152:155], v222, s[24:27], s39 offen offset:0 sc1
    s_xor_b32 s39, s39, 1024
    v_mul_f32 v170, v170, v199
    v_mfma_f32_16x16x32_bf16 a[112:115], a[224:227], v[0:3], a[112:115]
    v_mul_f32 v171, v171, v199
    v_mul_f32 v172, v172, v199
    v_mul_f32 v173, v173, v199
    v_mfma_f32_16x16x32_bf16 a[116:119], a[224:227], v[4:7], a[116:119]
    v_mul_f32 v174, v174, v199
    v_mul_f32 v175, v175, v199
    v_cvt_pk_bf16_f32 v168, v168, v169
    v_mfma_f32_16x16x32_bf16 a[120:123], a[224:227], v[8:11], a[120:123]
    v_cvt_pk_bf16_f32 v169, v170, v171
    v_cvt_pk_bf16_f32 v170, v172, v173
    v_cvt_pk_bf16_f32 v171, v174, v175
    v_mfma_f32_16x16x32_bf16 a[124:127], a[224:227], v[12:15], a[124:127]
    ds_read_b64_tr_b16 a[240:241], v215 offset:32768
    ds_read_b64_tr_b16 a[242:243], v215 offset:36864
    ds_read_b128 a[16:19], v204 offset:4096
    v_mfma_f32_16x16x32_bf16 a[112:115], a[228:231], v[16:19], a[112:115]
    v_mfma_f32_16x16x32_bf16 a[116:119], a[228:231], v[20:23], a[116:119]
    ds_read_b64_tr_b16 a[244:245], v215 offset:40960
    ds_read_b64_tr_b16 a[246:247], v215 offset:45056
    ds_read_b128 a[20:23], v204 offset:5120
    v_mfma_f32_16x16x32_bf16 a[120:123], a[228:231], v[24:27], a[120:123]
    v_mfma_f32_16x16x32_bf16 a[124:127], a[228:231], v[28:31], a[124:127]
    s_waitcnt lgkmcnt(6)
    ds_read_b128 a[24:27], v204 offset:6144
    v_mfma_f32_16x16x32_bf16 a[112:115], a[232:235], v[32:35], a[112:115]
    v_mfma_f32_16x16x32_bf16 a[116:119], a[232:235], v[36:39], a[116:119]
    ds_read_b128 a[28:31], v204 offset:7168
    v_mfma_f32_16x16x32_bf16 a[120:123], a[232:235], v[40:43], a[120:123]
    buffer_store_dwordx4 v[160:163], v222, s[24:27], s40 offen offset:0 sc1
    s_xor_b32 s40, s40, 1024
    v_mfma_f32_16x16x32_bf16 a[124:127], a[232:235], v[44:47], a[124:127]
    ds_read_b64_tr_b16 a[248:249], v215 offset:49152
    ds_read_b64_tr_b16 a[250:251], v215 offset:53248
    ds_read_b128 a[32:35], v205 offset:0
    v_mfma_f32_16x16x32_bf16 a[112:115], a[236:239], v[48:51], a[112:115]
    v_mfma_f32_16x16x32_bf16 a[116:119], a[236:239], v[52:55], a[116:119]
    ds_read_b64_tr_b16 a[252:253], v215 offset:57344
    ds_read_b64_tr_b16 a[254:255], v215 offset:61440
    ds_read_b128 a[36:39], v205 offset:1024
    v_mfma_f32_16x16x32_bf16 a[120:123], a[236:239], v[56:59], a[120:123]
    v_mfma_f32_16x16x32_bf16 a[124:127], a[236:239], v[60:63], a[124:127]
    s_waitcnt lgkmcnt(9)
    ds_read_b128 a[40:43], v205 offset:2048
    v_mfma_f32_16x16x32_bf16 a[112:115], a[240:243], v[64:67], a[112:115]
    v_mfma_f32_16x16x32_bf16 a[116:119], a[240:243], v[68:71], a[116:119]
    ds_read_b128 a[44:47], v205 offset:3072
    v_mfma_f32_16x16x32_bf16 a[120:123], a[240:243], v[72:75], a[120:123]
    v_mfma_f32_16x16x32_bf16 a[124:127], a[240:243], v[76:79], a[124:127]
    ds_read_b128 a[48:51], v205 offset:4096
    v_mfma_f32_16x16x32_bf16 a[112:115], a[244:247], v[80:83], a[112:115]
    v_mfma_f32_16x16x32_bf16 a[116:119], a[244:247], v[84:87], a[116:119]
    buffer_store_dwordx4 v[168:171], v222, s[24:27], s41 offen offset:0 sc1
    s_xor_b32 s41, s41, 1024
    ds_read_b128 a[52:55], v205 offset:5120
    v_mfma_f32_16x16x32_bf16 a[120:123], a[244:247], v[88:91], a[120:123]
    v_mfma_f32_16x16x32_bf16 a[124:127], a[244:247], v[92:95], a[124:127]
    s_waitcnt lgkmcnt(5)
    ds_read_b128 a[56:59], v205 offset:6144
    v_mfma_f32_16x16x32_bf16 a[112:115], a[248:251], v[96:99], a[112:115]
    s_barrier
    v_mfma_f32_16x16x32_bf16 a[116:119], a[248:251], v[100:103], a[116:119]
    ds_read_b128 a[60:63], v205 offset:7168
    v_mfma_f32_16x16x32_bf16 a[120:123], a[248:251], v[104:107], a[120:123]
    v_mfma_f32_16x16x32_bf16 a[124:127], a[248:251], v[108:111], a[124:127]
    v_mfma_f32_16x16x32_bf16 a[112:115], a[252:255], v[112:115], a[112:115]
    v_mfma_f32_16x16x32_bf16 a[116:119], a[252:255], v[116:119], a[116:119]
    v_mfma_f32_16x16x32_bf16 a[120:123], a[252:255], v[120:123], a[120:123]
    v_mfma_f32_16x16x32_bf16 a[124:127], a[252:255], v[124:127], a[124:127]
    s_nop 4
    s_lshr_b32 s43, s74, 7
    s_load_dwordx2 s[28:29], s[70:71], s43 glc
    s_lshr_b32 s43, s75, 7
    s_load_dwordx2 s[46:47], s[70:71], s43 glc
    v_accvgpr_read_b32 v128, a96
    v_accvgpr_read_b32 v129, a97
    v_accvgpr_read_b32 v130, a98
    v_accvgpr_read_b32 v131, a99
    v_accvgpr_read_b32 v132, a112
    v_accvgpr_read_b32 v133, a113
    v_accvgpr_read_b32 v134, a114
    v_accvgpr_read_b32 v135, a115
    v_pk_mul_f32 v[128:129], v[128:129], v[196:197] op_sel:[0,0] op_sel_hi:[1,0]
    v_pk_mul_f32 v[130:131], v[130:131], v[196:197] op_sel:[0,0] op_sel_hi:[1,0]
    v_pk_mul_f32 v[132:133], v[132:133], v[196:197] op_sel:[0,0] op_sel_hi:[1,0]
    v_pk_mul_f32 v[134:135], v[134:135], v[196:197] op_sel:[0,0] op_sel_hi:[1,0]
    v_cvt_pk_bf16_f32 v128, v128, v129
    v_cvt_pk_bf16_f32 v129, v130, v131
    v_cvt_pk_bf16_f32 v130, v132, v133
    v_cvt_pk_bf16_f32 v131, v134, v135
    s_nop 0
    buffer_store_dwordx4 v[128:131], v222, s[24:27], s38 offen offset:0 sc1
    v_accvgpr_read_b32 v136, a100
    v_accvgpr_read_b32 v137, a101
    v_accvgpr_read_b32 v138, a102
    v_accvgpr_read_b32 v139, a103
    v_accvgpr_read_b32 v140, a116
    v_accvgpr_read_b32 v141, a117
    v_accvgpr_read_b32 v142, a118
    v_accvgpr_read_b32 v143, a119
    v_pk_mul_f32 v[136:137], v[136:137], v[196:197] op_sel:[0,1] op_sel_hi:[1,1]
    v_pk_mul_f32 v[138:139], v[138:139], v[196:197] op_sel:[0,1] op_sel_hi:[1,1]
    v_pk_mul_f32 v[140:141], v[140:141], v[196:197] op_sel:[0,1] op_sel_hi:[1,1]
    v_pk_mul_f32 v[142:143], v[142:143], v[196:197] op_sel:[0,1] op_sel_hi:[1,1]
    v_cvt_pk_bf16_f32 v136, v136, v137
    v_cvt_pk_bf16_f32 v137, v138, v139
    v_cvt_pk_bf16_f32 v138, v140, v141
    v_cvt_pk_bf16_f32 v139, v142, v143
    s_nop 0
    buffer_store_dwordx4 v[136:139], v222, s[24:27], s39 offen offset:0 sc1
    v_accvgpr_read_b32 v144, a104
    v_accvgpr_read_b32 v145, a105
    v_accvgpr_read_b32 v146, a106
    v_accvgpr_read_b32 v147, a107
    v_accvgpr_read_b32 v148, a120
    v_accvgpr_read_b32 v149, a121
    v_accvgpr_read_b32 v150, a122
    v_accvgpr_read_b32 v151, a123
    v_pk_mul_f32 v[144:145], v[144:145], v[198:199] op_sel:[0,0] op_sel_hi:[1,0]
    v_pk_mul_f32 v[146:147], v[146:147], v[198:199] op_sel:[0,0] op_sel_hi:[1,0]
    v_pk_mul_f32 v[148:149], v[148:149], v[198:199] op_sel:[0,0] op_sel_hi:[1,0]
    v_pk_mul_f32 v[150:151], v[150:151], v[198:199] op_sel:[0,0] op_sel_hi:[1,0]
    v_cvt_pk_bf16_f32 v144, v144, v145
    v_cvt_pk_bf16_f32 v145, v146, v147
    v_cvt_pk_bf16_f32 v146, v148, v149
    v_cvt_pk_bf16_f32 v147, v150, v151
    s_nop 0
    buffer_store_dwordx4 v[144:147], v222, s[24:27], s40 offen offset:0 sc1
    v_accvgpr_read_b32 v152, a108
    v_accvgpr_read_b32 v153, a109
    v_accvgpr_read_b32 v154, a110
    v_accvgpr_read_b32 v155, a111
    v_accvgpr_read_b32 v156, a124
    v_accvgpr_read_b32 v157, a125
    v_accvgpr_read_b32 v158, a126
    v_accvgpr_read_b32 v159, a127
    v_pk_mul_f32 v[152:153], v[152:153], v[198:199] op_sel:[0,1] op_sel_hi:[1,1]
    v_pk_mul_f32 v[154:155], v[154:155], v[198:199] op_sel:[0,1] op_sel_hi:[1,1]
    v_pk_mul_f32 v[156:157], v[156:157], v[198:199] op_sel:[0,1] op_sel_hi:[1,1]
    v_pk_mul_f32 v[158:159], v[158:159], v[198:199] op_sel:[0,1] op_sel_hi:[1,1]
    v_cvt_pk_bf16_f32 v152, v152, v153
    v_cvt_pk_bf16_f32 v153, v154, v155
    v_cvt_pk_bf16_f32 v154, v156, v157
    v_cvt_pk_bf16_f32 v155, v158, v159
    s_nop 0
    buffer_store_dwordx4 v[152:155], v222, s[24:27], s41 offen offset:0 sc1
    s_waitcnt lgkmcnt(0)
    s_cmp_eq_u64 s[28:29], s[64:65]
    s_cselect_b64 s[56:57], -1, 0
    s_cmp_eq_u64 s[46:47], s[64:65]
    s_cselect_b64 s[56:57], s[56:57], 0
    s_xor_b32 s33, s0, s74
    s_xor_b32 s34, s33, 262144
    s_add_u32 m0, s99, 32768
    s_mov_b64 exec, s[56:57]
    buffer_load_dwordx4 v222, s[48:51], s34 offen sc1 lds
    s_mov_b64 exec, -1
    s_mov_b64 exec, s[56:57]
    buffer_load_dwordx4 v216, s[48:51], s34 offen offset:1024 sc1 lds
    s_mov_b64 exec, -1
    s_xor_b32 s34, s33, 525312
    s_add_u32 m0, s99, 34816
    s_mov_b64 exec, s[56:57]
    buffer_load_dwordx4 v222, s[48:51], s34 offen sc1 lds
    s_mov_b64 exec, -1
    s_mov_b64 exec, s[56:57]
    buffer_load_dwordx4 v216, s[48:51], s34 offen offset:1024 sc1 lds
    s_mov_b64 exec, -1
    s_xor_b32 s34, s33, 787456
    s_add_u32 m0, s99, 36864
    s_mov_b64 exec, s[56:57]
    buffer_load_dwordx4 v222, s[48:51], s34 offen sc1 lds
    s_mov_b64 exec, -1
    s_mov_b64 exec, s[56:57]
    buffer_load_dwordx4 v216, s[48:51], s34 offen offset:1024 sc1 lds
    s_mov_b64 exec, -1
    s_xor_b32 s33, s0, s75
    s_xor_b32 s34, s33, 262144
    s_add_u32 m0, s99, 65536
    s_mov_b64 exec, s[56:57]
    buffer_load_dwordx4 v222, s[48:51], s34 offen sc1 lds
    s_mov_b64 exec, -1
    s_mov_b64 exec, s[56:57]
    buffer_load_dwordx4 v216, s[48:51], s34 offen offset:1024 sc1 lds
    s_mov_b64 exec, -1
    s_xor_b32 s34, s33, 525312
    s_add_u32 m0, s99, 67584
    s_mov_b64 exec, s[56:57]
    buffer_load_dwordx4 v222, s[48:51], s34 offen sc1 lds
    s_mov_b64 exec, -1
    s_mov_b64 exec, s[56:57]
    buffer_load_dwordx4 v216, s[48:51], s34 offen offset:1024 sc1 lds
    s_mov_b64 exec, -1
    s_xor_b32 s34, s33, 787456
    s_add_u32 m0, s99, 69632
    s_mov_b64 exec, s[56:57]
    buffer_load_dwordx4 v222, s[48:51], s34 offen sc1 lds
    s_mov_b64 exec, -1
    s_mov_b64 exec, s[56:57]
    buffer_load_dwordx4 v216, s[48:51], s34 offen offset:1024 sc1 lds
    s_mov_b64 exec, -1
    s_lshr_b32 s43, s76, 7
    s_load_dwordx2 s[72:73], s[70:71], s43 glc
    s_lshl1_add_u32 s31, s76, s1
    buffer_load_dwordx4 a[128:131], v222, s[48:51], s31 offen offset:0 sc1
    buffer_load_dwordx4 a[132:135], v222, s[48:51], s31 offen offset:1024 sc1
    buffer_load_dwordx4 a[136:139], v222, s[48:51], s31 offen offset:2048 sc1
    buffer_load_dwordx4 a[140:143], v222, s[48:51], s31 offen offset:3072 sc1
    s_add_u32 s32, s31, 4096
    buffer_load_dwordx4 a[144:147], v222, s[48:51], s32 offen offset:0 sc1
    buffer_load_dwordx4 a[148:151], v222, s[48:51], s32 offen offset:1024 sc1
    buffer_load_dwordx4 a[152:155], v222, s[48:51], s32 offen offset:2048 sc1
    buffer_load_dwordx4 a[156:159], v222, s[48:51], s32 offen offset:3072 sc1
    s_waitcnt vmcnt(20)
    s_mov_b64 exec, 1
    buffer_store_dword v200, off, s[48:51], s62 sc1
    s_mov_b64 exec, -1
    s_cmp_eq_u64 s[56:57], 0
    s_cbranch_scc1 F_LATE
F_LBACK:
    s_cmp_eq_u32 s7, 0
    s_cbranch_scc1 F_RA
F_RAB:
    s_waitcnt vmcnt(15) lgkmcnt(0)
    s_cmp_eq_u64 s[72:73], s[64:65]
    s_cbranch_scc0 F_W2
F_WB2:
    s_cmp_eq_u32 s69, 8
    s_barrier
    s_cbranch_scc0 F_GD
F_G8:
    ds_read_b128 v[128:131], v192 offset:0
    ds_read_b128 v[132:135], v192 offset:1024
    ds_read_b128 v[136:139], v192 offset:2048
    ds_read_b128 v[140:143], v192 offset:3072
    ds_read_b128 v[144:147], v192 offset:4096
    ds_read_b128 v[148:151], v192 offset:5120
    ds_read_b128 v[152:155], v192 offset:6144
    ds_read_b128 v[156:159], v192 offset:7168
    ds_read_b128 v[160:163], v192 offset:8192
    ds_read_b128 v[164:167], v192 offset:9216
    ds_read_b128 v[168:171], v192 offset:10240
    ds_read_b128 v[172:175], v192 offset:11264
    s_waitcnt lgkmcnt(10)
    v_mfma_f32_16x16x32_bf16 v[80:83], v[224:227], v[128:131], 0
    s_xor_b32 s33, s0, s76
    s_xor_b32 s34, s33, 262144
    s_add_u32 m0, s99, 98304
    v_mfma_f32_16x16x32_bf16 v[84:87], v[228:231], v[128:131], 0
    buffer_load_dwordx4 v222, s[48:51], s34 offen sc1 lds
    v_mfma_f32_16x16x32_bf16 v[88:91], v[224:227], v[132:135], 0
    ds_read_b128 v[128:131], v192 offset:12288
    v_mfma_f32_16x16x32_bf16 v[92:95], v[228:231], v[132:135], 0
    s_waitcnt lgkmcnt(9)
    v_mfma_f32_16x16x32_bf16 v[96:99], v[224:227], v[136:139], 0
    s_lshr_b32 s43, s77, 7
    s_load_dwordx2 s[72:73], s[70:71], s43 glc
    ds_read_b128 v[132:135], v192 offset:13312
    v_mfma_f32_16x16x32_bf16 v[100:103], v[228:231], v[136:139], 0
    buffer_load_dwordx4 v216, s[48:51], s34 offen offset:1024 sc1 lds
    v_mfma_f32_16x16x32_bf16 v[104:107], v[224:227], v[140:143], 0
    ds_read_b128 v[136:139], v192 offset:14336
    v_mfma_f32_16x16x32_bf16 v[108:111], v[228:231], v[140:143], 0
    s_waitcnt lgkmcnt(9)
    v_mfma_f32_16x16x32_bf16 v[112:115], v[224:227], v[144:147], 0
    s_xor_b32 s34, s33, 525312
    s_add_u32 m0, s99, 100352
    ds_read_b128 v[140:143], v192 offset:15360
    v_mfma_f32_16x16x32_bf16 v[116:119], v[228:231], v[144:147], 0
    buffer_load_dwordx4 v222, s[48:51], s34 offen sc1 lds
    v_mfma_f32_16x16x32_bf16 v[120:123], v[224:227], v[148:151], 0
    ds_read_b128 v[144:147], v192 offset:16384
    v_mfma_f32_16x16x32_bf16 v[124:127], v[228:231], v[148:151], 0
    s_waitcnt lgkmcnt(9)
    v_mfma_f32_16x16x32_bf16 v[80:83], v[232:235], v[152:155], v[80:83]
    ds_read_b128 v[148:151], v192 offset:17408
    v_mfma_f32_16x16x32_bf16 v[84:87], v[236:239], v[152:155], v[84:87]
    buffer_load_dwordx4 v216, s[48:51], s34 offen offset:1024 sc1 lds
    v_mfma_f32_16x16x32_bf16 v[88:91], v[232:235], v[156:159], v[88:91]
    ds_read_b128 v[152:155], v192 offset:18432
    v_mfma_f32_16x16x32_bf16 v[92:95], v[236:239], v[156:159], v[92:95]
    s_waitcnt lgkmcnt(9)
    v_mfma_f32_16x16x32_bf16 v[96:99], v[232:235], v[160:163], v[96:99]
    s_xor_b32 s34, s33, 787456
    s_add_u32 m0, s99, 102400
    ds_read_b128 v[156:159], v192 offset:19456
    v_mfma_f32_16x16x32_bf16 v[100:103], v[236:239], v[160:163], v[100:103]
    buffer_load_dwordx4 v222, s[48:51], s34 offen sc1 lds
    v_mfma_f32_16x16x32_bf16 v[104:107], v[232:235], v[164:167], v[104:107]
    ds_read_b128 v[160:163], v192 offset:20480
    v_mfma_f32_16x16x32_bf16 v[108:111], v[236:239], v[164:167], v[108:111]
    s_waitcnt lgkmcnt(9)
    v_mfma_f32_16x16x32_bf16 v[112:115], v[232:235], v[168:171], v[112:115]
    ds_read_b128 v[164:167], v192 offset:21504
    v_mfma_f32_16x16x32_bf16 v[116:119], v[236:239], v[168:171], v[116:119]
    buffer_load_dwordx4 v216, s[48:51], s34 offen offset:1024 sc1 lds
    v_mfma_f32_16x16x32_bf16 v[120:123], v[232:235], v[172:175], v[120:123]
    ds_read_b128 v[168:171], v192 offset:22528
    v_mfma_f32_16x16x32_bf16 v[124:127], v[236:239], v[172:175], v[124:127]
    s_waitcnt lgkmcnt(9)
    v_mfma_f32_16x16x32_bf16 v[80:83], v[240:243], v[128:131], v[80:83]
    s_lshl1_add_u32 s31, s77, s1
    ds_read_b128 v[172:175], v192 offset:23552
    v_mfma_f32_16x16x32_bf16 v[84:87], v[244:247], v[128:131], v[84:87]
    buffer_load_dwordx4 a[160:163], v222, s[48:51], s31 offen offset:0 sc1
    v_mfma_f32_16x16x32_bf16 v[88:91], v[240:243], v[132:135], v[88:91]
    v_mfma_f32_16x16x32_bf16 v[92:95], v[244:247], v[132:135], v[92:95]
    s_waitcnt lgkmcnt(8)
    v_mfma_f32_16x16x32_bf16 v[96:99], v[240:243], v[136:139], v[96:99]
    v_mfma_f32_16x16x32_bf16 v[100:103], v[244:247], v[136:139], v[100:103]
    buffer_load_dwordx4 a[164:167], v222, s[48:51], s31 offen offset:1024 sc1
    v_mfma_f32_16x16x32_bf16 v[104:107], v[240:243], v[140:143], v[104:107]
    v_mfma_f32_16x16x32_bf16 v[108:111], v[244:247], v[140:143], v[108:111]
    s_waitcnt lgkmcnt(6)
    v_mfma_f32_16x16x32_bf16 v[112:115], v[240:243], v[144:147], v[112:115]
    s_waitcnt vmcnt(17) lgkmcnt(0)
    v_mfma_f32_16x16x32_bf16 v[116:119], v[244:247], v[144:147], v[116:119]
    s_cmp_eq_u64 s[72:73], s[64:65]
    s_cbranch_scc0 F_W3_8
F_WB3_8:
    s_barrier
    v_mfma_f32_16x16x32_bf16 v[120:123], v[240:243], v[148:151], v[120:123]
    ds_read_b128 v[128:131], v192 offset:32768
    v_mfma_f32_16x16x32_bf16 v[124:127], v[244:247], v[148:151], v[124:127]
    s_waitcnt lgkmcnt(5)
    ds_read_b128 v[132:135], v192 offset:33792
    v_mfma_f32_16x16x32_bf16 v[80:83], v[248:251], v[152:155], v[80:83]
    ds_read_b128 v[136:139], v192 offset:34816
    v_mfma_f32_16x16x32_bf16 v[84:87], v[252:255], v[152:155], v[84:87]
    ds_read_b128 v[140:143], v192 offset:35840
    v_mfma_f32_16x16x32_bf16 v[88:91], v[248:251], v[156:159], v[88:91]
    ds_read_b128 v[144:147], v192 offset:36864
    v_mfma_f32_16x16x32_bf16 v[92:95], v[252:255], v[156:159], v[92:95]
    s_waitcnt lgkmcnt(7)
    ds_read_b128 v[148:151], v192 offset:37888
    v_mfma_f32_16x16x32_bf16 v[96:99], v[248:251], v[160:163], v[96:99]
    ds_read_b128 v[152:155], v192 offset:38912
    v_mfma_f32_16x16x32_bf16 v[100:103], v[252:255], v[160:163], v[100:103]
    ds_read_b128 v[156:159], v192 offset:39936
    v_mfma_f32_16x16x32_bf16 v[104:107], v[248:251], v[164:167], v[104:107]
    ds_read_b128 v[160:163], v192 offset:40960
    v_mfma_f32_16x16x32_bf16 v[108:111], v[252:255], v[164:167], v[108:111]
    s_waitcnt lgkmcnt(9)
    buffer_load_dwordx4 a[168:171], v222, s[48:51], s31 offen offset:2048 sc1
    v_mfma_f32_16x16x32_bf16 v[112:115], v[248:251], v[168:171], v[112:115]
    ds_read_b128 v[164:167], v192 offset:41984
    v_mfma_f32_16x16x32_bf16 v[116:119], v[252:255], v[168:171], v[116:119]
    v_mfma_f32_16x16x32_bf16 v[120:123], v[248:251], v[172:175], v[120:123]
    s_xor_b32 s33, s0, s77
    s_xor_b32 s34, s33, 262144
    s_add_u32 m0, s99, 32768
    ds_read_b128 v[168:171], v192 offset:43008
    v_mfma_f32_16x16x32_bf16 v[124:127], v[252:255], v[172:175], v[124:127]
    s_waitcnt lgkmcnt(9)
    buffer_load_dwordx4 v222, s[48:51], s34 offen sc1 lds
    v_mfma_f32_16x16x32_bf16 v[80:83], a[192:195], v[128:131], v[80:83]
    ds_read_b128 v[172:175], v192 offset:44032
    v_mfma_f32_16x16x32_bf16 v[84:87], a[196:199], v[128:131], v[84:87]
    v_mfma_f32_16x16x32_bf16 v[88:91], a[192:195], v[132:135], v[88:91]
    ds_read_b128 v[128:131], v192 offset:45056
    v_mfma_f32_16x16x32_bf16 v[92:95], a[196:199], v[132:135], v[92:95]
    s_waitcnt lgkmcnt(9)
    buffer_load_dwordx4 v216, s[48:51], s34 offen offset:1024 sc1 lds
    v_mfma_f32_16x16x32_bf16 v[96:99], a[192:195], v[136:139], v[96:99]
    s_lshr_b32 s43, s78, 7
    s_load_dwordx2 s[72:73], s[70:71], s43 glc
    ds_read_b128 v[132:135], v192 offset:46080
    v_mfma_f32_16x16x32_bf16 v[100:103], a[196:199], v[136:139], v[100:103]
    v_mfma_f32_16x16x32_bf16 v[104:107], a[192:195], v[140:143], v[104:107]
    s_xor_b32 s34, s33, 525312
    s_add_u32 m0, s99, 34816
    ds_read_b128 v[136:139], v192 offset:47104
    v_mfma_f32_16x16x32_bf16 v[108:111], a[196:199], v[140:143], v[108:111]
    s_waitcnt lgkmcnt(9)
    buffer_load_dwordx4 v222, s[48:51], s34 offen sc1 lds
    v_mfma_f32_16x16x32_bf16 v[112:115], a[192:195], v[144:147], v[112:115]
    ds_read_b128 v[140:143], v192 offset:48128
    v_mfma_f32_16x16x32_bf16 v[116:119], a[196:199], v[144:147], v[116:119]
    v_mfma_f32_16x16x32_bf16 v[120:123], a[192:195], v[148:151], v[120:123]
    ds_read_b128 v[144:147], v192 offset:49152
    v_mfma_f32_16x16x32_bf16 v[124:127], a[196:199], v[148:151], v[124:127]
    s_waitcnt lgkmcnt(9)
    buffer_load_dwordx4 v216, s[48:51], s34 offen offset:1024 sc1 lds
    v_mfma_f32_16x16x32_bf16 v[80:83], a[200:203], v[152:155], v[80:83]
    ds_read_b128 v[148:151], v192 offset:50176
    v_mfma_f32_16x16x32_bf16 v[84:87], a[204:207], v[152:155], v[84:87]
    v_mfma_f32_16x16x32_bf16 v[88:91], a[200:203], v[156:159], v[88:91]
    s_xor_b32 s34, s33, 787456
    s_add_u32 m0, s99, 36864
    ds_read_b128 v[152:155], v192 offset:51200
    v_mfma_f32_16x16x32_bf16 v[92:95], a[204:207], v[156:159], v[92:95]
    s_waitcnt lgkmcnt(9)
    buffer_load_dwordx4 v222, s[48:51], s34 offen sc1 lds
    v_mfma_f32_16x16x32_bf16 v[96:99], a[200:203], v[160:163], v[96:99]
    ds_read_b128 v[156:159], v192 offset:52224
    v_mfma_f32_16x16x32_bf16 v[100:103], a[204:207], v[160:163], v[100:103]
    v_mfma_f32_16x16x32_bf16 v[104:107], a[200:203], v[164:167], v[104:107]
    ds_read_b128 v[160:163], v192 offset:53248
    v_mfma_f32_16x16x32_bf16 v[108:111], a[204:207], v[164:167], v[108:111]
    s_waitcnt lgkmcnt(9)
    buffer_load_dwordx4 v216, s[48:51], s34 offen offset:1024 sc1 lds
    v_mfma_f32_16x16x32_bf16 v[112:115], a[200:203], v[168:171], v[112:115]
    ds_read_b128 v[164:167], v192 offset:54272
    v_mfma_f32_16x16x32_bf16 v[116:119], a[204:207], v[168:171], v[116:119]
    v_mfma_f32_16x16x32_bf16 v[120:123], a[200:203], v[172:175], v[120:123]
    ds_read_b128 v[168:171], v192 offset:55296
    v_mfma_f32_16x16x32_bf16 v[124:127], a[204:207], v[172:175], v[124:127]
    s_waitcnt lgkmcnt(9)
    buffer_load_dwordx4 a[172:175], v222, s[48:51], s31 offen offset:3072 sc1
    v_mfma_f32_16x16x32_bf16 v[80:83], a[208:211], v[128:131], v[80:83]
    ds_read_b128 v[172:175], v192 offset:56320
    v_mfma_f32_16x16x32_bf16 v[84:87], a[212:215], v[128:131], v[84:87]
    v_mfma_f32_16x16x32_bf16 v[88:91], a[208:211], v[132:135], v[88:91]
    s_add_u32 s32, s31, 4096
    v_mfma_f32_16x16x32_bf16 v[92:95], a[212:215], v[132:135], v[92:95]
    s_waitcnt lgkmcnt(8)
    buffer_load_dwordx4 a[176:179], v222, s[48:51], s32 offen offset:0 sc1
    v_mfma_f32_16x16x32_bf16 v[96:99], a[208:211], v[136:139], v[96:99]
    v_mfma_f32_16x16x32_bf16 v[100:103], a[212:215], v[136:139], v[100:103]
    v_mfma_f32_16x16x32_bf16 v[104:107], a[208:211], v[140:143], v[104:107]
    v_mfma_f32_16x16x32_bf16 v[108:111], a[212:215], v[140:143], v[108:111]
    s_waitcnt lgkmcnt(6)
    buffer_load_dwordx4 a[180:183], v222, s[48:51], s32 offen offset:1024 sc1
    v_mfma_f32_16x16x32_bf16 v[112:115], a[208:211], v[144:147], v[112:115]
    s_waitcnt vmcnt(12) lgkmcnt(0)
    v_mfma_f32_16x16x32_bf16 v[116:119], a[212:215], v[144:147], v[116:119]
    s_cmp_eq_u64 s[72:73], s[64:65]
    s_cbranch_scc0 F_W4_8
F_WB4_8:
    s_barrier
    v_mfma_f32_16x16x32_bf16 v[120:123], a[208:211], v[148:151], v[120:123]
    ds_read_b128 v[128:131], v193 offset:0
    v_mfma_f32_16x16x32_bf16 v[124:127], a[212:215], v[148:151], v[124:127]
    s_waitcnt lgkmcnt(5)
    ds_read_b128 v[132:135], v193 offset:1024
    v_mfma_f32_16x16x32_bf16 v[80:83], a[216:219], v[152:155], v[80:83]
    s_cmp_eq_u32 s7, 0
    s_cbranch_scc1 F_RB8
F_RBB8:
    ds_read_b128 v[136:139], v193 offset:2048
    v_mfma_f32_16x16x32_bf16 v[84:87], a[220:223], v[152:155], v[84:87]
    ds_read_b128 v[140:143], v193 offset:3072
    v_mfma_f32_16x16x32_bf16 v[88:91], a[216:219], v[156:159], v[88:91]
    ds_read_b128 v[144:147], v193 offset:4096
    v_mfma_f32_16x16x32_bf16 v[92:95], a[220:223], v[156:159], v[92:95]
    s_waitcnt lgkmcnt(7)
    ds_read_b128 v[148:151], v193 offset:5120
    v_mfma_f32_16x16x32_bf16 v[96:99], a[216:219], v[160:163], v[96:99]
    ds_read_b128 v[152:155], v193 offset:6144
    v_mfma_f32_16x16x32_bf16 v[100:103], a[220:223], v[160:163], v[100:103]
    ds_read_b128 v[156:159], v193 offset:7168
    v_mfma_f32_16x16x32_bf16 v[104:107], a[216:219], v[164:167], v[104:107]
    ds_read_b128 v[160:163], v193 offset:8192
    v_mfma_f32_16x16x32_bf16 v[108:111], a[220:223], v[164:167], v[108:111]
    s_waitcnt lgkmcnt(9)
    buffer_load_dwordx4 a[184:187], v222, s[48:51], s32 offen offset:2048 sc1
    v_mfma_f32_16x16x32_bf16 v[112:115], a[216:219], v[168:171], v[112:115]
    ds_read_b128 v[164:167], v193 offset:9216
    v_mfma_f32_16x16x32_bf16 v[116:119], a[220:223], v[168:171], v[116:119]
    buffer_load_dwordx4 v[48:51], v194, s[16:19], s97 offen
    v_mfma_f32_16x16x32_bf16 v[120:123], a[216:219], v[172:175], v[120:123]
    ds_read_b128 v[168:171], v193 offset:10240
    v_mfma_f32_16x16x32_bf16 v[124:127], a[220:223], v[172:175], v[124:127]
    s_waitcnt vmcnt(21) lgkmcnt(9)
    buffer_load_dwordx4 a[188:191], v222, s[48:51], s32 offen offset:3072 sc1
    v_mfma_f32_16x16x32_bf16 v[80:83], a[128:131], v[128:131], v[80:83]
    ds_read_b128 v[172:175], v193 offset:11264
    v_mfma_f32_16x16x32_bf16 v[84:87], a[132:135], v[128:131], v[84:87]
    buffer_load_dwordx4 v[52:55], v194, s[16:19], s6 offen
    v_mfma_f32_16x16x32_bf16 v[88:91], a[128:131], v[132:135], v[88:91]
    s_xor_b32 s33, s0, s78
    s_xor_b32 s34, s33, 262144
    s_add_u32 m0, s99, 65536
    ds_read_b128 v[128:131], v193 offset:12288
    v_lshlrev_b32 v176, 16, v184
    v_mfma_f32_16x16x32_bf16 v[92:95], a[132:135], v[132:135], v[92:95]
    s_waitcnt lgkmcnt(9)
    buffer_load_dwordx4 v222, s[48:51], s34 offen sc1 lds
    v_mfma_f32_16x16x32_bf16 v[96:99], a[128:131], v[136:139], v[96:99]
    s_lshr_b32 s43, s79, 7
    s_load_dwordx2 s[72:73], s[70:71], s43 glc
    ds_read_b128 v[132:135], v193 offset:13312
    v_and_b32 v177, 0xffff0000, v184
    v_mfma_f32_16x16x32_bf16 v[100:103], a[132:135], v[136:139], v[100:103]
    v_lshlrev_b32 v178, 16, v185
    v_and_b32 v179, 0xffff0000, v185
    v_mfma_f32_16x16x32_bf16 v[104:107], a[128:131], v[140:143], v[104:107]
    ds_read_b128 v[136:139], v193 offset:14336
    v_lshlrev_b32 v180, 16, v186
    v_mfma_f32_16x16x32_bf16 v[108:111], a[132:135], v[140:143], v[108:111]
    s_waitcnt lgkmcnt(9)
    buffer_load_dwordx4 v216, s[48:51], s34 offen offset:1024 sc1 lds
    v_mfma_f32_16x16x32_bf16 v[112:115], a[128:131], v[144:147], v[112:115]
    ds_read_b128 v[140:143], v193 offset:15360
    v_and_b32 v181, 0xffff0000, v186
    v_mfma_f32_16x16x32_bf16 v[116:119], a[132:135], v[144:147], v[116:119]
    v_lshlrev_b32 v182, 16, v187
    v_and_b32 v183, 0xffff0000, v187
    v_mfma_f32_16x16x32_bf16 v[120:123], a[128:131], v[148:151], v[120:123]
    s_xor_b32 s34, s33, 525312
    s_add_u32 m0, s99, 67584
    ds_read_b128 v[144:147], v193 offset:16384
    v_lshlrev_b32 v184, 16, v188
    v_mfma_f32_16x16x32_bf16 v[124:127], a[132:135], v[148:151], v[124:127]
    s_waitcnt lgkmcnt(9)
    buffer_load_dwordx4 v222, s[48:51], s34 offen sc1 lds
    v_mfma_f32_16x16x32_bf16 v[80:83], a[136:139], v[152:155], v[80:83]
    ds_read_b128 v[148:151], v193 offset:17408
    v_and_b32 v185, 0xffff0000, v188
    v_mfma_f32_16x16x32_bf16 v[84:87], a[140:143], v[152:155], v[84:87]
    v_lshlrev_b32 v186, 16, v189
    v_and_b32 v187, 0xffff0000, v189
    v_mfma_f32_16x16x32_bf16 v[88:91], a[136:139], v[156:159], v[88:91]
    ds_read_b128 v[152:155], v193 offset:18432
    v_lshlrev_b32 v188, 16, v190
    v_mfma_f32_16x16x32_bf16 v[92:95], a[140:143], v[156:159], v[92:95]
    s_waitcnt lgkmcnt(9)
    buffer_load_dwordx4 v216, s[48:51], s34 offen offset:1024 sc1 lds
    v_mfma_f32_16x16x32_bf16 v[96:99], a[136:139], v[160:163], v[96:99]
    ds_read_b128 v[156:159], v193 offset:19456
    v_and_b32 v189, 0xffff0000, v190
    v_mfma_f32_16x16x32_bf16 v[100:103], a[140:143], v[160:163], v[100:103]
    v_lshlrev_b32 v190, 16, v191
    v_and_b32 v191, 0xffff0000, v191
    v_mfma_f32_16x16x32_bf16 v[104:107], a[136:139], v[164:167], v[104:107]
    s_xor_b32 s34, s33, 787456
    s_add_u32 m0, s99, 69632
    ds_read_b128 v[160:163], v193 offset:20480
    v_mul_f32 v16, s36, v176
    v_mfma_f32_16x16x32_bf16 v[108:111], a[140:143], v[164:167], v[108:111]
    s_waitcnt lgkmcnt(9)
    buffer_load_dwordx4 v222, s[48:51], s34 offen sc1 lds
    v_mfma_f32_16x16x32_bf16 v[112:115], a[136:139], v[168:171], v[112:115]
    ds_read_b128 v[164:167], v193 offset:21504
    v_mul_f32 v17, s36, v177
    v_mfma_f32_16x16x32_bf16 v[116:119], a[140:143], v[168:171], v[116:119]
    v_mul_f32 v18, s36, v178
    v_mul_f32 v19, s36, v179
    v_mfma_f32_16x16x32_bf16 v[120:123], a[136:139], v[172:175], v[120:123]
    ds_read_b128 v[168:171], v193 offset:22528
    v_mul_f32 v20, s36, v180
    v_mfma_f32_16x16x32_bf16 v[124:127], a[140:143], v[172:175], v[124:127]
    s_waitcnt lgkmcnt(9)
    buffer_load_dwordx4 v216, s[48:51], s34 offen offset:1024 sc1 lds
    v_mfma_f32_16x16x32_bf16 v[80:83], a[144:147], v[128:131], v[80:83]
    ds_read_b128 v[172:175], v193 offset:23552
    v_mul_f32 v21, s36, v181
    v_mfma_f32_16x16x32_bf16 v[84:87], a[148:151], v[128:131], v[84:87]
    v_mul_f32 v22, s36, v182
    v_mul_f32 v23, s36, v183
    v_mfma_f32_16x16x32_bf16 v[88:91], a[144:147], v[132:135], v[88:91]
    s_lshl1_add_u32 s31, s78, s1
    v_mul_f32 v24, s36, v184
    v_mul_f32 v25, s36, v185
    v_mfma_f32_16x16x32_bf16 v[92:95], a[148:151], v[132:135], v[92:95]
    s_waitcnt lgkmcnt(8)
    buffer_load_dwordx4 a[224:227], v222, s[48:51], s31 offen offset:0 sc1
    v_mfma_f32_16x16x32_bf16 v[96:99], a[144:147], v[136:139], v[96:99]
    v_mul_f32 v26, s36, v186
    v_mul_f32 v27, s36, v187
    v_mfma_f32_16x16x32_bf16 v[100:103], a[148:151], v[136:139], v[100:103]
    v_mul_f32 v28, s36, v188
    v_mul_f32 v29, s36, v189
    v_mfma_f32_16x16x32_bf16 v[104:107], a[144:147], v[140:143], v[104:107]
    v_mul_f32 v30, s36, v190
    v_mul_f32 v31, s36, v191
    v_mfma_f32_16x16x32_bf16 v[108:111], a[148:151], v[140:143], v[108:111]
    s_waitcnt lgkmcnt(6)
    buffer_load_dwordx4 a[228:231], v222, s[48:51], s31 offen offset:1024 sc1
    v_mfma_f32_16x16x32_bf16 v[112:115], a[144:147], v[144:147], v[112:115]
    s_waitcnt vmcnt(15) lgkmcnt(0)
    v_exp_f32 v16, v16
    v_mfma_f32_16x16x32_bf16 v[116:119], a[148:151], v[144:147], v[116:119]
    s_cmp_eq_u64 s[72:73], s[64:65]
    s_cbranch_scc0 F_W5_8
F_WB5_8:
    s_barrier
    v_exp_f32 v17, v17
    v_mfma_f32_16x16x32_bf16 v[120:123], a[144:147], v[148:151], v[120:123]
    ds_read_b128 v[128:131], v192 offset:0
    v_mfma_f32_16x16x32_bf16 v[124:127], a[148:151], v[148:151], v[124:127]
    s_waitcnt lgkmcnt(5)
    ds_read_b128 v[132:135], v192 offset:1024
    v_mfma_f32_16x16x32_bf16 v[80:83], a[152:155], v[152:155], v[80:83]
    ds_read_b128 v[136:139], v192 offset:2048
    v_mfma_f32_16x16x32_bf16 v[84:87], a[156:159], v[152:155], v[84:87]
    ds_read_b128 v[140:143], v192 offset:3072
    v_mfma_f32_16x16x32_bf16 v[88:91], a[152:155], v[156:159], v[88:91]
    ds_read_b128 v[144:147], v192 offset:4096
    v_mfma_f32_16x16x32_bf16 v[92:95], a[156:159], v[156:159], v[92:95]
    s_waitcnt lgkmcnt(7)
    ds_read_b128 v[148:151], v192 offset:5120
    v_mfma_f32_16x16x32_bf16 v[96:99], a[152:155], v[160:163], v[96:99]
    ds_read_b128 v[152:155], v192 offset:6144
    v_mfma_f32_16x16x32_bf16 v[100:103], a[156:159], v[160:163], v[100:103]
    ds_read_b128 v[156:159], v192 offset:7168
    v_mfma_f32_16x16x32_bf16 v[104:107], a[152:155], v[164:167], v[104:107]
    ds_read_b128 v[160:163], v192 offset:8192
    v_mfma_f32_16x16x32_bf16 v[108:111], a[156:159], v[164:167], v[108:111]
    s_waitcnt lgkmcnt(9)
    buffer_load_dwordx4 a[232:235], v222, s[48:51], s31 offen offset:2048 sc1
    v_mfma_f32_16x16x32_bf16 v[112:115], a[152:155], v[168:171], v[112:115]
    ds_read_b128 v[164:167], v192 offset:9216
    v_mfma_f32_16x16x32_bf16 v[116:119], a[156:159], v[168:171], v[116:119]
    v_exp_f32 v18, v18
    v_mfma_f32_16x16x32_bf16 v[120:123], a[152:155], v[172:175], v[120:123]
    ds_read_b128 v[168:171], v192 offset:10240
    v_mfma_f32_16x16x32_bf16 v[124:127], a[156:159], v[172:175], v[124:127]
    s_waitcnt vmcnt(10) lgkmcnt(9)
    buffer_load_dwordx4 a[236:239], v222, s[48:51], s31 offen offset:3072 sc1
    v_mfma_f32_16x16x32_bf16 v[80:83], a[160:163], v[128:131], v[80:83]
    ds_read_b128 v[172:175], v192 offset:11264
    v_mfma_f32_16x16x32_bf16 v[84:87], a[164:167], v[128:131], v[84:87]
    v_exp_f32 v19, v19
    v_mfma_f32_16x16x32_bf16 v[88:91], a[160:163], v[132:135], v[88:91]
    s_add_u32 s32, s31, 4096
    ds_read_b128 v[128:131], v192 offset:12288
    v_mfma_f32_16x16x32_bf16 v[92:95], a[164:167], v[132:135], v[92:95]
    s_waitcnt lgkmcnt(9)
    buffer_load_dwordx4 a[240:243], v222, s[48:51], s32 offen offset:0 sc1
    v_mfma_f32_16x16x32_bf16 v[96:99], a[160:163], v[136:139], v[96:99]
    s_lshr_b32 s43, s82, 7
    s_load_dwordx2 s[72:73], s[70:71], s43 glc
    ds_read_b128 v[132:135], v192 offset:13312
    v_mfma_f32_16x16x32_bf16 v[100:103], a[164:167], v[136:139], v[100:103]
    v_exp_f32 v20, v20
    v_mfma_f32_16x16x32_bf16 v[104:107], a[160:163], v[140:143], v[104:107]
    ds_read_b128 v[136:139], v192 offset:14336
    v_mfma_f32_16x16x32_bf16 v[108:111], a[164:167], v[140:143], v[108:111]
    s_waitcnt lgkmcnt(9)
    buffer_load_dwordx4 a[244:247], v222, s[48:51], s32 offen offset:1024 sc1
    v_mfma_f32_16x16x32_bf16 v[112:115], a[160:163], v[144:147], v[112:115]
    ds_read_b128 v[140:143], v192 offset:15360
    v_mfma_f32_16x16x32_bf16 v[116:119], a[164:167], v[144:147], v[116:119]
    v_exp_f32 v21, v21
    v_mfma_f32_16x16x32_bf16 v[120:123], a[160:163], v[148:151], v[120:123]
    ds_read_b128 v[144:147], v192 offset:16384
    v_mfma_f32_16x16x32_bf16 v[124:127], a[164:167], v[148:151], v[124:127]
    s_waitcnt lgkmcnt(9)
    buffer_load_dwordx4 a[248:251], v222, s[48:51], s32 offen offset:2048 sc1
    v_mfma_f32_16x16x32_bf16 v[80:83], a[168:171], v[152:155], v[80:83]
    ds_read_b128 v[148:151], v192 offset:17408
    v_mfma_f32_16x16x32_bf16 v[84:87], a[172:175], v[152:155], v[84:87]
    v_exp_f32 v22, v22
    v_mfma_f32_16x16x32_bf16 v[88:91], a[168:171], v[156:159], v[88:91]
    ds_read_b128 v[152:155], v192 offset:18432
    v_mfma_f32_16x16x32_bf16 v[92:95], a[172:175], v[156:159], v[92:95]
    s_waitcnt lgkmcnt(9)
    buffer_load_dwordx4 a[252:255], v222, s[48:51], s32 offen offset:3072 sc1
    v_mfma_f32_16x16x32_bf16 v[96:99], a[168:171], v[160:163], v[96:99]
    ds_read_b128 v[156:159], v192 offset:19456
    v_mfma_f32_16x16x32_bf16 v[100:103], a[172:175], v[160:163], v[100:103]
    v_exp_f32 v23, v23
    v_mfma_f32_16x16x32_bf16 v[104:107], a[168:171], v[164:167], v[104:107]
    s_xor_b32 s34, s0, s74
    s_add_u32 m0, s68, 0
    ds_read_b128 v[160:163], v192 offset:20480
    v_mfma_f32_16x16x32_bf16 v[108:111], a[172:175], v[164:167], v[108:111]
    s_waitcnt lgkmcnt(9)
    buffer_load_dwordx4 v222, s[48:51], s34 offen sc1 lds
    v_mfma_f32_16x16x32_bf16 v[112:115], a[168:171], v[168:171], v[112:115]
    ds_read_b128 v[164:167], v192 offset:21504
    v_mfma_f32_16x16x32_bf16 v[116:119], a[172:175], v[168:171], v[116:119]
    v_exp_f32 v24, v24
    v_mfma_f32_16x16x32_bf16 v[120:123], a[168:171], v[172:175], v[120:123]
    ds_read_b128 v[168:171], v192 offset:22528
    v_mfma_f32_16x16x32_bf16 v[124:127], a[172:175], v[172:175], v[124:127]
    s_waitcnt lgkmcnt(9)
    buffer_load_dwordx4 v216, s[48:51], s34 offen offset:1024 sc1 lds
    v_mfma_f32_16x16x32_bf16 v[80:83], a[176:179], v[128:131], v[80:83]
    ds_read_b128 v[172:175], v192 offset:23552
    v_mfma_f32_16x16x32_bf16 v[84:87], a[180:183], v[128:131], v[84:87]
    v_exp_f32 v25, v25
    v_mfma_f32_16x16x32_bf16 v[88:91], a[176:179], v[132:135], v[88:91]
    s_xor_b32 s34, s0, s75
    s_add_u32 m0, s68, 8192
    v_exp_f32 v26, v26
    v_mfma_f32_16x16x32_bf16 v[92:95], a[180:183], v[132:135], v[92:95]
    s_waitcnt lgkmcnt(8)
    buffer_load_dwordx4 v222, s[48:51], s34 offen sc1 lds
    v_mfma_f32_16x16x32_bf16 v[96:99], a[176:179], v[136:139], v[96:99]
    v_exp_f32 v27, v27
    v_mfma_f32_16x16x32_bf16 v[100:103], a[180:183], v[136:139], v[100:103]
    v_exp_f32 v28, v28
    v_mfma_f32_16x16x32_bf16 v[104:107], a[176:179], v[140:143], v[104:107]
    v_exp_f32 v29, v29
    v_mfma_f32_16x16x32_bf16 v[108:111], a[180:183], v[140:143], v[108:111]
    s_waitcnt lgkmcnt(6)
    buffer_load_dwordx4 v216, s[48:51], s34 offen offset:1024 sc1 lds
    v_mfma_f32_16x16x32_bf16 v[112:115], a[176:179], v[144:147], v[112:115]
    s_waitcnt vmcnt(12) lgkmcnt(0)
    v_exp_f32 v30, v30
    v_mfma_f32_16x16x32_bf16 v[116:119], a[180:183], v[144:147], v[116:119]
    s_cmp_eq_u64 s[72:73], s[64:65]
    s_cbranch_scc0 F_W6_8
F_WB6_8:
    s_barrier
    v_exp_f32 v31, v31
    v_mfma_f32_16x16x32_bf16 v[120:123], a[176:179], v[148:151], v[120:123]
    ds_read_b128 v[128:131], v192 offset:32768
    v_add_f32 v16, 1.0, v16
    v_mfma_f32_16x16x32_bf16 v[124:127], a[180:183], v[148:151], v[124:127]
    s_waitcnt lgkmcnt(5)
    ds_read_b128 v[132:135], v192 offset:33792
    v_add_f32 v17, 1.0, v17
    v_mfma_f32_16x16x32_bf16 v[80:83], a[184:187], v[152:155], v[80:83]
    ds_read_b128 v[136:139], v192 offset:34816
    v_add_f32 v18, 1.0, v18
    v_mfma_f32_16x16x32_bf16 v[84:87], a[188:191], v[152:155], v[84:87]
    ds_read_b128 v[140:143], v192 offset:35840
    v_add_f32 v19, 1.0, v19
    v_mfma_f32_16x16x32_bf16 v[88:91], a[184:187], v[156:159], v[88:91]
    ds_read_b128 v[144:147], v192 offset:36864
    v_add_f32 v20, 1.0, v20
    v_mfma_f32_16x16x32_bf16 v[92:95], a[188:191], v[156:159], v[92:95]
    s_waitcnt lgkmcnt(7)
    ds_read_b128 v[148:151], v192 offset:37888
    v_add_f32 v21, 1.0, v21
    v_mfma_f32_16x16x32_bf16 v[96:99], a[184:187], v[160:163], v[96:99]
    ds_read_b128 v[152:155], v192 offset:38912
    v_add_f32 v22, 1.0, v22
    v_mfma_f32_16x16x32_bf16 v[100:103], a[188:191], v[160:163], v[100:103]
    ds_read_b128 v[156:159], v192 offset:39936
    v_add_f32 v23, 1.0, v23
    v_mfma_f32_16x16x32_bf16 v[104:107], a[184:187], v[164:167], v[104:107]
    s_xor_b32 s33, s0, s79
    s_xor_b32 s34, s33, 262144
    s_add_u32 m0, s99, 98304
    ds_read_b128 v[160:163], v192 offset:40960
    v_add_f32 v24, 1.0, v24
    v_mfma_f32_16x16x32_bf16 v[108:111], a[188:191], v[164:167], v[108:111]
    s_waitcnt lgkmcnt(9)
    buffer_load_dwordx4 v222, s[48:51], s34 offen sc1 lds
    v_mfma_f32_16x16x32_bf16 v[112:115], a[184:187], v[168:171], v[112:115]
    ds_read_b128 v[164:167], v192 offset:41984
    v_add_f32 v25, 1.0, v25
    v_mfma_f32_16x16x32_bf16 v[116:119], a[188:191], v[168:171], v[116:119]
    v_add_f32 v26, 1.0, v26
    v_add_f32 v27, 1.0, v27
    v_mfma_f32_16x16x32_bf16 v[120:123], a[184:187], v[172:175], v[120:123]
    ds_read_b128 v[168:171], v192 offset:43008
    v_add_f32 v28, 1.0, v28
    v_mfma_f32_16x16x32_bf16 v[124:127], a[188:191], v[172:175], v[124:127]
    s_waitcnt vmcnt(5) lgkmcnt(9)
    buffer_load_dwordx4 v216, s[48:51], s34 offen offset:1024 sc1 lds
    v_mfma_f32_16x16x32_bf16 v[80:83], a[224:227], v[128:131], v[80:83]
    ds_read_b128 v[172:175], v192 offset:44032
    v_add_f32 v29, 1.0, v29
    v_mfma_f32_16x16x32_bf16 v[84:87], a[228:231], v[128:131], v[84:87]
    v_add_f32 v30, 1.0, v30
    v_add_f32 v31, 1.0, v31
    v_mfma_f32_16x16x32_bf16 v[88:91], a[224:227], v[132:135], v[88:91]
    s_xor_b32 s34, s33, 525312
    s_add_u32 m0, s99, 100352
    ds_read_b128 v[128:131], v192 offset:45056
    v_mfma_f32_16x16x32_bf16 v[92:95], a[228:231], v[132:135], v[92:95]
    s_waitcnt lgkmcnt(9)
    buffer_load_dwordx4 v222, s[48:51], s34 offen sc1 lds
    v_mfma_f32_16x16x32_bf16 v[96:99], a[224:227], v[136:139], v[96:99]
    ds_read_b128 v[132:135], v192 offset:46080
    v_mfma_f32_16x16x32_bf16 v[100:103], a[228:231], v[136:139], v[100:103]
    v_rcp_f32 v16, v16
    v_mfma_f32_16x16x32_bf16 v[104:107], a[224:227], v[140:143], v[104:107]
    ds_read_b128 v[136:139], v192 offset:47104
    v_mfma_f32_16x16x32_bf16 v[108:111], a[228:231], v[140:143], v[108:111]
    s_waitcnt lgkmcnt(9)
    buffer_load_dwordx4 v216, s[48:51], s34 offen offset:1024 sc1 lds
    v_mfma_f32_16x16x32_bf16 v[112:115], a[224:227], v[144:147], v[112:115]
    ds_read_b128 v[140:143], v192 offset:48128
    v_mfma_f32_16x16x32_bf16 v[116:119], a[228:231], v[144:147], v[116:119]
    v_rcp_f32 v17, v17
    v_mfma_f32_16x16x32_bf16 v[120:123], a[224:227], v[148:151], v[120:123]
    s_xor_b32 s34, s33, 787456
    s_add_u32 m0, s99, 102400
    ds_read_b128 v[144:147], v192 offset:49152
    v_mfma_f32_16x16x32_bf16 v[124:127], a[228:231], v[148:151], v[124:127]
    s_waitcnt lgkmcnt(9)
    buffer_load_dwordx4 v222, s[48:51], s34 offen sc1 lds
    v_mfma_f32_16x16x32_bf16 v[80:83], a[232:235], v[152:155], v[80:83]
    ds_read_b128 v[148:151], v192 offset:50176
    v_mfma_f32_16x16x32_bf16 v[84:87], a[236:239], v[152:155], v[84:87]
    v_rcp_f32 v18, v18
    v_mfma_f32_16x16x32_bf16 v[88:91], a[232:235], v[156:159], v[88:91]
    ds_read_b128 v[152:155], v192 offset:51200
    v_mfma_f32_16x16x32_bf16 v[92:95], a[236:239], v[156:159], v[92:95]
    s_waitcnt lgkmcnt(9)
    buffer_load_dwordx4 v216, s[48:51], s34 offen offset:1024 sc1 lds
    v_mfma_f32_16x16x32_bf16 v[96:99], a[232:235], v[160:163], v[96:99]
    ds_read_b128 v[156:159], v192 offset:52224
    v_mfma_f32_16x16x32_bf16 v[100:103], a[236:239], v[160:163], v[100:103]
    v_rcp_f32 v19, v19
    v_mfma_f32_16x16x32_bf16 v[104:107], a[232:235], v[164:167], v[104:107]
    s_xor_b32 s33, s0, s82
    s_xor_b32 s34, s33, 262144
    s_add_u32 m0, s99, 32768
    ds_read_b128 v[160:163], v192 offset:53248
    v_mfma_f32_16x16x32_bf16 v[108:111], a[236:239], v[164:167], v[108:111]
    s_waitcnt lgkmcnt(9)
    buffer_load_dwordx4 v222, s[48:51], s34 offen sc1 lds
    v_mfma_f32_16x16x32_bf16 v[112:115], a[232:235], v[168:171], v[112:115]
    ds_read_b128 v[164:167], v192 offset:54272
    v_mfma_f32_16x16x32_bf16 v[116:119], a[236:239], v[168:171], v[116:119]
    v_rcp_f32 v20, v20
    v_mfma_f32_16x16x32_bf16 v[120:123], a[232:235], v[172:175], v[120:123]
    ds_read_b128 v[168:171], v192 offset:55296
    v_mfma_f32_16x16x32_bf16 v[124:127], a[236:239], v[172:175], v[124:127]
    s_waitcnt lgkmcnt(9)
    buffer_load_dwordx4 v216, s[48:51], s34 offen offset:1024 sc1 lds
    v_mfma_f32_16x16x32_bf16 v[80:83], a[240:243], v[128:131], v[80:83]
    ds_read_b128 v[172:175], v192 offset:56320
    v_mfma_f32_16x16x32_bf16 v[84:87], a[244:247], v[128:131], v[84:87]
    v_rcp_f32 v21, v21
    v_mfma_f32_16x16x32_bf16 v[88:91], a[240:243], v[132:135], v[88:91]
    s_xor_b32 s34, s33, 525312
    s_add_u32 m0, s99, 34816
    v_rcp_f32 v22, v22
    v_mfma_f32_16x16x32_bf16 v[92:95], a[244:247], v[132:135], v[92:95]
    s_waitcnt lgkmcnt(8)
    buffer_load_dwordx4 v222, s[48:51], s34 offen sc1 lds
    v_mfma_f32_16x16x32_bf16 v[96:99], a[240:243], v[136:139], v[96:99]
    v_rcp_f32 v23, v23
    v_mfma_f32_16x16x32_bf16 v[100:103], a[244:247], v[136:139], v[100:103]
    v_rcp_f32 v24, v24
    v_mfma_f32_16x16x32_bf16 v[104:107], a[240:243], v[140:143], v[104:107]
    v_rcp_f32 v25, v25
    v_mfma_f32_16x16x32_bf16 v[108:111], a[244:247], v[140:143], v[108:111]
    s_waitcnt lgkmcnt(6)
    buffer_load_dwordx4 v216, s[48:51], s34 offen offset:1024 sc1 lds
    v_mfma_f32_16x16x32_bf16 v[112:115], a[240:243], v[144:147], v[112:115]
    s_waitcnt vmcnt(10) lgkmcnt(0)
    v_rcp_f32 v26, v26
    v_mfma_f32_16x16x32_bf16 v[116:119], a[244:247], v[144:147], v[116:119]
    s_barrier
    v_rcp_f32 v27, v27
    v_mfma_f32_16x16x32_bf16 v[120:123], a[240:243], v[148:151], v[120:123]
    ds_read_b128 v[128:131], v222 offset:0
    v_mfma_f32_16x16x32_bf16 v[124:127], a[244:247], v[148:151], v[124:127]
    s_waitcnt lgkmcnt(5)
    ds_read_b128 v[132:135], v222 offset:1024
    v_mfma_f32_16x16x32_bf16 v[80:83], a[248:251], v[152:155], v[80:83]
    s_lshr_b32 s43, s83, 7
    s_load_dwordx2 s[72:73], s[70:71], s43 glc
    ds_read_b128 v[136:139], v222 offset:2048
    v_mfma_f32_16x16x32_bf16 v[84:87], a[252:255], v[152:155], v[84:87]
    ds_read_b128 v[140:143], v222 offset:3072
    v_mfma_f32_16x16x32_bf16 v[88:91], a[248:251], v[156:159], v[88:91]
    ds_read_b128 v[144:147], v222 offset:4096
    v_mfma_f32_16x16x32_bf16 v[92:95], a[252:255], v[156:159], v[92:95]
    s_waitcnt lgkmcnt(7)
    ds_read_b128 v[148:151], v222 offset:5120
    v_mfma_f32_16x16x32_bf16 v[96:99], a[248:251], v[160:163], v[96:99]
    ds_read_b128 v[152:155], v222 offset:6144
    v_mfma_f32_16x16x32_bf16 v[100:103], a[252:255], v[160:163], v[100:103]
    ds_read_b128 v[156:159], v222 offset:7168
    v_mfma_f32_16x16x32_bf16 v[104:107], a[248:251], v[164:167], v[104:107]
    s_xor_b32 s34, s33, 787456
    s_add_u32 m0, s99, 36864
    ds_read_b128 v[160:163], v222 offset:8192
    v_mfma_f32_16x16x32_bf16 v[108:111], a[252:255], v[164:167], v[108:111]
    s_waitcnt lgkmcnt(9)
    buffer_load_dwordx4 v222, s[48:51], s34 offen sc1 lds
    v_mfma_f32_16x16x32_bf16 v[112:115], a[248:251], v[168:171], v[112:115]
    ds_read_b128 v[164:167], v222 offset:9216
    v_mfma_f32_16x16x32_bf16 v[116:119], a[252:255], v[168:171], v[116:119]
    v_rcp_f32 v28, v28
    v_mfma_f32_16x16x32_bf16 v[120:123], a[248:251], v[172:175], v[120:123]
    ds_read_b128 v[168:171], v222 offset:10240
    v_mfma_f32_16x16x32_bf16 v[124:127], a[252:255], v[172:175], v[124:127]
    s_waitcnt lgkmcnt(9)
    buffer_load_dwordx4 v216, s[48:51], s34 offen offset:1024 sc1 lds
    v_mfma_f32_16x16x32_bf16 v[64:67], v[224:227], v[128:131], 0
    ds_read_b128 v[172:175], v222 offset:11264
    v_mfma_f32_16x16x32_bf16 v[68:71], v[228:231], v[128:131], 0
    v_rcp_f32 v29, v29
    v_mfma_f32_16x16x32_bf16 v[72:75], v[224:227], v[132:135], 0
    s_lshl1_add_u32 s31, s83, s1
    ds_read_b128 v[128:131], v222 offset:12288
    v_mfma_f32_16x16x32_bf16 v[76:79], v[228:231], v[132:135], 0
    s_waitcnt lgkmcnt(9)
    buffer_load_dwordx4 a[64:67], v222, s[48:51], s31 offen offset:0 sc1
    v_mfma_f32_16x16x32_bf16 v[64:67], v[232:235], v[136:139], v[64:67]
    ds_read_b128 v[132:135], v222 offset:13312
    v_mfma_f32_16x16x32_bf16 v[68:71], v[236:239], v[136:139], v[68:71]
    v_rcp_f32 v30, v30
    v_mfma_f32_16x16x32_bf16 v[72:75], v[232:235], v[140:143], v[72:75]
    ds_read_b128 v[136:139], v222 offset:14336
    v_mfma_f32_16x16x32_bf16 v[76:79], v[236:239], v[140:143], v[76:79]
    s_waitcnt lgkmcnt(9)
    buffer_load_dwordx4 a[68:71], v222, s[48:51], s31 offen offset:1024 sc1
    v_mfma_f32_16x16x32_bf16 v[64:67], v[240:243], v[144:147], v[64:67]
    ds_read_b128 v[140:143], v222 offset:15360
    v_mfma_f32_16x16x32_bf16 v[68:71], v[244:247], v[144:147], v[68:71]
    v_rcp_f32 v31, v31
    v_mfma_f32_16x16x32_bf16 v[72:75], v[240:243], v[148:151], v[72:75]
    v_mul_f32 v16, v16, v176
    v_mul_f32 v17, v17, v177
    v_mfma_f32_16x16x32_bf16 v[76:79], v[244:247], v[148:151], v[76:79]
    s_waitcnt lgkmcnt(8)
    buffer_load_dwordx4 a[72:75], v222, s[48:51], s31 offen offset:2048 sc1
    v_mfma_f32_16x16x32_bf16 v[64:67], v[248:251], v[152:155], v[64:67]
    v_mul_f32 v18, v18, v178
    v_mul_f32 v19, v19, v179
    v_mfma_f32_16x16x32_bf16 v[68:71], v[252:255], v[152:155], v[68:71]
    v_mul_f32 v20, v20, v180
    v_mul_f32 v21, v21, v181
    v_mfma_f32_16x16x32_bf16 v[72:75], v[248:251], v[156:159], v[72:75]
    v_mul_f32 v22, v22, v182
    v_mul_f32 v23, v23, v183
    v_mfma_f32_16x16x32_bf16 v[76:79], v[252:255], v[156:159], v[76:79]
    s_waitcnt lgkmcnt(6)
    buffer_load_dwordx4 a[76:79], v222, s[48:51], s31 offen offset:3072 sc1
    v_mfma_f32_16x16x32_bf16 v[64:67], a[192:195], v[160:163], v[64:67]
    s_waitcnt vmcnt(10) lgkmcnt(0)
    v_mul_f32 v24, v24, v184
    v_mul_f32 v25, v25, v185
    v_mfma_f32_16x16x32_bf16 v[68:71], a[196:199], v[160:163], v[68:71]
    s_cmp_eq_u64 s[72:73], s[64:65]
    s_cbranch_scc0 F_W7_8
F_WB7_8:
    s_barrier
    v_mul_f32 v26, v26, v186
    v_mul_f32 v27, v27, v187
    v_mfma_f32_16x16x32_bf16 v[72:75], a[192:195], v[164:167], v[72:75]
    ds_read_b128 v[144:147], v193 offset:0
    v_mul_f32 v28, v28, v188
    v_mfma_f32_16x16x32_bf16 v[76:79], a[196:199], v[164:167], v[76:79]
    s_waitcnt lgkmcnt(5)
    ds_read_b128 v[148:151], v193 offset:1024
    v_mul_f32 v29, v29, v189
    v_mfma_f32_16x16x32_bf16 v[64:67], a[200:203], v[168:171], v[64:67]
    ds_read_b128 v[152:155], v193 offset:2048
    v_mul_f32 v30, v30, v190
    v_mfma_f32_16x16x32_bf16 v[68:71], a[204:207], v[168:171], v[68:71]
    ds_read_b128 v[156:159], v193 offset:3072
    v_mul_f32 v31, v31, v191
    v_mfma_f32_16x16x32_bf16 v[72:75], a[200:203], v[172:175], v[72:75]
    ds_read_b128 v[160:163], v193 offset:4096
    v_cvt_pk_bf16_f32 v16, v16, v17
    v_mfma_f32_16x16x32_bf16 v[76:79], a[204:207], v[172:175], v[76:79]
    s_waitcnt lgkmcnt(7)
    ds_read_b128 v[164:167], v193 offset:5120
    v_cvt_pk_bf16_f32 v18, v18, v19
    v_mfma_f32_16x16x32_bf16 v[64:67], a[208:211], v[128:131], v[64:67]
    ds_read_b128 v[168:171], v193 offset:6144
    v_cvt_pk_bf16_f32 v20, v20, v21
    v_mfma_f32_16x16x32_bf16 v[68:71], a[212:215], v[128:131], v[68:71]
    ds_read_b128 v[172:175], v193 offset:7168
    v_cvt_pk_bf16_f32 v22, v22, v23
    v_mfma_f32_16x16x32_bf16 v[72:75], a[208:211], v[132:135], v[72:75]
    s_xor_b32 s33, s0, s83
    s_xor_b32 s34, s33, 262144
    s_add_u32 m0, s99, 65536
    ds_read_b128 v[128:131], v193 offset:8192
    v_cvt_pk_bf16_f32 v24, v24, v25
    v_mfma_f32_16x16x32_bf16 v[76:79], a[212:215], v[132:135], v[76:79]
    s_waitcnt lgkmcnt(9)
    buffer_load_dwordx4 v222, s[48:51], s34 offen sc1 lds
    v_mfma_f32_16x16x32_bf16 v[64:67], a[216:219], v[136:139], v[64:67]
    ds_read_b128 v[132:135], v193 offset:9216
    v_cvt_pk_bf16_f32 v26, v26, v27
    v_mfma_f32_16x16x32_bf16 v[68:71], a[220:223], v[136:139], v[68:71]
    v_cvt_pk_bf16_f32 v28, v28, v29
    v_cvt_pk_bf16_f32 v30, v30, v31
    v_mfma_f32_16x16x32_bf16 v[72:75], a[216:219], v[140:143], v[72:75]
    ds_read_b128 v[136:139], v193 offset:10240
    v_lshlrev_b32 v176, 16, v16
    v_mfma_f32_16x16x32_bf16 v[76:79], a[220:223], v[140:143], v[76:79]
    s_waitcnt lgkmcnt(9)
    buffer_load_dwordx4 v216, s[48:51], s34 offen offset:1024 sc1 lds
    v_mfma_f32_16x16x32_bf16 v[80:83], a[0:3], v[144:147], v[80:83]
    ds_read_b128 v[140:143], v193 offset:11264
    v_and_b32 v177, 0xffff0000, v16
    v_mfma_f32_16x16x32_bf16 v[84:87], a[4:7], v[144:147], v[84:87]
    v_lshlrev_b32 v178, 16, v18
    v_and_b32 v179, 0xffff0000, v18
    v_mfma_f32_16x16x32_bf16 v[88:91], a[0:3], v[148:151], v[88:91]
    s_xor_b32 s34, s33, 525312
    s_add_u32 m0, s99, 67584
    ds_read_b128 v[144:147], v193 offset:12288
    v_lshlrev_b32 v180, 16, v20
    v_mfma_f32_16x16x32_bf16 v[92:95], a[4:7], v[148:151], v[92:95]
    s_waitcnt lgkmcnt(9)
    buffer_load_dwordx4 v222, s[48:51], s34 offen sc1 lds
    v_mfma_f32_16x16x32_bf16 v[96:99], a[0:3], v[152:155], v[96:99]
    ds_read_b128 v[148:151], v193 offset:13312
    v_and_b32 v181, 0xffff0000, v20
    v_mfma_f32_16x16x32_bf16 v[100:103], a[4:7], v[152:155], v[100:103]
    v_lshlrev_b32 v182, 16, v22
    v_and_b32 v183, 0xffff0000, v22
    v_mfma_f32_16x16x32_bf16 v[104:107], a[0:3], v[156:159], v[104:107]
    ds_read_b128 v[152:155], v193 offset:14336
    v_lshlrev_b32 v184, 16, v24
    v_mfma_f32_16x16x32_bf16 v[108:111], a[4:7], v[156:159], v[108:111]
    s_waitcnt lgkmcnt(9)
    buffer_load_dwordx4 v216, s[48:51], s34 offen offset:1024 sc1 lds
    v_mfma_f32_16x16x32_bf16 v[112:115], a[0:3], v[160:163], v[112:115]
    ds_read_b128 v[156:159], v193 offset:15360
    v_and_b32 v185, 0xffff0000, v24
    v_mfma_f32_16x16x32_bf16 v[116:119], a[4:7], v[160:163], v[116:119]
    v_lshlrev_b32 v186, 16, v26
    v_and_b32 v187, 0xffff0000, v26
    v_mfma_f32_16x16x32_bf16 v[120:123], a[0:3], v[164:167], v[120:123]
    s_xor_b32 s34, s33, 787456
    s_add_u32 m0, s99, 69632
    ds_read_b128 v[160:163], v193 offset:16384
    v_lshlrev_b32 v188, 16, v28
    v_mfma_f32_16x16x32_bf16 v[124:127], a[4:7], v[164:167], v[124:127]
    s_waitcnt lgkmcnt(9)
    buffer_load_dwordx4 v222, s[48:51], s34 offen sc1 lds
    v_mfma_f32_16x16x32_bf16 v[80:83], a[8:11], v[168:171], v[80:83]
    ds_read_b128 v[164:167], v193 offset:17408
    v_and_b32 v189, 0xffff0000, v28
    v_mfma_f32_16x16x32_bf16 v[84:87], a[12:15], v[168:171], v[84:87]
    v_lshlrev_b32 v190, 16, v30
    v_and_b32 v191, 0xffff0000, v30
    v_mfma_f32_16x16x32_bf16 v[88:91], a[8:11], v[172:175], v[88:91]
    s_waitcnt vmcnt(39)
    ds_read_b128 v[168:171], v193 offset:18432
    v_lshlrev_b32 v32, 16, v48
    v_mfma_f32_16x16x32_bf16 v[92:95], a[12:15], v[172:175], v[92:95]
    s_waitcnt lgkmcnt(9)
    buffer_load_dwordx4 v216, s[48:51], s34 offen offset:1024 sc1 lds
    v_mfma_f32_16x16x32_bf16 v[96:99], a[8:11], v[128:131], v[96:99]
    ds_read_b128 v[172:175], v193 offset:19456
    v_and_b32 v33, 0xffff0000, v48
    v_mfma_f32_16x16x32_bf16 v[100:103], a[12:15], v[128:131], v[100:103]
    v_lshlrev_b32 v34, 16, v49
    v_and_b32 v35, 0xffff0000, v49
    v_mfma_f32_16x16x32_bf16 v[104:107], a[8:11], v[132:135], v[104:107]
    s_add_u32 s32, s31, 4096
    ds_read_b128 v[128:131], v193 offset:20480
    v_lshlrev_b32 v36, 16, v50
    v_mfma_f32_16x16x32_bf16 v[108:111], a[12:15], v[132:135], v[108:111]
    s_waitcnt lgkmcnt(9)
    buffer_load_dwordx4 a[80:83], v222, s[48:51], s32 offen offset:0 sc1
    v_mfma_f32_16x16x32_bf16 v[112:115], a[8:11], v[136:139], v[112:115]
    ds_read_b128 v[132:135], v193 offset:21504
    v_and_b32 v37, 0xffff0000, v50
    v_mfma_f32_16x16x32_bf16 v[116:119], a[12:15], v[136:139], v[116:119]
    v_lshlrev_b32 v38, 16, v51
    v_and_b32 v39, 0xffff0000, v51
    v_mfma_f32_16x16x32_bf16 v[120:123], a[8:11], v[140:143], v[120:123]
    ds_read_b128 v[136:139], v193 offset:22528
    v_lshlrev_b32 v40, 16, v52
    v_mfma_f32_16x16x32_bf16 v[124:127], a[12:15], v[140:143], v[124:127]
    s_waitcnt lgkmcnt(9)
    buffer_load_dwordx4 a[84:87], v222, s[48:51], s32 offen offset:1024 sc1
    v_mfma_f32_16x16x32_bf16 v[80:83], a[16:19], v[144:147], v[80:83]
    ds_read_b128 v[140:143], v193 offset:23552
    v_and_b32 v41, 0xffff0000, v52
    v_mfma_f32_16x16x32_bf16 v[84:87], a[20:23], v[144:147], v[84:87]
    v_lshlrev_b32 v42, 16, v53
    v_and_b32 v43, 0xffff0000, v53
    v_mfma_f32_16x16x32_bf16 v[88:91], a[16:19], v[148:151], v[88:91]
    v_lshlrev_b32 v44, 16, v54
    v_and_b32 v45, 0xffff0000, v54
    v_mfma_f32_16x16x32_bf16 v[92:95], a[20:23], v[148:151], v[92:95]
    s_waitcnt lgkmcnt(8)
    buffer_load_dwordx4 a[88:91], v222, s[48:51], s32 offen offset:2048 sc1
    v_mfma_f32_16x16x32_bf16 v[96:99], a[16:19], v[152:155], v[96:99]
    v_lshlrev_b32 v46, 16, v55
    v_and_b32 v47, 0xffff0000, v55
    v_mfma_f32_16x16x32_bf16 v[100:103], a[20:23], v[152:155], v[100:103]
    v_lshrrev_b32 v8, 8, v222
    v_bfe_u32 v9, v222, 6, 2
    v_mfma_f32_16x16x32_bf16 v[104:107], a[16:19], v[156:159], v[104:107]
    v_and_b32 v12, 16, v222
    v_mov_b32 v11, 0x3f80
    v_mfma_f32_16x16x32_bf16 v[108:111], a[20:23], v[156:159], v[108:111]
    s_waitcnt lgkmcnt(6)
    buffer_load_dwordx4 a[92:95], v222, s[48:51], s32 offen offset:3072 sc1
    v_mfma_f32_16x16x32_bf16 v[112:115], a[16:19], v[160:163], v[112:115]
    s_waitcnt vmcnt(14) lgkmcnt(0)
    v_cmp_eq_u32 vcc, v8, v9
    v_lshlrev_b32 v11, v12, v11
    v_mfma_f32_16x16x32_bf16 v[116:119], a[20:23], v[160:163], v[116:119]
    s_barrier
    v_and_b32 v13, 32, v222
    v_mfma_f32_16x16x32_bf16 v[120:123], a[16:19], v[164:167], v[120:123]
    ds_read_b128 v[144:147], v192 offset:0
    v_cndmask_b32 v11, 0, v11, vcc
    v_mfma_f32_16x16x32_bf16 v[124:127], a[20:23], v[164:167], v[124:127]
    s_waitcnt lgkmcnt(5)
    ds_read_b128 v[148:151], v192 offset:1024
    v_cmp_eq_u32 vcc, 0, v13
    v_mfma_f32_16x16x32_bf16 v[80:83], a[24:27], v[168:171], v[80:83]
    ds_read_b128 v[152:155], v192 offset:2048
    v_mov_b32 v8, 0
    v_mfma_f32_16x16x32_bf16 v[84:87], a[28:31], v[168:171], v[84:87]
    ds_read_b128 v[156:159], v192 offset:3072
    v_cndmask_b32 v10, 0, v11, vcc
    v_mfma_f32_16x16x32_bf16 v[88:91], a[24:27], v[172:175], v[88:91]
    ds_read_b128 v[160:163], v192 offset:4096
    v_mov_b32 v9, 0
    v_mfma_f32_16x16x32_bf16 v[92:95], a[28:31], v[172:175], v[92:95]
    s_waitcnt lgkmcnt(7)
    ds_read_b128 v[164:167], v192 offset:5120
    v_mov_b32 v12, 0
    v_mfma_f32_16x16x32_bf16 v[96:99], a[24:27], v[128:131], v[96:99]
    ds_read_b128 v[168:171], v192 offset:6144
    v_xor_b32 v11, v11, v10
    v_mfma_f32_16x16x32_bf16 v[100:103], a[28:31], v[128:131], v[100:103]
    ds_read_b128 v[172:175], v192 offset:7168
    v_mov_b32 v13, 0
    v_mfma_f32_16x16x32_bf16 v[104:107], a[24:27], v[132:135], v[104:107]
    s_xor_b32 s34, s0, s76
    s_add_u32 m0, s68, 16384
    ds_read_b128 v[128:131], v192 offset:8192
    v_mfma_f32_16x16x32_bf16 v[108:111], a[28:31], v[132:135], v[108:111]
    s_waitcnt lgkmcnt(9)
    buffer_load_dwordx4 v222, s[48:51], s34 offen sc1 lds
    v_mfma_f32_16x16x32_bf16 v[112:115], a[24:27], v[136:139], v[112:115]
    ds_read_b128 v[132:135], v192 offset:9216
    v_mfma_f32_16x16x32_bf16 v[116:119], a[28:31], v[136:139], v[116:119]
    v_mfma_f32_16x16x32_bf16 v[120:123], a[24:27], v[140:143], v[120:123]
    ds_read_b128 v[136:139], v192 offset:10240
    v_mfma_f32_16x16x32_bf16 v[124:127], a[28:31], v[140:143], v[124:127]
    s_waitcnt lgkmcnt(9)
    buffer_load_dwordx4 v216, s[48:51], s34 offen offset:1024 sc1 lds
    v_mfma_f32_16x16x32_bf16 v[80:83], a[32:35], v[144:147], v[80:83]
    ds_read_b128 v[140:143], v192 offset:11264
    v_mfma_f32_16x16x32_bf16 v[84:87], a[36:39], v[144:147], v[84:87]
    v_mfma_f32_16x16x32_bf16 v[88:91], a[32:35], v[148:151], v[88:91]
    s_xor_b32 s34, s0, s77
    s_add_u32 m0, s68, 24576
    ds_read_b128 v[144:147], v192 offset:12288
    v_mfma_f32_16x16x32_bf16 v[92:95], a[36:39], v[148:151], v[92:95]
    s_waitcnt lgkmcnt(9)
    buffer_load_dwordx4 v222, s[48:51], s34 offen sc1 lds
    v_mfma_f32_16x16x32_bf16 v[96:99], a[32:35], v[152:155], v[96:99]
    ds_read_b128 v[148:151], v192 offset:13312
    v_mfma_f32_16x16x32_bf16 v[100:103], a[36:39], v[152:155], v[100:103]
    v_mfma_f32_16x16x32_bf16 v[104:107], a[32:35], v[156:159], v[104:107]
    ds_read_b128 v[152:155], v192 offset:14336
    v_mfma_f32_16x16x32_bf16 v[108:111], a[36:39], v[156:159], v[108:111]
    s_waitcnt lgkmcnt(9)
    buffer_load_dwordx4 v216, s[48:51], s34 offen offset:1024 sc1 lds
    v_mfma_f32_16x16x32_bf16 v[112:115], a[32:35], v[160:163], v[112:115]
    ds_read_b128 v[156:159], v192 offset:15360
    v_mfma_f32_16x16x32_bf16 v[116:119], a[36:39], v[160:163], v[116:119]
    v_mfma_f32_16x16x32_bf16 v[120:123], a[32:35], v[164:167], v[120:123]
    s_xor_b32 s34, s0, s78
    s_add_u32 m0, s68, 131072
    ds_read_b128 v[160:163], v192 offset:16384
    v_mfma_f32_16x16x32_bf16 v[124:127], a[36:39], v[164:167], v[124:127]
    s_waitcnt lgkmcnt(9)
    buffer_load_dwordx4 v222, s[48:51], s34 offen sc1 lds
    v_mfma_f32_16x16x32_bf16 v[80:83], a[40:43], v[168:171], v[80:83]
    ds_read_b128 v[164:167], v192 offset:17408
    v_mfma_f32_16x16x32_bf16 v[84:87], a[44:47], v[168:171], v[84:87]
    v_mfma_f32_16x16x32_bf16 v[88:91], a[40:43], v[172:175], v[88:91]
    ds_read_b128 v[168:171], v192 offset:18432
    v_mfma_f32_16x16x32_bf16 v[92:95], a[44:47], v[172:175], v[92:95]
    s_waitcnt lgkmcnt(9)
    buffer_load_dwordx4 v216, s[48:51], s34 offen offset:1024 sc1 lds
    v_mfma_f32_16x16x32_bf16 v[96:99], a[40:43], v[128:131], v[96:99]
    ds_read_b128 v[172:175], v192 offset:19456
    v_mfma_f32_16x16x32_bf16 v[100:103], a[44:47], v[128:131], v[100:103]
    v_mfma_f32_16x16x32_bf16 v[104:107], a[40:43], v[132:135], v[104:107]
    s_xor_b32 s34, s0, s79
    s_add_u32 m0, s68, 139264
    ds_read_b128 v[128:131], v192 offset:20480
    v_mfma_f32_16x16x32_bf16 v[108:111], a[44:47], v[132:135], v[108:111]
    s_waitcnt lgkmcnt(9)
    buffer_load_dwordx4 v222, s[48:51], s34 offen sc1 lds
    v_mfma_f32_16x16x32_bf16 v[112:115], a[40:43], v[136:139], v[112:115]
    ds_read_b128 v[132:135], v192 offset:21504
    v_mfma_f32_16x16x32_bf16 v[116:119], a[44:47], v[136:139], v[116:119]
    v_mfma_f32_16x16x32_bf16 v[120:123], a[40:43], v[140:143], v[120:123]
    ds_read_b128 v[136:139], v192 offset:22528
    v_mfma_f32_16x16x32_bf16 v[124:127], a[44:47], v[140:143], v[124:127]
    s_waitcnt lgkmcnt(9)
    buffer_load_dwordx4 v216, s[48:51], s34 offen offset:1024 sc1 lds
    v_mfma_f32_16x16x32_bf16 v[80:83], a[48:51], v[144:147], v[80:83]
    ds_read_b128 v[140:143], v192 offset:23552
    v_mfma_f32_16x16x32_bf16 v[84:87], a[52:55], v[144:147], v[84:87]
    v_mfma_f32_16x16x32_bf16 v[88:91], a[48:51], v[148:151], v[88:91]
    s_xor_b32 s34, s0, s82
    s_add_u32 m0, s68, 147456
    v_mfma_f32_16x16x32_bf16 v[92:95], a[52:55], v[148:151], v[92:95]
    s_waitcnt lgkmcnt(8)
    buffer_load_dwordx4 v222, s[48:51], s34 offen sc1 lds
    v_mfma_f32_16x16x32_bf16 v[96:99], a[48:51], v[152:155], v[96:99]
    v_mfma_f32_16x16x32_bf16 v[100:103], a[52:55], v[152:155], v[100:103]
    v_mfma_f32_16x16x32_bf16 v[104:107], a[48:51], v[156:159], v[104:107]
    v_mfma_f32_16x16x32_bf16 v[108:111], a[52:55], v[156:159], v[108:111]
    s_waitcnt lgkmcnt(6)
    buffer_load_dwordx4 v216, s[48:51], s34 offen offset:1024 sc1 lds
    v_mfma_f32_16x16x32_bf16 v[112:115], a[48:51], v[160:163], v[112:115]
    s_waitcnt vmcnt(14) lgkmcnt(0)
    v_mfma_f32_16x16x32_bf16 v[116:119], a[52:55], v[160:163], v[116:119]
    s_barrier
    v_mfma_f32_16x16x32_bf16 v[120:123], a[48:51], v[164:167], v[120:123]
    ds_read_b128 v[144:147], v192 offset:32768
    v_mfma_f32_16x16x32_bf16 v[124:127], a[52:55], v[164:167], v[124:127]
    s_waitcnt lgkmcnt(5)
    ds_read_b128 v[148:151], v192 offset:33792
    v_mfma_f32_16x16x32_bf16 v[80:83], a[56:59], v[168:171], v[80:83]
    ds_read_b128 v[152:155], v192 offset:38912
    v_mfma_f32_16x16x32_bf16 v[84:87], a[60:63], v[168:171], v[84:87]
    ds_read_b128 v[156:159], v192 offset:39936
    v_mfma_f32_16x16x32_bf16 v[88:91], a[56:59], v[172:175], v[88:91]
    ds_read_b128 v[160:163], v192 offset:45056
    v_mfma_f32_16x16x32_bf16 v[92:95], a[60:63], v[172:175], v[92:95]
    s_waitcnt lgkmcnt(7)
    ds_read_b128 v[164:167], v192 offset:46080
    v_mfma_f32_16x16x32_bf16 v[96:99], a[56:59], v[128:131], v[96:99]
    ds_read_b128 v[168:171], v192 offset:51200
    v_mfma_f32_16x16x32_bf16 v[100:103], a[60:63], v[128:131], v[100:103]
    ds_read_b128 v[172:175], v192 offset:52224
    v_mfma_f32_16x16x32_bf16 v[104:107], a[56:59], v[132:135], v[104:107]
    s_xor_b32 s34, s0, s83
    s_add_u32 m0, s68, 155648
    ds_read_b128 v[128:131], v192 offset:34816
    v_mfma_f32_16x16x32_bf16 v[108:111], a[60:63], v[132:135], v[108:111]
    s_waitcnt lgkmcnt(9)
    buffer_load_dwordx4 v222, s[48:51], s34 offen sc1 lds
    v_mfma_f32_16x16x32_bf16 v[112:115], a[56:59], v[136:139], v[112:115]
    ds_read_b128 v[132:135], v192 offset:35840
    v_mfma_f32_16x16x32_bf16 v[116:119], a[60:63], v[136:139], v[116:119]
    v_mfma_f32_16x16x32_bf16 v[120:123], a[56:59], v[140:143], v[120:123]
    ds_read_b128 v[136:139], v192 offset:40960
    v_mfma_f32_16x16x32_bf16 v[124:127], a[60:63], v[140:143], v[124:127]
    s_waitcnt vmcnt(11) lgkmcnt(9)
    buffer_load_dwordx4 v216, s[48:51], s34 offen offset:1024 sc1 lds
    v_mfma_f32_16x16x32_bf16 v[80:83], a[64:67], v[144:147], v[80:83]
    ds_read_b128 v[140:143], v192 offset:41984
    v_mfma_f32_16x16x32_bf16 v[84:87], a[68:71], v[144:147], v[84:87]
    v_mfma_f32_16x16x32_bf16 v[88:91], a[64:67], v[148:151], v[88:91]
    ds_read_b128 v[144:147], v192 offset:47104
    v_mfma_f32_16x16x32_bf16 v[92:95], a[68:71], v[148:151], v[92:95]
    s_waitcnt lgkmcnt(9)
    v_mfma_f32_16x16x32_bf16 v[80:83], a[72:75], v[152:155], v[80:83]
    ds_read_b128 v[148:151], v192 offset:48128
    v_mfma_f32_16x16x32_bf16 v[84:87], a[76:79], v[152:155], v[84:87]
    v_mfma_f32_16x16x32_bf16 v[88:91], a[72:75], v[156:159], v[88:91]
    ds_read_b128 v[152:155], v192 offset:53248
    v_mfma_f32_16x16x32_bf16 v[92:95], a[76:79], v[156:159], v[92:95]
    s_waitcnt lgkmcnt(9)
    v_mfma_f32_16x16x32_bf16 v[80:83], a[80:83], v[160:163], v[80:83]
    ds_read_b128 v[156:159], v192 offset:54272
    v_mfma_f32_16x16x32_bf16 v[84:87], a[84:87], v[160:163], v[84:87]
    v_mfma_f32_16x16x32_bf16 v[88:91], a[80:83], v[164:167], v[88:91]
    ds_read_b128 v[160:163], v192 offset:36864
    v_mfma_f32_16x16x32_bf16 v[92:95], a[84:87], v[164:167], v[92:95]
    s_waitcnt lgkmcnt(9)
    v_mfma_f32_16x16x32_bf16 v[80:83], a[88:91], v[168:171], v[80:83]
    ds_read_b128 v[164:167], v192 offset:37888
    v_mfma_f32_16x16x32_bf16 v[84:87], a[92:95], v[168:171], v[84:87]
    v_mfma_f32_16x16x32_bf16 v[88:91], a[88:91], v[172:175], v[88:91]
    ds_read_b128 v[168:171], v192 offset:43008
    v_mfma_f32_16x16x32_bf16 v[92:95], a[92:95], v[172:175], v[92:95]
    s_waitcnt lgkmcnt(9)
    v_mfma_f32_16x16x32_bf16 v[96:99], a[64:67], v[128:131], v[96:99]
    ds_read_b128 v[172:175], v192 offset:44032
    v_mfma_f32_16x16x32_bf16 v[100:103], a[68:71], v[128:131], v[100:103]
    v_mfma_f32_16x16x32_bf16 v[104:107], a[64:67], v[132:135], v[104:107]
    ds_read_b128 v[128:131], v192 offset:49152
    v_mfma_f32_16x16x32_bf16 v[108:111], a[68:71], v[132:135], v[108:111]
    s_waitcnt lgkmcnt(9)
    v_mfma_f32_16x16x32_bf16 v[96:99], a[72:75], v[136:139], v[96:99]
    s_add_u32 s42, s98, 4096
    ds_read_b128 v[132:135], v192 offset:50176
    v_cvt_pk_bf16_f32 v80, v80, v81
    v_mfma_f32_16x16x32_bf16 v[100:103], a[76:79], v[136:139], v[100:103]
    v_cvt_pk_bf16_f32 v81, v82, v83
    v_cvt_pk_bf16_f32 v82, v84, v85
    v_mfma_f32_16x16x32_bf16 v[104:107], a[72:75], v[140:143], v[104:107]
    ds_read_b128 v[136:139], v192 offset:55296
    v_cvt_pk_bf16_f32 v83, v86, v87
    v_mfma_f32_16x16x32_bf16 v[108:111], a[76:79], v[140:143], v[108:111]
    s_waitcnt lgkmcnt(9)
    buffer_store_dwordx4 v[80:83], v222, s[48:51], s42 offen offset:0 sc1
    v_mfma_f32_16x16x32_bf16 v[96:99], a[80:83], v[144:147], v[96:99]
    ds_read_b128 v[140:143], v192 offset:56320
    v_cvt_pk_bf16_f32 v84, v88, v89
    v_mfma_f32_16x16x32_bf16 v[100:103], a[84:87], v[144:147], v[100:103]
    v_cvt_pk_bf16_f32 v85, v90, v91
    v_cvt_pk_bf16_f32 v86, v92, v93
    v_mfma_f32_16x16x32_bf16 v[104:107], a[80:83], v[148:151], v[104:107]
    v_cvt_pk_bf16_f32 v87, v94, v95
    v_mfma_f32_16x16x32_bf16 v[108:111], a[84:87], v[148:151], v[108:111]
    s_waitcnt lgkmcnt(8)
    buffer_store_dwordx4 v[84:87], v222, s[48:51], s42 offen offset:1024 sc1
    v_mfma_f32_16x16x32_bf16 v[96:99], a[88:91], v[152:155], v[96:99]
    v_mfma_f32_16x16x32_bf16 v[100:103], a[92:95], v[152:155], v[100:103]
    v_mfma_f32_16x16x32_bf16 v[104:107], a[88:91], v[156:159], v[104:107]
    v_mfma_f32_16x16x32_bf16 v[108:111], a[92:95], v[156:159], v[108:111]
    s_waitcnt lgkmcnt(6)
    v_mfma_f32_16x16x32_bf16 v[112:115], a[64:67], v[160:163], v[112:115]
    s_waitcnt vmcnt(2) lgkmcnt(0)
    v_mfma_f32_16x16x32_bf16 v[116:119], a[68:71], v[160:163], v[116:119]
    s_barrier
    v_mfma_f32_16x16x32_bf16 v[120:123], a[64:67], v[164:167], v[120:123]
    ds_read_b128 v[144:147], v222 offset:16384
    v_mfma_f32_16x16x32_bf16 v[124:127], a[68:71], v[164:167], v[124:127]
    s_waitcnt lgkmcnt(5)
    ds_read_b128 v[148:151], v222 offset:17408
    v_mfma_f32_16x16x32_bf16 v[112:115], a[72:75], v[168:171], v[112:115]
    ds_read_b128 v[152:155], v222 offset:18432
    v_mfma_f32_16x16x32_bf16 v[116:119], a[76:79], v[168:171], v[116:119]
    s_add_u32 s42, s98, 8192
    ds_read_b128 v[156:159], v222 offset:19456
    v_cvt_pk_bf16_f32 v96, v96, v97
    v_mfma_f32_16x16x32_bf16 v[120:123], a[72:75], v[172:175], v[120:123]
    ds_read_b128 v[160:163], v222 offset:20480
    v_cvt_pk_bf16_f32 v97, v98, v99
    v_mfma_f32_16x16x32_bf16 v[124:127], a[76:79], v[172:175], v[124:127]
    s_waitcnt lgkmcnt(7)
    ds_read_b128 v[164:167], v222 offset:21504
    v_cvt_pk_bf16_f32 v98, v100, v101
    v_mfma_f32_16x16x32_bf16 v[112:115], a[80:83], v[128:131], v[112:115]
    ds_read_b128 v[168:171], v222 offset:22528
    v_cvt_pk_bf16_f32 v99, v102, v103
    v_mfma_f32_16x16x32_bf16 v[116:119], a[84:87], v[128:131], v[116:119]
    ds_read_b128 v[172:175], v222 offset:23552
    v_mfma_f32_16x16x32_bf16 v[120:123], a[80:83], v[132:135], v[120:123]
    ds_read_b128 v[128:131], v222 offset:24576
    v_mfma_f32_16x16x32_bf16 v[124:127], a[84:87], v[132:135], v[124:127]
    s_waitcnt lgkmcnt(9)
    buffer_store_dwordx4 v[96:99], v222, s[48:51], s42 offen offset:0 sc1
    v_mfma_f32_16x16x32_bf16 v[112:115], a[88:91], v[136:139], v[112:115]
    ds_read_b128 v[132:135], v222 offset:25600
    v_cvt_pk_bf16_f32 v100, v104, v105
    v_mfma_f32_16x16x32_bf16 v[116:119], a[92:95], v[136:139], v[116:119]
    v_cvt_pk_bf16_f32 v101, v106, v107
    v_cvt_pk_bf16_f32 v102, v108, v109
    v_mfma_f32_16x16x32_bf16 v[120:123], a[88:91], v[140:143], v[120:123]
    ds_read_b128 v[136:139], v222 offset:26624
    v_cvt_pk_bf16_f32 v103, v110, v111
    v_mfma_f32_16x16x32_bf16 v[124:127], a[92:95], v[140:143], v[124:127]
    s_waitcnt lgkmcnt(9)
    buffer_store_dwordx4 v[100:103], v222, s[48:51], s42 offen offset:1024 sc1
    v_mfma_f32_16x16x32_bf16 v[64:67], a[128:131], v[144:147], v[64:67]
    ds_read_b128 v[140:143], v222 offset:27648
    v_mfma_f32_16x16x32_bf16 v[68:71], a[132:135], v[144:147], v[68:71]
    v_mfma_f32_16x16x32_bf16 v[72:75], a[128:131], v[148:151], v[72:75]
    ds_read_b128 v[144:147], v222 offset:28672
    v_mfma_f32_16x16x32_bf16 v[76:79], a[132:135], v[148:151], v[76:79]
    s_waitcnt lgkmcnt(9)
    v_mfma_f32_16x16x32_bf16 v[64:67], a[136:139], v[152:155], v[64:67]
    ds_read_b128 v[148:151], v222 offset:29696
    v_mfma_f32_16x16x32_bf16 v[68:71], a[140:143], v[152:155], v[68:71]
    s_add_u32 s42, s98, 12288
    v_cvt_pk_bf16_f32 v112, v112, v113
    v_cvt_pk_bf16_f32 v113, v114, v115
    v_mfma_f32_16x16x32_bf16 v[72:75], a[136:139], v[156:159], v[72:75]
    ds_read_b128 v[152:155], v222 offset:30720
    v_cvt_pk_bf16_f32 v114, v116, v117
    v_mfma_f32_16x16x32_bf16 v[76:79], a[140:143], v[156:159], v[76:79]
    s_waitcnt lgkmcnt(9)
    v_cvt_pk_bf16_f32 v115, v118, v119
    v_mfma_f32_16x16x32_bf16 v[64:67], a[144:147], v[160:163], v[64:67]
    ds_read_b128 v[156:159], v222 offset:31744
    v_mfma_f32_16x16x32_bf16 v[68:71], a[148:151], v[160:163], v[68:71]
    buffer_store_dwordx4 v[112:115], v222, s[48:51], s42 offen offset:0 sc1
    v_mfma_f32_16x16x32_bf16 v[72:75], a[144:147], v[164:167], v[72:75]
    ds_read_b128 v[160:163], v193 offset:32768
    v_cvt_pk_bf16_f32 v116, v120, v121
    v_mfma_f32_16x16x32_bf16 v[76:79], a[148:151], v[164:167], v[76:79]
    s_waitcnt lgkmcnt(9)
    v_cvt_pk_bf16_f32 v117, v122, v123
    v_cvt_pk_bf16_f32 v118, v124, v125
    v_mfma_f32_16x16x32_bf16 v[64:67], a[152:155], v[168:171], v[64:67]
    ds_read_b128 v[164:167], v193 offset:33792
    v_cvt_pk_bf16_f32 v119, v126, v127
    v_mfma_f32_16x16x32_bf16 v[68:71], a[156:159], v[168:171], v[68:71]
    buffer_store_dwordx4 v[116:119], v222, s[48:51], s42 offen offset:1024 sc1
    v_mfma_f32_16x16x32_bf16 v[72:75], a[152:155], v[172:175], v[72:75]
    s_xor_b32 s53, s98, 65536
    s_add_u32 s53, s53, 4096
    ds_read_b128 v[168:171], v193 offset:34816
    v_mfma_f32_16x16x32_bf16 v[76:79], a[156:159], v[172:175], v[76:79]
    s_waitcnt lgkmcnt(9)
    v_mfma_f32_16x16x32_bf16 v[64:67], a[160:163], v[128:131], v[64:67]
    s_xor_b32 s54, s98, 131072
    s_add_u32 s54, s54, 8192
    ds_read_b128 v[172:175], v193 offset:35840
    v_mfma_f32_16x16x32_bf16 v[68:71], a[164:167], v[128:131], v[68:71]
    s_xor_b32 s55, s98, 196608
    s_add_u32 s55, s55, 12288
    v_mfma_f32_16x16x32_bf16 v[72:75], a[160:163], v[132:135], v[72:75]
    ds_read_b128 v[128:131], v193 offset:36864
    v_mfma_f32_16x16x32_bf16 v[76:79], a[164:167], v[132:135], v[76:79]
    s_waitcnt lgkmcnt(9)
    v_mfma_f32_16x16x32_bf16 v[64:67], a[168:171], v[136:139], v[64:67]
    ds_read_b128 v[132:135], v193 offset:37888
    v_mfma_f32_16x16x32_bf16 v[68:71], a[172:175], v[136:139], v[68:71]
    v_mfma_f32_16x16x32_bf16 v[72:75], a[168:171], v[140:143], v[72:75]
    ds_read_b128 v[136:139], v193 offset:38912
    v_mfma_f32_16x16x32_bf16 v[76:79], a[172:175], v[140:143], v[76:79]
    s_waitcnt lgkmcnt(9)
    v_mfma_f32_16x16x32_bf16 v[64:67], a[176:179], v[144:147], v[64:67]
    ds_read_b128 v[140:143], v193 offset:39936
    v_mfma_f32_16x16x32_bf16 v[68:71], a[180:183], v[144:147], v[68:71]
    v_mfma_f32_16x16x32_bf16 v[72:75], a[176:179], v[148:151], v[72:75]
    ds_read_b128 v[144:147], v193 offset:40960
    v_mfma_f32_16x16x32_bf16 v[76:79], a[180:183], v[148:151], v[76:79]
    s_waitcnt lgkmcnt(9)
    v_mfma_f32_16x16x32_bf16 v[64:67], a[184:187], v[152:155], v[64:67]
    ds_read_b128 v[148:151], v193 offset:41984
    v_mfma_f32_16x16x32_bf16 v[68:71], a[188:191], v[152:155], v[68:71]
    v_mfma_f32_16x16x32_bf16 v[72:75], a[184:187], v[156:159], v[72:75]
    ds_read_b128 v[152:155], v193 offset:43008
    v_mfma_f32_16x16x32_bf16 v[76:79], a[188:191], v[156:159], v[76:79]
    s_waitcnt lgkmcnt(9)
    v_mfma_f32_16x16x32_bf16 v[64:67], a[224:227], v[160:163], v[64:67]
    ds_read_b128 v[156:159], v193 offset:44032
    v_mfma_f32_16x16x32_bf16 v[68:71], a[228:231], v[160:163], v[68:71]
    v_mfma_f32_16x16x32_bf16 v[72:75], a[224:227], v[164:167], v[72:75]
    ds_read_b128 v[160:163], v193 offset:45056
    v_mfma_f32_16x16x32_bf16 v[76:79], a[228:231], v[164:167], v[76:79]
    s_waitcnt lgkmcnt(9)
    v_mfma_f32_16x16x32_bf16 v[64:67], a[232:235], v[168:171], v[64:67]
    ds_read_b128 v[164:167], v193 offset:46080
    v_mfma_f32_16x16x32_bf16 v[68:71], a[236:239], v[168:171], v[68:71]
    v_mfma_f32_16x16x32_bf16 v[72:75], a[232:235], v[172:175], v[72:75]
    ds_read_b128 v[168:171], v193 offset:47104
    v_mfma_f32_16x16x32_bf16 v[76:79], a[236:239], v[172:175], v[76:79]
    s_waitcnt lgkmcnt(9)
    v_mfma_f32_16x16x32_bf16 v[64:67], a[240:243], v[128:131], v[64:67]
    ds_read_b128 v[172:175], v193 offset:48128
    v_mfma_f32_16x16x32_bf16 v[68:71], a[244:247], v[128:131], v[68:71]
    v_mfma_f32_16x16x32_bf16 v[72:75], a[240:243], v[132:135], v[72:75]
    ds_read_b128 v[128:131], v193 offset:49152
    v_mfma_f32_16x16x32_bf16 v[76:79], a[244:247], v[132:135], v[76:79]
    s_waitcnt lgkmcnt(9)
    v_mfma_f32_16x16x32_bf16 v[64:67], a[248:251], v[136:139], v[64:67]
    ds_read_b128 v[132:135], v193 offset:50176
    v_mfma_f32_16x16x32_bf16 v[68:71], a[252:255], v[136:139], v[68:71]
    v_mfma_f32_16x16x32_bf16 v[72:75], a[248:251], v[140:143], v[72:75]
    ds_read_b128 v[136:139], v193 offset:51200
    v_mfma_f32_16x16x32_bf16 v[76:79], a[252:255], v[140:143], v[76:79]
    s_waitcnt lgkmcnt(9)
    v_mfma_f32_16x16x32_bf16 v[64:67], a[0:3], v[144:147], v[64:67]
    ds_read_b128 v[140:143], v193 offset:52224
    v_mfma_f32_16x16x32_bf16 v[68:71], a[4:7], v[144:147], v[68:71]
    v_mfma_f32_16x16x32_bf16 v[72:75], a[0:3], v[148:151], v[72:75]
    ds_read_b128 v[144:147], v193 offset:53248
    v_mfma_f32_16x16x32_bf16 v[76:79], a[4:7], v[148:151], v[76:79]
    s_waitcnt lgkmcnt(9)
    v_mfma_f32_16x16x32_bf16 v[64:67], a[8:11], v[152:155], v[64:67]
    ds_read_b128 v[148:151], v193 offset:54272
    v_mfma_f32_16x16x32_bf16 v[68:71], a[12:15], v[152:155], v[68:71]
    v_mfma_f32_16x16x32_bf16 v[72:75], a[8:11], v[156:159], v[72:75]
    ds_read_b128 v[152:155], v193 offset:55296
    v_mfma_f32_16x16x32_bf16 v[76:79], a[12:15], v[156:159], v[76:79]
    s_waitcnt lgkmcnt(9)
    v_mfma_f32_16x16x32_bf16 v[64:67], a[16:19], v[160:163], v[64:67]
    ds_read_b128 v[156:159], v193 offset:56320
    v_mfma_f32_16x16x32_bf16 v[68:71], a[20:23], v[160:163], v[68:71]
    buffer_load_dwordx4 v[88:91], v222, s[48:51], s53 offen offset:0 sc1
    v_mfma_f32_16x16x32_bf16 v[72:75], a[16:19], v[164:167], v[72:75]
    ds_read_b128 v[160:163], v193 offset:57344
    v_mfma_f32_16x16x32_bf16 v[76:79], a[20:23], v[164:167], v[76:79]
    s_waitcnt lgkmcnt(9)
    buffer_load_dwordx4 v[92:95], v222, s[48:51], s53 offen offset:1024 sc1
    v_mfma_f32_16x16x32_bf16 v[64:67], a[24:27], v[168:171], v[64:67]
    ds_read_b128 v[164:167], v193 offset:58368
    v_mfma_f32_16x16x32_bf16 v[68:71], a[28:31], v[168:171], v[68:71]
    buffer_load_dwordx4 v[104:107], v222, s[48:51], s54 offen offset:0 sc1
    v_mfma_f32_16x16x32_bf16 v[72:75], a[24:27], v[172:175], v[72:75]
    ds_read_b128 v[168:171], v193 offset:59392
    v_mfma_f32_16x16x32_bf16 v[76:79], a[28:31], v[172:175], v[76:79]
    s_waitcnt lgkmcnt(9)
    buffer_load_dwordx4 v[108:111], v222, s[48:51], s54 offen offset:1024 sc1
    v_mfma_f32_16x16x32_bf16 v[64:67], a[32:35], v[128:131], v[64:67]
    ds_read_b128 v[172:175], v193 offset:60416
    v_mfma_f32_16x16x32_bf16 v[68:71], a[36:39], v[128:131], v[68:71]
    buffer_load_dwordx4 v[120:123], v222, s[48:51], s55 offen offset:0 sc1
    v_mfma_f32_16x16x32_bf16 v[72:75], a[32:35], v[132:135], v[72:75]
    ds_read_b128 v[128:131], v193 offset:61440
    v_mfma_f32_16x16x32_bf16 v[76:79], a[36:39], v[132:135], v[76:79]
    s_waitcnt lgkmcnt(9)
    buffer_load_dwordx4 v[124:127], v222, s[48:51], s55 offen offset:1024 sc1
    v_mfma_f32_16x16x32_bf16 v[64:67], a[40:43], v[136:139], v[64:67]
    ds_read_b128 v[132:135], v193 offset:62464
    v_mfma_f32_16x16x32_bf16 v[68:71], a[44:47], v[136:139], v[68:71]
    v_mfma_f32_16x16x32_bf16 v[72:75], a[40:43], v[140:143], v[72:75]
    ds_read_b128 v[136:139], v193 offset:63488
    v_mfma_f32_16x16x32_bf16 v[76:79], a[44:47], v[140:143], v[76:79]
    s_waitcnt lgkmcnt(9)
    v_mfma_f32_16x16x32_bf16 v[64:67], a[48:51], v[144:147], v[64:67]
    ds_read_b128 v[140:143], v193 offset:64512
    v_mfma_f32_16x16x32_bf16 v[68:71], a[52:55], v[144:147], v[68:71]
    v_mfma_f32_16x16x32_bf16 v[72:75], a[48:51], v[148:151], v[72:75]
    v_mfma_f32_16x16x32_bf16 v[76:79], a[52:55], v[148:151], v[76:79]
    s_waitcnt lgkmcnt(8)
    v_mfma_f32_16x16x32_bf16 v[64:67], a[56:59], v[152:155], v[64:67]
    v_mfma_f32_16x16x32_bf16 v[68:71], a[60:63], v[152:155], v[68:71]
    v_mfma_f32_16x16x32_bf16 v[72:75], a[56:59], v[156:159], v[72:75]
    v_mfma_f32_16x16x32_bf16 v[76:79], a[60:63], v[156:159], v[76:79]
    s_waitcnt lgkmcnt(6)
    v_mfma_f32_16x16x32_bf16 v[64:67], a[64:67], v[160:163], v[64:67]
    v_mfma_f32_16x16x32_bf16 v[68:71], a[68:71], v[160:163], v[68:71]
    v_mfma_f32_16x16x32_bf16 v[72:75], a[64:67], v[164:167], v[72:75]
    v_mfma_f32_16x16x32_bf16 v[76:79], a[68:71], v[164:167], v[76:79]
    s_waitcnt lgkmcnt(4)
    v_mfma_f32_16x16x32_bf16 v[64:67], a[72:75], v[168:171], v[64:67]
    v_mfma_f32_16x16x32_bf16 v[68:71], a[76:79], v[168:171], v[68:71]
    v_mfma_f32_16x16x32_bf16 v[72:75], a[72:75], v[172:175], v[72:75]
    v_mfma_f32_16x16x32_bf16 v[76:79], a[76:79], v[172:175], v[76:79]
    s_waitcnt lgkmcnt(2)
    v_mfma_f32_16x16x32_bf16 v[64:67], a[80:83], v[128:131], v[64:67]
    v_mfma_f32_16x16x32_bf16 v[68:71], a[84:87], v[128:131], v[68:71]
    v_mfma_f32_16x16x32_bf16 v[72:75], a[80:83], v[132:135], v[72:75]
    v_mfma_f32_16x16x32_bf16 v[76:79], a[84:87], v[132:135], v[76:79]
    s_waitcnt lgkmcnt(0)
    v_mfma_f32_16x16x32_bf16 v[64:67], a[88:91], v[136:139], v[64:67]
    v_mfma_f32_16x16x32_bf16 v[68:71], a[92:95], v[136:139], v[68:71]
    v_mfma_f32_16x16x32_bf16 v[72:75], a[88:91], v[140:143], v[72:75]
    v_mfma_f32_16x16x32_bf16 v[76:79], a[92:95], v[140:143], v[76:79]
    s_waitcnt vmcnt(0)
F_FIN:
    v_mfma_f32_16x16x32_bf16 v[128:131], v[10:13], v[88:91], v[64:67]
    v_max3_u32 v0, v88, v89, v90
    v_max3_u32 v1, v91, v92, v93
    v_max3_u32 v2, v94, v95, v104
    v_mfma_f32_16x16x32_bf16 v[132:135], v[8:11], v[88:91], v[68:71]
    v_max3_u32 v3, v105, v106, v107
    v_max3_u32 v4, v108, v109, v110
    v_max3_u32 v5, v111, v120, v121
    v_mfma_f32_16x16x32_bf16 v[128:131], v[10:13], v[104:107], v[128:131]
    v_max3_u32 v6, v122, v123, v124
    v_max3_u32 v7, v125, v126, v127
    v_max3_u32 v0, v0, v1, v2
    v_mfma_f32_16x16x32_bf16 v[132:135], v[8:11], v[104:107], v[132:135]
    v_max3_u32 v3, v3, v4, v5
    v_max3_u32 v0, v0, v6, v7
    v_max_u32 v0, v0, v3
    v_mfma_f32_16x16x32_bf16 v[128:131], v[10:13], v[120:123], v[128:131]
    v_cmp_ne_u32 vcc, -1, v0
    v_mfma_f32_16x16x32_bf16 v[132:135], v[8:11], v[120:123], v[132:135]
    v_mfma_f32_16x16x32_bf16 v[136:139], v[10:13], v[92:95], v[72:75]
    s_nop 1
    s_cmp_eq_u64 vcc, -1
    s_cbranch_scc0 F_SPIN4
F_CONT4:
    v_mfma_f32_16x16x32_bf16 v[140:143], v[8:11], v[92:95], v[76:79]
    v_mfma_f32_16x16x32_bf16 v[136:139], v[10:13], v[108:111], v[136:139]
    v_cvt_pk_bf16_f32 v128, 0, v128
    v_cvt_pk_bf16_f32 v129, 0, v129
    v_cvt_pk_bf16_f32 v130, 0, v130
    v_cvt_pk_bf16_f32 v131, 0, v131
    v_mfma_f32_16x16x32_bf16 v[140:143], v[8:11], v[108:111], v[140:143]
    v_cvt_pk_bf16_f32 v132, 0, v132
    v_cvt_pk_bf16_f32 v133, 0, v133
    v_cvt_pk_bf16_f32 v134, 0, v134
    v_cvt_pk_bf16_f32 v135, 0, v135
    v_mfma_f32_16x16x32_bf16 v[136:139], v[10:13], v[124:127], v[136:139]
    v_pk_mul_f32 v[128:129], v[128:129], v[176:177]
    v_pk_mul_f32 v[130:131], v[130:131], v[178:179]
    v_pk_mul_f32 v[132:133], v[132:133], v[180:181]
    v_pk_mul_f32 v[134:135], v[134:135], v[182:183]
    v_mfma_f32_16x16x32_bf16 v[140:143], v[8:11], v[124:127], v[140:143]
    v_cvt_pk_bf16_f32 v128, 0, v128
    v_cvt_pk_bf16_f32 v129, 0, v129
    v_cvt_pk_bf16_f32 v130, 0, v130
    v_cvt_pk_bf16_f32 v131, 0, v131
    v_cvt_pk_bf16_f32 v132, 0, v132
    v_cvt_pk_bf16_f32 v133, 0, v133
    v_cvt_pk_bf16_f32 v134, 0, v134
    v_cvt_pk_bf16_f32 v135, 0, v135
    v_pk_add_f32 v[128:129], v[128:129], v[32:33]
    v_pk_add_f32 v[130:131], v[130:131], v[34:35]
    v_pk_add_f32 v[132:133], v[132:133], v[36:37]
    v_pk_add_f32 v[134:135], v[134:135], v[38:39]
    v_cvt_pk_bf16_f32 v80, v128, v129
    v_cvt_pk_bf16_f32 v81, v130, v131
    v_cvt_pk_bf16_f32 v82, v132, v133
    v_cvt_pk_bf16_f32 v83, v134, v135
    buffer_store_dwordx4 v[80:83], v194, s[20:23], s97 offen
    v_cvt_pk_bf16_f32 v136, 0, v136
    v_cvt_pk_bf16_f32 v137, 0, v137
    v_cvt_pk_bf16_f32 v138, 0, v138
    v_cvt_pk_bf16_f32 v139, 0, v139
    v_cvt_pk_bf16_f32 v140, 0, v140
    v_cvt_pk_bf16_f32 v141, 0, v141
    v_cvt_pk_bf16_f32 v142, 0, v142
    v_cvt_pk_bf16_f32 v143, 0, v143
    v_pk_mul_f32 v[136:137], v[136:137], v[184:185]
    v_pk_mul_f32 v[138:139], v[138:139], v[186:187]
    v_pk_mul_f32 v[140:141], v[140:141], v[188:189]
    v_pk_mul_f32 v[142:143], v[142:143], v[190:191]
    v_cvt_pk_bf16_f32 v136, 0, v136
    v_cvt_pk_bf16_f32 v137, 0, v137
    v_cvt_pk_bf16_f32 v138, 0, v138
    v_cvt_pk_bf16_f32 v139, 0, v139
    v_cvt_pk_bf16_f32 v140, 0, v140
    v_cvt_pk_bf16_f32 v141, 0, v141
    v_cvt_pk_bf16_f32 v142, 0, v142
    v_cvt_pk_bf16_f32 v143, 0, v143
    v_pk_add_f32 v[136:137], v[136:137], v[40:41]
    v_pk_add_f32 v[138:139], v[138:139], v[42:43]
    v_pk_add_f32 v[140:141], v[140:141], v[44:45]
    v_pk_add_f32 v[142:143], v[142:143], v[46:47]
    v_cvt_pk_bf16_f32 v84, v136, v137
    v_cvt_pk_bf16_f32 v85, v138, v139
    v_cvt_pk_bf16_f32 v86, v140, v141
    v_cvt_pk_bf16_f32 v87, v142, v143
    buffer_store_dwordx4 v[84:87], v194, s[20:23], s6 offen
F_END:
    s_endpgm
F_JOBS:
    s_cmp_eq_u32 s35, 7
    s_cbranch_scc1 F_J7
    s_cmp_eq_u32 s35, 6
    s_cbranch_scc1 F_J6
    s_cmp_lg_u32 s37, 0
    s_cbranch_scc1 F_JRET
    s_cmp_eq_u32 s35, 2
    s_cbranch_scc1 F_J2
    s_cmp_eq_u32 s35, 3
    s_cbranch_scc1 F_J3
    s_cmp_eq_u32 s35, 4
    s_cbranch_scc1 F_J4
    s_cmp_eq_u32 s35, 5
    s_cbranch_scc1 F_J5
    s_mov_b32 s42, 2113536
    buffer_load_dwordx4 v[224:227], v222, s[48:51], s42 offen offset:0 sc1
    buffer_load_dwordx4 v[228:231], v222, s[48:51], s42 offen offset:1024 sc1
    v_lshrrev_b32 v241, 8, v222
    v_and_b32 v240, 0x70, v222
    v_lshlrev_b32 v241, 5, v241
    v_lshrrev_b32 v242, 7, v222
    v_xor_b32 v240, v240, v241
    v_lshl_add_u32 v240, v242, 10, v240
    s_add_u32 s20, s68, s7
    s_addc_u32 s21, s69, 0
    s_mov_b32 s22, 31872
    s_add_u32 m0, s30, 135168
    s_mov_b32 s52, 0
    s_mov_b32 s53, 7168
    s_mov_b32 s54, 14336
    s_mov_b32 s55, 21504
    buffer_load_dwordx4 v240, s[20:23], s52 offen offset:0 lds
    buffer_load_dwordx4 v240, s[20:23], s53 offen offset:1024 lds
    buffer_load_dwordx4 v240, s[20:23], s54 offen offset:2048 lds
    buffer_load_dwordx4 v240, s[20:23], s55 offen offset:3072 lds
    v_lshrrev_b32 v243, 4, v222
    s_mov_b32 s16, s74
    s_mov_b32 s17, s75
    s_cmp_lt_u32 s47, 172
    s_cselect_b32 s18, 1409024, 0
    v_mul_u32_u24 v243, 2752, v243
    s_mul_i32 s42, s3, 352256
    s_lshl_b32 s43, s47, 4
    s_add_u32 s42, s42, s43
    s_add_u32 m0, s30, 131072
    s_add_u32 s43, s42, 175104
    buffer_load_dwordx4 v243, s[16:19], s42 offen lds
    buffer_load_dwordx4 v243, s[16:19], s43 offen offset:1024 lds
    v_mov_b32 v244, -1
    v_mov_b32 v245, -1
    v_mov_b32 v246, -1
    v_mov_b32 v247, -1
    s_add_u32 s56, s98, 4096
    buffer_store_dwordx4 v[244:247], v222, s[48:51], s56 offen offset:0 sc1
    buffer_store_dwordx4 v[244:247], v222, s[48:51], s56 offen offset:1024 sc1
    s_memrealtime s[28:29]
    s_branch F_JRET
F_J2:
    v_cmp_eq_u32 s[52:53], s44, v225
    v_cmp_eq_u32 s[54:55], s44, v227
    v_cmp_eq_u32 s[56:57], s44, v229
    v_cmp_eq_u32 vcc, s44, v231
    v_lshrrev_b32 v236, 6, v222
    v_bfe_u32 v237, v222, 7, 2
    v_and_b32 v238, 0x30, v222
    v_lshlrev_b32 v237, 5, v237
    v_xor_b32 v237, v237, v238
    v_lshl_add_u32 v236, v236, 7, v237
    s_add_u32 s42, s30, 135168
    v_add_u32 v236, s42, v236
    v_xor_b32 v237, 64, v236
    ds_read_b64_tr_b16 v[240:241], v236 offset:0
    ds_read_b64_tr_b16 v[242:243], v236 offset:2048
    ds_read_b64_tr_b16 v[244:245], v236 offset:8
    ds_read_b64_tr_b16 v[246:247], v236 offset:2056
    ds_read_b64_tr_b16 v[248:249], v237 offset:0
    ds_read_b64_tr_b16 v[250:251], v237 offset:2048
    ds_read_b64_tr_b16 v[252:253], v237 offset:8
    ds_read_b64_tr_b16 v[254:255], v237 offset:2056
    s_mov_b32 s42, 2113536
    s_and_b64 s[52:53], s[52:53], s[54:55]
    s_and_b64 vcc, vcc, s[56:57]
    s_and_b64 vcc, vcc, s[52:53]
    s_cmp_eq_u64 vcc, -1
    s_cbranch_scc0 F_SPIN2
F_BACK2:
    v_max3_u32 v224, v224, v226, v228
    v_max_u32 v224, v224, v230
    v_lshrrev_b32 v239, 8, v222
    s_bfe_u32 s43, s2, 0x30003
    v_max_u32_dpp v224, v224, v224 quad_perm:[1,0,3,2] row_mask:0xf bank_mask:0xf
    v_lshlrev_b32 v239, 4, v239
    s_lshl_b32 s43, s43, 19
    v_max_u32_dpp v224, v224, v224 quad_perm:[2,3,0,1] row_mask:0xf bank_mask:0xf
    s_lshr_b32 s59, s7, 15
    s_lshl_b32 s59, s59, 11
    v_max_u32_dpp v224, v224, v224 row_half_mirror row_mask:0xf bank_mask:0xf
    s_add_u32 s43, s43, s59
    s_add_u32 s43, s43, 4194304
    v_max_u32_dpp v224, v224, v224 row_mirror row_mask:0xf bank_mask:0xf
    v_mov_b32 v225, v224
    s_add_u32 s59, s43, 262144
    s_lshl_b32 s58, s3, 8
    v_permlane16_swap_b32 v224, v225
    v_max_u32 v224, v224, v225
    v_mov_b32 v225, v224
    s_nop 1
    v_permlane32_swap_b32 v224, v225
    v_max_u32 v224, v224, v225
    s_nop 0
    v_readfirstlane_b32 s86, v224
    s_waitcnt lgkmcnt(0)
    buffer_store_dwordx4 v[240:243], v222, s[48:51], s43 offen offset:0 sc1
    buffer_store_dwordx4 v[244:247], v222, s[48:51], s43 offen offset:1024 sc1
    buffer_store_dwordx4 v[248:251], v222, s[48:51], s59 offen offset:0 sc1
    buffer_store_dwordx4 v[252:255], v222, s[48:51], s59 offen offset:1024 sc1
    s_and_b32 s87, s86, 0xffff
    s_sub_u32 s87, 0xffff, s87
    s_lshl_b32 s87, s87, 10
    s_add_u32 s58, s58, s87
    buffer_load_dwordx4 v[224:227], v239, s[48:51], s58 offen offset:0 sc1
    buffer_load_dwordx4 v[228:231], v239, s[48:51], s58 offen offset:64 sc1
    buffer_load_dwordx4 v[232:235], v239, s[48:51], s58 offen offset:128 sc1
    buffer_load_dwordx4 v[236:239], v239, s[48:51], s58 offen offset:192 sc1
    v_lshrrev_b32 v240, 4, v222
    s_mov_b32 s16, s76
    s_mov_b32 s17, s77
    s_cmp_lt_u32 s47, 172
    s_cselect_b32 s18, 1409024, 0
    v_mul_u32_u24 v240, 2752, v240
    s_mul_i32 s42, s3, 352256
    s_lshl_b32 s43, s47, 4
    s_add_u32 s42, s42, s43
    s_add_u32 m0, s30, 133120
    s_add_u32 s43, s42, 175104
    buffer_load_dwordx4 v240, s[16:19], s42 offen lds
    buffer_load_dwordx4 v240, s[16:19], s43 offen offset:1024 lds
    s_branch F_JRET
F_J3:
    v_lshrrev_b32 v252, 8, v222
    v_bfe_u32 v253, v222, 6, 2
    v_bfe_u32 v254, v222, 4, 1
    v_bfe_u32 v255, v222, 5, 1
    v_lshl_add_u32 v253, v252, 3, v253
    s_add_u32 s42, s30, 131072
    v_lshlrev_b32 v253, 4, v253
    v_lshl_add_u32 v253, v254, 3, v253
    v_lshl_add_u32 v253, v255, 11, v253
    v_add_u32 v253, s42, v253
    ds_read_b64_tr_b16 v[240:241], v253 offset:0
    ds_read_b64_tr_b16 v[242:243], v253 offset:64
    ds_read_b64_tr_b16 v[244:245], v253 offset:512
    ds_read_b64_tr_b16 v[246:247], v253 offset:576
    v_lshl_add_u32 v252, v252, 4, s42
    s_mov_b32 s54, 0x00010001
    s_mov_b32 s55, 0x00010001
    s_waitcnt lgkmcnt(2)
    v_mfma_f32_16x16x32_bf16 v[248:251], v[240:243], v[224:227], 0
    ds_read_b64_tr_b16 v[240:241], v253 offset:1024
    ds_read_b64_tr_b16 v[242:243], v253 offset:1088
    s_waitcnt lgkmcnt(2)
    v_mfma_f32_16x16x32_bf16 v[248:251], v[244:247], v[228:231], v[248:251]
    ds_read_b64_tr_b16 v[244:245], v253 offset:1536
    ds_read_b64_tr_b16 v[246:247], v253 offset:1600
    v_lshrrev_b32 v254, 8, v222
    v_and_b32 v255, 0xf0, v222
    s_mov_b32 s16, s78
    s_mov_b32 s17, s79
    s_cmp_lt_u32 s47, 172
    s_cselect_b32 s18, 1409024, 0
    v_lshl_add_u32 v254, v254, 10, v255
    s_lshl_b32 s56, s3, 8
    s_lshl_b32 s57, s47, 13
    s_add_u32 s56, s56, s57
    s_add_u32 m0, s30, 135168
    s_add_u32 s57, s56, 3072
    s_waitcnt lgkmcnt(2)
    v_mfma_f32_16x16x32_bf16 v[248:251], v[240:243], v[232:235], v[248:251]
    buffer_load_dwordx4 v254, s[16:19], s56 offen lds
    s_waitcnt lgkmcnt(0)
    v_mfma_f32_16x16x32_bf16 v[248:251], v[244:247], v[236:239], v[248:251]
    buffer_load_dwordx4 v254, s[16:19], s57 offen offset:1024 lds
    s_mov_b64 exec, s[54:55]
    s_nop 5
    ds_write_b128 v252, v[248:251] offset:6144
    s_mov_b64 exec, -1
    v_mov_b32 v224, -1
    v_mov_b32 v225, -1
    v_mov_b32 v226, -1
    v_mov_b32 v227, -1
    s_add_u32 s56, s98, 8192
    buffer_store_dwordx4 v[224:227], v222, s[48:51], s56 offen offset:0 sc1
    buffer_store_dwordx4 v[224:227], v222, s[48:51], s56 offen offset:1024 sc1
    s_branch F_JRET
F_J4:
    v_lshrrev_b32 v252, 8, v222
    v_lshrrev_b32 v253, 2, v222
    s_add_u32 s42, s30, 135168
    v_lshlrev_b32 v252, 4, v252
    v_add_u32 v253, s42, v253
    v_add_u32 v252, 137216, v252
    ds_read_b128 v[224:227], v252 offset:0
    ds_read_b128 v[228:231], v252 offset:8192
    ds_read_b128 v[232:235], v252 offset:16384
    ds_read_b128 v[236:239], v252 offset:24576
    ds_read2st64_b32 v[240:241], v253 offset0:0 offset1:1
    ds_read2st64_b32 v[242:243], v253 offset0:2 offset1:3
    ds_read2st64_b32 v[244:245], v253 offset0:4 offset1:5
    ds_read2st64_b32 v[246:247], v253 offset0:6 offset1:7
    v_lshrrev_b32 v252, 2, v222
    s_and_b32 s42, s2, 15
    s_lshl_b32 s42, s42, 11
    s_lshl_b32 s43, s3, 9
    s_add_u32 s42, s42, s43
    s_add_u32 s42, s42, 2162688
    s_waitcnt lgkmcnt(4)
    v_add_f32 v224, v224, v228
    v_add_f32 v225, v225, v229
    v_add_f32 v226, v226, v230
    v_add_f32 v227, v227, v231
    v_add_f32 v232, v232, v236
    v_add_f32 v233, v233, v237
    v_add_f32 v234, v234, v238
    v_add_f32 v235, v235, v239
    v_add_f32 v224, v224, v232
    v_add_f32 v225, v225, v233
    v_add_f32 v226, v226, v234
    v_add_f32 v227, v227, v235
    v_cvt_pk_bf16_f32 v232, v224, v225
    v_cvt_pk_bf16_f32 v233, v226, v227
    v_mov_b32 v234, v232
    v_mov_b32 v235, v233
    s_nop 0
    v_permlane32_swap_b32 v232, v234
    v_permlane32_swap_b32 v233, v235
    v_lshlrev_b32 v224, 16, v232
    v_and_b32 v225, 0xffff0000, v232
    v_lshlrev_b32 v226, 16, v233
    v_and_b32 v227, 0xffff0000, v233
    v_lshlrev_b32 v228, 16, v234
    v_and_b32 v229, 0xffff0000, v234
    v_lshlrev_b32 v230, 16, v235
    v_and_b32 v231, 0xffff0000, v235
    v_mul_f32 v232, s36, v224
    v_mul_f32 v233, s36, v225
    v_mul_f32 v234, s36, v226
    v_mul_f32 v235, s36, v227
    v_exp_f32 v232, v232
    v_exp_f32 v233, v233
    v_exp_f32 v234, v234
    v_exp_f32 v235, v235
    v_add_f32 v232, 1.0, v232
    v_add_f32 v233, 1.0, v233
    v_add_f32 v234, 1.0, v234
    v_add_f32 v235, 1.0, v235
    v_rcp_f32 v232, v232
    v_rcp_f32 v233, v233
    v_rcp_f32 v234, v234
    v_rcp_f32 v235, v235
    v_mul_f32 v232, v232, v224
    v_mul_f32 v233, v233, v225
    v_mul_f32 v234, v234, v226
    v_mul_f32 v235, v235, v227
    v_cvt_pk_bf16_f32 v232, v232, v233
    v_cvt_pk_bf16_f32 v234, v234, v235
    v_lshlrev_b32 v224, 16, v232
    v_and_b32 v225, 0xffff0000, v232
    v_lshlrev_b32 v226, 16, v234
    v_and_b32 v227, 0xffff0000, v234
    v_mul_f32 v224, v224, v228
    v_mul_f32 v225, v225, v229
    v_mul_f32 v226, v226, v230
    v_mul_f32 v227, v227, v231
    v_cvt_pk_bf16_f32 v232, v224, v225
    v_cvt_pk_bf16_f32 v233, v226, v227
    v_lshlrev_b32 v224, 16, v232
    v_and_b32 v225, 0xffff0000, v232
    v_lshlrev_b32 v226, 16, v233
    v_and_b32 v227, 0xffff0000, v233
    v_readlane_b32 s52, v224, 0
    v_readlane_b32 s53, v225, 0
    v_readlane_b32 s54, v226, 0
    v_readlane_b32 s55, v227, 0
    v_readlane_b32 s56, v224, 16
    v_readlane_b32 s57, v225, 16
    v_readlane_b32 s58, v226, 16
    v_readlane_b32 s59, v227, 16
    s_waitcnt lgkmcnt(0)
    v_lshlrev_b32 v224, 16, v240
    v_lshlrev_b32 v225, 16, v241
    v_lshlrev_b32 v226, 16, v242
    v_lshlrev_b32 v227, 16, v243
    v_lshlrev_b32 v228, 16, v244
    v_lshlrev_b32 v229, 16, v245
    v_lshlrev_b32 v230, 16, v246
    v_lshlrev_b32 v231, 16, v247
    v_and_b32 v240, 0xffff0000, v240
    v_and_b32 v241, 0xffff0000, v241
    v_and_b32 v242, 0xffff0000, v242
    v_and_b32 v243, 0xffff0000, v243
    v_and_b32 v244, 0xffff0000, v244
    v_and_b32 v245, 0xffff0000, v245
    v_and_b32 v246, 0xffff0000, v246
    v_and_b32 v247, 0xffff0000, v247
    v_mul_f32 v248, s52, v224
    v_mul_f32 v249, s52, v240
    v_fmac_f32 v248, s53, v225
    v_fmac_f32 v249, s53, v241
    v_fmac_f32 v248, s54, v226
    v_fmac_f32 v249, s54, v242
    v_fmac_f32 v248, s55, v227
    v_fmac_f32 v249, s55, v243
    v_fmac_f32 v248, s56, v228
    v_fmac_f32 v249, s56, v244
    v_fmac_f32 v248, s57, v229
    v_fmac_f32 v249, s57, v245
    v_fmac_f32 v248, s58, v230
    v_fmac_f32 v249, s58, v246
    v_fmac_f32 v248, s59, v231
    v_fmac_f32 v249, s59, v247
    s_cmp_lt_u32 s47, 172
    s_cselect_b64 exec, -1, 0
    buffer_atomic_add_f32 v248, v252, s[48:51], s42 offen offset:0
    buffer_atomic_add_f32 v249, v252, s[48:51], s42 offen offset:256
    s_mov_b64 exec, -1
    v_mov_b32 v224, -1
    v_mov_b32 v225, -1
    v_mov_b32 v226, -1
    v_mov_b32 v227, -1
    s_add_u32 s56, s98, 12288
    buffer_store_dwordx4 v[224:227], v222, s[48:51], s56 offen offset:0 sc1
    buffer_store_dwordx4 v[224:227], v222, s[48:51], s56 offen offset:1024 sc1
    s_memrealtime s[72:73]
    s_branch F_JRET
F_J5:
    s_sub_u32 s42, s72, s28
    s_mul_i32 s42, s42, 21
    s_lshr_b32 s42, s42, 4
    s_add_u32 s72, s72, s42
    v_mov_b32 v224, s44
    v_mov_b32 v225, s45
    v_mov_b32 v226, s72
    v_mov_b32 v227, s44
    s_mov_b32 s42, 3407872
    s_cmp_eq_u32 s2, 0
    s_cselect_b64 s[52:53], s[84:85], 0
    s_mov_b64 exec, s[84:85]
    buffer_store_dwordx4 v[224:227], off, s[48:51], s63 sc1
    s_mov_b64 exec, s[52:53]
    buffer_store_dword v224, off, s[48:51], s42 sc1
    s_mov_b64 exec, -1
    v_lshl_add_u32 v232, v222, 3, s30
    v_add_u32 v234, 32768, v232
    v_add_u32 v236, 65536, v232
    v_min_u32 v232, F_FB-F_LAST-4, v232
    v_min_u32 v234, F_FB-F_LAST-4, v234
    v_min_u32 v236, F_FB-F_LAST-4, v236
    global_load_dword v233, v232, s[100:101]
    global_load_dword v235, v234, s[100:101]
    global_load_dword v237, v236, s[100:101]
    s_branch F_JRET
F_J6:
    s_and_b32 s53, s2, 3
    v_lshrrev_b32 v232, 8, v222
    v_and_b32 v225, 0x70, v222
    v_xor_b32 v232, s53, v232
    v_lshl_add_u32 v224, v222, 3, s30
    v_lshl_add_u32 v225, v232, 7, v225
    v_and_b32 v232, 0x30, v222
    s_and_b32 s43, s2, 4
    s_lshr_b32 s52, s2, 6
    s_add_u32 s43, s43, s52
    s_lshl_b32 s43, s43, 12
    s_add_u32 s43, s43, 3276800
    s_mov_b32 s42, 3276800
    s_andn2_b32 s52, s2, 3
    s_lshl_b32 s52, s52, 7
    s_add_u32 s56, s52, s42
    v_lshlrev_b32 v225, 3, v225
    v_lshlrev_b32 v232, 3, v232
    buffer_load_dwordx2 v[226:227], v224, s[48:51], s42 offen sc1
    buffer_load_dwordx2 v[228:229], v225, s[48:51], s43 offen offset:8 sc1
    buffer_load_dwordx2 v[230:231], v232, s[48:51], s56 offen offset:8 sc1
    s_branch F_JRET
F_J7:
    v_cmp_eq_u32 vcc, s44, v226
    v_cmp_eq_u32 s[52:53], s45, v227
    v_cmp_eq_u32 s[54:55], s44, v229
    v_cmp_eq_u32 s[58:59], s44, v231
    v_bfe_u32 v245, v222, 4, 3
    v_add_u32 v216, 130048, v222
    s_lshl_b32 s68, s3, 11
    s_and_b64 vcc, vcc, s[52:53]
    s_and_b64 s[54:55], s[54:55], s[58:59]
    s_and_b64 vcc, vcc, s[54:55]
    s_cmp_eq_u64 vcc, -1
    s_cbranch_scc0 F_SPIN3
F_BACK3:
    v_readfirstlane_b32 s42, v230
    v_lshrrev_b32 v235, 2, v222
    v_mov_b32 v234, 0
    v_and_b32 v235, 0xc0, v235
    s_and_b32 s43, s2, 3
    s_sub_u32 s42, s42, 0x100000
    v_subrev_u32 v246, s42, v230
    v_subrev_u32 v244, s42, v228
    v_bfe_u32 v246, v246, 0, 27
    v_lshrrev_b32 v232, 7, v232
    v_bfe_u32 v244, v244, 0, 27
    v_lshl_or_b32 v246, v246, 2, v232
    v_lshl_or_b32 v244, v244, 3, v245
    v_lshlrev_b32 v245, 5, v225
    v_readlane_b32 s52, v246, 0
    v_readlane_b32 s53, v246, 1
    v_readlane_b32 s54, v246, 2
    v_readlane_b32 s55, v246, 3
    v_readlane_b32 s56, v246, s43
    v_sub_u32_dpp v237, v244, v244 row_ror:1 row_mask:0xf bank_mask:0xf
    s_min_u32 s57, s52, s53
    s_max_u32 s53, s52, s53
    s_min_u32 s58, s54, s55
    v_sub_u32_dpp v238, v244, v244 row_ror:2 row_mask:0xf bank_mask:0xf
    s_max_u32 s55, s54, s55
    s_min_u32 s52, s57, s58
    s_max_u32 s58, s57, s58
    v_sub_u32_dpp v239, v244, v244 row_ror:3 row_mask:0xf bank_mask:0xf
    s_max_u32 s54, s53, s55
    s_min_u32 s53, s53, s55
    s_min_u32 s57, s58, s53
    v_sub_u32_dpp v240, v244, v244 row_ror:4 row_mask:0xf bank_mask:0xf
    s_max_u32 s58, s58, s53
    s_cmp_gt_u32 s56, s52
    s_cselect_b32 s59, 1, 0
    v_sub_u32_dpp v241, v244, v244 row_ror:5 row_mask:0xf bank_mask:0xf
    s_cmp_gt_u32 s56, s57
    s_addc_u32 s59, s59, 0
    s_cmp_gt_u32 s56, s58
    v_sub_u32_dpp v242, v244, v244 row_ror:6 row_mask:0xf bank_mask:0xf
    s_addc_u32 s59, s59, 0
    s_sub_u32 s53, s58, s57
    s_cmp_gt_u32 s53, 680
    v_sub_u32_dpp v243, v244, v244 row_ror:7 row_mask:0xf bank_mask:0xf
    s_cselect_b32 s55, 1, 0
    s_sub_u32 s56, s54, s58
    s_sub_u32 s53, s54, s57
    v_alignbit_b32 v234, v234, v237, 31
    s_cmp_gt_u32 s53, 720
    s_cselect_b32 s53, s56, 0
    s_cmp_gt_u32 s53, 280
    v_alignbit_b32 v234, v234, v238, 31
    s_cselect_b32 s55, 2, s55
    s_cmp_gt_u32 s56, 800
    s_cselect_b32 s55, 3, s55
    v_alignbit_b32 v234, v234, v239, 31
    s_lshl_b32 s56, s59, 2
    s_add_u32 s56, s56, s55
    s_cmp_eq_u32 s56, 5
    v_alignbit_b32 v234, v234, v240, 31
    s_cselect_b32 s54, s58, s54
    s_and_b32 s54, s54, 3
    s_xor_b32 s54, s54, s43
    v_alignbit_b32 v234, v234, v241, 31
    s_lshl_b32 s54, s54, 4
    s_cmp_eq_u32 s55, 1
    s_cselect_b32 s57, 0, s59
    v_alignbit_b32 v234, v234, v242, 31
    s_cselect_b32 s58, 2, s55
    s_min_u32 s53, s57, 1
    s_add_u32 s54, s54, s57
    v_alignbit_b32 v234, v234, v243, 31
    s_add_u32 s54, s54, s53
    s_cmp_lt_u32 s59, s58
    s_cselect_b32 s69, 9, 8
    v_bcnt_u32_b32 v234, v234, 0
    s_cselect_b32 s54, s54, 1
    s_cselect_b32 s52, 0x11111110, 0
    s_add_u32 s52, s52, 0x76543210
    v_lshlrev_b32 v234, 2, v234
    s_cmp_eq_u32 s59, 3
    s_cselect_b32 s55, s55, 0
    s_cmp_eq_u32 s56, 9
    s_cselect_b32 s55, 1, s55
    s_sub_u32 s69, s69, s55
    s_cmp_eq_u32 s55, 1
    s_cselect_b32 s52, 0x43652107, s52
    s_cmp_eq_u32 s55, 2
    s_cselect_b32 s52, 0x36521074, s52
    s_cmp_eq_u32 s55, 3
    s_cselect_b32 s52, 0x65210743, s52
    v_lshrrev_b32 v234, v234, s52
    v_and_b32 v234, 15, v234
    v_lshl_add_u32 v234, v234, 2, v235
    ds_permute_b32 v244, v234, v245
    s_mov_b32 s16, s60
    s_mov_b32 s17, s61
    s_mov_b32 s18, 2097152
    s_mov_b32 s19, 0x00020000
    s_mov_b32 s20, s80
    s_mov_b32 s21, s81
    s_mov_b32 s22, 2097152
    s_mov_b32 s23, 0x00020000
    s_waitcnt lgkmcnt(0)
    v_readlane_b32 s74, v244, 0
    v_readlane_b32 s75, v244, s54
    v_readlane_b32 s76, v244, 2
    v_readlane_b32 s77, v244, 3
    v_readlane_b32 s78, v244, 4
    v_readlane_b32 s79, v244, 5
    v_readlane_b32 s82, v244, 6
    v_readlane_b32 s83, v244, 7
    v_readlane_b32 s63, v244, 8
    s_branch F_JRET
F_LATE:
    s_waitcnt lgkmcnt(0)
    s_mov_b32 s67, 200000
F_LT0L:
    s_lshr_b32 s43, s74, 7
    s_load_dwordx2 s[72:73], s[70:71], s43 glc
    s_add_u32 s66, s66, 4096
    s_waitcnt lgkmcnt(0)
    s_cmp_eq_u64 s[72:73], s[64:65]
    s_cbranch_scc1 F_LT0B
    s_sub_u32 s67, s67, 1
    s_cmp_lg_u32 s67, 0
    s_cbranch_scc1 F_LT0L
F_LT0B:
    s_xor_b32 s33, s0, s74
    s_xor_b32 s34, s33, 262144
    s_add_u32 m0, s99, 32768
    s_nop 0
    buffer_load_dwordx4 v222, s[48:51], s34 offen sc1 lds
    buffer_load_dwordx4 v216, s[48:51], s34 offen offset:1024 sc1 lds
    s_xor_b32 s34, s33, 525312
    s_add_u32 m0, s99, 34816
    s_nop 0
    buffer_load_dwordx4 v222, s[48:51], s34 offen sc1 lds
    buffer_load_dwordx4 v216, s[48:51], s34 offen offset:1024 sc1 lds
    s_xor_b32 s34, s33, 787456
    s_add_u32 m0, s99, 36864
    s_nop 0
    buffer_load_dwordx4 v222, s[48:51], s34 offen sc1 lds
    buffer_load_dwordx4 v216, s[48:51], s34 offen offset:1024 sc1 lds
    s_mov_b32 s67, 200000
F_LT1L:
    s_lshr_b32 s43, s75, 7
    s_load_dwordx2 s[72:73], s[70:71], s43 glc
    s_add_u32 s66, s66, 4096
    s_waitcnt lgkmcnt(0)
    s_cmp_eq_u64 s[72:73], s[64:65]
    s_cbranch_scc1 F_LT1B
    s_sub_u32 s67, s67, 1
    s_cmp_lg_u32 s67, 0
    s_cbranch_scc1 F_LT1L
F_LT1B:
    s_xor_b32 s33, s0, s75
    s_xor_b32 s34, s33, 262144
    s_add_u32 m0, s99, 65536
    s_nop 0
    buffer_load_dwordx4 v222, s[48:51], s34 offen sc1 lds
    buffer_load_dwordx4 v216, s[48:51], s34 offen offset:1024 sc1 lds
    s_xor_b32 s34, s33, 525312
    s_add_u32 m0, s99, 67584
    s_nop 0
    buffer_load_dwordx4 v222, s[48:51], s34 offen sc1 lds
    buffer_load_dwordx4 v216, s[48:51], s34 offen offset:1024 sc1 lds
    s_xor_b32 s34, s33, 787456
    s_add_u32 m0, s99, 69632
    s_nop 0
    buffer_load_dwordx4 v222, s[48:51], s34 offen sc1 lds
    buffer_load_dwordx4 v216, s[48:51], s34 offen offset:1024 sc1 lds
    s_lshr_b32 s43, s76, 7
    s_load_dwordx2 s[72:73], s[70:71], s43 glc
    s_waitcnt vmcnt(0)
    s_branch F_LBACK
F_W2:
    s_mov_b32 s67, 200000
F_W2L:
    s_lshr_b32 s43, s76, 7
    s_load_dwordx2 s[72:73], s[70:71], s43 glc
    s_add_u32 s66, s66, 524288
    s_waitcnt lgkmcnt(0)
    s_cmp_eq_u64 s[72:73], s[64:65]
    s_cbranch_scc1 F_WB2
    s_sub_u32 s67, s67, 1
    s_cmp_lg_u32 s67, 0
    s_cbranch_scc1 F_W2L
    s_branch F_WB2
F_W3_8:
    s_mov_b32 s67, 200000
F_W3_8L:
    s_lshr_b32 s43, s77, 7
    s_load_dwordx2 s[72:73], s[70:71], s43 glc
    s_add_u32 s66, s66, 524288
    s_waitcnt lgkmcnt(0)
    s_cmp_eq_u64 s[72:73], s[64:65]
    s_cbranch_scc1 F_WB3_8
    s_sub_u32 s67, s67, 1
    s_cmp_lg_u32 s67, 0
    s_cbranch_scc1 F_W3_8L
    s_branch F_WB3_8
F_W4_8:
    s_mov_b32 s67, 200000
F_W4_8L:
    s_lshr_b32 s43, s78, 7
    s_load_dwordx2 s[72:73], s[70:71], s43 glc
    s_add_u32 s66, s66, 524288
    s_waitcnt lgkmcnt(0)
    s_cmp_eq_u64 s[72:73], s[64:65]
    s_cbranch_scc1 F_WB4_8
    s_sub_u32 s67, s67, 1
    s_cmp_lg_u32 s67, 0
    s_cbranch_scc1 F_W4_8L
    s_branch F_WB4_8
F_W5_8:
    s_mov_b32 s67, 200000
F_W5_8L:
    s_lshr_b32 s43, s79, 7
    s_load_dwordx2 s[72:73], s[70:71], s43 glc
    s_add_u32 s66, s66, 524288
    s_waitcnt lgkmcnt(0)
    s_cmp_eq_u64 s[72:73], s[64:65]
    s_cbranch_scc1 F_WB5_8
    s_sub_u32 s67, s67, 1
    s_cmp_lg_u32 s67, 0
    s_cbranch_scc1 F_W5_8L
    s_branch F_WB5_8
F_W6_8:
    s_mov_b32 s67, 200000
F_W6_8L:
    s_lshr_b32 s43, s82, 7
    s_load_dwordx2 s[72:73], s[70:71], s43 glc
    s_add_u32 s66, s66, 524288
    s_waitcnt lgkmcnt(0)
    s_cmp_eq_u64 s[72:73], s[64:65]
    s_cbranch_scc1 F_WB6_8
    s_sub_u32 s67, s67, 1
    s_cmp_lg_u32 s67, 0
    s_cbranch_scc1 F_W6_8L
    s_branch F_WB6_8
F_W7_8:
    s_mov_b32 s67, 200000
F_W7_8L:
    s_lshr_b32 s43, s83, 7
    s_load_dwordx2 s[72:73], s[70:71], s43 glc
    s_add_u32 s66, s66, 524288
    s_waitcnt lgkmcnt(0)
    s_cmp_eq_u64 s[72:73], s[64:65]
    s_cbranch_scc1 F_WB7_8
    s_sub_u32 s67, s67, 1
    s_cmp_lg_u32 s67, 0
    s_cbranch_scc1 F_W7_8L
    s_branch F_WB7_8
F_SPIN4:
    s_mov_b32 s67, 200000
F_SPINL4:
    buffer_load_dwordx4 v[88:91], v222, s[48:51], s53 offen offset:0 sc1
    buffer_load_dwordx4 v[92:95], v222, s[48:51], s53 offen offset:1024 sc1
    buffer_load_dwordx4 v[104:107], v222, s[48:51], s54 offen offset:0 sc1
    buffer_load_dwordx4 v[108:111], v222, s[48:51], s54 offen offset:1024 sc1
    buffer_load_dwordx4 v[120:123], v222, s[48:51], s55 offen offset:0 sc1
    buffer_load_dwordx4 v[124:127], v222, s[48:51], s55 offen offset:1024 sc1
    s_add_u32 s66, s66, 67108864
    s_waitcnt vmcnt(0)
    v_max3_u32 v0, v88, v89, v90
    v_max3_u32 v1, v91, v92, v93
    v_max3_u32 v2, v94, v95, v104
    v_max3_u32 v3, v105, v106, v107
    v_max3_u32 v4, v108, v109, v110
    v_max3_u32 v5, v111, v120, v121
    v_max3_u32 v6, v122, v123, v124
    v_max3_u32 v7, v125, v126, v127
    v_max3_u32 v0, v0, v1, v2
    v_max3_u32 v3, v3, v4, v5
    v_max3_u32 v0, v0, v6, v7
    v_max_u32 v0, v0, v3
    v_cmp_ne_u32 vcc, -1, v0
    s_nop 3
    s_cmp_eq_u64 vcc, -1
    s_cbranch_scc1 F_BACK4
    s_sub_u32 s67, s67, 1
    s_cmp_lg_u32 s67, 0
    s_cbranch_scc1 F_SPINL4
    s_branch F_BACK4
F_BACK4:
    v_mfma_f32_16x16x32_bf16 v[128:131], v[10:13], v[88:91], v[64:67]
    v_mfma_f32_16x16x32_bf16 v[132:135], v[8:11], v[88:91], v[68:71]
    v_mfma_f32_16x16x32_bf16 v[128:131], v[10:13], v[104:107], v[128:131]
    v_mfma_f32_16x16x32_bf16 v[132:135], v[8:11], v[104:107], v[132:135]
    v_mfma_f32_16x16x32_bf16 v[128:131], v[10:13], v[120:123], v[128:131]
    v_mfma_f32_16x16x32_bf16 v[132:135], v[8:11], v[120:123], v[132:135]
    v_mfma_f32_16x16x32_bf16 v[136:139], v[10:13], v[92:95], v[72:75]
    s_nop 3
    s_branch F_CONT4
F_RA:
    v_and_b32 v195, 0x3c00, v194
    s_and_b32 s52, s97, 0x3c0
    s_and_b32 s53, s97, 0x300
    s_add_u32 s52, s52, s53
    s_add_u32 s52, s52, 2162688
    v_add_u32 v195, v195, v194
    buffer_load_dwordx4 v[176:179], v195, s[48:51], s52 offen offset:0 sc1
    buffer_load_dwordx4 v[180:183], v195, s[48:51], s52 offen offset:256 sc1
    s_branch F_RAB
F_RB8:
    s_and_b32 s42, s86, 0xffff0000
    s_xor_b32 s54, s42, 0x80000000
    s_xor_b32 s55, s42, 0xffff0000
    s_bitcmp1_b32 s42, 31
    s_cselect_b32 s42, s54, s55
    v_mov_b32 v16, s42
    v_mul_f32 v16, s36, v16
    v_exp_f32 v16, v16
    v_add_f32_dpp v0, v176, v176 quad_perm:[1,0,3,2] row_mask:0xf bank_mask:0xf
    v_add_f32_dpp v1, v180, v180 quad_perm:[1,0,3,2] row_mask:0xf bank_mask:0xf
    v_add_f32_dpp v2, v177, v177 quad_perm:[1,0,3,2] row_mask:0xf bank_mask:0xf
    v_add_f32_dpp v3, v181, v181 quad_perm:[1,0,3,2] row_mask:0xf bank_mask:0xf
    v_add_f32_dpp v4, v178, v178 quad_perm:[1,0,3,2] row_mask:0xf bank_mask:0xf
    v_add_f32_dpp v5, v182, v182 quad_perm:[1,0,3,2] row_mask:0xf bank_mask:0xf
    v_add_f32_dpp v6, v179, v179 quad_perm:[1,0,3,2] row_mask:0xf bank_mask:0xf
    v_add_f32_dpp v7, v183, v183 quad_perm:[1,0,3,2] row_mask:0xf bank_mask:0xf
    v_add_f32_dpp v0, v0, v0 quad_perm:[2,3,0,1] row_mask:0xf bank_mask:0xf
    v_add_f32_dpp v1, v1, v1 quad_perm:[2,3,0,1] row_mask:0xf bank_mask:0xf
    v_add_f32_dpp v2, v2, v2 quad_perm:[2,3,0,1] row_mask:0xf bank_mask:0xf
    v_add_f32_dpp v3, v3, v3 quad_perm:[2,3,0,1] row_mask:0xf bank_mask:0xf
    v_add_f32_dpp v4, v4, v4 quad_perm:[2,3,0,1] row_mask:0xf bank_mask:0xf
    v_add_f32_dpp v5, v5, v5 quad_perm:[2,3,0,1] row_mask:0xf bank_mask:0xf
    v_add_f32_dpp v6, v6, v6 quad_perm:[2,3,0,1] row_mask:0xf bank_mask:0xf
    v_add_f32_dpp v7, v7, v7 quad_perm:[2,3,0,1] row_mask:0xf bank_mask:0xf
    v_add_f32_dpp v0, v0, v0 row_half_mirror row_mask:0xf bank_mask:0xf
    v_add_f32_dpp v1, v1, v1 row_half_mirror row_mask:0xf bank_mask:0xf
    v_add_f32_dpp v2, v2, v2 row_half_mirror row_mask:0xf bank_mask:0xf
    v_add_f32_dpp v3, v3, v3 row_half_mirror row_mask:0xf bank_mask:0xf
    v_add_f32_dpp v4, v4, v4 row_half_mirror row_mask:0xf bank_mask:0xf
    v_add_f32_dpp v5, v5, v5 row_half_mirror row_mask:0xf bank_mask:0xf
    v_add_f32_dpp v6, v6, v6 row_half_mirror row_mask:0xf bank_mask:0xf
    v_add_f32_dpp v7, v7, v7 row_half_mirror row_mask:0xf bank_mask:0xf
    v_add_f32_dpp v0, v0, v0 row_mirror row_mask:0xf bank_mask:0xf
    v_add_f32_dpp v1, v1, v1 row_mirror row_mask:0xf bank_mask:0xf
    v_add_f32_dpp v2, v2, v2 row_mirror row_mask:0xf bank_mask:0xf
    v_add_f32_dpp v3, v3, v3 row_mirror row_mask:0xf bank_mask:0xf
    v_add_f32_dpp v4, v4, v4 row_mirror row_mask:0xf bank_mask:0xf
    v_add_f32_dpp v5, v5, v5 row_mirror row_mask:0xf bank_mask:0xf
    v_add_f32_dpp v6, v6, v6 row_mirror row_mask:0xf bank_mask:0xf
    v_add_f32_dpp v7, v7, v7 row_mirror row_mask:0xf bank_mask:0xf
    v_add_f32 v16, 1.0, v16
    v_rcp_f32 v16, v16
    s_bfe_u32 s42, s87, 0x4000a
    s_mov_b32 s54, 0x00010001
    s_lshl_b32 s54, s54, s42
    s_mov_b32 s55, s54
    v_cvt_pk_bf16_f32 v16, v16, v16
    v_lshlrev_b32 v16, 16, v16
    v_cvt_pk_bf16_f32 v8, v0, v1
    v_cvt_pk_bf16_f32 v9, v2, v3
    v_cvt_pk_bf16_f32 v10, v4, v5
    v_cvt_pk_bf16_f32 v11, v6, v7
    v_lshlrev_b32 v0, 16, v8
    v_and_b32 v1, 0xffff0000, v8
    v_lshlrev_b32 v2, 16, v9
    v_and_b32 v3, 0xffff0000, v9
    v_lshlrev_b32 v4, 16, v10
    v_and_b32 v5, 0xffff0000, v10
    v_lshlrev_b32 v6, 16, v11
    v_and_b32 v7, 0xffff0000, v11
    v_mul_f32 v0, v0, v16
    v_mul_f32 v1, v1, v16
    v_mul_f32 v2, v2, v16
    v_mul_f32 v3, v3, v16
    v_mul_f32 v4, v4, v16
    v_mul_f32 v5, v5, v16
    v_mul_f32 v6, v6, v16
    v_mul_f32 v7, v7, v16
    v_cvt_pk_bf16_f32 v8, v0, v1
    v_cvt_pk_bf16_f32 v9, v2, v3
    v_cvt_pk_bf16_f32 v10, v4, v5
    v_cvt_pk_bf16_f32 v11, v6, v7
    v_lshlrev_b32 v0, 16, v8
    v_and_b32 v1, 0xffff0000, v8
    v_lshlrev_b32 v2, 16, v9
    v_and_b32 v3, 0xffff0000, v9
    v_lshlrev_b32 v4, 16, v10
    v_and_b32 v5, 0xffff0000, v10
    v_lshlrev_b32 v6, 16, v11
    v_and_b32 v7, 0xffff0000, v11
    s_bitcmp0_b32 s87, 14
    s_cselect_b64 exec, s[54:55], 0
    v_lshlrev_b32 v8, 16, v184
    v_and_b32 v9, 0xffff0000, v184
    v_lshlrev_b32 v10, 16, v185
    v_and_b32 v11, 0xffff0000, v185
    v_lshlrev_b32 v12, 16, v186
    v_and_b32 v13, 0xffff0000, v186
    v_lshlrev_b32 v14, 16, v187
    v_and_b32 v15, 0xffff0000, v187
    v_add_f32 v8, v8, v0
    v_add_f32 v9, v9, v1
    v_add_f32 v10, v10, v2
    v_add_f32 v11, v11, v3
    v_add_f32 v12, v12, v4
    v_add_f32 v13, v13, v5
    v_add_f32 v14, v14, v6
    v_add_f32 v15, v15, v7
    v_cvt_pk_bf16_f32 v184, v8, v9
    v_cvt_pk_bf16_f32 v185, v10, v11
    v_cvt_pk_bf16_f32 v186, v12, v13
    v_cvt_pk_bf16_f32 v187, v14, v15
    s_bitcmp1_b32 s87, 14
    s_cselect_b64 exec, s[54:55], 0
    v_lshlrev_b32 v8, 16, v188
    v_and_b32 v9, 0xffff0000, v188
    v_lshlrev_b32 v10, 16, v189
    v_and_b32 v11, 0xffff0000, v189
    v_lshlrev_b32 v12, 16, v190
    v_and_b32 v13, 0xffff0000, v190
    v_lshlrev_b32 v14, 16, v191
    v_and_b32 v15, 0xffff0000, v191
    v_add_f32 v8, v8, v0
    v_add_f32 v9, v9, v1
    v_add_f32 v10, v10, v2
    v_add_f32 v11, v11, v3
    v_add_f32 v12, v12, v4
    v_add_f32 v13, v13, v5
    v_add_f32 v14, v14, v6
    v_add_f32 v15, v15, v7
    v_cvt_pk_bf16_f32 v188, v8, v9
    v_cvt_pk_bf16_f32 v189, v10, v11
    v_cvt_pk_bf16_f32 v190, v12, v13
    v_cvt_pk_bf16_f32 v191, v14, v15
    s_mov_b64 exec, -1
    s_branch F_RBB8
F_GD:
    s_cmp_eq_u32 s69, 9
    s_cbranch_scc1 F_G9
    s_cmp_eq_u32 s69, 7
    s_cbranch_scc1 F_G7
    s_cmp_eq_u32 s69, 6
    s_cbranch_scc1 F_G6
    s_branch F_G5
F_G9:
    ds_read_b128 v[128:131], v192 offset:0
    ds_read_b128 v[132:135], v192 offset:1024
    ds_read_b128 v[136:139], v192 offset:2048
    ds_read_b128 v[140:143], v192 offset:3072
    ds_read_b128 v[144:147], v192 offset:4096
    ds_read_b128 v[148:151], v192 offset:5120
    ds_read_b128 v[152:155], v192 offset:6144
    ds_read_b128 v[156:159], v192 offset:7168
    ds_read_b128 v[160:163], v192 offset:8192
    ds_read_b128 v[164:167], v192 offset:9216
    ds_read_b128 v[168:171], v192 offset:10240
    ds_read_b128 v[172:175], v192 offset:11264
    s_waitcnt lgkmcnt(10)
    v_mfma_f32_16x16x32_bf16 v[80:83], v[224:227], v[128:131], 0
    s_xor_b32 s33, s0, s76
    s_xor_b32 s34, s33, 262144
    s_add_u32 m0, s99, 98304
    v_mfma_f32_16x16x32_bf16 v[84:87], v[228:231], v[128:131], 0
    buffer_load_dwordx4 v222, s[48:51], s34 offen sc1 lds
    v_mfma_f32_16x16x32_bf16 v[88:91], v[224:227], v[132:135], 0
    ds_read_b128 v[128:131], v192 offset:12288
    v_mfma_f32_16x16x32_bf16 v[92:95], v[228:231], v[132:135], 0
    s_waitcnt lgkmcnt(9)
    v_mfma_f32_16x16x32_bf16 v[96:99], v[224:227], v[136:139], 0
    s_lshr_b32 s43, s77, 7
    s_load_dwordx2 s[72:73], s[70:71], s43 glc
    ds_read_b128 v[132:135], v192 offset:13312
    v_mfma_f32_16x16x32_bf16 v[100:103], v[228:231], v[136:139], 0
    buffer_load_dwordx4 v216, s[48:51], s34 offen offset:1024 sc1 lds
    v_mfma_f32_16x16x32_bf16 v[104:107], v[224:227], v[140:143], 0
    ds_read_b128 v[136:139], v192 offset:14336
    v_mfma_f32_16x16x32_bf16 v[108:111], v[228:231], v[140:143], 0
    s_waitcnt lgkmcnt(9)
    v_mfma_f32_16x16x32_bf16 v[112:115], v[224:227], v[144:147], 0
    s_xor_b32 s34, s33, 525312
    s_add_u32 m0, s99, 100352
    ds_read_b128 v[140:143], v192 offset:15360
    v_mfma_f32_16x16x32_bf16 v[116:119], v[228:231], v[144:147], 0
    buffer_load_dwordx4 v222, s[48:51], s34 offen sc1 lds
    v_mfma_f32_16x16x32_bf16 v[120:123], v[224:227], v[148:151], 0
    ds_read_b128 v[144:147], v192 offset:16384
    v_mfma_f32_16x16x32_bf16 v[124:127], v[228:231], v[148:151], 0
    s_waitcnt lgkmcnt(9)
    v_mfma_f32_16x16x32_bf16 v[80:83], v[232:235], v[152:155], v[80:83]
    ds_read_b128 v[148:151], v192 offset:17408
    v_mfma_f32_16x16x32_bf16 v[84:87], v[236:239], v[152:155], v[84:87]
    buffer_load_dwordx4 v216, s[48:51], s34 offen offset:1024 sc1 lds
    v_mfma_f32_16x16x32_bf16 v[88:91], v[232:235], v[156:159], v[88:91]
    ds_read_b128 v[152:155], v192 offset:18432
    v_mfma_f32_16x16x32_bf16 v[92:95], v[236:239], v[156:159], v[92:95]
    s_waitcnt lgkmcnt(9)
    v_mfma_f32_16x16x32_bf16 v[96:99], v[232:235], v[160:163], v[96:99]
    s_xor_b32 s34, s33, 787456
    s_add_u32 m0, s99, 102400
    ds_read_b128 v[156:159], v192 offset:19456
    v_mfma_f32_16x16x32_bf16 v[100:103], v[236:239], v[160:163], v[100:103]
    buffer_load_dwordx4 v222, s[48:51], s34 offen sc1 lds
    v_mfma_f32_16x16x32_bf16 v[104:107], v[232:235], v[164:167], v[104:107]
    ds_read_b128 v[160:163], v192 offset:20480
    v_mfma_f32_16x16x32_bf16 v[108:111], v[236:239], v[164:167], v[108:111]
    s_waitcnt lgkmcnt(9)
    v_mfma_f32_16x16x32_bf16 v[112:115], v[232:235], v[168:171], v[112:115]
    ds_read_b128 v[164:167], v192 offset:21504
    v_mfma_f32_16x16x32_bf16 v[116:119], v[236:239], v[168:171], v[116:119]
    buffer_load_dwordx4 v216, s[48:51], s34 offen offset:1024 sc1 lds
    v_mfma_f32_16x16x32_bf16 v[120:123], v[232:235], v[172:175], v[120:123]
    ds_read_b128 v[168:171], v192 offset:22528
    v_mfma_f32_16x16x32_bf16 v[124:127], v[236:239], v[172:175], v[124:127]
    s_waitcnt lgkmcnt(9)
    v_mfma_f32_16x16x32_bf16 v[80:83], v[240:243], v[128:131], v[80:83]
    s_lshl1_add_u32 s31, s77, s1
    ds_read_b128 v[172:175], v192 offset:23552
    v_mfma_f32_16x16x32_bf16 v[84:87], v[244:247], v[128:131], v[84:87]
    buffer_load_dwordx4 a[160:163], v222, s[48:51], s31 offen offset:0 sc1
    v_mfma_f32_16x16x32_bf16 v[88:91], v[240:243], v[132:135], v[88:91]
    v_mfma_f32_16x16x32_bf16 v[92:95], v[244:247], v[132:135], v[92:95]
    s_waitcnt lgkmcnt(8)
    v_mfma_f32_16x16x32_bf16 v[96:99], v[240:243], v[136:139], v[96:99]
    v_mfma_f32_16x16x32_bf16 v[100:103], v[244:247], v[136:139], v[100:103]
    buffer_load_dwordx4 a[164:167], v222, s[48:51], s31 offen offset:1024 sc1
    v_mfma_f32_16x16x32_bf16 v[104:107], v[240:243], v[140:143], v[104:107]
    v_mfma_f32_16x16x32_bf16 v[108:111], v[244:247], v[140:143], v[108:111]
    s_waitcnt lgkmcnt(6)
    v_mfma_f32_16x16x32_bf16 v[112:115], v[240:243], v[144:147], v[112:115]
    s_waitcnt vmcnt(17) lgkmcnt(0)
    v_mfma_f32_16x16x32_bf16 v[116:119], v[244:247], v[144:147], v[116:119]
    s_cmp_eq_u64 s[72:73], s[64:65]
    s_cbranch_scc0 F_W3_9
F_WB3_9:
    s_barrier
    v_mfma_f32_16x16x32_bf16 v[120:123], v[240:243], v[148:151], v[120:123]
    ds_read_b128 v[128:131], v192 offset:32768
    v_mfma_f32_16x16x32_bf16 v[124:127], v[244:247], v[148:151], v[124:127]
    s_waitcnt lgkmcnt(5)
    ds_read_b128 v[132:135], v192 offset:33792
    v_mfma_f32_16x16x32_bf16 v[80:83], v[248:251], v[152:155], v[80:83]
    ds_read_b128 v[136:139], v192 offset:34816
    v_mfma_f32_16x16x32_bf16 v[84:87], v[252:255], v[152:155], v[84:87]
    ds_read_b128 v[140:143], v192 offset:35840
    v_mfma_f32_16x16x32_bf16 v[88:91], v[248:251], v[156:159], v[88:91]
    ds_read_b128 v[144:147], v192 offset:36864
    v_mfma_f32_16x16x32_bf16 v[92:95], v[252:255], v[156:159], v[92:95]
    s_waitcnt lgkmcnt(7)
    ds_read_b128 v[148:151], v192 offset:37888
    v_mfma_f32_16x16x32_bf16 v[96:99], v[248:251], v[160:163], v[96:99]
    ds_read_b128 v[152:155], v192 offset:38912
    v_mfma_f32_16x16x32_bf16 v[100:103], v[252:255], v[160:163], v[100:103]
    ds_read_b128 v[156:159], v192 offset:39936
    v_mfma_f32_16x16x32_bf16 v[104:107], v[248:251], v[164:167], v[104:107]
    ds_read_b128 v[160:163], v192 offset:40960
    v_mfma_f32_16x16x32_bf16 v[108:111], v[252:255], v[164:167], v[108:111]
    s_waitcnt lgkmcnt(9)
    buffer_load_dwordx4 a[168:171], v222, s[48:51], s31 offen offset:2048 sc1
    v_mfma_f32_16x16x32_bf16 v[112:115], v[248:251], v[168:171], v[112:115]
    ds_read_b128 v[164:167], v192 offset:41984
    v_mfma_f32_16x16x32_bf16 v[116:119], v[252:255], v[168:171], v[116:119]
    v_mfma_f32_16x16x32_bf16 v[120:123], v[248:251], v[172:175], v[120:123]
    s_xor_b32 s33, s0, s77
    s_xor_b32 s34, s33, 262144
    s_add_u32 m0, s99, 32768
    ds_read_b128 v[168:171], v192 offset:43008
    v_mfma_f32_16x16x32_bf16 v[124:127], v[252:255], v[172:175], v[124:127]
    s_waitcnt lgkmcnt(9)
    buffer_load_dwordx4 v222, s[48:51], s34 offen sc1 lds
    v_mfma_f32_16x16x32_bf16 v[80:83], a[192:195], v[128:131], v[80:83]
    ds_read_b128 v[172:175], v192 offset:44032
    v_mfma_f32_16x16x32_bf16 v[84:87], a[196:199], v[128:131], v[84:87]
    v_mfma_f32_16x16x32_bf16 v[88:91], a[192:195], v[132:135], v[88:91]
    ds_read_b128 v[128:131], v192 offset:45056
    v_mfma_f32_16x16x32_bf16 v[92:95], a[196:199], v[132:135], v[92:95]
    s_waitcnt lgkmcnt(9)
    buffer_load_dwordx4 v216, s[48:51], s34 offen offset:1024 sc1 lds
    v_mfma_f32_16x16x32_bf16 v[96:99], a[192:195], v[136:139], v[96:99]
    s_lshr_b32 s43, s78, 7
    s_load_dwordx2 s[72:73], s[70:71], s43 glc
    ds_read_b128 v[132:135], v192 offset:46080
    v_mfma_f32_16x16x32_bf16 v[100:103], a[196:199], v[136:139], v[100:103]
    v_mfma_f32_16x16x32_bf16 v[104:107], a[192:195], v[140:143], v[104:107]
    s_xor_b32 s34, s33, 525312
    s_add_u32 m0, s99, 34816
    ds_read_b128 v[136:139], v192 offset:47104
    v_mfma_f32_16x16x32_bf16 v[108:111], a[196:199], v[140:143], v[108:111]
    s_waitcnt lgkmcnt(9)
    buffer_load_dwordx4 v222, s[48:51], s34 offen sc1 lds
    v_mfma_f32_16x16x32_bf16 v[112:115], a[192:195], v[144:147], v[112:115]
    ds_read_b128 v[140:143], v192 offset:48128
    v_mfma_f32_16x16x32_bf16 v[116:119], a[196:199], v[144:147], v[116:119]
    v_mfma_f32_16x16x32_bf16 v[120:123], a[192:195], v[148:151], v[120:123]
    ds_read_b128 v[144:147], v192 offset:49152
    v_mfma_f32_16x16x32_bf16 v[124:127], a[196:199], v[148:151], v[124:127]
    s_waitcnt lgkmcnt(9)
    buffer_load_dwordx4 v216, s[48:51], s34 offen offset:1024 sc1 lds
    v_mfma_f32_16x16x32_bf16 v[80:83], a[200:203], v[152:155], v[80:83]
    ds_read_b128 v[148:151], v192 offset:50176
    v_mfma_f32_16x16x32_bf16 v[84:87], a[204:207], v[152:155], v[84:87]
    v_mfma_f32_16x16x32_bf16 v[88:91], a[200:203], v[156:159], v[88:91]
    s_xor_b32 s34, s33, 787456
    s_add_u32 m0, s99, 36864
    ds_read_b128 v[152:155], v192 offset:51200
    v_mfma_f32_16x16x32_bf16 v[92:95], a[204:207], v[156:159], v[92:95]
    s_waitcnt lgkmcnt(9)
    buffer_load_dwordx4 v222, s[48:51], s34 offen sc1 lds
    v_mfma_f32_16x16x32_bf16 v[96:99], a[200:203], v[160:163], v[96:99]
    ds_read_b128 v[156:159], v192 offset:52224
    v_mfma_f32_16x16x32_bf16 v[100:103], a[204:207], v[160:163], v[100:103]
    v_mfma_f32_16x16x32_bf16 v[104:107], a[200:203], v[164:167], v[104:107]
    ds_read_b128 v[160:163], v192 offset:53248
    v_mfma_f32_16x16x32_bf16 v[108:111], a[204:207], v[164:167], v[108:111]
    s_waitcnt lgkmcnt(9)
    buffer_load_dwordx4 v216, s[48:51], s34 offen offset:1024 sc1 lds
    v_mfma_f32_16x16x32_bf16 v[112:115], a[200:203], v[168:171], v[112:115]
    ds_read_b128 v[164:167], v192 offset:54272
    v_mfma_f32_16x16x32_bf16 v[116:119], a[204:207], v[168:171], v[116:119]
    v_mfma_f32_16x16x32_bf16 v[120:123], a[200:203], v[172:175], v[120:123]
    ds_read_b128 v[168:171], v192 offset:55296
    v_mfma_f32_16x16x32_bf16 v[124:127], a[204:207], v[172:175], v[124:127]
    s_waitcnt lgkmcnt(9)
    buffer_load_dwordx4 a[172:175], v222, s[48:51], s31 offen offset:3072 sc1
    v_mfma_f32_16x16x32_bf16 v[80:83], a[208:211], v[128:131], v[80:83]
    ds_read_b128 v[172:175], v192 offset:56320
    v_mfma_f32_16x16x32_bf16 v[84:87], a[212:215], v[128:131], v[84:87]
    v_mfma_f32_16x16x32_bf16 v[88:91], a[208:211], v[132:135], v[88:91]
    s_add_u32 s32, s31, 4096
    v_mfma_f32_16x16x32_bf16 v[92:95], a[212:215], v[132:135], v[92:95]
    s_waitcnt lgkmcnt(8)
    buffer_load_dwordx4 a[176:179], v222, s[48:51], s32 offen offset:0 sc1
    v_mfma_f32_16x16x32_bf16 v[96:99], a[208:211], v[136:139], v[96:99]
    v_mfma_f32_16x16x32_bf16 v[100:103], a[212:215], v[136:139], v[100:103]
    v_mfma_f32_16x16x32_bf16 v[104:107], a[208:211], v[140:143], v[104:107]
    v_mfma_f32_16x16x32_bf16 v[108:111], a[212:215], v[140:143], v[108:111]
    s_waitcnt lgkmcnt(6)
    buffer_load_dwordx4 a[180:183], v222, s[48:51], s32 offen offset:1024 sc1
    v_mfma_f32_16x16x32_bf16 v[112:115], a[208:211], v[144:147], v[112:115]
    s_waitcnt vmcnt(12) lgkmcnt(0)
    v_mfma_f32_16x16x32_bf16 v[116:119], a[212:215], v[144:147], v[116:119]
    s_cmp_eq_u64 s[72:73], s[64:65]
    s_cbranch_scc0 F_W4_9
F_WB4_9:
    s_barrier
    v_mfma_f32_16x16x32_bf16 v[120:123], a[208:211], v[148:151], v[120:123]
    ds_read_b128 v[128:131], v193 offset:0
    v_mfma_f32_16x16x32_bf16 v[124:127], a[212:215], v[148:151], v[124:127]
    s_waitcnt lgkmcnt(5)
    ds_read_b128 v[132:135], v193 offset:1024
    v_mfma_f32_16x16x32_bf16 v[80:83], a[216:219], v[152:155], v[80:83]
    s_cmp_eq_u32 s7, 0
    s_cbranch_scc1 F_RB9
F_RBB9:
    ds_read_b128 v[136:139], v193 offset:2048
    v_mfma_f32_16x16x32_bf16 v[84:87], a[220:223], v[152:155], v[84:87]
    ds_read_b128 v[140:143], v193 offset:3072
    v_mfma_f32_16x16x32_bf16 v[88:91], a[216:219], v[156:159], v[88:91]
    ds_read_b128 v[144:147], v193 offset:4096
    v_mfma_f32_16x16x32_bf16 v[92:95], a[220:223], v[156:159], v[92:95]
    s_waitcnt lgkmcnt(7)
    ds_read_b128 v[148:151], v193 offset:5120
    v_mfma_f32_16x16x32_bf16 v[96:99], a[216:219], v[160:163], v[96:99]
    ds_read_b128 v[152:155], v193 offset:6144
    v_mfma_f32_16x16x32_bf16 v[100:103], a[220:223], v[160:163], v[100:103]
    ds_read_b128 v[156:159], v193 offset:7168
    v_mfma_f32_16x16x32_bf16 v[104:107], a[216:219], v[164:167], v[104:107]
    ds_read_b128 v[160:163], v193 offset:8192
    v_mfma_f32_16x16x32_bf16 v[108:111], a[220:223], v[164:167], v[108:111]
    s_waitcnt lgkmcnt(9)
    buffer_load_dwordx4 a[184:187], v222, s[48:51], s32 offen offset:2048 sc1
    v_mfma_f32_16x16x32_bf16 v[112:115], a[216:219], v[168:171], v[112:115]
    ds_read_b128 v[164:167], v193 offset:9216
    v_mfma_f32_16x16x32_bf16 v[116:119], a[220:223], v[168:171], v[116:119]
    buffer_load_dwordx4 v[48:51], v194, s[16:19], s97 offen
    v_mfma_f32_16x16x32_bf16 v[120:123], a[216:219], v[172:175], v[120:123]
    ds_read_b128 v[168:171], v193 offset:10240
    v_mfma_f32_16x16x32_bf16 v[124:127], a[220:223], v[172:175], v[124:127]
    s_waitcnt vmcnt(21) lgkmcnt(9)
    buffer_load_dwordx4 a[188:191], v222, s[48:51], s32 offen offset:3072 sc1
    v_mfma_f32_16x16x32_bf16 v[80:83], a[128:131], v[128:131], v[80:83]
    ds_read_b128 v[172:175], v193 offset:11264
    v_mfma_f32_16x16x32_bf16 v[84:87], a[132:135], v[128:131], v[84:87]
    buffer_load_dwordx4 v[52:55], v194, s[16:19], s6 offen
    v_mfma_f32_16x16x32_bf16 v[88:91], a[128:131], v[132:135], v[88:91]
    s_xor_b32 s33, s0, s78
    s_xor_b32 s34, s33, 262144
    s_add_u32 m0, s99, 65536
    ds_read_b128 v[128:131], v193 offset:12288
    v_lshlrev_b32 v176, 16, v184
    v_mfma_f32_16x16x32_bf16 v[92:95], a[132:135], v[132:135], v[92:95]
    s_waitcnt lgkmcnt(9)
    buffer_load_dwordx4 v222, s[48:51], s34 offen sc1 lds
    v_mfma_f32_16x16x32_bf16 v[96:99], a[128:131], v[136:139], v[96:99]
    s_lshr_b32 s43, s79, 7
    s_load_dwordx2 s[72:73], s[70:71], s43 glc
    ds_read_b128 v[132:135], v193 offset:13312
    v_and_b32 v177, 0xffff0000, v184
    v_mfma_f32_16x16x32_bf16 v[100:103], a[132:135], v[136:139], v[100:103]
    v_lshlrev_b32 v178, 16, v185
    v_and_b32 v179, 0xffff0000, v185
    v_mfma_f32_16x16x32_bf16 v[104:107], a[128:131], v[140:143], v[104:107]
    ds_read_b128 v[136:139], v193 offset:14336
    v_lshlrev_b32 v180, 16, v186
    v_mfma_f32_16x16x32_bf16 v[108:111], a[132:135], v[140:143], v[108:111]
    s_waitcnt lgkmcnt(9)
    buffer_load_dwordx4 v216, s[48:51], s34 offen offset:1024 sc1 lds
    v_mfma_f32_16x16x32_bf16 v[112:115], a[128:131], v[144:147], v[112:115]
    ds_read_b128 v[140:143], v193 offset:15360
    v_and_b32 v181, 0xffff0000, v186
    v_mfma_f32_16x16x32_bf16 v[116:119], a[132:135], v[144:147], v[116:119]
    v_lshlrev_b32 v182, 16, v187
    v_and_b32 v183, 0xffff0000, v187
    v_mfma_f32_16x16x32_bf16 v[120:123], a[128:131], v[148:151], v[120:123]
    s_xor_b32 s34, s33, 525312
    s_add_u32 m0, s99, 67584
    ds_read_b128 v[144:147], v193 offset:16384
    v_lshlrev_b32 v184, 16, v188
    v_mfma_f32_16x16x32_bf16 v[124:127], a[132:135], v[148:151], v[124:127]
    s_waitcnt lgkmcnt(9)
    buffer_load_dwordx4 v222, s[48:51], s34 offen sc1 lds
    v_mfma_f32_16x16x32_bf16 v[80:83], a[136:139], v[152:155], v[80:83]
    ds_read_b128 v[148:151], v193 offset:17408
    v_and_b32 v185, 0xffff0000, v188
    v_mfma_f32_16x16x32_bf16 v[84:87], a[140:143], v[152:155], v[84:87]
    v_lshlrev_b32 v186, 16, v189
    v_and_b32 v187, 0xffff0000, v189
    v_mfma_f32_16x16x32_bf16 v[88:91], a[136:139], v[156:159], v[88:91]
    ds_read_b128 v[152:155], v193 offset:18432
    v_lshlrev_b32 v188, 16, v190
    v_mfma_f32_16x16x32_bf16 v[92:95], a[140:143], v[156:159], v[92:95]
    s_waitcnt lgkmcnt(9)
    buffer_load_dwordx4 v216, s[48:51], s34 offen offset:1024 sc1 lds
    v_mfma_f32_16x16x32_bf16 v[96:99], a[136:139], v[160:163], v[96:99]
    ds_read_b128 v[156:159], v193 offset:19456
    v_and_b32 v189, 0xffff0000, v190
    v_mfma_f32_16x16x32_bf16 v[100:103], a[140:143], v[160:163], v[100:103]
    v_lshlrev_b32 v190, 16, v191
    v_and_b32 v191, 0xffff0000, v191
    v_mfma_f32_16x16x32_bf16 v[104:107], a[136:139], v[164:167], v[104:107]
    s_xor_b32 s34, s33, 787456
    s_add_u32 m0, s99, 69632
    ds_read_b128 v[160:163], v193 offset:20480
    v_mul_f32 v16, s36, v176
    v_mfma_f32_16x16x32_bf16 v[108:111], a[140:143], v[164:167], v[108:111]
    s_waitcnt lgkmcnt(9)
    buffer_load_dwordx4 v222, s[48:51], s34 offen sc1 lds
    v_mfma_f32_16x16x32_bf16 v[112:115], a[136:139], v[168:171], v[112:115]
    ds_read_b128 v[164:167], v193 offset:21504
    v_mul_f32 v17, s36, v177
    v_mfma_f32_16x16x32_bf16 v[116:119], a[140:143], v[168:171], v[116:119]
    v_mul_f32 v18, s36, v178
    v_mul_f32 v19, s36, v179
    v_mfma_f32_16x16x32_bf16 v[120:123], a[136:139], v[172:175], v[120:123]
    ds_read_b128 v[168:171], v193 offset:22528
    v_mul_f32 v20, s36, v180
    v_mfma_f32_16x16x32_bf16 v[124:127], a[140:143], v[172:175], v[124:127]
    s_waitcnt lgkmcnt(9)
    buffer_load_dwordx4 v216, s[48:51], s34 offen offset:1024 sc1 lds
    v_mfma_f32_16x16x32_bf16 v[80:83], a[144:147], v[128:131], v[80:83]
    ds_read_b128 v[172:175], v193 offset:23552
    v_mul_f32 v21, s36, v181
    v_mfma_f32_16x16x32_bf16 v[84:87], a[148:151], v[128:131], v[84:87]
    v_mul_f32 v22, s36, v182
    v_mul_f32 v23, s36, v183
    v_mfma_f32_16x16x32_bf16 v[88:91], a[144:147], v[132:135], v[88:91]
    s_lshl1_add_u32 s31, s78, s1
    v_mul_f32 v24, s36, v184
    v_mul_f32 v25, s36, v185
    v_mfma_f32_16x16x32_bf16 v[92:95], a[148:151], v[132:135], v[92:95]
    s_waitcnt lgkmcnt(8)
    buffer_load_dwordx4 a[224:227], v222, s[48:51], s31 offen offset:0 sc1
    v_mfma_f32_16x16x32_bf16 v[96:99], a[144:147], v[136:139], v[96:99]
    v_mul_f32 v26, s36, v186
    v_mul_f32 v27, s36, v187
    v_mfma_f32_16x16x32_bf16 v[100:103], a[148:151], v[136:139], v[100:103]
    v_mul_f32 v28, s36, v188
    v_mul_f32 v29, s36, v189
    v_mfma_f32_16x16x32_bf16 v[104:107], a[144:147], v[140:143], v[104:107]
    v_mul_f32 v30, s36, v190
    v_mul_f32 v31, s36, v191
    v_mfma_f32_16x16x32_bf16 v[108:111], a[148:151], v[140:143], v[108:111]
    s_waitcnt lgkmcnt(6)
    buffer_load_dwordx4 a[228:231], v222, s[48:51], s31 offen offset:1024 sc1
    v_mfma_f32_16x16x32_bf16 v[112:115], a[144:147], v[144:147], v[112:115]
    s_waitcnt vmcnt(15) lgkmcnt(0)
    v_exp_f32 v16, v16
    v_mfma_f32_16x16x32_bf16 v[116:119], a[148:151], v[144:147], v[116:119]
    s_cmp_eq_u64 s[72:73], s[64:65]
    s_cbranch_scc0 F_W5_9
F_WB5_9:
    s_barrier
    v_exp_f32 v17, v17
    v_mfma_f32_16x16x32_bf16 v[120:123], a[144:147], v[148:151], v[120:123]
    ds_read_b128 v[128:131], v192 offset:0
    v_mfma_f32_16x16x32_bf16 v[124:127], a[148:151], v[148:151], v[124:127]
    s_waitcnt lgkmcnt(5)
    ds_read_b128 v[132:135], v192 offset:1024
    v_mfma_f32_16x16x32_bf16 v[80:83], a[152:155], v[152:155], v[80:83]
    ds_read_b128 v[136:139], v192 offset:2048
    v_mfma_f32_16x16x32_bf16 v[84:87], a[156:159], v[152:155], v[84:87]
    ds_read_b128 v[140:143], v192 offset:3072
    v_mfma_f32_16x16x32_bf16 v[88:91], a[152:155], v[156:159], v[88:91]
    ds_read_b128 v[144:147], v192 offset:4096
    v_mfma_f32_16x16x32_bf16 v[92:95], a[156:159], v[156:159], v[92:95]
    s_waitcnt lgkmcnt(7)
    ds_read_b128 v[148:151], v192 offset:5120
    v_mfma_f32_16x16x32_bf16 v[96:99], a[152:155], v[160:163], v[96:99]
    ds_read_b128 v[152:155], v192 offset:6144
    v_mfma_f32_16x16x32_bf16 v[100:103], a[156:159], v[160:163], v[100:103]
    ds_read_b128 v[156:159], v192 offset:7168
    v_mfma_f32_16x16x32_bf16 v[104:107], a[152:155], v[164:167], v[104:107]
    ds_read_b128 v[160:163], v192 offset:8192
    v_mfma_f32_16x16x32_bf16 v[108:111], a[156:159], v[164:167], v[108:111]
    s_waitcnt lgkmcnt(9)
    buffer_load_dwordx4 a[232:235], v222, s[48:51], s31 offen offset:2048 sc1
    v_mfma_f32_16x16x32_bf16 v[112:115], a[152:155], v[168:171], v[112:115]
    ds_read_b128 v[164:167], v192 offset:9216
    v_mfma_f32_16x16x32_bf16 v[116:119], a[156:159], v[168:171], v[116:119]
    v_exp_f32 v18, v18
    v_mfma_f32_16x16x32_bf16 v[120:123], a[152:155], v[172:175], v[120:123]
    ds_read_b128 v[168:171], v192 offset:10240
    v_mfma_f32_16x16x32_bf16 v[124:127], a[156:159], v[172:175], v[124:127]
    s_waitcnt vmcnt(10) lgkmcnt(9)
    buffer_load_dwordx4 a[236:239], v222, s[48:51], s31 offen offset:3072 sc1
    v_mfma_f32_16x16x32_bf16 v[80:83], a[160:163], v[128:131], v[80:83]
    ds_read_b128 v[172:175], v192 offset:11264
    v_mfma_f32_16x16x32_bf16 v[84:87], a[164:167], v[128:131], v[84:87]
    v_exp_f32 v19, v19
    v_mfma_f32_16x16x32_bf16 v[88:91], a[160:163], v[132:135], v[88:91]
    s_add_u32 s32, s31, 4096
    ds_read_b128 v[128:131], v192 offset:12288
    v_mfma_f32_16x16x32_bf16 v[92:95], a[164:167], v[132:135], v[92:95]
    s_waitcnt lgkmcnt(9)
    buffer_load_dwordx4 a[240:243], v222, s[48:51], s32 offen offset:0 sc1
    v_mfma_f32_16x16x32_bf16 v[96:99], a[160:163], v[136:139], v[96:99]
    s_lshr_b32 s43, s82, 7
    s_load_dwordx2 s[72:73], s[70:71], s43 glc
    ds_read_b128 v[132:135], v192 offset:13312
    v_mfma_f32_16x16x32_bf16 v[100:103], a[164:167], v[136:139], v[100:103]
    v_exp_f32 v20, v20
    v_mfma_f32_16x16x32_bf16 v[104:107], a[160:163], v[140:143], v[104:107]
    ds_read_b128 v[136:139], v192 offset:14336
    v_mfma_f32_16x16x32_bf16 v[108:111], a[164:167], v[140:143], v[108:111]
    s_waitcnt lgkmcnt(9)
    buffer_load_dwordx4 a[244:247], v222, s[48:51], s32 offen offset:1024 sc1
    v_mfma_f32_16x16x32_bf16 v[112:115], a[160:163], v[144:147], v[112:115]
    ds_read_b128 v[140:143], v192 offset:15360
    v_mfma_f32_16x16x32_bf16 v[116:119], a[164:167], v[144:147], v[116:119]
    v_exp_f32 v21, v21
    v_mfma_f32_16x16x32_bf16 v[120:123], a[160:163], v[148:151], v[120:123]
    ds_read_b128 v[144:147], v192 offset:16384
    v_mfma_f32_16x16x32_bf16 v[124:127], a[164:167], v[148:151], v[124:127]
    s_waitcnt lgkmcnt(9)
    buffer_load_dwordx4 a[248:251], v222, s[48:51], s32 offen offset:2048 sc1
    v_mfma_f32_16x16x32_bf16 v[80:83], a[168:171], v[152:155], v[80:83]
    ds_read_b128 v[148:151], v192 offset:17408
    v_mfma_f32_16x16x32_bf16 v[84:87], a[172:175], v[152:155], v[84:87]
    v_exp_f32 v22, v22
    v_mfma_f32_16x16x32_bf16 v[88:91], a[168:171], v[156:159], v[88:91]
    ds_read_b128 v[152:155], v192 offset:18432
    v_mfma_f32_16x16x32_bf16 v[92:95], a[172:175], v[156:159], v[92:95]
    s_waitcnt lgkmcnt(9)
    buffer_load_dwordx4 a[252:255], v222, s[48:51], s32 offen offset:3072 sc1
    v_mfma_f32_16x16x32_bf16 v[96:99], a[168:171], v[160:163], v[96:99]
    ds_read_b128 v[156:159], v192 offset:19456
    v_mfma_f32_16x16x32_bf16 v[100:103], a[172:175], v[160:163], v[100:103]
    v_exp_f32 v23, v23
    v_mfma_f32_16x16x32_bf16 v[104:107], a[168:171], v[164:167], v[104:107]
    s_xor_b32 s33, s0, s79
    s_xor_b32 s34, s33, 262144
    s_add_u32 m0, s99, 98304
    ds_read_b128 v[160:163], v192 offset:20480
    v_mfma_f32_16x16x32_bf16 v[108:111], a[172:175], v[164:167], v[108:111]
    s_waitcnt lgkmcnt(9)
    buffer_load_dwordx4 v222, s[48:51], s34 offen sc1 lds
    v_mfma_f32_16x16x32_bf16 v[112:115], a[168:171], v[168:171], v[112:115]
    ds_read_b128 v[164:167], v192 offset:21504
    v_mfma_f32_16x16x32_bf16 v[116:119], a[172:175], v[168:171], v[116:119]
    v_exp_f32 v24, v24
    v_mfma_f32_16x16x32_bf16 v[120:123], a[168:171], v[172:175], v[120:123]
    ds_read_b128 v[168:171], v192 offset:22528
    v_mfma_f32_16x16x32_bf16 v[124:127], a[172:175], v[172:175], v[124:127]
    s_waitcnt lgkmcnt(9)
    buffer_load_dwordx4 v216, s[48:51], s34 offen offset:1024 sc1 lds
    v_mfma_f32_16x16x32_bf16 v[80:83], a[176:179], v[128:131], v[80:83]
    ds_read_b128 v[172:175], v192 offset:23552
    v_mfma_f32_16x16x32_bf16 v[84:87], a[180:183], v[128:131], v[84:87]
    v_exp_f32 v25, v25
    v_mfma_f32_16x16x32_bf16 v[88:91], a[176:179], v[132:135], v[88:91]
    s_xor_b32 s34, s33, 525312
    s_add_u32 m0, s99, 100352
    v_exp_f32 v26, v26
    v_mfma_f32_16x16x32_bf16 v[92:95], a[180:183], v[132:135], v[92:95]
    s_waitcnt lgkmcnt(8)
    buffer_load_dwordx4 v222, s[48:51], s34 offen sc1 lds
    v_mfma_f32_16x16x32_bf16 v[96:99], a[176:179], v[136:139], v[96:99]
    v_exp_f32 v27, v27
    v_mfma_f32_16x16x32_bf16 v[100:103], a[180:183], v[136:139], v[100:103]
    v_exp_f32 v28, v28
    v_mfma_f32_16x16x32_bf16 v[104:107], a[176:179], v[140:143], v[104:107]
    v_exp_f32 v29, v29
    v_mfma_f32_16x16x32_bf16 v[108:111], a[180:183], v[140:143], v[108:111]
    s_waitcnt lgkmcnt(6)
    buffer_load_dwordx4 v216, s[48:51], s34 offen offset:1024 sc1 lds
    v_mfma_f32_16x16x32_bf16 v[112:115], a[176:179], v[144:147], v[112:115]
    s_waitcnt vmcnt(12) lgkmcnt(0)
    v_exp_f32 v30, v30
    v_mfma_f32_16x16x32_bf16 v[116:119], a[180:183], v[144:147], v[116:119]
    s_cmp_eq_u64 s[72:73], s[64:65]
    s_cbranch_scc0 F_W6_9
F_WB6_9:
    s_barrier
    v_exp_f32 v31, v31
    v_mfma_f32_16x16x32_bf16 v[120:123], a[176:179], v[148:151], v[120:123]
    ds_read_b128 v[128:131], v192 offset:32768
    v_add_f32 v16, 1.0, v16
    v_mfma_f32_16x16x32_bf16 v[124:127], a[180:183], v[148:151], v[124:127]
    s_waitcnt lgkmcnt(5)
    ds_read_b128 v[132:135], v192 offset:33792
    v_add_f32 v17, 1.0, v17
    v_mfma_f32_16x16x32_bf16 v[80:83], a[184:187], v[152:155], v[80:83]
    ds_read_b128 v[136:139], v192 offset:34816
    v_add_f32 v18, 1.0, v18
    v_mfma_f32_16x16x32_bf16 v[84:87], a[188:191], v[152:155], v[84:87]
    ds_read_b128 v[140:143], v192 offset:35840
    v_add_f32 v19, 1.0, v19
    v_mfma_f32_16x16x32_bf16 v[88:91], a[184:187], v[156:159], v[88:91]
    ds_read_b128 v[144:147], v192 offset:36864
    v_add_f32 v20, 1.0, v20
    v_mfma_f32_16x16x32_bf16 v[92:95], a[188:191], v[156:159], v[92:95]
    s_waitcnt lgkmcnt(7)
    ds_read_b128 v[148:151], v192 offset:37888
    v_add_f32 v21, 1.0, v21
    v_mfma_f32_16x16x32_bf16 v[96:99], a[184:187], v[160:163], v[96:99]
    ds_read_b128 v[152:155], v192 offset:38912
    v_add_f32 v22, 1.0, v22
    v_mfma_f32_16x16x32_bf16 v[100:103], a[188:191], v[160:163], v[100:103]
    ds_read_b128 v[156:159], v192 offset:39936
    v_add_f32 v23, 1.0, v23
    v_mfma_f32_16x16x32_bf16 v[104:107], a[184:187], v[164:167], v[104:107]
    s_xor_b32 s34, s33, 787456
    s_add_u32 m0, s99, 102400
    ds_read_b128 v[160:163], v192 offset:40960
    v_add_f32 v24, 1.0, v24
    v_mfma_f32_16x16x32_bf16 v[108:111], a[188:191], v[164:167], v[108:111]
    s_waitcnt lgkmcnt(9)
    buffer_load_dwordx4 v222, s[48:51], s34 offen sc1 lds
    v_mfma_f32_16x16x32_bf16 v[112:115], a[184:187], v[168:171], v[112:115]
    ds_read_b128 v[164:167], v192 offset:41984
    v_add_f32 v25, 1.0, v25
    v_mfma_f32_16x16x32_bf16 v[116:119], a[188:191], v[168:171], v[116:119]
    v_add_f32 v26, 1.0, v26
    v_add_f32 v27, 1.0, v27
    v_mfma_f32_16x16x32_bf16 v[120:123], a[184:187], v[172:175], v[120:123]
    ds_read_b128 v[168:171], v192 offset:43008
    v_add_f32 v28, 1.0, v28
    v_mfma_f32_16x16x32_bf16 v[124:127], a[188:191], v[172:175], v[124:127]
    s_waitcnt vmcnt(5) lgkmcnt(9)
    buffer_load_dwordx4 v216, s[48:51], s34 offen offset:1024 sc1 lds
    v_mfma_f32_16x16x32_bf16 v[80:83], a[224:227], v[128:131], v[80:83]
    ds_read_b128 v[172:175], v192 offset:44032
    v_add_f32 v29, 1.0, v29
    v_mfma_f32_16x16x32_bf16 v[84:87], a[228:231], v[128:131], v[84:87]
    v_add_f32 v30, 1.0, v30
    v_add_f32 v31, 1.0, v31
    v_mfma_f32_16x16x32_bf16 v[88:91], a[224:227], v[132:135], v[88:91]
    s_xor_b32 s34, s0, s74
    s_add_u32 m0, s68, 0
    ds_read_b128 v[128:131], v192 offset:45056
    v_mfma_f32_16x16x32_bf16 v[92:95], a[228:231], v[132:135], v[92:95]
    s_waitcnt lgkmcnt(9)
    buffer_load_dwordx4 v222, s[48:51], s34 offen sc1 lds
    v_mfma_f32_16x16x32_bf16 v[96:99], a[224:227], v[136:139], v[96:99]
    s_lshr_b32 s43, s83, 7
    s_load_dwordx2 s[72:73], s[70:71], s43 glc
    ds_read_b128 v[132:135], v192 offset:46080
    v_mfma_f32_16x16x32_bf16 v[100:103], a[228:231], v[136:139], v[100:103]
    v_rcp_f32 v16, v16
    v_mfma_f32_16x16x32_bf16 v[104:107], a[224:227], v[140:143], v[104:107]
    ds_read_b128 v[136:139], v192 offset:47104
    v_mfma_f32_16x16x32_bf16 v[108:111], a[228:231], v[140:143], v[108:111]
    s_waitcnt lgkmcnt(9)
    buffer_load_dwordx4 v216, s[48:51], s34 offen offset:1024 sc1 lds
    v_mfma_f32_16x16x32_bf16 v[112:115], a[224:227], v[144:147], v[112:115]
    ds_read_b128 v[140:143], v192 offset:48128
    v_mfma_f32_16x16x32_bf16 v[116:119], a[228:231], v[144:147], v[116:119]
    v_rcp_f32 v17, v17
    v_mfma_f32_16x16x32_bf16 v[120:123], a[224:227], v[148:151], v[120:123]
    s_xor_b32 s34, s0, s75
    s_add_u32 m0, s68, 8192
    ds_read_b128 v[144:147], v192 offset:49152
    v_mfma_f32_16x16x32_bf16 v[124:127], a[228:231], v[148:151], v[124:127]
    s_waitcnt lgkmcnt(9)
    buffer_load_dwordx4 v222, s[48:51], s34 offen sc1 lds
    v_mfma_f32_16x16x32_bf16 v[80:83], a[232:235], v[152:155], v[80:83]
    ds_read_b128 v[148:151], v192 offset:50176
    v_mfma_f32_16x16x32_bf16 v[84:87], a[236:239], v[152:155], v[84:87]
    v_rcp_f32 v18, v18
    v_mfma_f32_16x16x32_bf16 v[88:91], a[232:235], v[156:159], v[88:91]
    ds_read_b128 v[152:155], v192 offset:51200
    v_mfma_f32_16x16x32_bf16 v[92:95], a[236:239], v[156:159], v[92:95]
    s_waitcnt lgkmcnt(9)
    buffer_load_dwordx4 v216, s[48:51], s34 offen offset:1024 sc1 lds
    v_mfma_f32_16x16x32_bf16 v[96:99], a[232:235], v[160:163], v[96:99]
    ds_read_b128 v[156:159], v192 offset:52224
    v_mfma_f32_16x16x32_bf16 v[100:103], a[236:239], v[160:163], v[100:103]
    v_rcp_f32 v19, v19
    v_mfma_f32_16x16x32_bf16 v[104:107], a[232:235], v[164:167], v[104:107]
    s_xor_b32 s34, s0, s76
    s_add_u32 m0, s68, 16384
    ds_read_b128 v[160:163], v192 offset:53248
    v_mfma_f32_16x16x32_bf16 v[108:111], a[236:239], v[164:167], v[108:111]
    s_waitcnt lgkmcnt(9)
    buffer_load_dwordx4 v222, s[48:51], s34 offen sc1 lds
    v_mfma_f32_16x16x32_bf16 v[112:115], a[232:235], v[168:171], v[112:115]
    ds_read_b128 v[164:167], v192 offset:54272
    v_mfma_f32_16x16x32_bf16 v[116:119], a[236:239], v[168:171], v[116:119]
    v_rcp_f32 v20, v20
    v_mfma_f32_16x16x32_bf16 v[120:123], a[232:235], v[172:175], v[120:123]
    ds_read_b128 v[168:171], v192 offset:55296
    v_mfma_f32_16x16x32_bf16 v[124:127], a[236:239], v[172:175], v[124:127]
    s_waitcnt lgkmcnt(9)
    buffer_load_dwordx4 v216, s[48:51], s34 offen offset:1024 sc1 lds
    v_mfma_f32_16x16x32_bf16 v[80:83], a[240:243], v[128:131], v[80:83]
    ds_read_b128 v[172:175], v192 offset:56320
    v_mfma_f32_16x16x32_bf16 v[84:87], a[244:247], v[128:131], v[84:87]
    v_rcp_f32 v21, v21
    v_mfma_f32_16x16x32_bf16 v[88:91], a[240:243], v[132:135], v[88:91]
    s_xor_b32 s34, s0, s77
    s_add_u32 m0, s68, 24576
    v_rcp_f32 v22, v22
    v_mfma_f32_16x16x32_bf16 v[92:95], a[244:247], v[132:135], v[92:95]
    s_waitcnt lgkmcnt(8)
    buffer_load_dwordx4 v222, s[48:51], s34 offen sc1 lds
    v_mfma_f32_16x16x32_bf16 v[96:99], a[240:243], v[136:139], v[96:99]
    v_rcp_f32 v23, v23
    v_mfma_f32_16x16x32_bf16 v[100:103], a[244:247], v[136:139], v[100:103]
    v_rcp_f32 v24, v24
    v_mfma_f32_16x16x32_bf16 v[104:107], a[240:243], v[140:143], v[104:107]
    v_rcp_f32 v25, v25
    v_mfma_f32_16x16x32_bf16 v[108:111], a[244:247], v[140:143], v[108:111]
    s_waitcnt lgkmcnt(6)
    buffer_load_dwordx4 v216, s[48:51], s34 offen offset:1024 sc1 lds
    v_mfma_f32_16x16x32_bf16 v[112:115], a[240:243], v[144:147], v[112:115]
    s_waitcnt vmcnt(8) lgkmcnt(0)
    v_rcp_f32 v26, v26
    v_mfma_f32_16x16x32_bf16 v[116:119], a[244:247], v[144:147], v[116:119]
    s_cmp_eq_u64 s[72:73], s[64:65]
    s_cbranch_scc0 F_W7_9
F_WB7_9:
    s_barrier
    v_rcp_f32 v27, v27
    v_mfma_f32_16x16x32_bf16 v[120:123], a[240:243], v[148:151], v[120:123]
    ds_read_b128 v[128:131], v193 offset:0
    v_mfma_f32_16x16x32_bf16 v[124:127], a[244:247], v[148:151], v[124:127]
    s_waitcnt lgkmcnt(5)
    ds_read_b128 v[132:135], v193 offset:1024
    v_mfma_f32_16x16x32_bf16 v[80:83], a[248:251], v[152:155], v[80:83]
    ds_read_b128 v[136:139], v193 offset:2048
    v_mfma_f32_16x16x32_bf16 v[84:87], a[252:255], v[152:155], v[84:87]
    ds_read_b128 v[140:143], v193 offset:3072
    v_mfma_f32_16x16x32_bf16 v[88:91], a[248:251], v[156:159], v[88:91]
    ds_read_b128 v[144:147], v193 offset:4096
    v_mfma_f32_16x16x32_bf16 v[92:95], a[252:255], v[156:159], v[92:95]
    s_waitcnt lgkmcnt(7)
    ds_read_b128 v[148:151], v193 offset:5120
    v_mfma_f32_16x16x32_bf16 v[96:99], a[248:251], v[160:163], v[96:99]
    ds_read_b128 v[152:155], v193 offset:6144
    v_mfma_f32_16x16x32_bf16 v[100:103], a[252:255], v[160:163], v[100:103]
    ds_read_b128 v[156:159], v193 offset:7168
    v_mfma_f32_16x16x32_bf16 v[104:107], a[248:251], v[164:167], v[104:107]
    s_xor_b32 s33, s0, s82
    s_xor_b32 s34, s33, 262144
    s_add_u32 m0, s99, 32768
    ds_read_b128 v[160:163], v193 offset:8192
    v_mfma_f32_16x16x32_bf16 v[108:111], a[252:255], v[164:167], v[108:111]
    s_waitcnt lgkmcnt(9)
    buffer_load_dwordx4 v222, s[48:51], s34 offen sc1 lds
    v_mfma_f32_16x16x32_bf16 v[112:115], a[248:251], v[168:171], v[112:115]
    ds_read_b128 v[164:167], v193 offset:9216
    v_mfma_f32_16x16x32_bf16 v[116:119], a[252:255], v[168:171], v[116:119]
    v_rcp_f32 v28, v28
    v_mfma_f32_16x16x32_bf16 v[120:123], a[248:251], v[172:175], v[120:123]
    ds_read_b128 v[168:171], v193 offset:10240
    v_mfma_f32_16x16x32_bf16 v[124:127], a[252:255], v[172:175], v[124:127]
    s_waitcnt lgkmcnt(9)
    buffer_load_dwordx4 v216, s[48:51], s34 offen offset:1024 sc1 lds
    v_mfma_f32_16x16x32_bf16 v[80:83], a[0:3], v[128:131], v[80:83]
    ds_read_b128 v[172:175], v193 offset:11264
    v_mfma_f32_16x16x32_bf16 v[84:87], a[4:7], v[128:131], v[84:87]
    v_rcp_f32 v29, v29
    v_mfma_f32_16x16x32_bf16 v[88:91], a[0:3], v[132:135], v[88:91]
    s_xor_b32 s34, s33, 525312
    s_add_u32 m0, s99, 34816
    ds_read_b128 v[128:131], v193 offset:12288
    v_mfma_f32_16x16x32_bf16 v[92:95], a[4:7], v[132:135], v[92:95]
    s_waitcnt lgkmcnt(9)
    buffer_load_dwordx4 v222, s[48:51], s34 offen sc1 lds
    v_mfma_f32_16x16x32_bf16 v[96:99], a[0:3], v[136:139], v[96:99]
    ds_read_b128 v[132:135], v193 offset:13312
    v_mfma_f32_16x16x32_bf16 v[100:103], a[4:7], v[136:139], v[100:103]
    v_rcp_f32 v30, v30
    v_mfma_f32_16x16x32_bf16 v[104:107], a[0:3], v[140:143], v[104:107]
    ds_read_b128 v[136:139], v193 offset:14336
    v_mfma_f32_16x16x32_bf16 v[108:111], a[4:7], v[140:143], v[108:111]
    s_waitcnt lgkmcnt(9)
    buffer_load_dwordx4 v216, s[48:51], s34 offen offset:1024 sc1 lds
    v_mfma_f32_16x16x32_bf16 v[112:115], a[0:3], v[144:147], v[112:115]
    ds_read_b128 v[140:143], v193 offset:15360
    v_mfma_f32_16x16x32_bf16 v[116:119], a[4:7], v[144:147], v[116:119]
    v_rcp_f32 v31, v31
    v_mfma_f32_16x16x32_bf16 v[120:123], a[0:3], v[148:151], v[120:123]
    s_xor_b32 s34, s33, 787456
    s_add_u32 m0, s99, 36864
    ds_read_b128 v[144:147], v193 offset:16384
    v_mul_f32 v16, v16, v176
    v_mfma_f32_16x16x32_bf16 v[124:127], a[4:7], v[148:151], v[124:127]
    s_waitcnt lgkmcnt(9)
    buffer_load_dwordx4 v222, s[48:51], s34 offen sc1 lds
    v_mfma_f32_16x16x32_bf16 v[80:83], a[8:11], v[152:155], v[80:83]
    ds_read_b128 v[148:151], v193 offset:17408
    v_mul_f32 v17, v17, v177
    v_mfma_f32_16x16x32_bf16 v[84:87], a[12:15], v[152:155], v[84:87]
    v_mul_f32 v18, v18, v178
    v_mul_f32 v19, v19, v179
    v_mfma_f32_16x16x32_bf16 v[88:91], a[8:11], v[156:159], v[88:91]
    ds_read_b128 v[152:155], v193 offset:18432
    v_mul_f32 v20, v20, v180
    v_mfma_f32_16x16x32_bf16 v[92:95], a[12:15], v[156:159], v[92:95]
    s_waitcnt lgkmcnt(9)
    buffer_load_dwordx4 v216, s[48:51], s34 offen offset:1024 sc1 lds
    v_mfma_f32_16x16x32_bf16 v[96:99], a[8:11], v[160:163], v[96:99]
    ds_read_b128 v[156:159], v193 offset:19456
    v_mul_f32 v21, v21, v181
    v_mfma_f32_16x16x32_bf16 v[100:103], a[12:15], v[160:163], v[100:103]
    v_mul_f32 v22, v22, v182
    v_mul_f32 v23, v23, v183
    v_mfma_f32_16x16x32_bf16 v[104:107], a[8:11], v[164:167], v[104:107]
    s_xor_b32 s33, s0, s83
    s_xor_b32 s34, s33, 262144
    s_add_u32 m0, s99, 65536
    ds_read_b128 v[160:163], v193 offset:20480
    v_mul_f32 v24, v24, v184
    v_mfma_f32_16x16x32_bf16 v[108:111], a[12:15], v[164:167], v[108:111]
    s_waitcnt lgkmcnt(9)
    buffer_load_dwordx4 v222, s[48:51], s34 offen sc1 lds
    v_mfma_f32_16x16x32_bf16 v[112:115], a[8:11], v[168:171], v[112:115]
    ds_read_b128 v[164:167], v193 offset:21504
    v_mul_f32 v25, v25, v185
    v_mfma_f32_16x16x32_bf16 v[116:119], a[12:15], v[168:171], v[116:119]
    v_mul_f32 v26, v26, v186
    v_mul_f32 v27, v27, v187
    v_mfma_f32_16x16x32_bf16 v[120:123], a[8:11], v[172:175], v[120:123]
    ds_read_b128 v[168:171], v193 offset:22528
    v_mul_f32 v28, v28, v188
    v_mfma_f32_16x16x32_bf16 v[124:127], a[12:15], v[172:175], v[124:127]
    s_waitcnt lgkmcnt(9)
    buffer_load_dwordx4 v216, s[48:51], s34 offen offset:1024 sc1 lds
    v_mfma_f32_16x16x32_bf16 v[80:83], a[16:19], v[128:131], v[80:83]
    ds_read_b128 v[172:175], v193 offset:23552
    v_mul_f32 v29, v29, v189
    v_mfma_f32_16x16x32_bf16 v[84:87], a[20:23], v[128:131], v[84:87]
    v_mul_f32 v30, v30, v190
    v_mul_f32 v31, v31, v191
    v_mfma_f32_16x16x32_bf16 v[88:91], a[16:19], v[132:135], v[88:91]
    s_xor_b32 s34, s33, 525312
    s_add_u32 m0, s99, 67584
    v_cvt_pk_bf16_f32 v16, v16, v17
    v_cvt_pk_bf16_f32 v18, v18, v19
    v_mfma_f32_16x16x32_bf16 v[92:95], a[20:23], v[132:135], v[92:95]
    s_waitcnt lgkmcnt(8)
    buffer_load_dwordx4 v222, s[48:51], s34 offen sc1 lds
    v_mfma_f32_16x16x32_bf16 v[96:99], a[16:19], v[136:139], v[96:99]
    v_cvt_pk_bf16_f32 v20, v20, v21
    v_cvt_pk_bf16_f32 v22, v22, v23
    v_mfma_f32_16x16x32_bf16 v[100:103], a[20:23], v[136:139], v[100:103]
    v_cvt_pk_bf16_f32 v24, v24, v25
    v_cvt_pk_bf16_f32 v26, v26, v27
    v_mfma_f32_16x16x32_bf16 v[104:107], a[16:19], v[140:143], v[104:107]
    v_cvt_pk_bf16_f32 v28, v28, v29
    v_cvt_pk_bf16_f32 v30, v30, v31
    v_mfma_f32_16x16x32_bf16 v[108:111], a[20:23], v[140:143], v[108:111]
    s_waitcnt lgkmcnt(6)
    buffer_load_dwordx4 v216, s[48:51], s34 offen offset:1024 sc1 lds
    v_mfma_f32_16x16x32_bf16 v[112:115], a[16:19], v[144:147], v[112:115]
    s_waitcnt vmcnt(10) lgkmcnt(0)
    v_lshlrev_b32 v176, 16, v16
    v_and_b32 v177, 0xffff0000, v16
    v_mfma_f32_16x16x32_bf16 v[116:119], a[20:23], v[144:147], v[116:119]
    s_barrier
    v_lshlrev_b32 v178, 16, v18
    v_and_b32 v179, 0xffff0000, v18
    v_mfma_f32_16x16x32_bf16 v[120:123], a[16:19], v[148:151], v[120:123]
    ds_read_b128 v[128:131], v222 offset:0
    v_lshlrev_b32 v180, 16, v20
    v_mfma_f32_16x16x32_bf16 v[124:127], a[20:23], v[148:151], v[124:127]
    s_waitcnt lgkmcnt(5)
    ds_read_b128 v[132:135], v222 offset:1024
    v_and_b32 v181, 0xffff0000, v20
    v_mfma_f32_16x16x32_bf16 v[80:83], a[24:27], v[152:155], v[80:83]
    ds_read_b128 v[136:139], v222 offset:2048
    v_lshlrev_b32 v182, 16, v22
    v_mfma_f32_16x16x32_bf16 v[84:87], a[28:31], v[152:155], v[84:87]
    ds_read_b128 v[140:143], v222 offset:3072
    v_and_b32 v183, 0xffff0000, v22
    v_mfma_f32_16x16x32_bf16 v[88:91], a[24:27], v[156:159], v[88:91]
    ds_read_b128 v[144:147], v222 offset:4096
    v_lshlrev_b32 v184, 16, v24
    v_mfma_f32_16x16x32_bf16 v[92:95], a[28:31], v[156:159], v[92:95]
    s_waitcnt lgkmcnt(7)
    ds_read_b128 v[148:151], v222 offset:5120
    v_and_b32 v185, 0xffff0000, v24
    v_mfma_f32_16x16x32_bf16 v[96:99], a[24:27], v[160:163], v[96:99]
    ds_read_b128 v[152:155], v222 offset:6144
    v_lshlrev_b32 v186, 16, v26
    v_mfma_f32_16x16x32_bf16 v[100:103], a[28:31], v[160:163], v[100:103]
    ds_read_b128 v[156:159], v222 offset:7168
    v_and_b32 v187, 0xffff0000, v26
    v_mfma_f32_16x16x32_bf16 v[104:107], a[24:27], v[164:167], v[104:107]
    s_xor_b32 s34, s33, 787456
    s_add_u32 m0, s99, 69632
    ds_read_b128 v[160:163], v222 offset:8192
    v_lshlrev_b32 v188, 16, v28
    v_mfma_f32_16x16x32_bf16 v[108:111], a[28:31], v[164:167], v[108:111]
    s_waitcnt lgkmcnt(9)
    buffer_load_dwordx4 v222, s[48:51], s34 offen sc1 lds
    v_mfma_f32_16x16x32_bf16 v[112:115], a[24:27], v[168:171], v[112:115]
    ds_read_b128 v[164:167], v222 offset:9216
    v_and_b32 v189, 0xffff0000, v28
    v_mfma_f32_16x16x32_bf16 v[116:119], a[28:31], v[168:171], v[116:119]
    v_lshlrev_b32 v190, 16, v30
    v_and_b32 v191, 0xffff0000, v30
    v_mfma_f32_16x16x32_bf16 v[120:123], a[24:27], v[172:175], v[120:123]
    s_waitcnt vmcnt(39)
    ds_read_b128 v[168:171], v222 offset:10240
    v_lshlrev_b32 v32, 16, v48
    v_mfma_f32_16x16x32_bf16 v[124:127], a[28:31], v[172:175], v[124:127]
    s_waitcnt lgkmcnt(9)
    buffer_load_dwordx4 v216, s[48:51], s34 offen offset:1024 sc1 lds
    v_mfma_f32_16x16x32_bf16 v[64:67], v[224:227], v[128:131], 0
    ds_read_b128 v[172:175], v222 offset:11264
    v_and_b32 v33, 0xffff0000, v48
    v_mfma_f32_16x16x32_bf16 v[68:71], v[228:231], v[128:131], 0
    v_lshlrev_b32 v34, 16, v49
    v_and_b32 v35, 0xffff0000, v49
    v_mfma_f32_16x16x32_bf16 v[72:75], v[224:227], v[132:135], 0
    s_lshl1_add_u32 s31, s83, s1
    ds_read_b128 v[128:131], v222 offset:12288
    v_lshlrev_b32 v36, 16, v50
    v_mfma_f32_16x16x32_bf16 v[76:79], v[228:231], v[132:135], 0
    s_waitcnt lgkmcnt(9)
    buffer_load_dwordx4 a[64:67], v222, s[48:51], s31 offen offset:0 sc1
    v_mfma_f32_16x16x32_bf16 v[64:67], v[232:235], v[136:139], v[64:67]
    ds_read_b128 v[132:135], v222 offset:13312
    v_and_b32 v37, 0xffff0000, v50
    v_mfma_f32_16x16x32_bf16 v[68:71], v[236:239], v[136:139], v[68:71]
    v_lshlrev_b32 v38, 16, v51
    v_and_b32 v39, 0xffff0000, v51
    v_mfma_f32_16x16x32_bf16 v[72:75], v[232:235], v[140:143], v[72:75]
    ds_read_b128 v[136:139], v222 offset:14336
    v_lshlrev_b32 v40, 16, v52
    v_mfma_f32_16x16x32_bf16 v[76:79], v[236:239], v[140:143], v[76:79]
    s_waitcnt lgkmcnt(9)
    buffer_load_dwordx4 a[68:71], v222, s[48:51], s31 offen offset:1024 sc1
    v_mfma_f32_16x16x32_bf16 v[64:67], v[240:243], v[144:147], v[64:67]
    ds_read_b128 v[140:143], v222 offset:15360
    v_and_b32 v41, 0xffff0000, v52
    v_mfma_f32_16x16x32_bf16 v[68:71], v[244:247], v[144:147], v[68:71]
    v_lshlrev_b32 v42, 16, v53
    v_and_b32 v43, 0xffff0000, v53
    v_mfma_f32_16x16x32_bf16 v[72:75], v[240:243], v[148:151], v[72:75]
    ds_read_b128 v[144:147], v222 offset:16384
    v_lshlrev_b32 v44, 16, v54
    v_mfma_f32_16x16x32_bf16 v[76:79], v[244:247], v[148:151], v[76:79]
    s_waitcnt lgkmcnt(9)
    buffer_load_dwordx4 a[72:75], v222, s[48:51], s31 offen offset:2048 sc1
    v_mfma_f32_16x16x32_bf16 v[64:67], v[248:251], v[152:155], v[64:67]
    ds_read_b128 v[148:151], v222 offset:17408
    v_and_b32 v45, 0xffff0000, v54
    v_mfma_f32_16x16x32_bf16 v[68:71], v[252:255], v[152:155], v[68:71]
    v_lshlrev_b32 v46, 16, v55
    v_and_b32 v47, 0xffff0000, v55
    v_mfma_f32_16x16x32_bf16 v[72:75], v[248:251], v[156:159], v[72:75]
    ds_read_b128 v[152:155], v222 offset:18432
    v_lshrrev_b32 v8, 8, v222
    v_mfma_f32_16x16x32_bf16 v[76:79], v[252:255], v[156:159], v[76:79]
    s_waitcnt lgkmcnt(9)
    buffer_load_dwordx4 a[76:79], v222, s[48:51], s31 offen offset:3072 sc1
    v_mfma_f32_16x16x32_bf16 v[64:67], a[192:195], v[160:163], v[64:67]
    ds_read_b128 v[156:159], v222 offset:19456
    v_bfe_u32 v9, v222, 6, 2
    v_mfma_f32_16x16x32_bf16 v[68:71], a[196:199], v[160:163], v[68:71]
    v_and_b32 v12, 16, v222
    v_mov_b32 v11, 0x3f80
    v_mfma_f32_16x16x32_bf16 v[72:75], a[192:195], v[164:167], v[72:75]
    s_add_u32 s32, s31, 4096
    ds_read_b128 v[160:163], v222 offset:20480
    v_cmp_eq_u32 vcc, v8, v9
    v_mfma_f32_16x16x32_bf16 v[76:79], a[196:199], v[164:167], v[76:79]
    s_waitcnt lgkmcnt(9)
    buffer_load_dwordx4 a[80:83], v222, s[48:51], s32 offen offset:0 sc1
    v_mfma_f32_16x16x32_bf16 v[64:67], a[200:203], v[168:171], v[64:67]
    s_lshr_b32 s43, s63, 7
    s_load_dwordx2 s[72:73], s[70:71], s43 glc
    ds_read_b128 v[164:167], v222 offset:21504
    v_lshlrev_b32 v11, v12, v11
    v_mfma_f32_16x16x32_bf16 v[68:71], a[204:207], v[168:171], v[68:71]
    v_and_b32 v13, 32, v222
    v_cndmask_b32 v11, 0, v11, vcc
    v_mfma_f32_16x16x32_bf16 v[72:75], a[200:203], v[172:175], v[72:75]
    ds_read_b128 v[168:171], v222 offset:22528
    v_cmp_eq_u32 vcc, 0, v13
    v_mfma_f32_16x16x32_bf16 v[76:79], a[204:207], v[172:175], v[76:79]
    s_waitcnt lgkmcnt(9)
    buffer_load_dwordx4 a[84:87], v222, s[48:51], s32 offen offset:1024 sc1
    v_mfma_f32_16x16x32_bf16 v[64:67], a[208:211], v[128:131], v[64:67]
    ds_read_b128 v[172:175], v222 offset:23552
    v_mov_b32 v8, 0
    v_mfma_f32_16x16x32_bf16 v[68:71], a[212:215], v[128:131], v[68:71]
    v_cndmask_b32 v10, 0, v11, vcc
    v_mov_b32 v9, 0
    v_mfma_f32_16x16x32_bf16 v[72:75], a[208:211], v[132:135], v[72:75]
    ds_read_b128 v[128:131], v222 offset:24576
    v_mov_b32 v12, 0
    v_mfma_f32_16x16x32_bf16 v[76:79], a[212:215], v[132:135], v[76:79]
    s_waitcnt lgkmcnt(9)
    buffer_load_dwordx4 a[88:91], v222, s[48:51], s32 offen offset:2048 sc1
    v_mfma_f32_16x16x32_bf16 v[64:67], a[216:219], v[136:139], v[64:67]
    ds_read_b128 v[132:135], v222 offset:25600
    v_xor_b32 v11, v11, v10
    v_mfma_f32_16x16x32_bf16 v[68:71], a[220:223], v[136:139], v[68:71]
    v_mov_b32 v13, 0
    v_mfma_f32_16x16x32_bf16 v[72:75], a[216:219], v[140:143], v[72:75]
    ds_read_b128 v[136:139], v222 offset:26624
    v_mfma_f32_16x16x32_bf16 v[76:79], a[220:223], v[140:143], v[76:79]
    s_waitcnt lgkmcnt(9)
    buffer_load_dwordx4 a[92:95], v222, s[48:51], s32 offen offset:3072 sc1
    v_mfma_f32_16x16x32_bf16 v[64:67], a[128:131], v[144:147], v[64:67]
    ds_read_b128 v[140:143], v222 offset:27648
    v_mfma_f32_16x16x32_bf16 v[68:71], a[132:135], v[144:147], v[68:71]
    v_mfma_f32_16x16x32_bf16 v[72:75], a[128:131], v[148:151], v[72:75]
    s_lshl1_add_u32 s31, s63, s1
    ds_read_b128 v[144:147], v222 offset:28672
    v_mfma_f32_16x16x32_bf16 v[76:79], a[132:135], v[148:151], v[76:79]
    s_waitcnt lgkmcnt(9)
    buffer_load_dwordx4 a[96:99], v222, s[48:51], s31 offen offset:0 sc1
    v_mfma_f32_16x16x32_bf16 v[64:67], a[136:139], v[152:155], v[64:67]
    ds_read_b128 v[148:151], v222 offset:29696
    v_mfma_f32_16x16x32_bf16 v[68:71], a[140:143], v[152:155], v[68:71]
    v_mfma_f32_16x16x32_bf16 v[72:75], a[136:139], v[156:159], v[72:75]
    ds_read_b128 v[152:155], v222 offset:30720
    v_mfma_f32_16x16x32_bf16 v[76:79], a[140:143], v[156:159], v[76:79]
    s_waitcnt lgkmcnt(9)
    buffer_load_dwordx4 a[100:103], v222, s[48:51], s31 offen offset:1024 sc1
    v_mfma_f32_16x16x32_bf16 v[64:67], a[144:147], v[160:163], v[64:67]
    ds_read_b128 v[156:159], v222 offset:31744
    v_mfma_f32_16x16x32_bf16 v[68:71], a[148:151], v[160:163], v[68:71]
    v_mfma_f32_16x16x32_bf16 v[72:75], a[144:147], v[164:167], v[72:75]
    v_mfma_f32_16x16x32_bf16 v[76:79], a[148:151], v[164:167], v[76:79]
    s_waitcnt lgkmcnt(8)
    buffer_load_dwordx4 a[104:107], v222, s[48:51], s31 offen offset:2048 sc1
    v_mfma_f32_16x16x32_bf16 v[64:67], a[152:155], v[168:171], v[64:67]
    v_mfma_f32_16x16x32_bf16 v[68:71], a[156:159], v[168:171], v[68:71]
    v_mfma_f32_16x16x32_bf16 v[72:75], a[152:155], v[172:175], v[72:75]
    v_mfma_f32_16x16x32_bf16 v[76:79], a[156:159], v[172:175], v[76:79]
    s_waitcnt lgkmcnt(6)
    buffer_load_dwordx4 a[108:111], v222, s[48:51], s31 offen offset:3072 sc1
    v_mfma_f32_16x16x32_bf16 v[64:67], a[160:163], v[128:131], v[64:67]
    s_waitcnt vmcnt(18) lgkmcnt(0)
    v_mfma_f32_16x16x32_bf16 v[68:71], a[164:167], v[128:131], v[68:71]
    s_cmp_eq_u64 s[72:73], s[64:65]
    s_cbranch_scc0 F_W8_9
F_WB8_9:
    s_barrier
    v_mfma_f32_16x16x32_bf16 v[72:75], a[160:163], v[132:135], v[72:75]
    ds_read_b128 v[160:163], v192 offset:0
    v_mfma_f32_16x16x32_bf16 v[76:79], a[164:167], v[132:135], v[76:79]
    s_waitcnt lgkmcnt(5)
    ds_read_b128 v[164:167], v192 offset:1024
    v_mfma_f32_16x16x32_bf16 v[64:67], a[168:171], v[136:139], v[64:67]
    ds_read_b128 v[168:171], v192 offset:2048
    v_mfma_f32_16x16x32_bf16 v[68:71], a[172:175], v[136:139], v[68:71]
    ds_read_b128 v[172:175], v192 offset:3072
    v_mfma_f32_16x16x32_bf16 v[72:75], a[168:171], v[140:143], v[72:75]
    ds_read_b128 v[128:131], v192 offset:4096
    v_mfma_f32_16x16x32_bf16 v[76:79], a[172:175], v[140:143], v[76:79]
    s_waitcnt lgkmcnt(7)
    ds_read_b128 v[132:135], v192 offset:5120
    v_mfma_f32_16x16x32_bf16 v[64:67], a[176:179], v[144:147], v[64:67]
    ds_read_b128 v[136:139], v192 offset:6144
    v_mfma_f32_16x16x32_bf16 v[68:71], a[180:183], v[144:147], v[68:71]
    ds_read_b128 v[140:143], v192 offset:7168
    v_mfma_f32_16x16x32_bf16 v[72:75], a[176:179], v[148:151], v[72:75]
    s_xor_b32 s33, s0, s63
    s_xor_b32 s34, s33, 262144
    s_add_u32 m0, s99, 98304
    ds_read_b128 v[144:147], v192 offset:8192
    v_mfma_f32_16x16x32_bf16 v[76:79], a[180:183], v[148:151], v[76:79]
    s_waitcnt lgkmcnt(9)
    buffer_load_dwordx4 v222, s[48:51], s34 offen sc1 lds
    v_mfma_f32_16x16x32_bf16 v[64:67], a[184:187], v[152:155], v[64:67]
    ds_read_b128 v[148:151], v192 offset:9216
    v_mfma_f32_16x16x32_bf16 v[68:71], a[188:191], v[152:155], v[68:71]
    v_mfma_f32_16x16x32_bf16 v[72:75], a[184:187], v[156:159], v[72:75]
    ds_read_b128 v[152:155], v192 offset:10240
    v_mfma_f32_16x16x32_bf16 v[76:79], a[188:191], v[156:159], v[76:79]
    s_waitcnt lgkmcnt(9)
    buffer_load_dwordx4 v216, s[48:51], s34 offen offset:1024 sc1 lds
    v_mfma_f32_16x16x32_bf16 v[80:83], a[32:35], v[160:163], v[80:83]
    ds_read_b128 v[156:159], v192 offset:11264
    v_mfma_f32_16x16x32_bf16 v[84:87], a[36:39], v[160:163], v[84:87]
    v_mfma_f32_16x16x32_bf16 v[88:91], a[32:35], v[164:167], v[88:91]
    s_xor_b32 s34, s33, 525312
    s_add_u32 m0, s99, 100352
    ds_read_b128 v[160:163], v192 offset:12288
    v_mfma_f32_16x16x32_bf16 v[92:95], a[36:39], v[164:167], v[92:95]
    s_waitcnt lgkmcnt(9)
    buffer_load_dwordx4 v222, s[48:51], s34 offen sc1 lds
    v_mfma_f32_16x16x32_bf16 v[96:99], a[32:35], v[168:171], v[96:99]
    ds_read_b128 v[164:167], v192 offset:13312
    v_mfma_f32_16x16x32_bf16 v[100:103], a[36:39], v[168:171], v[100:103]
    v_mfma_f32_16x16x32_bf16 v[104:107], a[32:35], v[172:175], v[104:107]
    ds_read_b128 v[168:171], v192 offset:14336
    v_mfma_f32_16x16x32_bf16 v[108:111], a[36:39], v[172:175], v[108:111]
    s_waitcnt lgkmcnt(9)
    buffer_load_dwordx4 v216, s[48:51], s34 offen offset:1024 sc1 lds
    v_mfma_f32_16x16x32_bf16 v[112:115], a[32:35], v[128:131], v[112:115]
    ds_read_b128 v[172:175], v192 offset:15360
    v_mfma_f32_16x16x32_bf16 v[116:119], a[36:39], v[128:131], v[116:119]
    v_mfma_f32_16x16x32_bf16 v[120:123], a[32:35], v[132:135], v[120:123]
    s_xor_b32 s34, s33, 787456
    s_add_u32 m0, s99, 102400
    ds_read_b128 v[128:131], v192 offset:16384
    v_mfma_f32_16x16x32_bf16 v[124:127], a[36:39], v[132:135], v[124:127]
    s_waitcnt lgkmcnt(9)
    buffer_load_dwordx4 v222, s[48:51], s34 offen sc1 lds
    v_mfma_f32_16x16x32_bf16 v[80:83], a[40:43], v[136:139], v[80:83]
    ds_read_b128 v[132:135], v192 offset:17408
    v_mfma_f32_16x16x32_bf16 v[84:87], a[44:47], v[136:139], v[84:87]
    v_mfma_f32_16x16x32_bf16 v[88:91], a[40:43], v[140:143], v[88:91]
    ds_read_b128 v[136:139], v192 offset:18432
    v_mfma_f32_16x16x32_bf16 v[92:95], a[44:47], v[140:143], v[92:95]
    s_waitcnt lgkmcnt(9)
    buffer_load_dwordx4 v216, s[48:51], s34 offen offset:1024 sc1 lds
    v_mfma_f32_16x16x32_bf16 v[96:99], a[40:43], v[144:147], v[96:99]
    ds_read_b128 v[140:143], v192 offset:19456
    v_mfma_f32_16x16x32_bf16 v[100:103], a[44:47], v[144:147], v[100:103]
    v_mfma_f32_16x16x32_bf16 v[104:107], a[40:43], v[148:151], v[104:107]
    s_add_u32 s32, s31, 4096
    ds_read_b128 v[144:147], v192 offset:20480
    v_mfma_f32_16x16x32_bf16 v[108:111], a[44:47], v[148:151], v[108:111]
    s_waitcnt lgkmcnt(9)
    buffer_load_dwordx4 a[112:115], v222, s[48:51], s32 offen offset:0 sc1
    v_mfma_f32_16x16x32_bf16 v[112:115], a[40:43], v[152:155], v[112:115]
    ds_read_b128 v[148:151], v192 offset:21504
    v_mfma_f32_16x16x32_bf16 v[116:119], a[44:47], v[152:155], v[116:119]
    v_mfma_f32_16x16x32_bf16 v[120:123], a[40:43], v[156:159], v[120:123]
    ds_read_b128 v[152:155], v192 offset:22528
    v_mfma_f32_16x16x32_bf16 v[124:127], a[44:47], v[156:159], v[124:127]
    s_waitcnt lgkmcnt(9)
    buffer_load_dwordx4 a[116:119], v222, s[48:51], s32 offen offset:1024 sc1
    v_mfma_f32_16x16x32_bf16 v[80:83], a[48:51], v[160:163], v[80:83]
    ds_read_b128 v[156:159], v192 offset:23552
    v_mfma_f32_16x16x32_bf16 v[84:87], a[52:55], v[160:163], v[84:87]
    v_mfma_f32_16x16x32_bf16 v[88:91], a[48:51], v[164:167], v[88:91]
    v_mfma_f32_16x16x32_bf16 v[92:95], a[52:55], v[164:167], v[92:95]
    s_waitcnt lgkmcnt(8)
    buffer_load_dwordx4 a[120:123], v222, s[48:51], s32 offen offset:2048 sc1
    v_mfma_f32_16x16x32_bf16 v[96:99], a[48:51], v[168:171], v[96:99]
    v_mfma_f32_16x16x32_bf16 v[100:103], a[52:55], v[168:171], v[100:103]
    v_mfma_f32_16x16x32_bf16 v[104:107], a[48:51], v[172:175], v[104:107]
    v_mfma_f32_16x16x32_bf16 v[108:111], a[52:55], v[172:175], v[108:111]
    s_waitcnt lgkmcnt(6)
    buffer_load_dwordx4 a[124:127], v222, s[48:51], s32 offen offset:3072 sc1
    v_mfma_f32_16x16x32_bf16 v[112:115], a[48:51], v[128:131], v[112:115]
    s_waitcnt vmcnt(22) lgkmcnt(0)
    v_mfma_f32_16x16x32_bf16 v[116:119], a[52:55], v[128:131], v[116:119]
    s_barrier
    v_mfma_f32_16x16x32_bf16 v[120:123], a[48:51], v[132:135], v[120:123]
    ds_read_b128 v[160:163], v192 offset:32768
    v_mfma_f32_16x16x32_bf16 v[124:127], a[52:55], v[132:135], v[124:127]
    s_waitcnt lgkmcnt(5)
    ds_read_b128 v[164:167], v192 offset:33792
    v_mfma_f32_16x16x32_bf16 v[80:83], a[56:59], v[136:139], v[80:83]
    ds_read_b128 v[168:171], v192 offset:34816
    v_mfma_f32_16x16x32_bf16 v[84:87], a[60:63], v[136:139], v[84:87]
    ds_read_b128 v[172:175], v192 offset:35840
    v_mfma_f32_16x16x32_bf16 v[88:91], a[56:59], v[140:143], v[88:91]
    ds_read_b128 v[128:131], v192 offset:36864
    v_mfma_f32_16x16x32_bf16 v[92:95], a[60:63], v[140:143], v[92:95]
    s_waitcnt lgkmcnt(7)
    ds_read_b128 v[132:135], v192 offset:37888
    v_mfma_f32_16x16x32_bf16 v[96:99], a[56:59], v[144:147], v[96:99]
    ds_read_b128 v[136:139], v192 offset:38912
    v_mfma_f32_16x16x32_bf16 v[100:103], a[60:63], v[144:147], v[100:103]
    ds_read_b128 v[140:143], v192 offset:39936
    v_mfma_f32_16x16x32_bf16 v[104:107], a[56:59], v[148:151], v[104:107]
    s_xor_b32 s34, s0, s78
    s_add_u32 m0, s68, 131072
    ds_read_b128 v[144:147], v192 offset:40960
    v_mfma_f32_16x16x32_bf16 v[108:111], a[60:63], v[148:151], v[108:111]
    s_waitcnt lgkmcnt(9)
    buffer_load_dwordx4 v222, s[48:51], s34 offen sc1 lds
    v_mfma_f32_16x16x32_bf16 v[112:115], a[56:59], v[152:155], v[112:115]
    ds_read_b128 v[148:151], v192 offset:41984
    v_mfma_f32_16x16x32_bf16 v[116:119], a[60:63], v[152:155], v[116:119]
    v_mfma_f32_16x16x32_bf16 v[120:123], a[56:59], v[156:159], v[120:123]
    ds_read_b128 v[152:155], v192 offset:43008
    v_mfma_f32_16x16x32_bf16 v[124:127], a[60:63], v[156:159], v[124:127]
    s_waitcnt vmcnt(15) lgkmcnt(9)
    buffer_load_dwordx4 v216, s[48:51], s34 offen offset:1024 sc1 lds
    v_mfma_f32_16x16x32_bf16 v[80:83], a[64:67], v[160:163], v[80:83]
    ds_read_b128 v[156:159], v192 offset:44032
    v_mfma_f32_16x16x32_bf16 v[84:87], a[68:71], v[160:163], v[84:87]
    v_mfma_f32_16x16x32_bf16 v[88:91], a[64:67], v[164:167], v[88:91]
    s_xor_b32 s34, s0, s79
    s_add_u32 m0, s68, 139264
    ds_read_b128 v[160:163], v192 offset:45056
    v_mfma_f32_16x16x32_bf16 v[92:95], a[68:71], v[164:167], v[92:95]
    s_waitcnt lgkmcnt(9)
    buffer_load_dwordx4 v222, s[48:51], s34 offen sc1 lds
    v_mfma_f32_16x16x32_bf16 v[96:99], a[64:67], v[168:171], v[96:99]
    ds_read_b128 v[164:167], v192 offset:46080
    v_mfma_f32_16x16x32_bf16 v[100:103], a[68:71], v[168:171], v[100:103]
    v_mfma_f32_16x16x32_bf16 v[104:107], a[64:67], v[172:175], v[104:107]
    ds_read_b128 v[168:171], v192 offset:47104
    v_mfma_f32_16x16x32_bf16 v[108:111], a[68:71], v[172:175], v[108:111]
    s_waitcnt lgkmcnt(9)
    buffer_load_dwordx4 v216, s[48:51], s34 offen offset:1024 sc1 lds
    v_mfma_f32_16x16x32_bf16 v[112:115], a[64:67], v[128:131], v[112:115]
    ds_read_b128 v[172:175], v192 offset:48128
    v_mfma_f32_16x16x32_bf16 v[116:119], a[68:71], v[128:131], v[116:119]
    v_mfma_f32_16x16x32_bf16 v[120:123], a[64:67], v[132:135], v[120:123]
    s_xor_b32 s34, s0, s82
    s_add_u32 m0, s68, 147456
    ds_read_b128 v[128:131], v192 offset:49152
    v_mfma_f32_16x16x32_bf16 v[124:127], a[68:71], v[132:135], v[124:127]
    s_waitcnt lgkmcnt(9)
    buffer_load_dwordx4 v222, s[48:51], s34 offen sc1 lds
    v_mfma_f32_16x16x32_bf16 v[80:83], a[72:75], v[136:139], v[80:83]
    ds_read_b128 v[132:135], v192 offset:50176
    v_mfma_f32_16x16x32_bf16 v[84:87], a[76:79], v[136:139], v[84:87]
    v_mfma_f32_16x16x32_bf16 v[88:91], a[72:75], v[140:143], v[88:91]
    ds_read_b128 v[136:139], v192 offset:51200
    v_mfma_f32_16x16x32_bf16 v[92:95], a[76:79], v[140:143], v[92:95]
    s_waitcnt lgkmcnt(9)
    buffer_load_dwordx4 v216, s[48:51], s34 offen offset:1024 sc1 lds
    v_mfma_f32_16x16x32_bf16 v[96:99], a[72:75], v[144:147], v[96:99]
    ds_read_b128 v[140:143], v192 offset:52224
    v_mfma_f32_16x16x32_bf16 v[100:103], a[76:79], v[144:147], v[100:103]
    v_mfma_f32_16x16x32_bf16 v[104:107], a[72:75], v[148:151], v[104:107]
    s_xor_b32 s34, s0, s83
    s_add_u32 m0, s68, 155648
    ds_read_b128 v[144:147], v192 offset:53248
    v_mfma_f32_16x16x32_bf16 v[108:111], a[76:79], v[148:151], v[108:111]
    s_waitcnt lgkmcnt(9)
    buffer_load_dwordx4 v222, s[48:51], s34 offen sc1 lds
    v_mfma_f32_16x16x32_bf16 v[112:115], a[72:75], v[152:155], v[112:115]
    ds_read_b128 v[148:151], v192 offset:54272
    v_mfma_f32_16x16x32_bf16 v[116:119], a[76:79], v[152:155], v[116:119]
    v_mfma_f32_16x16x32_bf16 v[120:123], a[72:75], v[156:159], v[120:123]
    ds_read_b128 v[152:155], v192 offset:55296
    v_mfma_f32_16x16x32_bf16 v[124:127], a[76:79], v[156:159], v[124:127]
    s_waitcnt lgkmcnt(9)
    buffer_load_dwordx4 v216, s[48:51], s34 offen offset:1024 sc1 lds
    v_mfma_f32_16x16x32_bf16 v[80:83], a[80:83], v[160:163], v[80:83]
    ds_read_b128 v[156:159], v192 offset:56320
    v_mfma_f32_16x16x32_bf16 v[84:87], a[84:87], v[160:163], v[84:87]
    v_mfma_f32_16x16x32_bf16 v[88:91], a[80:83], v[164:167], v[88:91]
    s_xor_b32 s34, s0, s63
    s_add_u32 m0, s68, 57344
    v_mfma_f32_16x16x32_bf16 v[92:95], a[84:87], v[164:167], v[92:95]
    s_waitcnt lgkmcnt(8)
    buffer_load_dwordx4 v222, s[48:51], s34 offen sc1 lds
    v_mfma_f32_16x16x32_bf16 v[96:99], a[80:83], v[168:171], v[96:99]
    v_mfma_f32_16x16x32_bf16 v[100:103], a[84:87], v[168:171], v[100:103]
    v_mfma_f32_16x16x32_bf16 v[104:107], a[80:83], v[172:175], v[104:107]
    v_mfma_f32_16x16x32_bf16 v[108:111], a[84:87], v[172:175], v[108:111]
    s_waitcnt lgkmcnt(6)
    buffer_load_dwordx4 v216, s[48:51], s34 offen offset:1024 sc1 lds
    v_mfma_f32_16x16x32_bf16 v[112:115], a[80:83], v[128:131], v[112:115]
    s_waitcnt vmcnt(14) lgkmcnt(0)
    v_mfma_f32_16x16x32_bf16 v[116:119], a[84:87], v[128:131], v[116:119]
    s_barrier
    v_mfma_f32_16x16x32_bf16 v[120:123], a[80:83], v[132:135], v[120:123]
    ds_read_b128 v[160:163], v193 offset:0
    v_mfma_f32_16x16x32_bf16 v[124:127], a[84:87], v[132:135], v[124:127]
    s_waitcnt lgkmcnt(5)
    ds_read_b128 v[164:167], v193 offset:1024
    v_mfma_f32_16x16x32_bf16 v[80:83], a[88:91], v[136:139], v[80:83]
    ds_read_b128 v[168:171], v193 offset:6144
    v_mfma_f32_16x16x32_bf16 v[84:87], a[92:95], v[136:139], v[84:87]
    ds_read_b128 v[172:175], v193 offset:7168
    v_mfma_f32_16x16x32_bf16 v[88:91], a[88:91], v[140:143], v[88:91]
    ds_read_b128 v[128:131], v193 offset:12288
    v_mfma_f32_16x16x32_bf16 v[92:95], a[92:95], v[140:143], v[92:95]
    s_waitcnt lgkmcnt(7)
    ds_read_b128 v[132:135], v193 offset:13312
    v_mfma_f32_16x16x32_bf16 v[96:99], a[88:91], v[144:147], v[96:99]
    ds_read_b128 v[136:139], v193 offset:18432
    v_mfma_f32_16x16x32_bf16 v[100:103], a[92:95], v[144:147], v[100:103]
    ds_read_b128 v[140:143], v193 offset:19456
    v_mfma_f32_16x16x32_bf16 v[104:107], a[88:91], v[148:151], v[104:107]
    ds_read_b128 v[144:147], v193 offset:2048
    v_mfma_f32_16x16x32_bf16 v[108:111], a[92:95], v[148:151], v[108:111]
    s_waitcnt lgkmcnt(9)
    v_mfma_f32_16x16x32_bf16 v[112:115], a[88:91], v[152:155], v[112:115]
    ds_read_b128 v[148:151], v193 offset:3072
    v_mfma_f32_16x16x32_bf16 v[116:119], a[92:95], v[152:155], v[116:119]
    v_mfma_f32_16x16x32_bf16 v[120:123], a[88:91], v[156:159], v[120:123]
    ds_read_b128 v[152:155], v193 offset:8192
    v_mfma_f32_16x16x32_bf16 v[124:127], a[92:95], v[156:159], v[124:127]
    s_waitcnt vmcnt(10) lgkmcnt(9)
    v_mfma_f32_16x16x32_bf16 v[80:83], a[96:99], v[160:163], v[80:83]
    ds_read_b128 v[156:159], v193 offset:9216
    v_mfma_f32_16x16x32_bf16 v[84:87], a[100:103], v[160:163], v[84:87]
    v_mfma_f32_16x16x32_bf16 v[88:91], a[96:99], v[164:167], v[88:91]
    ds_read_b128 v[160:163], v193 offset:14336
    v_mfma_f32_16x16x32_bf16 v[92:95], a[100:103], v[164:167], v[92:95]
    s_waitcnt lgkmcnt(9)
    v_mfma_f32_16x16x32_bf16 v[80:83], a[104:107], v[168:171], v[80:83]
    ds_read_b128 v[164:167], v193 offset:15360
    v_mfma_f32_16x16x32_bf16 v[84:87], a[108:111], v[168:171], v[84:87]
    v_mfma_f32_16x16x32_bf16 v[88:91], a[104:107], v[172:175], v[88:91]
    ds_read_b128 v[168:171], v193 offset:20480
    v_mfma_f32_16x16x32_bf16 v[92:95], a[108:111], v[172:175], v[92:95]
    s_waitcnt lgkmcnt(9)
    v_mfma_f32_16x16x32_bf16 v[80:83], a[112:115], v[128:131], v[80:83]
    ds_read_b128 v[172:175], v193 offset:21504
    v_mfma_f32_16x16x32_bf16 v[84:87], a[116:119], v[128:131], v[84:87]
    v_mfma_f32_16x16x32_bf16 v[88:91], a[112:115], v[132:135], v[88:91]
    ds_read_b128 v[128:131], v193 offset:4096
    v_mfma_f32_16x16x32_bf16 v[92:95], a[116:119], v[132:135], v[92:95]
    s_waitcnt lgkmcnt(9)
    v_mfma_f32_16x16x32_bf16 v[80:83], a[120:123], v[136:139], v[80:83]
    ds_read_b128 v[132:135], v193 offset:5120
    v_mfma_f32_16x16x32_bf16 v[84:87], a[124:127], v[136:139], v[84:87]
    v_mfma_f32_16x16x32_bf16 v[88:91], a[120:123], v[140:143], v[88:91]
    ds_read_b128 v[136:139], v193 offset:10240
    v_mfma_f32_16x16x32_bf16 v[92:95], a[124:127], v[140:143], v[92:95]
    s_waitcnt lgkmcnt(9)
    v_mfma_f32_16x16x32_bf16 v[96:99], a[96:99], v[144:147], v[96:99]
    ds_read_b128 v[140:143], v193 offset:11264
    v_mfma_f32_16x16x32_bf16 v[100:103], a[100:103], v[144:147], v[100:103]
    v_mfma_f32_16x16x32_bf16 v[104:107], a[96:99], v[148:151], v[104:107]
    ds_read_b128 v[144:147], v193 offset:16384
    v_mfma_f32_16x16x32_bf16 v[108:111], a[100:103], v[148:151], v[108:111]
    s_waitcnt lgkmcnt(9)
    v_mfma_f32_16x16x32_bf16 v[96:99], a[104:107], v[152:155], v[96:99]
    s_add_u32 s42, s98, 4096
    ds_read_b128 v[148:151], v193 offset:17408
    v_cvt_pk_bf16_f32 v80, v80, v81
    v_mfma_f32_16x16x32_bf16 v[100:103], a[108:111], v[152:155], v[100:103]
    v_cvt_pk_bf16_f32 v81, v82, v83
    v_cvt_pk_bf16_f32 v82, v84, v85
    v_mfma_f32_16x16x32_bf16 v[104:107], a[104:107], v[156:159], v[104:107]
    ds_read_b128 v[152:155], v193 offset:22528
    v_cvt_pk_bf16_f32 v83, v86, v87
    v_mfma_f32_16x16x32_bf16 v[108:111], a[108:111], v[156:159], v[108:111]
    s_waitcnt lgkmcnt(9)
    buffer_store_dwordx4 v[80:83], v222, s[48:51], s42 offen offset:0 sc1
    v_mfma_f32_16x16x32_bf16 v[96:99], a[112:115], v[160:163], v[96:99]
    ds_read_b128 v[156:159], v193 offset:23552
    v_cvt_pk_bf16_f32 v84, v88, v89
    v_mfma_f32_16x16x32_bf16 v[100:103], a[116:119], v[160:163], v[100:103]
    v_cvt_pk_bf16_f32 v85, v90, v91
    v_cvt_pk_bf16_f32 v86, v92, v93
    v_mfma_f32_16x16x32_bf16 v[104:107], a[112:115], v[164:167], v[104:107]
    v_cvt_pk_bf16_f32 v87, v94, v95
    v_mfma_f32_16x16x32_bf16 v[108:111], a[116:119], v[164:167], v[108:111]
    s_waitcnt lgkmcnt(8)
    buffer_store_dwordx4 v[84:87], v222, s[48:51], s42 offen offset:1024 sc1
    v_mfma_f32_16x16x32_bf16 v[96:99], a[120:123], v[168:171], v[96:99]
    v_mfma_f32_16x16x32_bf16 v[100:103], a[124:127], v[168:171], v[100:103]
    v_mfma_f32_16x16x32_bf16 v[104:107], a[120:123], v[172:175], v[104:107]
    v_mfma_f32_16x16x32_bf16 v[108:111], a[124:127], v[172:175], v[108:111]
    s_waitcnt lgkmcnt(6)
    v_mfma_f32_16x16x32_bf16 v[112:115], a[96:99], v[128:131], v[112:115]
    s_waitcnt vmcnt(2) lgkmcnt(0)
    v_mfma_f32_16x16x32_bf16 v[116:119], a[100:103], v[128:131], v[116:119]
    s_barrier
    v_mfma_f32_16x16x32_bf16 v[120:123], a[96:99], v[132:135], v[120:123]
    ds_read_b128 v[160:163], v193 offset:32768
    v_mfma_f32_16x16x32_bf16 v[124:127], a[100:103], v[132:135], v[124:127]
    s_waitcnt lgkmcnt(5)
    ds_read_b128 v[164:167], v193 offset:33792
    v_mfma_f32_16x16x32_bf16 v[112:115], a[104:107], v[136:139], v[112:115]
    ds_read_b128 v[168:171], v193 offset:34816
    v_mfma_f32_16x16x32_bf16 v[116:119], a[108:111], v[136:139], v[116:119]
    s_add_u32 s42, s98, 8192
    ds_read_b128 v[172:175], v193 offset:35840
    v_cvt_pk_bf16_f32 v96, v96, v97
    v_mfma_f32_16x16x32_bf16 v[120:123], a[104:107], v[140:143], v[120:123]
    ds_read_b128 v[128:131], v193 offset:36864
    v_cvt_pk_bf16_f32 v97, v98, v99
    v_mfma_f32_16x16x32_bf16 v[124:127], a[108:111], v[140:143], v[124:127]
    s_waitcnt lgkmcnt(7)
    ds_read_b128 v[132:135], v193 offset:37888
    v_cvt_pk_bf16_f32 v98, v100, v101
    v_mfma_f32_16x16x32_bf16 v[112:115], a[112:115], v[144:147], v[112:115]
    ds_read_b128 v[136:139], v193 offset:38912
    v_cvt_pk_bf16_f32 v99, v102, v103
    v_mfma_f32_16x16x32_bf16 v[116:119], a[116:119], v[144:147], v[116:119]
    ds_read_b128 v[140:143], v193 offset:39936
    v_mfma_f32_16x16x32_bf16 v[120:123], a[112:115], v[148:151], v[120:123]
    ds_read_b128 v[144:147], v193 offset:40960
    v_mfma_f32_16x16x32_bf16 v[124:127], a[116:119], v[148:151], v[124:127]
    s_waitcnt lgkmcnt(9)
    buffer_store_dwordx4 v[96:99], v222, s[48:51], s42 offen offset:0 sc1
    v_mfma_f32_16x16x32_bf16 v[112:115], a[120:123], v[152:155], v[112:115]
    ds_read_b128 v[148:151], v193 offset:41984
    v_cvt_pk_bf16_f32 v100, v104, v105
    v_mfma_f32_16x16x32_bf16 v[116:119], a[124:127], v[152:155], v[116:119]
    v_cvt_pk_bf16_f32 v101, v106, v107
    v_cvt_pk_bf16_f32 v102, v108, v109
    v_mfma_f32_16x16x32_bf16 v[120:123], a[120:123], v[156:159], v[120:123]
    ds_read_b128 v[152:155], v193 offset:43008
    v_cvt_pk_bf16_f32 v103, v110, v111
    v_mfma_f32_16x16x32_bf16 v[124:127], a[124:127], v[156:159], v[124:127]
    s_waitcnt lgkmcnt(9)
    buffer_store_dwordx4 v[100:103], v222, s[48:51], s42 offen offset:1024 sc1
    v_mfma_f32_16x16x32_bf16 v[64:67], a[224:227], v[160:163], v[64:67]
    ds_read_b128 v[156:159], v193 offset:44032
    v_mfma_f32_16x16x32_bf16 v[68:71], a[228:231], v[160:163], v[68:71]
    v_mfma_f32_16x16x32_bf16 v[72:75], a[224:227], v[164:167], v[72:75]
    ds_read_b128 v[160:163], v193 offset:45056
    v_mfma_f32_16x16x32_bf16 v[76:79], a[228:231], v[164:167], v[76:79]
    s_waitcnt lgkmcnt(9)
    v_mfma_f32_16x16x32_bf16 v[64:67], a[232:235], v[168:171], v[64:67]
    ds_read_b128 v[164:167], v193 offset:46080
    v_mfma_f32_16x16x32_bf16 v[68:71], a[236:239], v[168:171], v[68:71]
    s_add_u32 s42, s98, 12288
    v_cvt_pk_bf16_f32 v112, v112, v113
    v_cvt_pk_bf16_f32 v113, v114, v115
    v_mfma_f32_16x16x32_bf16 v[72:75], a[232:235], v[172:175], v[72:75]
    ds_read_b128 v[168:171], v193 offset:47104
    v_cvt_pk_bf16_f32 v114, v116, v117
    v_mfma_f32_16x16x32_bf16 v[76:79], a[236:239], v[172:175], v[76:79]
    s_waitcnt lgkmcnt(9)
    v_cvt_pk_bf16_f32 v115, v118, v119
    v_mfma_f32_16x16x32_bf16 v[64:67], a[240:243], v[128:131], v[64:67]
    ds_read_b128 v[172:175], v193 offset:48128
    v_mfma_f32_16x16x32_bf16 v[68:71], a[244:247], v[128:131], v[68:71]
    buffer_store_dwordx4 v[112:115], v222, s[48:51], s42 offen offset:0 sc1
    v_mfma_f32_16x16x32_bf16 v[72:75], a[240:243], v[132:135], v[72:75]
    ds_read_b128 v[128:131], v193 offset:49152
    v_cvt_pk_bf16_f32 v116, v120, v121
    v_mfma_f32_16x16x32_bf16 v[76:79], a[244:247], v[132:135], v[76:79]
    s_waitcnt lgkmcnt(9)
    v_cvt_pk_bf16_f32 v117, v122, v123
    v_cvt_pk_bf16_f32 v118, v124, v125
    v_mfma_f32_16x16x32_bf16 v[64:67], a[248:251], v[136:139], v[64:67]
    ds_read_b128 v[132:135], v193 offset:50176
    v_cvt_pk_bf16_f32 v119, v126, v127
    v_mfma_f32_16x16x32_bf16 v[68:71], a[252:255], v[136:139], v[68:71]
    buffer_store_dwordx4 v[116:119], v222, s[48:51], s42 offen offset:1024 sc1
    v_mfma_f32_16x16x32_bf16 v[72:75], a[248:251], v[140:143], v[72:75]
    s_xor_b32 s53, s98, 65536
    s_add_u32 s53, s53, 4096
    ds_read_b128 v[136:139], v193 offset:51200
    v_mfma_f32_16x16x32_bf16 v[76:79], a[252:255], v[140:143], v[76:79]
    s_waitcnt lgkmcnt(9)
    v_mfma_f32_16x16x32_bf16 v[64:67], a[0:3], v[144:147], v[64:67]
    s_xor_b32 s54, s98, 131072
    s_add_u32 s54, s54, 8192
    ds_read_b128 v[140:143], v193 offset:52224
    v_mfma_f32_16x16x32_bf16 v[68:71], a[4:7], v[144:147], v[68:71]
    s_xor_b32 s55, s98, 196608
    s_add_u32 s55, s55, 12288
    v_mfma_f32_16x16x32_bf16 v[72:75], a[0:3], v[148:151], v[72:75]
    ds_read_b128 v[144:147], v193 offset:53248
    v_mfma_f32_16x16x32_bf16 v[76:79], a[4:7], v[148:151], v[76:79]
    s_waitcnt lgkmcnt(9)
    v_mfma_f32_16x16x32_bf16 v[64:67], a[8:11], v[152:155], v[64:67]
    ds_read_b128 v[148:151], v193 offset:54272
    v_mfma_f32_16x16x32_bf16 v[68:71], a[12:15], v[152:155], v[68:71]
    v_mfma_f32_16x16x32_bf16 v[72:75], a[8:11], v[156:159], v[72:75]
    ds_read_b128 v[152:155], v193 offset:55296
    v_mfma_f32_16x16x32_bf16 v[76:79], a[12:15], v[156:159], v[76:79]
    s_waitcnt lgkmcnt(9)
    v_mfma_f32_16x16x32_bf16 v[64:67], a[16:19], v[160:163], v[64:67]
    ds_read_b128 v[156:159], v193 offset:56320
    v_mfma_f32_16x16x32_bf16 v[68:71], a[20:23], v[160:163], v[68:71]
    v_mfma_f32_16x16x32_bf16 v[72:75], a[16:19], v[164:167], v[72:75]
    ds_read_b128 v[160:163], v193 offset:57344
    v_mfma_f32_16x16x32_bf16 v[76:79], a[20:23], v[164:167], v[76:79]
    s_waitcnt lgkmcnt(9)
    v_mfma_f32_16x16x32_bf16 v[64:67], a[24:27], v[168:171], v[64:67]
    ds_read_b128 v[164:167], v193 offset:58368
    v_mfma_f32_16x16x32_bf16 v[68:71], a[28:31], v[168:171], v[68:71]
    v_mfma_f32_16x16x32_bf16 v[72:75], a[24:27], v[172:175], v[72:75]
    ds_read_b128 v[168:171], v193 offset:59392
    v_mfma_f32_16x16x32_bf16 v[76:79], a[28:31], v[172:175], v[76:79]
    s_waitcnt lgkmcnt(9)
    v_mfma_f32_16x16x32_bf16 v[64:67], a[32:35], v[128:131], v[64:67]
    ds_read_b128 v[172:175], v193 offset:60416
    v_mfma_f32_16x16x32_bf16 v[68:71], a[36:39], v[128:131], v[68:71]
    v_mfma_f32_16x16x32_bf16 v[72:75], a[32:35], v[132:135], v[72:75]
    ds_read_b128 v[128:131], v193 offset:61440
    v_mfma_f32_16x16x32_bf16 v[76:79], a[36:39], v[132:135], v[76:79]
    s_waitcnt lgkmcnt(9)
    v_mfma_f32_16x16x32_bf16 v[64:67], a[40:43], v[136:139], v[64:67]
    ds_read_b128 v[132:135], v193 offset:62464
    v_mfma_f32_16x16x32_bf16 v[68:71], a[44:47], v[136:139], v[68:71]
    v_mfma_f32_16x16x32_bf16 v[72:75], a[40:43], v[140:143], v[72:75]
    ds_read_b128 v[136:139], v193 offset:63488
    v_mfma_f32_16x16x32_bf16 v[76:79], a[44:47], v[140:143], v[76:79]
    s_waitcnt lgkmcnt(9)
    v_mfma_f32_16x16x32_bf16 v[64:67], a[48:51], v[144:147], v[64:67]
    ds_read_b128 v[140:143], v193 offset:64512
    v_mfma_f32_16x16x32_bf16 v[68:71], a[52:55], v[144:147], v[68:71]
    v_mfma_f32_16x16x32_bf16 v[72:75], a[48:51], v[148:151], v[72:75]
    ds_read_b128 v[144:147], v192 offset:24576
    v_mfma_f32_16x16x32_bf16 v[76:79], a[52:55], v[148:151], v[76:79]
    s_waitcnt lgkmcnt(9)
    v_mfma_f32_16x16x32_bf16 v[64:67], a[56:59], v[152:155], v[64:67]
    ds_read_b128 v[148:151], v192 offset:25600
    v_mfma_f32_16x16x32_bf16 v[68:71], a[60:63], v[152:155], v[68:71]
    buffer_load_dwordx4 v[88:91], v222, s[48:51], s53 offen offset:0 sc1
    v_mfma_f32_16x16x32_bf16 v[72:75], a[56:59], v[156:159], v[72:75]
    ds_read_b128 v[152:155], v192 offset:26624
    v_mfma_f32_16x16x32_bf16 v[76:79], a[60:63], v[156:159], v[76:79]
    s_waitcnt lgkmcnt(9)
    buffer_load_dwordx4 v[92:95], v222, s[48:51], s53 offen offset:1024 sc1
    v_mfma_f32_16x16x32_bf16 v[64:67], a[64:67], v[160:163], v[64:67]
    ds_read_b128 v[156:159], v192 offset:27648
    v_mfma_f32_16x16x32_bf16 v[68:71], a[68:71], v[160:163], v[68:71]
    buffer_load_dwordx4 v[104:107], v222, s[48:51], s54 offen offset:0 sc1
    v_mfma_f32_16x16x32_bf16 v[72:75], a[64:67], v[164:167], v[72:75]
    ds_read_b128 v[160:163], v192 offset:28672
    v_mfma_f32_16x16x32_bf16 v[76:79], a[68:71], v[164:167], v[76:79]
    s_waitcnt lgkmcnt(9)
    buffer_load_dwordx4 v[108:111], v222, s[48:51], s54 offen offset:1024 sc1
    v_mfma_f32_16x16x32_bf16 v[64:67], a[72:75], v[168:171], v[64:67]
    ds_read_b128 v[164:167], v192 offset:29696
    v_mfma_f32_16x16x32_bf16 v[68:71], a[76:79], v[168:171], v[68:71]
    buffer_load_dwordx4 v[120:123], v222, s[48:51], s55 offen offset:0 sc1
    v_mfma_f32_16x16x32_bf16 v[72:75], a[72:75], v[172:175], v[72:75]
    ds_read_b128 v[168:171], v192 offset:30720
    v_mfma_f32_16x16x32_bf16 v[76:79], a[76:79], v[172:175], v[76:79]
    s_waitcnt lgkmcnt(9)
    buffer_load_dwordx4 v[124:127], v222, s[48:51], s55 offen offset:1024 sc1
    v_mfma_f32_16x16x32_bf16 v[64:67], a[80:83], v[128:131], v[64:67]
    ds_read_b128 v[172:175], v192 offset:31744
    v_mfma_f32_16x16x32_bf16 v[68:71], a[84:87], v[128:131], v[68:71]
    v_mfma_f32_16x16x32_bf16 v[72:75], a[80:83], v[132:135], v[72:75]
    v_mfma_f32_16x16x32_bf16 v[76:79], a[84:87], v[132:135], v[76:79]
    s_waitcnt lgkmcnt(8)
    v_mfma_f32_16x16x32_bf16 v[64:67], a[88:91], v[136:139], v[64:67]
    v_mfma_f32_16x16x32_bf16 v[68:71], a[92:95], v[136:139], v[68:71]
    v_mfma_f32_16x16x32_bf16 v[72:75], a[88:91], v[140:143], v[72:75]
    v_mfma_f32_16x16x32_bf16 v[76:79], a[92:95], v[140:143], v[76:79]
    s_waitcnt lgkmcnt(6)
    v_mfma_f32_16x16x32_bf16 v[64:67], a[96:99], v[144:147], v[64:67]
    v_mfma_f32_16x16x32_bf16 v[68:71], a[100:103], v[144:147], v[68:71]
    v_mfma_f32_16x16x32_bf16 v[72:75], a[96:99], v[148:151], v[72:75]
    v_mfma_f32_16x16x32_bf16 v[76:79], a[100:103], v[148:151], v[76:79]
    s_waitcnt lgkmcnt(4)
    v_mfma_f32_16x16x32_bf16 v[64:67], a[104:107], v[152:155], v[64:67]
    v_mfma_f32_16x16x32_bf16 v[68:71], a[108:111], v[152:155], v[68:71]
    v_mfma_f32_16x16x32_bf16 v[72:75], a[104:107], v[156:159], v[72:75]
    v_mfma_f32_16x16x32_bf16 v[76:79], a[108:111], v[156:159], v[76:79]
    s_waitcnt lgkmcnt(2)
    v_mfma_f32_16x16x32_bf16 v[64:67], a[112:115], v[160:163], v[64:67]
    v_mfma_f32_16x16x32_bf16 v[68:71], a[116:119], v[160:163], v[68:71]
    v_mfma_f32_16x16x32_bf16 v[72:75], a[112:115], v[164:167], v[72:75]
    v_mfma_f32_16x16x32_bf16 v[76:79], a[116:119], v[164:167], v[76:79]
    s_waitcnt lgkmcnt(0)
    v_mfma_f32_16x16x32_bf16 v[64:67], a[120:123], v[168:171], v[64:67]
    v_mfma_f32_16x16x32_bf16 v[68:71], a[124:127], v[168:171], v[68:71]
    v_mfma_f32_16x16x32_bf16 v[72:75], a[120:123], v[172:175], v[72:75]
    v_mfma_f32_16x16x32_bf16 v[76:79], a[124:127], v[172:175], v[76:79]
    s_waitcnt vmcnt(0)
    s_branch F_FIN
F_RB9:
    s_and_b32 s42, s86, 0xffff0000
    s_xor_b32 s54, s42, 0x80000000
    s_xor_b32 s55, s42, 0xffff0000
    s_bitcmp1_b32 s42, 31
    s_cselect_b32 s42, s54, s55
    v_mov_b32 v16, s42
    v_mul_f32 v16, s36, v16
    v_exp_f32 v16, v16
    v_add_f32_dpp v0, v176, v176 quad_perm:[1,0,3,2] row_mask:0xf bank_mask:0xf
    v_add_f32_dpp v1, v180, v180 quad_perm:[1,0,3,2] row_mask:0xf bank_mask:0xf
    v_add_f32_dpp v2, v177, v177 quad_perm:[1,0,3,2] row_mask:0xf bank_mask:0xf
    v_add_f32_dpp v3, v181, v181 quad_perm:[1,0,3,2] row_mask:0xf bank_mask:0xf
    v_add_f32_dpp v4, v178, v178 quad_perm:[1,0,3,2] row_mask:0xf bank_mask:0xf
    v_add_f32_dpp v5, v182, v182 quad_perm:[1,0,3,2] row_mask:0xf bank_mask:0xf
    v_add_f32_dpp v6, v179, v179 quad_perm:[1,0,3,2] row_mask:0xf bank_mask:0xf
    v_add_f32_dpp v7, v183, v183 quad_perm:[1,0,3,2] row_mask:0xf bank_mask:0xf
    v_add_f32_dpp v0, v0, v0 quad_perm:[2,3,0,1] row_mask:0xf bank_mask:0xf
    v_add_f32_dpp v1, v1, v1 quad_perm:[2,3,0,1] row_mask:0xf bank_mask:0xf
    v_add_f32_dpp v2, v2, v2 quad_perm:[2,3,0,1] row_mask:0xf bank_mask:0xf
    v_add_f32_dpp v3, v3, v3 quad_perm:[2,3,0,1] row_mask:0xf bank_mask:0xf
    v_add_f32_dpp v4, v4, v4 quad_perm:[2,3,0,1] row_mask:0xf bank_mask:0xf
    v_add_f32_dpp v5, v5, v5 quad_perm:[2,3,0,1] row_mask:0xf bank_mask:0xf
    v_add_f32_dpp v6, v6, v6 quad_perm:[2,3,0,1] row_mask:0xf bank_mask:0xf
    v_add_f32_dpp v7, v7, v7 quad_perm:[2,3,0,1] row_mask:0xf bank_mask:0xf
    v_add_f32_dpp v0, v0, v0 row_half_mirror row_mask:0xf bank_mask:0xf
    v_add_f32_dpp v1, v1, v1 row_half_mirror row_mask:0xf bank_mask:0xf
    v_add_f32_dpp v2, v2, v2 row_half_mirror row_mask:0xf bank_mask:0xf
    v_add_f32_dpp v3, v3, v3 row_half_mirror row_mask:0xf bank_mask:0xf
    v_add_f32_dpp v4, v4, v4 row_half_mirror row_mask:0xf bank_mask:0xf
    v_add_f32_dpp v5, v5, v5 row_half_mirror row_mask:0xf bank_mask:0xf
    v_add_f32_dpp v6, v6, v6 row_half_mirror row_mask:0xf bank_mask:0xf
    v_add_f32_dpp v7, v7, v7 row_half_mirror row_mask:0xf bank_mask:0xf
    v_add_f32_dpp v0, v0, v0 row_mirror row_mask:0xf bank_mask:0xf
    v_add_f32_dpp v1, v1, v1 row_mirror row_mask:0xf bank_mask:0xf
    v_add_f32_dpp v2, v2, v2 row_mirror row_mask:0xf bank_mask:0xf
    v_add_f32_dpp v3, v3, v3 row_mirror row_mask:0xf bank_mask:0xf
    v_add_f32_dpp v4, v4, v4 row_mirror row_mask:0xf bank_mask:0xf
    v_add_f32_dpp v5, v5, v5 row_mirror row_mask:0xf bank_mask:0xf
    v_add_f32_dpp v6, v6, v6 row_mirror row_mask:0xf bank_mask:0xf
    v_add_f32_dpp v7, v7, v7 row_mirror row_mask:0xf bank_mask:0xf
    v_add_f32 v16, 1.0, v16
    v_rcp_f32 v16, v16
    s_bfe_u32 s42, s87, 0x4000a
    s_mov_b32 s54, 0x00010001
    s_lshl_b32 s54, s54, s42
    s_mov_b32 s55, s54
    v_cvt_pk_bf16_f32 v16, v16, v16
    v_lshlrev_b32 v16, 16, v16
    v_cvt_pk_bf16_f32 v8, v0, v1
    v_cvt_pk_bf16_f32 v9, v2, v3
    v_cvt_pk_bf16_f32 v10, v4, v5
    v_cvt_pk_bf16_f32 v11, v6, v7
    v_lshlrev_b32 v0, 16, v8
    v_and_b32 v1, 0xffff0000, v8
    v_lshlrev_b32 v2, 16, v9
    v_and_b32 v3, 0xffff0000, v9
    v_lshlrev_b32 v4, 16, v10
    v_and_b32 v5, 0xffff0000, v10
    v_lshlrev_b32 v6, 16, v11
    v_and_b32 v7, 0xffff0000, v11
    v_mul_f32 v0, v0, v16
    v_mul_f32 v1, v1, v16
    v_mul_f32 v2, v2, v16
    v_mul_f32 v3, v3, v16
    v_mul_f32 v4, v4, v16
    v_mul_f32 v5, v5, v16
    v_mul_f32 v6, v6, v16
    v_mul_f32 v7, v7, v16
    v_cvt_pk_bf16_f32 v8, v0, v1
    v_cvt_pk_bf16_f32 v9, v2, v3
    v_cvt_pk_bf16_f32 v10, v4, v5
    v_cvt_pk_bf16_f32 v11, v6, v7
    v_lshlrev_b32 v0, 16, v8
    v_and_b32 v1, 0xffff0000, v8
    v_lshlrev_b32 v2, 16, v9
    v_and_b32 v3, 0xffff0000, v9
    v_lshlrev_b32 v4, 16, v10
    v_and_b32 v5, 0xffff0000, v10
    v_lshlrev_b32 v6, 16, v11
    v_and_b32 v7, 0xffff0000, v11
    s_bitcmp0_b32 s87, 14
    s_cselect_b64 exec, s[54:55], 0
    v_lshlrev_b32 v8, 16, v184
    v_and_b32 v9, 0xffff0000, v184
    v_lshlrev_b32 v10, 16, v185
    v_and_b32 v11, 0xffff0000, v185
    v_lshlrev_b32 v12, 16, v186
    v_and_b32 v13, 0xffff0000, v186
    v_lshlrev_b32 v14, 16, v187
    v_and_b32 v15, 0xffff0000, v187
    v_add_f32 v8, v8, v0
    v_add_f32 v9, v9, v1
    v_add_f32 v10, v10, v2
    v_add_f32 v11, v11, v3
    v_add_f32 v12, v12, v4
    v_add_f32 v13, v13, v5
    v_add_f32 v14, v14, v6
    v_add_f32 v15, v15, v7
    v_cvt_pk_bf16_f32 v184, v8, v9
    v_cvt_pk_bf16_f32 v185, v10, v11
    v_cvt_pk_bf16_f32 v186, v12, v13
    v_cvt_pk_bf16_f32 v187, v14, v15
    s_bitcmp1_b32 s87, 14
    s_cselect_b64 exec, s[54:55], 0
    v_lshlrev_b32 v8, 16, v188
    v_and_b32 v9, 0xffff0000, v188
    v_lshlrev_b32 v10, 16, v189
    v_and_b32 v11, 0xffff0000, v189
    v_lshlrev_b32 v12, 16, v190
    v_and_b32 v13, 0xffff0000, v190
    v_lshlrev_b32 v14, 16, v191
    v_and_b32 v15, 0xffff0000, v191
    v_add_f32 v8, v8, v0
    v_add_f32 v9, v9, v1
    v_add_f32 v10, v10, v2
    v_add_f32 v11, v11, v3
    v_add_f32 v12, v12, v4
    v_add_f32 v13, v13, v5
    v_add_f32 v14, v14, v6
    v_add_f32 v15, v15, v7
    v_cvt_pk_bf16_f32 v188, v8, v9
    v_cvt_pk_bf16_f32 v189, v10, v11
    v_cvt_pk_bf16_f32 v190, v12, v13
    v_cvt_pk_bf16_f32 v191, v14, v15
    s_mov_b64 exec, -1
    s_branch F_RBB9
F_W3_9:
    s_mov_b32 s67, 200000
F_W3_9L:
    s_lshr_b32 s43, s77, 7
    s_load_dwordx2 s[72:73], s[70:71], s43 glc
    s_add_u32 s66, s66, 524288
    s_waitcnt lgkmcnt(0)
    s_cmp_eq_u64 s[72:73], s[64:65]
    s_cbranch_scc1 F_WB3_9
    s_sub_u32 s67, s67, 1
    s_cmp_lg_u32 s67, 0
    s_cbranch_scc1 F_W3_9L
    s_branch F_WB3_9
F_W4_9:
    s_mov_b32 s67, 200000
F_W4_9L:
    s_lshr_b32 s43, s78, 7
    s_load_dwordx2 s[72:73], s[70:71], s43 glc
    s_add_u32 s66, s66, 524288
    s_waitcnt lgkmcnt(0)
    s_cmp_eq_u64 s[72:73], s[64:65]
    s_cbranch_scc1 F_WB4_9
    s_sub_u32 s67, s67, 1
    s_cmp_lg_u32 s67, 0
    s_cbranch_scc1 F_W4_9L
    s_branch F_WB4_9
F_W5_9:
    s_mov_b32 s67, 200000
F_W5_9L:
    s_lshr_b32 s43, s79, 7
    s_load_dwordx2 s[72:73], s[70:71], s43 glc
    s_add_u32 s66, s66, 524288
    s_waitcnt lgkmcnt(0)
    s_cmp_eq_u64 s[72:73], s[64:65]
    s_cbranch_scc1 F_WB5_9
    s_sub_u32 s67, s67, 1
    s_cmp_lg_u32 s67, 0
    s_cbranch_scc1 F_W5_9L
    s_branch F_WB5_9
F_W6_9:
    s_mov_b32 s67, 200000
F_W6_9L:
    s_lshr_b32 s43, s82, 7
    s_load_dwordx2 s[72:73], s[70:71], s43 glc
    s_add_u32 s66, s66, 524288
    s_waitcnt lgkmcnt(0)
    s_cmp_eq_u64 s[72:73], s[64:65]
    s_cbranch_scc1 F_WB6_9
    s_sub_u32 s67, s67, 1
    s_cmp_lg_u32 s67, 0
    s_cbranch_scc1 F_W6_9L
    s_branch F_WB6_9
F_W7_9:
    s_mov_b32 s67, 200000
F_W7_9L:
    s_lshr_b32 s43, s83, 7
    s_load_dwordx2 s[72:73], s[70:71], s43 glc
    s_add_u32 s66, s66, 524288
    s_waitcnt lgkmcnt(0)
    s_cmp_eq_u64 s[72:73], s[64:65]
    s_cbranch_scc1 F_WB7_9
    s_sub_u32 s67, s67, 1
    s_cmp_lg_u32 s67, 0
    s_cbranch_scc1 F_W7_9L
    s_branch F_WB7_9
F_W8_9:
    s_mov_b32 s67, 200000
F_W8_9L:
    s_lshr_b32 s43, s63, 7
    s_load_dwordx2 s[72:73], s[70:71], s43 glc
    s_add_u32 s66, s66, 524288
    s_waitcnt lgkmcnt(0)
    s_cmp_eq_u64 s[72:73], s[64:65]
    s_cbranch_scc1 F_WB8_9
    s_sub_u32 s67, s67, 1
    s_cmp_lg_u32 s67, 0
    s_cbranch_scc1 F_W8_9L
    s_branch F_WB8_9
F_G7:
    ds_read_b128 v[128:131], v192 offset:0
    ds_read_b128 v[132:135], v192 offset:1024
    ds_read_b128 v[136:139], v192 offset:2048
    ds_read_b128 v[140:143], v192 offset:3072
    ds_read_b128 v[144:147], v192 offset:4096
    ds_read_b128 v[148:151], v192 offset:5120
    ds_read_b128 v[152:155], v192 offset:6144
    ds_read_b128 v[156:159], v192 offset:7168
    ds_read_b128 v[160:163], v192 offset:8192
    ds_read_b128 v[164:167], v192 offset:9216
    ds_read_b128 v[168:171], v192 offset:10240
    ds_read_b128 v[172:175], v192 offset:11264
    s_waitcnt lgkmcnt(10)
    v_mfma_f32_16x16x32_bf16 v[80:83], v[224:227], v[128:131], 0
    s_xor_b32 s33, s0, s76
    s_xor_b32 s34, s33, 262144
    s_add_u32 m0, s99, 98304
    v_mfma_f32_16x16x32_bf16 v[84:87], v[228:231], v[128:131], 0
    buffer_load_dwordx4 v222, s[48:51], s34 offen sc1 lds
    v_mfma_f32_16x16x32_bf16 v[88:91], v[224:227], v[132:135], 0
    ds_read_b128 v[128:131], v192 offset:12288
    v_mfma_f32_16x16x32_bf16 v[92:95], v[228:231], v[132:135], 0
    s_waitcnt lgkmcnt(9)
    v_mfma_f32_16x16x32_bf16 v[96:99], v[224:227], v[136:139], 0
    s_lshr_b32 s43, s79, 7
    s_load_dwordx2 s[72:73], s[70:71], s43 glc
    ds_read_b128 v[132:135], v192 offset:13312
    v_mfma_f32_16x16x32_bf16 v[100:103], v[228:231], v[136:139], 0
    buffer_load_dwordx4 v216, s[48:51], s34 offen offset:1024 sc1 lds
    v_mfma_f32_16x16x32_bf16 v[104:107], v[224:227], v[140:143], 0
    ds_read_b128 v[136:139], v192 offset:14336
    v_mfma_f32_16x16x32_bf16 v[108:111], v[228:231], v[140:143], 0
    s_waitcnt lgkmcnt(9)
    v_mfma_f32_16x16x32_bf16 v[112:115], v[224:227], v[144:147], 0
    s_xor_b32 s34, s33, 525312
    s_add_u32 m0, s99, 100352
    ds_read_b128 v[140:143], v192 offset:15360
    v_mfma_f32_16x16x32_bf16 v[116:119], v[228:231], v[144:147], 0
    buffer_load_dwordx4 v222, s[48:51], s34 offen sc1 lds
    v_mfma_f32_16x16x32_bf16 v[120:123], v[224:227], v[148:151], 0
    ds_read_b128 v[144:147], v192 offset:16384
    v_mfma_f32_16x16x32_bf16 v[124:127], v[228:231], v[148:151], 0
    s_waitcnt lgkmcnt(9)
    v_mfma_f32_16x16x32_bf16 v[80:83], v[232:235], v[152:155], v[80:83]
    ds_read_b128 v[148:151], v192 offset:17408
    v_mfma_f32_16x16x32_bf16 v[84:87], v[236:239], v[152:155], v[84:87]
    buffer_load_dwordx4 v216, s[48:51], s34 offen offset:1024 sc1 lds
    v_mfma_f32_16x16x32_bf16 v[88:91], v[232:235], v[156:159], v[88:91]
    ds_read_b128 v[152:155], v192 offset:18432
    v_mfma_f32_16x16x32_bf16 v[92:95], v[236:239], v[156:159], v[92:95]
    s_waitcnt lgkmcnt(9)
    v_mfma_f32_16x16x32_bf16 v[96:99], v[232:235], v[160:163], v[96:99]
    s_xor_b32 s34, s33, 787456
    s_add_u32 m0, s99, 102400
    ds_read_b128 v[156:159], v192 offset:19456
    v_mfma_f32_16x16x32_bf16 v[100:103], v[236:239], v[160:163], v[100:103]
    buffer_load_dwordx4 v222, s[48:51], s34 offen sc1 lds
    v_mfma_f32_16x16x32_bf16 v[104:107], v[232:235], v[164:167], v[104:107]
    ds_read_b128 v[160:163], v192 offset:20480
    v_mfma_f32_16x16x32_bf16 v[108:111], v[236:239], v[164:167], v[108:111]
    s_waitcnt lgkmcnt(9)
    v_mfma_f32_16x16x32_bf16 v[112:115], v[232:235], v[168:171], v[112:115]
    ds_read_b128 v[164:167], v192 offset:21504
    v_mfma_f32_16x16x32_bf16 v[116:119], v[236:239], v[168:171], v[116:119]
    buffer_load_dwordx4 v216, s[48:51], s34 offen offset:1024 sc1 lds
    v_mfma_f32_16x16x32_bf16 v[120:123], v[232:235], v[172:175], v[120:123]
    ds_read_b128 v[168:171], v192 offset:22528
    v_mfma_f32_16x16x32_bf16 v[124:127], v[236:239], v[172:175], v[124:127]
    s_waitcnt lgkmcnt(9)
    v_mfma_f32_16x16x32_bf16 v[80:83], v[240:243], v[128:131], v[80:83]
    s_lshl1_add_u32 s31, s77, s1
    ds_read_b128 v[172:175], v192 offset:23552
    v_mfma_f32_16x16x32_bf16 v[84:87], v[244:247], v[128:131], v[84:87]
    buffer_load_dwordx4 a[160:163], v222, s[48:51], s31 offen offset:0 sc1
    v_mfma_f32_16x16x32_bf16 v[88:91], v[240:243], v[132:135], v[88:91]
    v_mfma_f32_16x16x32_bf16 v[92:95], v[244:247], v[132:135], v[92:95]
    s_waitcnt lgkmcnt(8)
    v_mfma_f32_16x16x32_bf16 v[96:99], v[240:243], v[136:139], v[96:99]
    v_mfma_f32_16x16x32_bf16 v[100:103], v[244:247], v[136:139], v[100:103]
    buffer_load_dwordx4 a[164:167], v222, s[48:51], s31 offen offset:1024 sc1
    v_mfma_f32_16x16x32_bf16 v[104:107], v[240:243], v[140:143], v[104:107]
    v_mfma_f32_16x16x32_bf16 v[108:111], v[244:247], v[140:143], v[108:111]
    s_waitcnt lgkmcnt(6)
    v_mfma_f32_16x16x32_bf16 v[112:115], v[240:243], v[144:147], v[112:115]
    s_waitcnt vmcnt(17) lgkmcnt(0)
    v_mfma_f32_16x16x32_bf16 v[116:119], v[244:247], v[144:147], v[116:119]
    s_cmp_eq_u64 s[72:73], s[64:65]
    s_cbranch_scc0 F_W3_7
F_WB3_7:
    s_barrier
    v_mfma_f32_16x16x32_bf16 v[120:123], v[240:243], v[148:151], v[120:123]
    ds_read_b128 v[128:131], v192 offset:32768
    v_mfma_f32_16x16x32_bf16 v[124:127], v[244:247], v[148:151], v[124:127]
    s_waitcnt lgkmcnt(5)
    ds_read_b128 v[132:135], v192 offset:33792
    v_mfma_f32_16x16x32_bf16 v[80:83], v[248:251], v[152:155], v[80:83]
    ds_read_b128 v[136:139], v192 offset:34816
    v_mfma_f32_16x16x32_bf16 v[84:87], v[252:255], v[152:155], v[84:87]
    ds_read_b128 v[140:143], v192 offset:35840
    v_mfma_f32_16x16x32_bf16 v[88:91], v[248:251], v[156:159], v[88:91]
    ds_read_b128 v[144:147], v192 offset:36864
    v_mfma_f32_16x16x32_bf16 v[92:95], v[252:255], v[156:159], v[92:95]
    s_waitcnt lgkmcnt(7)
    ds_read_b128 v[148:151], v192 offset:37888
    v_mfma_f32_16x16x32_bf16 v[96:99], v[248:251], v[160:163], v[96:99]
    ds_read_b128 v[152:155], v192 offset:38912
    v_mfma_f32_16x16x32_bf16 v[100:103], v[252:255], v[160:163], v[100:103]
    ds_read_b128 v[156:159], v192 offset:39936
    v_mfma_f32_16x16x32_bf16 v[104:107], v[248:251], v[164:167], v[104:107]
    ds_read_b128 v[160:163], v192 offset:40960
    v_mfma_f32_16x16x32_bf16 v[108:111], v[252:255], v[164:167], v[108:111]
    s_waitcnt lgkmcnt(9)
    buffer_load_dwordx4 a[168:171], v222, s[48:51], s31 offen offset:2048 sc1
    v_mfma_f32_16x16x32_bf16 v[112:115], v[248:251], v[168:171], v[112:115]
    ds_read_b128 v[164:167], v192 offset:41984
    v_mfma_f32_16x16x32_bf16 v[116:119], v[252:255], v[168:171], v[116:119]
    v_mfma_f32_16x16x32_bf16 v[120:123], v[248:251], v[172:175], v[120:123]
    s_xor_b32 s33, s0, s79
    s_xor_b32 s34, s33, 262144
    s_add_u32 m0, s99, 32768
    ds_read_b128 v[168:171], v192 offset:43008
    v_mfma_f32_16x16x32_bf16 v[124:127], v[252:255], v[172:175], v[124:127]
    s_waitcnt lgkmcnt(9)
    buffer_load_dwordx4 v222, s[48:51], s34 offen sc1 lds
    v_mfma_f32_16x16x32_bf16 v[80:83], a[192:195], v[128:131], v[80:83]
    ds_read_b128 v[172:175], v192 offset:44032
    v_mfma_f32_16x16x32_bf16 v[84:87], a[196:199], v[128:131], v[84:87]
    v_mfma_f32_16x16x32_bf16 v[88:91], a[192:195], v[132:135], v[88:91]
    ds_read_b128 v[128:131], v192 offset:45056
    v_mfma_f32_16x16x32_bf16 v[92:95], a[196:199], v[132:135], v[92:95]
    s_waitcnt lgkmcnt(9)
    buffer_load_dwordx4 v216, s[48:51], s34 offen offset:1024 sc1 lds
    v_mfma_f32_16x16x32_bf16 v[96:99], a[192:195], v[136:139], v[96:99]
    s_lshr_b32 s43, s82, 7
    s_load_dwordx2 s[72:73], s[70:71], s43 glc
    ds_read_b128 v[132:135], v192 offset:46080
    v_mfma_f32_16x16x32_bf16 v[100:103], a[196:199], v[136:139], v[100:103]
    v_mfma_f32_16x16x32_bf16 v[104:107], a[192:195], v[140:143], v[104:107]
    s_xor_b32 s34, s33, 525312
    s_add_u32 m0, s99, 34816
    ds_read_b128 v[136:139], v192 offset:47104
    v_mfma_f32_16x16x32_bf16 v[108:111], a[196:199], v[140:143], v[108:111]
    s_waitcnt lgkmcnt(9)
    buffer_load_dwordx4 v222, s[48:51], s34 offen sc1 lds
    v_mfma_f32_16x16x32_bf16 v[112:115], a[192:195], v[144:147], v[112:115]
    ds_read_b128 v[140:143], v192 offset:48128
    v_mfma_f32_16x16x32_bf16 v[116:119], a[196:199], v[144:147], v[116:119]
    v_mfma_f32_16x16x32_bf16 v[120:123], a[192:195], v[148:151], v[120:123]
    ds_read_b128 v[144:147], v192 offset:49152
    v_mfma_f32_16x16x32_bf16 v[124:127], a[196:199], v[148:151], v[124:127]
    s_waitcnt lgkmcnt(9)
    buffer_load_dwordx4 v216, s[48:51], s34 offen offset:1024 sc1 lds
    v_mfma_f32_16x16x32_bf16 v[80:83], a[200:203], v[152:155], v[80:83]
    ds_read_b128 v[148:151], v192 offset:50176
    v_mfma_f32_16x16x32_bf16 v[84:87], a[204:207], v[152:155], v[84:87]
    v_mfma_f32_16x16x32_bf16 v[88:91], a[200:203], v[156:159], v[88:91]
    s_xor_b32 s34, s33, 787456
    s_add_u32 m0, s99, 36864
    ds_read_b128 v[152:155], v192 offset:51200
    v_mfma_f32_16x16x32_bf16 v[92:95], a[204:207], v[156:159], v[92:95]
    s_waitcnt lgkmcnt(9)
    buffer_load_dwordx4 v222, s[48:51], s34 offen sc1 lds
    v_mfma_f32_16x16x32_bf16 v[96:99], a[200:203], v[160:163], v[96:99]
    ds_read_b128 v[156:159], v192 offset:52224
    v_mfma_f32_16x16x32_bf16 v[100:103], a[204:207], v[160:163], v[100:103]
    v_mfma_f32_16x16x32_bf16 v[104:107], a[200:203], v[164:167], v[104:107]
    ds_read_b128 v[160:163], v192 offset:53248
    v_mfma_f32_16x16x32_bf16 v[108:111], a[204:207], v[164:167], v[108:111]
    s_waitcnt lgkmcnt(9)
    buffer_load_dwordx4 v216, s[48:51], s34 offen offset:1024 sc1 lds
    v_mfma_f32_16x16x32_bf16 v[112:115], a[200:203], v[168:171], v[112:115]
    ds_read_b128 v[164:167], v192 offset:54272
    v_mfma_f32_16x16x32_bf16 v[116:119], a[204:207], v[168:171], v[116:119]
    v_mfma_f32_16x16x32_bf16 v[120:123], a[200:203], v[172:175], v[120:123]
    ds_read_b128 v[168:171], v192 offset:55296
    v_mfma_f32_16x16x32_bf16 v[124:127], a[204:207], v[172:175], v[124:127]
    s_waitcnt lgkmcnt(9)
    buffer_load_dwordx4 a[172:175], v222, s[48:51], s31 offen offset:3072 sc1
    v_mfma_f32_16x16x32_bf16 v[80:83], a[208:211], v[128:131], v[80:83]
    ds_read_b128 v[172:175], v192 offset:56320
    v_mfma_f32_16x16x32_bf16 v[84:87], a[212:215], v[128:131], v[84:87]
    v_mfma_f32_16x16x32_bf16 v[88:91], a[208:211], v[132:135], v[88:91]
    s_add_u32 s32, s31, 4096
    v_mfma_f32_16x16x32_bf16 v[92:95], a[212:215], v[132:135], v[92:95]
    s_waitcnt lgkmcnt(8)
    buffer_load_dwordx4 a[176:179], v222, s[48:51], s32 offen offset:0 sc1
    v_mfma_f32_16x16x32_bf16 v[96:99], a[208:211], v[136:139], v[96:99]
    v_mfma_f32_16x16x32_bf16 v[100:103], a[212:215], v[136:139], v[100:103]
    v_mfma_f32_16x16x32_bf16 v[104:107], a[208:211], v[140:143], v[104:107]
    v_mfma_f32_16x16x32_bf16 v[108:111], a[212:215], v[140:143], v[108:111]
    s_waitcnt lgkmcnt(6)
    buffer_load_dwordx4 a[180:183], v222, s[48:51], s32 offen offset:1024 sc1
    v_mfma_f32_16x16x32_bf16 v[112:115], a[208:211], v[144:147], v[112:115]
    s_waitcnt vmcnt(12) lgkmcnt(0)
    v_mfma_f32_16x16x32_bf16 v[116:119], a[212:215], v[144:147], v[116:119]
    s_cmp_eq_u64 s[72:73], s[64:65]
    s_cbranch_scc0 F_W4_7
F_WB4_7:
    s_barrier
    v_mfma_f32_16x16x32_bf16 v[120:123], a[208:211], v[148:151], v[120:123]
    ds_read_b128 v[128:131], v193 offset:0
    v_mfma_f32_16x16x32_bf16 v[124:127], a[212:215], v[148:151], v[124:127]
    s_waitcnt lgkmcnt(5)
    ds_read_b128 v[132:135], v193 offset:1024
    v_mfma_f32_16x16x32_bf16 v[80:83], a[216:219], v[152:155], v[80:83]
    s_cmp_eq_u32 s7, 0
    s_cbranch_scc1 F_RB7
F_RBB7:
    ds_read_b128 v[136:139], v193 offset:2048
    v_mfma_f32_16x16x32_bf16 v[84:87], a[220:223], v[152:155], v[84:87]
    ds_read_b128 v[140:143], v193 offset:3072
    v_mfma_f32_16x16x32_bf16 v[88:91], a[216:219], v[156:159], v[88:91]
    ds_read_b128 v[144:147], v193 offset:4096
    v_mfma_f32_16x16x32_bf16 v[92:95], a[220:223], v[156:159], v[92:95]
    s_waitcnt lgkmcnt(7)
    ds_read_b128 v[148:151], v193 offset:5120
    v_mfma_f32_16x16x32_bf16 v[96:99], a[216:219], v[160:163], v[96:99]
    ds_read_b128 v[152:155], v193 offset:6144
    v_mfma_f32_16x16x32_bf16 v[100:103], a[220:223], v[160:163], v[100:103]
    ds_read_b128 v[156:159], v193 offset:7168
    v_mfma_f32_16x16x32_bf16 v[104:107], a[216:219], v[164:167], v[104:107]
    s_xor_b32 s33, s0, s82
    s_xor_b32 s34, s33, 262144
    s_add_u32 m0, s99, 65536
    ds_read_b128 v[160:163], v193 offset:8192
    v_mfma_f32_16x16x32_bf16 v[108:111], a[220:223], v[164:167], v[108:111]
    s_waitcnt lgkmcnt(9)
    buffer_load_dwordx4 v222, s[48:51], s34 offen sc1 lds
    v_mfma_f32_16x16x32_bf16 v[112:115], a[216:219], v[168:171], v[112:115]
    ds_read_b128 v[164:167], v193 offset:9216
    v_mfma_f32_16x16x32_bf16 v[116:119], a[220:223], v[168:171], v[116:119]
    buffer_load_dwordx4 v[48:51], v194, s[16:19], s97 offen
    v_mfma_f32_16x16x32_bf16 v[120:123], a[216:219], v[172:175], v[120:123]
    ds_read_b128 v[168:171], v193 offset:10240
    v_mfma_f32_16x16x32_bf16 v[124:127], a[220:223], v[172:175], v[124:127]
    s_waitcnt vmcnt(21) lgkmcnt(9)
    buffer_load_dwordx4 v216, s[48:51], s34 offen offset:1024 sc1 lds
    v_mfma_f32_16x16x32_bf16 v[80:83], a[128:131], v[128:131], v[80:83]
    ds_read_b128 v[172:175], v193 offset:11264
    v_mfma_f32_16x16x32_bf16 v[84:87], a[132:135], v[128:131], v[84:87]
    buffer_load_dwordx4 v[52:55], v194, s[16:19], s6 offen
    v_mfma_f32_16x16x32_bf16 v[88:91], a[128:131], v[132:135], v[88:91]
    s_xor_b32 s34, s33, 525312
    s_add_u32 m0, s99, 67584
    ds_read_b128 v[128:131], v193 offset:12288
    v_lshlrev_b32 v176, 16, v184
    v_mfma_f32_16x16x32_bf16 v[92:95], a[132:135], v[132:135], v[92:95]
    s_waitcnt lgkmcnt(9)
    buffer_load_dwordx4 v222, s[48:51], s34 offen sc1 lds
    v_mfma_f32_16x16x32_bf16 v[96:99], a[128:131], v[136:139], v[96:99]
    s_lshr_b32 s43, s77, 7
    s_load_dwordx2 s[72:73], s[70:71], s43 glc
    ds_read_b128 v[132:135], v193 offset:13312
    v_and_b32 v177, 0xffff0000, v184
    v_mfma_f32_16x16x32_bf16 v[100:103], a[132:135], v[136:139], v[100:103]
    v_lshlrev_b32 v178, 16, v185
    v_and_b32 v179, 0xffff0000, v185
    v_mfma_f32_16x16x32_bf16 v[104:107], a[128:131], v[140:143], v[104:107]
    ds_read_b128 v[136:139], v193 offset:14336
    v_lshlrev_b32 v180, 16, v186
    v_mfma_f32_16x16x32_bf16 v[108:111], a[132:135], v[140:143], v[108:111]
    s_waitcnt lgkmcnt(9)
    buffer_load_dwordx4 v216, s[48:51], s34 offen offset:1024 sc1 lds
    v_mfma_f32_16x16x32_bf16 v[112:115], a[128:131], v[144:147], v[112:115]
    ds_read_b128 v[140:143], v193 offset:15360
    v_and_b32 v181, 0xffff0000, v186
    v_mfma_f32_16x16x32_bf16 v[116:119], a[132:135], v[144:147], v[116:119]
    v_lshlrev_b32 v182, 16, v187
    v_and_b32 v183, 0xffff0000, v187
    v_mfma_f32_16x16x32_bf16 v[120:123], a[128:131], v[148:151], v[120:123]
    s_xor_b32 s34, s33, 787456
    s_add_u32 m0, s99, 69632
    ds_read_b128 v[144:147], v193 offset:16384
    v_lshlrev_b32 v184, 16, v188
    v_mfma_f32_16x16x32_bf16 v[124:127], a[132:135], v[148:151], v[124:127]
    s_waitcnt lgkmcnt(9)
    buffer_load_dwordx4 v222, s[48:51], s34 offen sc1 lds
    v_mfma_f32_16x16x32_bf16 v[80:83], a[136:139], v[152:155], v[80:83]
    ds_read_b128 v[148:151], v193 offset:17408
    v_and_b32 v185, 0xffff0000, v188
    v_mfma_f32_16x16x32_bf16 v[84:87], a[140:143], v[152:155], v[84:87]
    v_lshlrev_b32 v186, 16, v189
    v_and_b32 v187, 0xffff0000, v189
    v_mfma_f32_16x16x32_bf16 v[88:91], a[136:139], v[156:159], v[88:91]
    ds_read_b128 v[152:155], v193 offset:18432
    v_lshlrev_b32 v188, 16, v190
    v_mfma_f32_16x16x32_bf16 v[92:95], a[140:143], v[156:159], v[92:95]
    s_waitcnt lgkmcnt(9)
    buffer_load_dwordx4 v216, s[48:51], s34 offen offset:1024 sc1 lds
    v_mfma_f32_16x16x32_bf16 v[96:99], a[136:139], v[160:163], v[96:99]
    ds_read_b128 v[156:159], v193 offset:19456
    v_and_b32 v189, 0xffff0000, v190
    v_mfma_f32_16x16x32_bf16 v[100:103], a[140:143], v[160:163], v[100:103]
    v_lshlrev_b32 v190, 16, v191
    v_and_b32 v191, 0xffff0000, v191
    v_mfma_f32_16x16x32_bf16 v[104:107], a[136:139], v[164:167], v[104:107]
    ds_read_b128 v[160:163], v193 offset:20480
    v_mul_f32 v16, s36, v176
    v_mfma_f32_16x16x32_bf16 v[108:111], a[140:143], v[164:167], v[108:111]
    s_waitcnt lgkmcnt(9)
    buffer_load_dwordx4 a[184:187], v222, s[48:51], s32 offen offset:2048 sc1
    v_mfma_f32_16x16x32_bf16 v[112:115], a[136:139], v[168:171], v[112:115]
    ds_read_b128 v[164:167], v193 offset:21504
    v_mul_f32 v17, s36, v177
    v_mfma_f32_16x16x32_bf16 v[116:119], a[140:143], v[168:171], v[116:119]
    v_mul_f32 v18, s36, v178
    v_mul_f32 v19, s36, v179
    v_mfma_f32_16x16x32_bf16 v[120:123], a[136:139], v[172:175], v[120:123]
    ds_read_b128 v[168:171], v193 offset:22528
    v_mul_f32 v20, s36, v180
    v_mfma_f32_16x16x32_bf16 v[124:127], a[140:143], v[172:175], v[124:127]
    s_waitcnt lgkmcnt(9)
    buffer_load_dwordx4 a[188:191], v222, s[48:51], s32 offen offset:3072 sc1
    v_mfma_f32_16x16x32_bf16 v[80:83], a[144:147], v[128:131], v[80:83]
    ds_read_b128 v[172:175], v193 offset:23552
    v_mul_f32 v21, s36, v181
    v_mfma_f32_16x16x32_bf16 v[84:87], a[148:151], v[128:131], v[84:87]
    v_mul_f32 v22, s36, v182
    v_mul_f32 v23, s36, v183
    v_mfma_f32_16x16x32_bf16 v[88:91], a[144:147], v[132:135], v[88:91]
    s_lshl1_add_u32 s31, s78, s1
    v_mul_f32 v24, s36, v184
    v_mul_f32 v25, s36, v185
    v_mfma_f32_16x16x32_bf16 v[92:95], a[148:151], v[132:135], v[92:95]
    s_waitcnt lgkmcnt(8)
    buffer_load_dwordx4 a[224:227], v222, s[48:51], s31 offen offset:0 sc1
    v_mfma_f32_16x16x32_bf16 v[96:99], a[144:147], v[136:139], v[96:99]
    v_mul_f32 v26, s36, v186
    v_mul_f32 v27, s36, v187
    v_mfma_f32_16x16x32_bf16 v[100:103], a[148:151], v[136:139], v[100:103]
    v_mul_f32 v28, s36, v188
    v_mul_f32 v29, s36, v189
    v_mfma_f32_16x16x32_bf16 v[104:107], a[144:147], v[140:143], v[104:107]
    v_mul_f32 v30, s36, v190
    v_mul_f32 v31, s36, v191
    v_mfma_f32_16x16x32_bf16 v[108:111], a[148:151], v[140:143], v[108:111]
    s_waitcnt lgkmcnt(6)
    buffer_load_dwordx4 a[228:231], v222, s[48:51], s31 offen offset:1024 sc1
    v_mfma_f32_16x16x32_bf16 v[112:115], a[144:147], v[144:147], v[112:115]
    s_waitcnt vmcnt(15) lgkmcnt(0)
    v_exp_f32 v16, v16
    v_mfma_f32_16x16x32_bf16 v[116:119], a[148:151], v[144:147], v[116:119]
    s_cmp_eq_u64 s[72:73], s[64:65]
    s_cbranch_scc0 F_W5_7
F_WB5_7:
    s_barrier
    v_exp_f32 v17, v17
    v_mfma_f32_16x16x32_bf16 v[120:123], a[144:147], v[148:151], v[120:123]
    ds_read_b128 v[128:131], v192 offset:0
    v_mfma_f32_16x16x32_bf16 v[124:127], a[148:151], v[148:151], v[124:127]
    s_waitcnt lgkmcnt(5)
    ds_read_b128 v[132:135], v192 offset:1024
    v_mfma_f32_16x16x32_bf16 v[80:83], a[152:155], v[152:155], v[80:83]
    ds_read_b128 v[136:139], v192 offset:2048
    v_mfma_f32_16x16x32_bf16 v[84:87], a[156:159], v[152:155], v[84:87]
    ds_read_b128 v[140:143], v192 offset:3072
    v_mfma_f32_16x16x32_bf16 v[88:91], a[152:155], v[156:159], v[88:91]
    ds_read_b128 v[144:147], v192 offset:4096
    v_mfma_f32_16x16x32_bf16 v[92:95], a[156:159], v[156:159], v[92:95]
    s_waitcnt lgkmcnt(7)
    ds_read_b128 v[148:151], v192 offset:5120
    v_mfma_f32_16x16x32_bf16 v[96:99], a[152:155], v[160:163], v[96:99]
    ds_read_b128 v[152:155], v192 offset:6144
    v_mfma_f32_16x16x32_bf16 v[100:103], a[156:159], v[160:163], v[100:103]
    ds_read_b128 v[156:159], v192 offset:7168
    v_mfma_f32_16x16x32_bf16 v[104:107], a[152:155], v[164:167], v[104:107]
    s_xor_b32 s33, s0, s77
    s_xor_b32 s34, s33, 262144
    s_add_u32 m0, s99, 98304
    ds_read_b128 v[160:163], v192 offset:8192
    v_mfma_f32_16x16x32_bf16 v[108:111], a[156:159], v[164:167], v[108:111]
    s_waitcnt lgkmcnt(9)
    buffer_load_dwordx4 v222, s[48:51], s34 offen sc1 lds
    v_mfma_f32_16x16x32_bf16 v[112:115], a[152:155], v[168:171], v[112:115]
    ds_read_b128 v[164:167], v192 offset:9216
    v_mfma_f32_16x16x32_bf16 v[116:119], a[156:159], v[168:171], v[116:119]
    v_exp_f32 v18, v18
    v_mfma_f32_16x16x32_bf16 v[120:123], a[152:155], v[172:175], v[120:123]
    ds_read_b128 v[168:171], v192 offset:10240
    v_mfma_f32_16x16x32_bf16 v[124:127], a[156:159], v[172:175], v[124:127]
    s_waitcnt lgkmcnt(9)
    buffer_load_dwordx4 v216, s[48:51], s34 offen offset:1024 sc1 lds
    v_mfma_f32_16x16x32_bf16 v[80:83], a[0:3], v[128:131], v[80:83]
    ds_read_b128 v[172:175], v192 offset:11264
    v_mfma_f32_16x16x32_bf16 v[84:87], a[4:7], v[128:131], v[84:87]
    v_exp_f32 v19, v19
    v_mfma_f32_16x16x32_bf16 v[88:91], a[0:3], v[132:135], v[88:91]
    s_xor_b32 s34, s33, 525312
    s_add_u32 m0, s99, 100352
    ds_read_b128 v[128:131], v192 offset:12288
    v_mfma_f32_16x16x32_bf16 v[92:95], a[4:7], v[132:135], v[92:95]
    s_waitcnt lgkmcnt(9)
    buffer_load_dwordx4 v222, s[48:51], s34 offen sc1 lds
    v_mfma_f32_16x16x32_bf16 v[96:99], a[0:3], v[136:139], v[96:99]
    s_lshr_b32 s43, s78, 7
    s_load_dwordx2 s[72:73], s[70:71], s43 glc
    ds_read_b128 v[132:135], v192 offset:13312
    v_mfma_f32_16x16x32_bf16 v[100:103], a[4:7], v[136:139], v[100:103]
    v_exp_f32 v20, v20
    v_mfma_f32_16x16x32_bf16 v[104:107], a[0:3], v[140:143], v[104:107]
    ds_read_b128 v[136:139], v192 offset:14336
    v_mfma_f32_16x16x32_bf16 v[108:111], a[4:7], v[140:143], v[108:111]
    s_waitcnt lgkmcnt(9)
    buffer_load_dwordx4 v216, s[48:51], s34 offen offset:1024 sc1 lds
    v_mfma_f32_16x16x32_bf16 v[112:115], a[0:3], v[144:147], v[112:115]
    ds_read_b128 v[140:143], v192 offset:15360
    v_mfma_f32_16x16x32_bf16 v[116:119], a[4:7], v[144:147], v[116:119]
    v_exp_f32 v21, v21
    v_mfma_f32_16x16x32_bf16 v[120:123], a[0:3], v[148:151], v[120:123]
    s_xor_b32 s34, s33, 787456
    s_add_u32 m0, s99, 102400
    ds_read_b128 v[144:147], v192 offset:16384
    v_mfma_f32_16x16x32_bf16 v[124:127], a[4:7], v[148:151], v[124:127]
    s_waitcnt lgkmcnt(9)
    buffer_load_dwordx4 v222, s[48:51], s34 offen sc1 lds
    v_mfma_f32_16x16x32_bf16 v[80:83], a[8:11], v[152:155], v[80:83]
    ds_read_b128 v[148:151], v192 offset:17408
    v_mfma_f32_16x16x32_bf16 v[84:87], a[12:15], v[152:155], v[84:87]
    v_exp_f32 v22, v22
    v_mfma_f32_16x16x32_bf16 v[88:91], a[8:11], v[156:159], v[88:91]
    ds_read_b128 v[152:155], v192 offset:18432
    v_mfma_f32_16x16x32_bf16 v[92:95], a[12:15], v[156:159], v[92:95]
    s_waitcnt lgkmcnt(9)
    buffer_load_dwordx4 v216, s[48:51], s34 offen offset:1024 sc1 lds
    v_mfma_f32_16x16x32_bf16 v[96:99], a[8:11], v[160:163], v[96:99]
    ds_read_b128 v[156:159], v192 offset:19456
    v_mfma_f32_16x16x32_bf16 v[100:103], a[12:15], v[160:163], v[100:103]
    v_exp_f32 v23, v23
    v_mfma_f32_16x16x32_bf16 v[104:107], a[8:11], v[164:167], v[104:107]
    ds_read_b128 v[160:163], v192 offset:20480
    v_mfma_f32_16x16x32_bf16 v[108:111], a[12:15], v[164:167], v[108:111]
    s_waitcnt lgkmcnt(9)
    buffer_load_dwordx4 a[232:235], v222, s[48:51], s31 offen offset:2048 sc1
    v_mfma_f32_16x16x32_bf16 v[112:115], a[8:11], v[168:171], v[112:115]
    ds_read_b128 v[164:167], v192 offset:21504
    v_mfma_f32_16x16x32_bf16 v[116:119], a[12:15], v[168:171], v[116:119]
    v_exp_f32 v24, v24
    v_mfma_f32_16x16x32_bf16 v[120:123], a[8:11], v[172:175], v[120:123]
    ds_read_b128 v[168:171], v192 offset:22528
    v_mfma_f32_16x16x32_bf16 v[124:127], a[12:15], v[172:175], v[124:127]
    s_waitcnt lgkmcnt(9)
    buffer_load_dwordx4 a[236:239], v222, s[48:51], s31 offen offset:3072 sc1
    v_mfma_f32_16x16x32_bf16 v[80:83], a[16:19], v[128:131], v[80:83]
    ds_read_b128 v[172:175], v192 offset:23552
    v_mfma_f32_16x16x32_bf16 v[84:87], a[20:23], v[128:131], v[84:87]
    v_exp_f32 v25, v25
    v_mfma_f32_16x16x32_bf16 v[88:91], a[16:19], v[132:135], v[88:91]
    s_add_u32 s32, s31, 4096
    v_exp_f32 v26, v26
    v_mfma_f32_16x16x32_bf16 v[92:95], a[20:23], v[132:135], v[92:95]
    s_waitcnt lgkmcnt(8)
    buffer_load_dwordx4 a[240:243], v222, s[48:51], s32 offen offset:0 sc1
    v_mfma_f32_16x16x32_bf16 v[96:99], a[16:19], v[136:139], v[96:99]
    v_exp_f32 v27, v27
    v_mfma_f32_16x16x32_bf16 v[100:103], a[20:23], v[136:139], v[100:103]
    v_exp_f32 v28, v28
    v_mfma_f32_16x16x32_bf16 v[104:107], a[16:19], v[140:143], v[104:107]
    v_exp_f32 v29, v29
    v_mfma_f32_16x16x32_bf16 v[108:111], a[20:23], v[140:143], v[108:111]
    s_waitcnt lgkmcnt(6)
    buffer_load_dwordx4 a[244:247], v222, s[48:51], s32 offen offset:1024 sc1
    v_mfma_f32_16x16x32_bf16 v[112:115], a[16:19], v[144:147], v[112:115]
    s_waitcnt vmcnt(14) lgkmcnt(0)
    v_exp_f32 v30, v30
    v_mfma_f32_16x16x32_bf16 v[116:119], a[20:23], v[144:147], v[116:119]
    s_cmp_eq_u64 s[72:73], s[64:65]
    s_cbranch_scc0 F_W6_7
F_WB6_7:
    s_barrier
    v_exp_f32 v31, v31
    v_mfma_f32_16x16x32_bf16 v[120:123], a[16:19], v[148:151], v[120:123]
    ds_read_b128 v[128:131], v192 offset:32768
    v_add_f32 v16, 1.0, v16
    v_mfma_f32_16x16x32_bf16 v[124:127], a[20:23], v[148:151], v[124:127]
    s_waitcnt lgkmcnt(5)
    ds_read_b128 v[132:135], v192 offset:33792
    v_add_f32 v17, 1.0, v17
    v_mfma_f32_16x16x32_bf16 v[80:83], a[24:27], v[152:155], v[80:83]
    ds_read_b128 v[136:139], v192 offset:34816
    v_add_f32 v18, 1.0, v18
    v_mfma_f32_16x16x32_bf16 v[84:87], a[28:31], v[152:155], v[84:87]
    ds_read_b128 v[140:143], v192 offset:35840
    v_add_f32 v19, 1.0, v19
    v_mfma_f32_16x16x32_bf16 v[88:91], a[24:27], v[156:159], v[88:91]
    ds_read_b128 v[144:147], v192 offset:36864
    v_add_f32 v20, 1.0, v20
    v_mfma_f32_16x16x32_bf16 v[92:95], a[28:31], v[156:159], v[92:95]
    s_waitcnt lgkmcnt(7)
    ds_read_b128 v[148:151], v192 offset:37888
    v_add_f32 v21, 1.0, v21
    v_mfma_f32_16x16x32_bf16 v[96:99], a[24:27], v[160:163], v[96:99]
    ds_read_b128 v[152:155], v192 offset:38912
    v_add_f32 v22, 1.0, v22
    v_mfma_f32_16x16x32_bf16 v[100:103], a[28:31], v[160:163], v[100:103]
    ds_read_b128 v[156:159], v192 offset:39936
    v_add_f32 v23, 1.0, v23
    v_mfma_f32_16x16x32_bf16 v[104:107], a[24:27], v[164:167], v[104:107]
    s_xor_b32 s33, s0, s78
    s_xor_b32 s34, s33, 262144
    s_add_u32 m0, s99, 32768
    ds_read_b128 v[160:163], v192 offset:40960
    v_add_f32 v24, 1.0, v24
    v_mfma_f32_16x16x32_bf16 v[108:111], a[28:31], v[164:167], v[108:111]
    s_waitcnt lgkmcnt(9)
    buffer_load_dwordx4 v222, s[48:51], s34 offen sc1 lds
    v_mfma_f32_16x16x32_bf16 v[112:115], a[24:27], v[168:171], v[112:115]
    ds_read_b128 v[164:167], v192 offset:41984
    v_add_f32 v25, 1.0, v25
    v_mfma_f32_16x16x32_bf16 v[116:119], a[28:31], v[168:171], v[116:119]
    v_add_f32 v26, 1.0, v26
    v_add_f32 v27, 1.0, v27
    v_mfma_f32_16x16x32_bf16 v[120:123], a[24:27], v[172:175], v[120:123]
    ds_read_b128 v[168:171], v192 offset:43008
    v_add_f32 v28, 1.0, v28
    v_mfma_f32_16x16x32_bf16 v[124:127], a[28:31], v[172:175], v[124:127]
    s_waitcnt lgkmcnt(9)
    buffer_load_dwordx4 v216, s[48:51], s34 offen offset:1024 sc1 lds
    v_mfma_f32_16x16x32_bf16 v[80:83], a[32:35], v[128:131], v[80:83]
    ds_read_b128 v[172:175], v192 offset:44032
    v_add_f32 v29, 1.0, v29
    v_mfma_f32_16x16x32_bf16 v[84:87], a[36:39], v[128:131], v[84:87]
    v_add_f32 v30, 1.0, v30
    v_add_f32 v31, 1.0, v31
    v_mfma_f32_16x16x32_bf16 v[88:91], a[32:35], v[132:135], v[88:91]
    s_xor_b32 s34, s33, 525312
    s_add_u32 m0, s99, 34816
    ds_read_b128 v[128:131], v192 offset:45056
    v_mfma_f32_16x16x32_bf16 v[92:95], a[36:39], v[132:135], v[92:95]
    s_waitcnt lgkmcnt(9)
    buffer_load_dwordx4 v222, s[48:51], s34 offen sc1 lds
    v_mfma_f32_16x16x32_bf16 v[96:99], a[32:35], v[136:139], v[96:99]
    ds_read_b128 v[132:135], v192 offset:46080
    v_mfma_f32_16x16x32_bf16 v[100:103], a[36:39], v[136:139], v[100:103]
    v_rcp_f32 v16, v16
    v_mfma_f32_16x16x32_bf16 v[104:107], a[32:35], v[140:143], v[104:107]
    ds_read_b128 v[136:139], v192 offset:47104
    v_mfma_f32_16x16x32_bf16 v[108:111], a[36:39], v[140:143], v[108:111]
    s_waitcnt lgkmcnt(9)
    buffer_load_dwordx4 v216, s[48:51], s34 offen offset:1024 sc1 lds
    v_mfma_f32_16x16x32_bf16 v[112:115], a[32:35], v[144:147], v[112:115]
    ds_read_b128 v[140:143], v192 offset:48128
    v_mfma_f32_16x16x32_bf16 v[116:119], a[36:39], v[144:147], v[116:119]
    v_rcp_f32 v17, v17
    v_mfma_f32_16x16x32_bf16 v[120:123], a[32:35], v[148:151], v[120:123]
    s_xor_b32 s34, s33, 787456
    s_add_u32 m0, s99, 36864
    ds_read_b128 v[144:147], v192 offset:49152
    v_mfma_f32_16x16x32_bf16 v[124:127], a[36:39], v[148:151], v[124:127]
    s_waitcnt lgkmcnt(9)
    buffer_load_dwordx4 v222, s[48:51], s34 offen sc1 lds
    v_mfma_f32_16x16x32_bf16 v[80:83], a[40:43], v[152:155], v[80:83]
    ds_read_b128 v[148:151], v192 offset:50176
    v_mfma_f32_16x16x32_bf16 v[84:87], a[44:47], v[152:155], v[84:87]
    v_rcp_f32 v18, v18
    v_mfma_f32_16x16x32_bf16 v[88:91], a[40:43], v[156:159], v[88:91]
    ds_read_b128 v[152:155], v192 offset:51200
    v_mfma_f32_16x16x32_bf16 v[92:95], a[44:47], v[156:159], v[92:95]
    s_waitcnt lgkmcnt(9)
    buffer_load_dwordx4 v216, s[48:51], s34 offen offset:1024 sc1 lds
    v_mfma_f32_16x16x32_bf16 v[96:99], a[40:43], v[160:163], v[96:99]
    ds_read_b128 v[156:159], v192 offset:52224
    v_mfma_f32_16x16x32_bf16 v[100:103], a[44:47], v[160:163], v[100:103]
    v_rcp_f32 v19, v19
    v_mfma_f32_16x16x32_bf16 v[104:107], a[40:43], v[164:167], v[104:107]
    ds_read_b128 v[160:163], v192 offset:53248
    v_mfma_f32_16x16x32_bf16 v[108:111], a[44:47], v[164:167], v[108:111]
    s_waitcnt lgkmcnt(9)
    buffer_load_dwordx4 a[248:251], v222, s[48:51], s32 offen offset:2048 sc1
    v_mfma_f32_16x16x32_bf16 v[112:115], a[40:43], v[168:171], v[112:115]
    ds_read_b128 v[164:167], v192 offset:54272
    v_mfma_f32_16x16x32_bf16 v[116:119], a[44:47], v[168:171], v[116:119]
    v_rcp_f32 v20, v20
    v_mfma_f32_16x16x32_bf16 v[120:123], a[40:43], v[172:175], v[120:123]
    ds_read_b128 v[168:171], v192 offset:55296
    v_mfma_f32_16x16x32_bf16 v[124:127], a[44:47], v[172:175], v[124:127]
    s_waitcnt lgkmcnt(9)
    buffer_load_dwordx4 a[252:255], v222, s[48:51], s32 offen offset:3072 sc1
    v_mfma_f32_16x16x32_bf16 v[80:83], a[48:51], v[128:131], v[80:83]
    ds_read_b128 v[172:175], v192 offset:56320
    v_mfma_f32_16x16x32_bf16 v[84:87], a[52:55], v[128:131], v[84:87]
    v_rcp_f32 v21, v21
    v_mfma_f32_16x16x32_bf16 v[88:91], a[48:51], v[132:135], v[88:91]
    s_xor_b32 s34, s0, s74
    s_add_u32 m0, s68, 0
    v_rcp_f32 v22, v22
    v_mfma_f32_16x16x32_bf16 v[92:95], a[52:55], v[132:135], v[92:95]
    s_waitcnt lgkmcnt(8)
    buffer_load_dwordx4 v222, s[48:51], s34 offen sc1 lds
    v_mfma_f32_16x16x32_bf16 v[96:99], a[48:51], v[136:139], v[96:99]
    v_rcp_f32 v23, v23
    v_mfma_f32_16x16x32_bf16 v[100:103], a[52:55], v[136:139], v[100:103]
    v_rcp_f32 v24, v24
    v_mfma_f32_16x16x32_bf16 v[104:107], a[48:51], v[140:143], v[104:107]
    v_rcp_f32 v25, v25
    v_mfma_f32_16x16x32_bf16 v[108:111], a[52:55], v[140:143], v[108:111]
    s_waitcnt lgkmcnt(6)
    buffer_load_dwordx4 v216, s[48:51], s34 offen offset:1024 sc1 lds
    v_mfma_f32_16x16x32_bf16 v[112:115], a[48:51], v[144:147], v[112:115]
    s_waitcnt vmcnt(14) lgkmcnt(0)
    v_rcp_f32 v26, v26
    v_mfma_f32_16x16x32_bf16 v[116:119], a[52:55], v[144:147], v[116:119]
    s_barrier
    v_rcp_f32 v27, v27
    v_mfma_f32_16x16x32_bf16 v[120:123], a[48:51], v[148:151], v[120:123]
    ds_read_b128 v[128:131], v193 offset:0
    v_mfma_f32_16x16x32_bf16 v[124:127], a[52:55], v[148:151], v[124:127]
    s_waitcnt lgkmcnt(5)
    ds_read_b128 v[132:135], v193 offset:1024
    v_mfma_f32_16x16x32_bf16 v[80:83], a[56:59], v[152:155], v[80:83]
    ds_read_b128 v[136:139], v193 offset:2048
    v_mfma_f32_16x16x32_bf16 v[84:87], a[60:63], v[152:155], v[84:87]
    ds_read_b128 v[140:143], v193 offset:3072
    v_mfma_f32_16x16x32_bf16 v[88:91], a[56:59], v[156:159], v[88:91]
    ds_read_b128 v[144:147], v193 offset:4096
    v_mfma_f32_16x16x32_bf16 v[92:95], a[60:63], v[156:159], v[92:95]
    s_waitcnt lgkmcnt(7)
    ds_read_b128 v[148:151], v193 offset:5120
    v_mfma_f32_16x16x32_bf16 v[96:99], a[56:59], v[160:163], v[96:99]
    ds_read_b128 v[152:155], v193 offset:6144
    v_mfma_f32_16x16x32_bf16 v[100:103], a[60:63], v[160:163], v[100:103]
    ds_read_b128 v[156:159], v193 offset:7168
    v_mfma_f32_16x16x32_bf16 v[104:107], a[56:59], v[164:167], v[104:107]
    s_xor_b32 s34, s0, s75
    s_add_u32 m0, s68, 8192
    ds_read_b128 v[160:163], v193 offset:8192
    v_mfma_f32_16x16x32_bf16 v[108:111], a[60:63], v[164:167], v[108:111]
    s_waitcnt lgkmcnt(9)
    buffer_load_dwordx4 v222, s[48:51], s34 offen sc1 lds
    v_mfma_f32_16x16x32_bf16 v[112:115], a[56:59], v[168:171], v[112:115]
    ds_read_b128 v[164:167], v193 offset:9216
    v_mfma_f32_16x16x32_bf16 v[116:119], a[60:63], v[168:171], v[116:119]
    v_rcp_f32 v28, v28
    v_mfma_f32_16x16x32_bf16 v[120:123], a[56:59], v[172:175], v[120:123]
    ds_read_b128 v[168:171], v193 offset:10240
    v_mfma_f32_16x16x32_bf16 v[124:127], a[60:63], v[172:175], v[124:127]
    s_waitcnt vmcnt(23) lgkmcnt(9)
    buffer_load_dwordx4 v216, s[48:51], s34 offen offset:1024 sc1 lds
    v_mfma_f32_16x16x32_bf16 v[80:83], a[160:163], v[128:131], v[80:83]
    ds_read_b128 v[172:175], v193 offset:11264
    v_mfma_f32_16x16x32_bf16 v[84:87], a[164:167], v[128:131], v[84:87]
    v_rcp_f32 v29, v29
    v_mfma_f32_16x16x32_bf16 v[88:91], a[160:163], v[132:135], v[88:91]
    s_xor_b32 s34, s0, s76
    s_add_u32 m0, s68, 16384
    ds_read_b128 v[128:131], v193 offset:12288
    v_mfma_f32_16x16x32_bf16 v[92:95], a[164:167], v[132:135], v[92:95]
    s_waitcnt lgkmcnt(9)
    buffer_load_dwordx4 v222, s[48:51], s34 offen sc1 lds
    v_mfma_f32_16x16x32_bf16 v[96:99], a[160:163], v[136:139], v[96:99]
    ds_read_b128 v[132:135], v193 offset:13312
    v_mfma_f32_16x16x32_bf16 v[100:103], a[164:167], v[136:139], v[100:103]
    v_rcp_f32 v30, v30
    v_mfma_f32_16x16x32_bf16 v[104:107], a[160:163], v[140:143], v[104:107]
    ds_read_b128 v[136:139], v193 offset:14336
    v_mfma_f32_16x16x32_bf16 v[108:111], a[164:167], v[140:143], v[108:111]
    s_waitcnt lgkmcnt(9)
    buffer_load_dwordx4 v216, s[48:51], s34 offen offset:1024 sc1 lds
    v_mfma_f32_16x16x32_bf16 v[112:115], a[160:163], v[144:147], v[112:115]
    ds_read_b128 v[140:143], v193 offset:15360
    v_mfma_f32_16x16x32_bf16 v[116:119], a[164:167], v[144:147], v[116:119]
    v_rcp_f32 v31, v31
    v_mfma_f32_16x16x32_bf16 v[120:123], a[160:163], v[148:151], v[120:123]
    s_xor_b32 s34, s0, s79
    s_add_u32 m0, s68, 24576
    ds_read_b128 v[144:147], v193 offset:16384
    v_mul_f32 v16, v16, v176
    v_mfma_f32_16x16x32_bf16 v[124:127], a[164:167], v[148:151], v[124:127]
    s_waitcnt lgkmcnt(9)
    buffer_load_dwordx4 v222, s[48:51], s34 offen sc1 lds
    v_mfma_f32_16x16x32_bf16 v[80:83], a[168:171], v[152:155], v[80:83]
    ds_read_b128 v[148:151], v193 offset:17408
    v_mul_f32 v17, v17, v177
    v_mfma_f32_16x16x32_bf16 v[84:87], a[172:175], v[152:155], v[84:87]
    v_mul_f32 v18, v18, v178
    v_mul_f32 v19, v19, v179
    v_mfma_f32_16x16x32_bf16 v[88:91], a[168:171], v[156:159], v[88:91]
    ds_read_b128 v[152:155], v193 offset:18432
    v_mul_f32 v20, v20, v180
    v_mfma_f32_16x16x32_bf16 v[92:95], a[172:175], v[156:159], v[92:95]
    s_waitcnt lgkmcnt(9)
    buffer_load_dwordx4 v216, s[48:51], s34 offen offset:1024 sc1 lds
    v_mfma_f32_16x16x32_bf16 v[96:99], a[168:171], v[160:163], v[96:99]
    ds_read_b128 v[156:159], v193 offset:19456
    v_mul_f32 v21, v21, v181
    v_mfma_f32_16x16x32_bf16 v[100:103], a[172:175], v[160:163], v[100:103]
    v_mul_f32 v22, v22, v182
    v_mul_f32 v23, v23, v183
    v_mfma_f32_16x16x32_bf16 v[104:107], a[168:171], v[164:167], v[104:107]
    s_xor_b32 s34, s0, s82
    s_add_u32 m0, s68, 131072
    ds_read_b128 v[160:163], v193 offset:20480
    v_mul_f32 v24, v24, v184
    v_mfma_f32_16x16x32_bf16 v[108:111], a[172:175], v[164:167], v[108:111]
    s_waitcnt lgkmcnt(9)
    buffer_load_dwordx4 v222, s[48:51], s34 offen sc1 lds
    v_mfma_f32_16x16x32_bf16 v[112:115], a[168:171], v[168:171], v[112:115]
    ds_read_b128 v[164:167], v193 offset:21504
    v_mul_f32 v25, v25, v185
    v_mfma_f32_16x16x32_bf16 v[116:119], a[172:175], v[168:171], v[116:119]
    v_mul_f32 v26, v26, v186
    v_mul_f32 v27, v27, v187
    v_mfma_f32_16x16x32_bf16 v[120:123], a[168:171], v[172:175], v[120:123]
    ds_read_b128 v[168:171], v193 offset:22528
    v_mul_f32 v28, v28, v188
    v_mfma_f32_16x16x32_bf16 v[124:127], a[172:175], v[172:175], v[124:127]
    s_waitcnt lgkmcnt(9)
    buffer_load_dwordx4 v216, s[48:51], s34 offen offset:1024 sc1 lds
    v_mfma_f32_16x16x32_bf16 v[80:83], a[176:179], v[128:131], v[80:83]
    ds_read_b128 v[172:175], v193 offset:23552
    v_mul_f32 v29, v29, v189
    v_mfma_f32_16x16x32_bf16 v[84:87], a[180:183], v[128:131], v[84:87]
    v_mul_f32 v30, v30, v190
    v_mul_f32 v31, v31, v191
    v_mfma_f32_16x16x32_bf16 v[88:91], a[176:179], v[132:135], v[88:91]
    s_xor_b32 s34, s0, s77
    s_add_u32 m0, s68, 139264
    v_cvt_pk_bf16_f32 v16, v16, v17
    v_cvt_pk_bf16_f32 v18, v18, v19
    v_mfma_f32_16x16x32_bf16 v[92:95], a[180:183], v[132:135], v[92:95]
    s_waitcnt lgkmcnt(8)
    buffer_load_dwordx4 v222, s[48:51], s34 offen sc1 lds
    v_mfma_f32_16x16x32_bf16 v[96:99], a[176:179], v[136:139], v[96:99]
    v_cvt_pk_bf16_f32 v20, v20, v21
    v_cvt_pk_bf16_f32 v22, v22, v23
    v_mfma_f32_16x16x32_bf16 v[100:103], a[180:183], v[136:139], v[100:103]
    v_cvt_pk_bf16_f32 v24, v24, v25
    v_cvt_pk_bf16_f32 v26, v26, v27
    v_mfma_f32_16x16x32_bf16 v[104:107], a[176:179], v[140:143], v[104:107]
    v_cvt_pk_bf16_f32 v28, v28, v29
    v_cvt_pk_bf16_f32 v30, v30, v31
    v_mfma_f32_16x16x32_bf16 v[108:111], a[180:183], v[140:143], v[108:111]
    s_waitcnt lgkmcnt(6)
    buffer_load_dwordx4 v216, s[48:51], s34 offen offset:1024 sc1 lds
    v_mfma_f32_16x16x32_bf16 v[112:115], a[176:179], v[144:147], v[112:115]
    s_waitcnt vmcnt(14) lgkmcnt(0)
    v_lshlrev_b32 v176, 16, v16
    v_and_b32 v177, 0xffff0000, v16
    v_mfma_f32_16x16x32_bf16 v[116:119], a[180:183], v[144:147], v[116:119]
    s_barrier
    v_lshlrev_b32 v178, 16, v18
    v_and_b32 v179, 0xffff0000, v18
    v_mfma_f32_16x16x32_bf16 v[120:123], a[176:179], v[148:151], v[120:123]
    ds_read_b128 v[128:131], v192 offset:0
    v_lshlrev_b32 v180, 16, v20
    v_mfma_f32_16x16x32_bf16 v[124:127], a[180:183], v[148:151], v[124:127]
    s_waitcnt lgkmcnt(5)
    ds_read_b128 v[132:135], v192 offset:1024
    v_and_b32 v181, 0xffff0000, v20
    v_mfma_f32_16x16x32_bf16 v[80:83], a[184:187], v[152:155], v[80:83]
    ds_read_b128 v[136:139], v192 offset:6144
    v_lshlrev_b32 v182, 16, v22
    v_mfma_f32_16x16x32_bf16 v[84:87], a[188:191], v[152:155], v[84:87]
    ds_read_b128 v[140:143], v192 offset:7168
    v_and_b32 v183, 0xffff0000, v22
    v_mfma_f32_16x16x32_bf16 v[88:91], a[184:187], v[156:159], v[88:91]
    ds_read_b128 v[144:147], v192 offset:12288
    v_lshlrev_b32 v184, 16, v24
    v_mfma_f32_16x16x32_bf16 v[92:95], a[188:191], v[156:159], v[92:95]
    s_waitcnt lgkmcnt(7)
    ds_read_b128 v[148:151], v192 offset:13312
    v_and_b32 v185, 0xffff0000, v24
    v_mfma_f32_16x16x32_bf16 v[96:99], a[184:187], v[160:163], v[96:99]
    ds_read_b128 v[152:155], v192 offset:18432
    v_lshlrev_b32 v186, 16, v26
    v_mfma_f32_16x16x32_bf16 v[100:103], a[188:191], v[160:163], v[100:103]
    ds_read_b128 v[156:159], v192 offset:19456
    v_and_b32 v187, 0xffff0000, v26
    v_mfma_f32_16x16x32_bf16 v[104:107], a[184:187], v[164:167], v[104:107]
    s_xor_b32 s34, s0, s78
    s_add_u32 m0, s68, 147456
    ds_read_b128 v[160:163], v192 offset:2048
    v_lshlrev_b32 v188, 16, v28
    v_mfma_f32_16x16x32_bf16 v[108:111], a[188:191], v[164:167], v[108:111]
    s_waitcnt lgkmcnt(9)
    buffer_load_dwordx4 v222, s[48:51], s34 offen sc1 lds
    v_mfma_f32_16x16x32_bf16 v[112:115], a[184:187], v[168:171], v[112:115]
    ds_read_b128 v[164:167], v192 offset:3072
    v_and_b32 v189, 0xffff0000, v28
    v_mfma_f32_16x16x32_bf16 v[116:119], a[188:191], v[168:171], v[116:119]
    v_lshlrev_b32 v190, 16, v30
    v_and_b32 v191, 0xffff0000, v30
    v_mfma_f32_16x16x32_bf16 v[120:123], a[184:187], v[172:175], v[120:123]
    s_waitcnt vmcnt(39)
    ds_read_b128 v[168:171], v192 offset:8192
    v_lshlrev_b32 v32, 16, v48
    v_mfma_f32_16x16x32_bf16 v[124:127], a[188:191], v[172:175], v[124:127]
    s_waitcnt vmcnt(13) lgkmcnt(9)
    buffer_load_dwordx4 v216, s[48:51], s34 offen offset:1024 sc1 lds
    v_mfma_f32_16x16x32_bf16 v[80:83], a[224:227], v[128:131], v[80:83]
    ds_read_b128 v[172:175], v192 offset:9216
    v_and_b32 v33, 0xffff0000, v48
    v_mfma_f32_16x16x32_bf16 v[84:87], a[228:231], v[128:131], v[84:87]
    v_lshlrev_b32 v34, 16, v49
    v_and_b32 v35, 0xffff0000, v49
    v_mfma_f32_16x16x32_bf16 v[88:91], a[224:227], v[132:135], v[88:91]
    ds_read_b128 v[128:131], v192 offset:14336
    v_lshlrev_b32 v36, 16, v50
    v_mfma_f32_16x16x32_bf16 v[92:95], a[228:231], v[132:135], v[92:95]
    s_waitcnt lgkmcnt(9)
    v_and_b32 v37, 0xffff0000, v50
    v_lshlrev_b32 v38, 16, v51
    v_mfma_f32_16x16x32_bf16 v[80:83], a[232:235], v[136:139], v[80:83]
    ds_read_b128 v[132:135], v192 offset:15360
    v_and_b32 v39, 0xffff0000, v51
    v_mfma_f32_16x16x32_bf16 v[84:87], a[236:239], v[136:139], v[84:87]
    v_lshlrev_b32 v40, 16, v52
    v_and_b32 v41, 0xffff0000, v52
    v_mfma_f32_16x16x32_bf16 v[88:91], a[232:235], v[140:143], v[88:91]
    ds_read_b128 v[136:139], v192 offset:20480
    v_lshlrev_b32 v42, 16, v53
    v_mfma_f32_16x16x32_bf16 v[92:95], a[236:239], v[140:143], v[92:95]
    s_waitcnt lgkmcnt(9)
    v_and_b32 v43, 0xffff0000, v53
    v_lshlrev_b32 v44, 16, v54
    v_mfma_f32_16x16x32_bf16 v[80:83], a[240:243], v[144:147], v[80:83]
    ds_read_b128 v[140:143], v192 offset:21504
    v_and_b32 v45, 0xffff0000, v54
    v_mfma_f32_16x16x32_bf16 v[84:87], a[244:247], v[144:147], v[84:87]
    v_lshlrev_b32 v46, 16, v55
    v_and_b32 v47, 0xffff0000, v55
    v_mfma_f32_16x16x32_bf16 v[88:91], a[240:243], v[148:151], v[88:91]
    ds_read_b128 v[144:147], v192 offset:4096
    v_lshrrev_b32 v8, 8, v222
    v_mfma_f32_16x16x32_bf16 v[92:95], a[244:247], v[148:151], v[92:95]
    s_waitcnt lgkmcnt(9)
    v_bfe_u32 v9, v222, 6, 2
    v_and_b32 v12, 16, v222
    v_mfma_f32_16x16x32_bf16 v[80:83], a[248:251], v[152:155], v[80:83]
    ds_read_b128 v[148:151], v192 offset:5120
    v_mov_b32 v11, 0x3f80
    v_mfma_f32_16x16x32_bf16 v[84:87], a[252:255], v[152:155], v[84:87]
    v_cmp_eq_u32 vcc, v8, v9
    v_lshlrev_b32 v11, v12, v11
    v_mfma_f32_16x16x32_bf16 v[88:91], a[248:251], v[156:159], v[88:91]
    ds_read_b128 v[152:155], v192 offset:10240
    v_and_b32 v13, 32, v222
    v_mfma_f32_16x16x32_bf16 v[92:95], a[252:255], v[156:159], v[92:95]
    s_waitcnt lgkmcnt(9)
    v_cndmask_b32 v11, 0, v11, vcc
    v_cmp_eq_u32 vcc, 0, v13
    v_mfma_f32_16x16x32_bf16 v[96:99], a[224:227], v[160:163], v[96:99]
    ds_read_b128 v[156:159], v192 offset:11264
    v_mov_b32 v8, 0
    v_mfma_f32_16x16x32_bf16 v[100:103], a[228:231], v[160:163], v[100:103]
    v_cndmask_b32 v10, 0, v11, vcc
    v_mov_b32 v9, 0
    v_mfma_f32_16x16x32_bf16 v[104:107], a[224:227], v[164:167], v[104:107]
    ds_read_b128 v[160:163], v192 offset:16384
    v_mov_b32 v12, 0
    v_mfma_f32_16x16x32_bf16 v[108:111], a[228:231], v[164:167], v[108:111]
    s_waitcnt lgkmcnt(9)
    v_xor_b32 v11, v11, v10
    v_mov_b32 v13, 0
    v_mfma_f32_16x16x32_bf16 v[96:99], a[232:235], v[168:171], v[96:99]
    s_add_u32 s42, s98, 4096
    ds_read_b128 v[164:167], v192 offset:17408
    v_cvt_pk_bf16_f32 v80, v80, v81
    v_mfma_f32_16x16x32_bf16 v[100:103], a[236:239], v[168:171], v[100:103]
    v_cvt_pk_bf16_f32 v81, v82, v83
    v_cvt_pk_bf16_f32 v82, v84, v85
    v_mfma_f32_16x16x32_bf16 v[104:107], a[232:235], v[172:175], v[104:107]
    ds_read_b128 v[168:171], v192 offset:22528
    v_cvt_pk_bf16_f32 v83, v86, v87
    v_mfma_f32_16x16x32_bf16 v[108:111], a[236:239], v[172:175], v[108:111]
    s_waitcnt lgkmcnt(9)
    buffer_store_dwordx4 v[80:83], v222, s[48:51], s42 offen offset:0 sc1
    v_mfma_f32_16x16x32_bf16 v[96:99], a[240:243], v[128:131], v[96:99]
    ds_read_b128 v[172:175], v192 offset:23552
    v_cvt_pk_bf16_f32 v84, v88, v89
    v_mfma_f32_16x16x32_bf16 v[100:103], a[244:247], v[128:131], v[100:103]
    v_cvt_pk_bf16_f32 v85, v90, v91
    v_cvt_pk_bf16_f32 v86, v92, v93
    v_mfma_f32_16x16x32_bf16 v[104:107], a[240:243], v[132:135], v[104:107]
    v_cvt_pk_bf16_f32 v87, v94, v95
    v_mfma_f32_16x16x32_bf16 v[108:111], a[244:247], v[132:135], v[108:111]
    s_waitcnt lgkmcnt(8)
    buffer_store_dwordx4 v[84:87], v222, s[48:51], s42 offen offset:1024 sc1
    v_mfma_f32_16x16x32_bf16 v[96:99], a[248:251], v[136:139], v[96:99]
    v_mfma_f32_16x16x32_bf16 v[100:103], a[252:255], v[136:139], v[100:103]
    v_mfma_f32_16x16x32_bf16 v[104:107], a[248:251], v[140:143], v[104:107]
    v_mfma_f32_16x16x32_bf16 v[108:111], a[252:255], v[140:143], v[108:111]
    s_waitcnt lgkmcnt(6)
    v_mfma_f32_16x16x32_bf16 v[112:115], a[224:227], v[144:147], v[112:115]
    s_waitcnt vmcnt(2) lgkmcnt(0)
    v_mfma_f32_16x16x32_bf16 v[116:119], a[228:231], v[144:147], v[116:119]
    s_barrier
    v_mfma_f32_16x16x32_bf16 v[120:123], a[224:227], v[148:151], v[120:123]
    ds_read_b128 v[128:131], v222 offset:0
    v_mfma_f32_16x16x32_bf16 v[124:127], a[228:231], v[148:151], v[124:127]
    s_waitcnt lgkmcnt(5)
    ds_read_b128 v[132:135], v222 offset:1024
    v_mfma_f32_16x16x32_bf16 v[112:115], a[232:235], v[152:155], v[112:115]
    ds_read_b128 v[136:139], v222 offset:2048
    v_mfma_f32_16x16x32_bf16 v[116:119], a[236:239], v[152:155], v[116:119]
    s_add_u32 s42, s98, 8192
    ds_read_b128 v[140:143], v222 offset:3072
    v_cvt_pk_bf16_f32 v96, v96, v97
    v_mfma_f32_16x16x32_bf16 v[120:123], a[232:235], v[156:159], v[120:123]
    ds_read_b128 v[144:147], v222 offset:4096
    v_cvt_pk_bf16_f32 v97, v98, v99
    v_mfma_f32_16x16x32_bf16 v[124:127], a[236:239], v[156:159], v[124:127]
    s_waitcnt lgkmcnt(7)
    ds_read_b128 v[148:151], v222 offset:5120
    v_cvt_pk_bf16_f32 v98, v100, v101
    v_mfma_f32_16x16x32_bf16 v[112:115], a[240:243], v[160:163], v[112:115]
    ds_read_b128 v[152:155], v222 offset:6144
    v_cvt_pk_bf16_f32 v99, v102, v103
    v_mfma_f32_16x16x32_bf16 v[116:119], a[244:247], v[160:163], v[116:119]
    ds_read_b128 v[156:159], v222 offset:7168
    v_mfma_f32_16x16x32_bf16 v[120:123], a[240:243], v[164:167], v[120:123]
    ds_read_b128 v[160:163], v222 offset:8192
    v_mfma_f32_16x16x32_bf16 v[124:127], a[244:247], v[164:167], v[124:127]
    s_waitcnt lgkmcnt(9)
    buffer_store_dwordx4 v[96:99], v222, s[48:51], s42 offen offset:0 sc1
    v_mfma_f32_16x16x32_bf16 v[112:115], a[248:251], v[168:171], v[112:115]
    ds_read_b128 v[164:167], v222 offset:9216
    v_cvt_pk_bf16_f32 v100, v104, v105
    v_mfma_f32_16x16x32_bf16 v[116:119], a[252:255], v[168:171], v[116:119]
    v_cvt_pk_bf16_f32 v101, v106, v107
    v_cvt_pk_bf16_f32 v102, v108, v109
    v_mfma_f32_16x16x32_bf16 v[120:123], a[248:251], v[172:175], v[120:123]
    ds_read_b128 v[168:171], v222 offset:10240
    v_cvt_pk_bf16_f32 v103, v110, v111
    v_mfma_f32_16x16x32_bf16 v[124:127], a[252:255], v[172:175], v[124:127]
    s_waitcnt lgkmcnt(9)
    buffer_store_dwordx4 v[100:103], v222, s[48:51], s42 offen offset:1024 sc1
    v_mfma_f32_16x16x32_bf16 v[64:67], v[224:227], v[128:131], 0
    ds_read_b128 v[172:175], v222 offset:11264
    v_mfma_f32_16x16x32_bf16 v[68:71], v[228:231], v[128:131], 0
    v_mfma_f32_16x16x32_bf16 v[72:75], v[224:227], v[132:135], 0
    ds_read_b128 v[128:131], v222 offset:12288
    v_mfma_f32_16x16x32_bf16 v[76:79], v[228:231], v[132:135], 0
    s_waitcnt lgkmcnt(9)
    v_mfma_f32_16x16x32_bf16 v[64:67], v[232:235], v[136:139], v[64:67]
    ds_read_b128 v[132:135], v222 offset:13312
    v_mfma_f32_16x16x32_bf16 v[68:71], v[236:239], v[136:139], v[68:71]
    s_add_u32 s42, s98, 12288
    v_cvt_pk_bf16_f32 v112, v112, v113
    v_cvt_pk_bf16_f32 v113, v114, v115
    v_mfma_f32_16x16x32_bf16 v[72:75], v[232:235], v[140:143], v[72:75]
    ds_read_b128 v[136:139], v222 offset:14336
    v_cvt_pk_bf16_f32 v114, v116, v117
    v_mfma_f32_16x16x32_bf16 v[76:79], v[236:239], v[140:143], v[76:79]
    s_waitcnt lgkmcnt(9)
    v_cvt_pk_bf16_f32 v115, v118, v119
    v_mfma_f32_16x16x32_bf16 v[64:67], v[240:243], v[144:147], v[64:67]
    ds_read_b128 v[140:143], v222 offset:15360
    v_mfma_f32_16x16x32_bf16 v[68:71], v[244:247], v[144:147], v[68:71]
    buffer_store_dwordx4 v[112:115], v222, s[48:51], s42 offen offset:0 sc1
    v_mfma_f32_16x16x32_bf16 v[72:75], v[240:243], v[148:151], v[72:75]
    ds_read_b128 v[144:147], v222 offset:16384
    v_cvt_pk_bf16_f32 v116, v120, v121
    v_mfma_f32_16x16x32_bf16 v[76:79], v[244:247], v[148:151], v[76:79]
    s_waitcnt lgkmcnt(9)
    v_cvt_pk_bf16_f32 v117, v122, v123
    v_cvt_pk_bf16_f32 v118, v124, v125
    v_mfma_f32_16x16x32_bf16 v[64:67], v[248:251], v[152:155], v[64:67]
    ds_read_b128 v[148:151], v222 offset:17408
    v_cvt_pk_bf16_f32 v119, v126, v127
    v_mfma_f32_16x16x32_bf16 v[68:71], v[252:255], v[152:155], v[68:71]
    buffer_store_dwordx4 v[116:119], v222, s[48:51], s42 offen offset:1024 sc1
    v_mfma_f32_16x16x32_bf16 v[72:75], v[248:251], v[156:159], v[72:75]
    s_xor_b32 s53, s98, 65536
    s_add_u32 s53, s53, 4096
    ds_read_b128 v[152:155], v222 offset:18432
    v_mfma_f32_16x16x32_bf16 v[76:79], v[252:255], v[156:159], v[76:79]
    s_waitcnt lgkmcnt(9)
    v_mfma_f32_16x16x32_bf16 v[64:67], a[192:195], v[160:163], v[64:67]
    s_xor_b32 s54, s98, 131072
    s_add_u32 s54, s54, 8192
    ds_read_b128 v[156:159], v222 offset:19456
    v_mfma_f32_16x16x32_bf16 v[68:71], a[196:199], v[160:163], v[68:71]
    s_xor_b32 s55, s98, 196608
    s_add_u32 s55, s55, 12288
    v_mfma_f32_16x16x32_bf16 v[72:75], a[192:195], v[164:167], v[72:75]
    ds_read_b128 v[160:163], v222 offset:20480
    v_mfma_f32_16x16x32_bf16 v[76:79], a[196:199], v[164:167], v[76:79]
    s_waitcnt lgkmcnt(9)
    v_mfma_f32_16x16x32_bf16 v[64:67], a[200:203], v[168:171], v[64:67]
    ds_read_b128 v[164:167], v222 offset:21504
    v_mfma_f32_16x16x32_bf16 v[68:71], a[204:207], v[168:171], v[68:71]
    v_mfma_f32_16x16x32_bf16 v[72:75], a[200:203], v[172:175], v[72:75]
    ds_read_b128 v[168:171], v222 offset:22528
    v_mfma_f32_16x16x32_bf16 v[76:79], a[204:207], v[172:175], v[76:79]
    s_waitcnt lgkmcnt(9)
    v_mfma_f32_16x16x32_bf16 v[64:67], a[208:211], v[128:131], v[64:67]
    ds_read_b128 v[172:175], v222 offset:23552
    v_mfma_f32_16x16x32_bf16 v[68:71], a[212:215], v[128:131], v[68:71]
    v_mfma_f32_16x16x32_bf16 v[72:75], a[208:211], v[132:135], v[72:75]
    ds_read_b128 v[128:131], v222 offset:24576
    v_mfma_f32_16x16x32_bf16 v[76:79], a[212:215], v[132:135], v[76:79]
    s_waitcnt lgkmcnt(9)
    v_mfma_f32_16x16x32_bf16 v[64:67], a[216:219], v[136:139], v[64:67]
    ds_read_b128 v[132:135], v222 offset:25600
    v_mfma_f32_16x16x32_bf16 v[68:71], a[220:223], v[136:139], v[68:71]
    v_mfma_f32_16x16x32_bf16 v[72:75], a[216:219], v[140:143], v[72:75]
    ds_read_b128 v[136:139], v222 offset:26624
    v_mfma_f32_16x16x32_bf16 v[76:79], a[220:223], v[140:143], v[76:79]
    s_waitcnt lgkmcnt(9)
    v_mfma_f32_16x16x32_bf16 v[64:67], a[128:131], v[144:147], v[64:67]
    ds_read_b128 v[140:143], v222 offset:27648
    v_mfma_f32_16x16x32_bf16 v[68:71], a[132:135], v[144:147], v[68:71]
    v_mfma_f32_16x16x32_bf16 v[72:75], a[128:131], v[148:151], v[72:75]
    ds_read_b128 v[144:147], v222 offset:28672
    v_mfma_f32_16x16x32_bf16 v[76:79], a[132:135], v[148:151], v[76:79]
    s_waitcnt lgkmcnt(9)
    v_mfma_f32_16x16x32_bf16 v[64:67], a[136:139], v[152:155], v[64:67]
    ds_read_b128 v[148:151], v222 offset:29696
    v_mfma_f32_16x16x32_bf16 v[68:71], a[140:143], v[152:155], v[68:71]
    v_mfma_f32_16x16x32_bf16 v[72:75], a[136:139], v[156:159], v[72:75]
    ds_read_b128 v[152:155], v222 offset:30720
    v_mfma_f32_16x16x32_bf16 v[76:79], a[140:143], v[156:159], v[76:79]
    s_waitcnt lgkmcnt(9)
    v_mfma_f32_16x16x32_bf16 v[64:67], a[144:147], v[160:163], v[64:67]
    ds_read_b128 v[156:159], v222 offset:31744
    v_mfma_f32_16x16x32_bf16 v[68:71], a[148:151], v[160:163], v[68:71]
    v_mfma_f32_16x16x32_bf16 v[72:75], a[144:147], v[164:167], v[72:75]
    ds_read_b128 v[160:163], v193 offset:32768
    v_mfma_f32_16x16x32_bf16 v[76:79], a[148:151], v[164:167], v[76:79]
    s_waitcnt lgkmcnt(9)
    v_mfma_f32_16x16x32_bf16 v[64:67], a[152:155], v[168:171], v[64:67]
    ds_read_b128 v[164:167], v193 offset:33792
    v_mfma_f32_16x16x32_bf16 v[68:71], a[156:159], v[168:171], v[68:71]
    v_mfma_f32_16x16x32_bf16 v[72:75], a[152:155], v[172:175], v[72:75]
    ds_read_b128 v[168:171], v193 offset:34816
    v_mfma_f32_16x16x32_bf16 v[76:79], a[156:159], v[172:175], v[76:79]
    s_waitcnt lgkmcnt(9)
    v_mfma_f32_16x16x32_bf16 v[64:67], a[0:3], v[128:131], v[64:67]
    ds_read_b128 v[172:175], v193 offset:35840
    v_mfma_f32_16x16x32_bf16 v[68:71], a[4:7], v[128:131], v[68:71]
    v_mfma_f32_16x16x32_bf16 v[72:75], a[0:3], v[132:135], v[72:75]
    ds_read_b128 v[128:131], v193 offset:36864
    v_mfma_f32_16x16x32_bf16 v[76:79], a[4:7], v[132:135], v[76:79]
    s_waitcnt lgkmcnt(9)
    v_mfma_f32_16x16x32_bf16 v[64:67], a[8:11], v[136:139], v[64:67]
    ds_read_b128 v[132:135], v193 offset:37888
    v_mfma_f32_16x16x32_bf16 v[68:71], a[12:15], v[136:139], v[68:71]
    v_mfma_f32_16x16x32_bf16 v[72:75], a[8:11], v[140:143], v[72:75]
    ds_read_b128 v[136:139], v193 offset:38912
    v_mfma_f32_16x16x32_bf16 v[76:79], a[12:15], v[140:143], v[76:79]
    s_waitcnt lgkmcnt(9)
    v_mfma_f32_16x16x32_bf16 v[64:67], a[16:19], v[144:147], v[64:67]
    ds_read_b128 v[140:143], v193 offset:39936
    v_mfma_f32_16x16x32_bf16 v[68:71], a[20:23], v[144:147], v[68:71]
    v_mfma_f32_16x16x32_bf16 v[72:75], a[16:19], v[148:151], v[72:75]
    ds_read_b128 v[144:147], v193 offset:40960
    v_mfma_f32_16x16x32_bf16 v[76:79], a[20:23], v[148:151], v[76:79]
    s_waitcnt lgkmcnt(9)
    v_mfma_f32_16x16x32_bf16 v[64:67], a[24:27], v[152:155], v[64:67]
    ds_read_b128 v[148:151], v193 offset:41984
    v_mfma_f32_16x16x32_bf16 v[68:71], a[28:31], v[152:155], v[68:71]
    v_mfma_f32_16x16x32_bf16 v[72:75], a[24:27], v[156:159], v[72:75]
    ds_read_b128 v[152:155], v193 offset:43008
    v_mfma_f32_16x16x32_bf16 v[76:79], a[28:31], v[156:159], v[76:79]
    s_waitcnt lgkmcnt(9)
    v_mfma_f32_16x16x32_bf16 v[64:67], a[32:35], v[160:163], v[64:67]
    ds_read_b128 v[156:159], v193 offset:44032
    v_mfma_f32_16x16x32_bf16 v[68:71], a[36:39], v[160:163], v[68:71]
    v_mfma_f32_16x16x32_bf16 v[72:75], a[32:35], v[164:167], v[72:75]
    ds_read_b128 v[160:163], v193 offset:45056
    v_mfma_f32_16x16x32_bf16 v[76:79], a[36:39], v[164:167], v[76:79]
    s_waitcnt lgkmcnt(9)
    v_mfma_f32_16x16x32_bf16 v[64:67], a[40:43], v[168:171], v[64:67]
    ds_read_b128 v[164:167], v193 offset:46080
    v_mfma_f32_16x16x32_bf16 v[68:71], a[44:47], v[168:171], v[68:71]
    v_mfma_f32_16x16x32_bf16 v[72:75], a[40:43], v[172:175], v[72:75]
    ds_read_b128 v[168:171], v193 offset:47104
    v_mfma_f32_16x16x32_bf16 v[76:79], a[44:47], v[172:175], v[76:79]
    s_waitcnt lgkmcnt(9)
    buffer_load_dwordx4 v[88:91], v222, s[48:51], s53 offen offset:0 sc1
    v_mfma_f32_16x16x32_bf16 v[64:67], a[48:51], v[128:131], v[64:67]
    ds_read_b128 v[172:175], v193 offset:48128
    v_mfma_f32_16x16x32_bf16 v[68:71], a[52:55], v[128:131], v[68:71]
    buffer_load_dwordx4 v[92:95], v222, s[48:51], s53 offen offset:1024 sc1
    v_mfma_f32_16x16x32_bf16 v[72:75], a[48:51], v[132:135], v[72:75]
    ds_read_b128 v[128:131], v193 offset:49152
    v_mfma_f32_16x16x32_bf16 v[76:79], a[52:55], v[132:135], v[76:79]
    s_waitcnt lgkmcnt(9)
    buffer_load_dwordx4 v[104:107], v222, s[48:51], s54 offen offset:0 sc1
    v_mfma_f32_16x16x32_bf16 v[64:67], a[56:59], v[136:139], v[64:67]
    ds_read_b128 v[132:135], v193 offset:50176
    v_mfma_f32_16x16x32_bf16 v[68:71], a[60:63], v[136:139], v[68:71]
    buffer_load_dwordx4 v[108:111], v222, s[48:51], s54 offen offset:1024 sc1
    v_mfma_f32_16x16x32_bf16 v[72:75], a[56:59], v[140:143], v[72:75]
    ds_read_b128 v[136:139], v193 offset:51200
    v_mfma_f32_16x16x32_bf16 v[76:79], a[60:63], v[140:143], v[76:79]
    s_waitcnt lgkmcnt(9)
    buffer_load_dwordx4 v[120:123], v222, s[48:51], s55 offen offset:0 sc1
    v_mfma_f32_16x16x32_bf16 v[64:67], a[160:163], v[144:147], v[64:67]
    ds_read_b128 v[140:143], v193 offset:52224
    v_mfma_f32_16x16x32_bf16 v[68:71], a[164:167], v[144:147], v[68:71]
    buffer_load_dwordx4 v[124:127], v222, s[48:51], s55 offen offset:1024 sc1
    v_mfma_f32_16x16x32_bf16 v[72:75], a[160:163], v[148:151], v[72:75]
    ds_read_b128 v[144:147], v193 offset:53248
    v_mfma_f32_16x16x32_bf16 v[76:79], a[164:167], v[148:151], v[76:79]
    s_waitcnt lgkmcnt(9)
    v_mfma_f32_16x16x32_bf16 v[64:67], a[168:171], v[152:155], v[64:67]
    ds_read_b128 v[148:151], v193 offset:54272
    v_mfma_f32_16x16x32_bf16 v[68:71], a[172:175], v[152:155], v[68:71]
    v_mfma_f32_16x16x32_bf16 v[72:75], a[168:171], v[156:159], v[72:75]
    ds_read_b128 v[152:155], v193 offset:55296
    v_mfma_f32_16x16x32_bf16 v[76:79], a[172:175], v[156:159], v[76:79]
    s_waitcnt lgkmcnt(9)
    v_mfma_f32_16x16x32_bf16 v[64:67], a[176:179], v[160:163], v[64:67]
    ds_read_b128 v[156:159], v193 offset:56320
    v_mfma_f32_16x16x32_bf16 v[68:71], a[180:183], v[160:163], v[68:71]
    v_mfma_f32_16x16x32_bf16 v[72:75], a[176:179], v[164:167], v[72:75]
    v_mfma_f32_16x16x32_bf16 v[76:79], a[180:183], v[164:167], v[76:79]
    s_waitcnt lgkmcnt(8)
    v_mfma_f32_16x16x32_bf16 v[64:67], a[184:187], v[168:171], v[64:67]
    v_mfma_f32_16x16x32_bf16 v[68:71], a[188:191], v[168:171], v[68:71]
    v_mfma_f32_16x16x32_bf16 v[72:75], a[184:187], v[172:175], v[72:75]
    v_mfma_f32_16x16x32_bf16 v[76:79], a[188:191], v[172:175], v[76:79]
    s_waitcnt lgkmcnt(6)
    v_mfma_f32_16x16x32_bf16 v[64:67], a[224:227], v[128:131], v[64:67]
    v_mfma_f32_16x16x32_bf16 v[68:71], a[228:231], v[128:131], v[68:71]
    v_mfma_f32_16x16x32_bf16 v[72:75], a[224:227], v[132:135], v[72:75]
    v_mfma_f32_16x16x32_bf16 v[76:79], a[228:231], v[132:135], v[76:79]
    s_waitcnt lgkmcnt(4)
    v_mfma_f32_16x16x32_bf16 v[64:67], a[232:235], v[136:139], v[64:67]
    v_mfma_f32_16x16x32_bf16 v[68:71], a[236:239], v[136:139], v[68:71]
    v_mfma_f32_16x16x32_bf16 v[72:75], a[232:235], v[140:143], v[72:75]
    v_mfma_f32_16x16x32_bf16 v[76:79], a[236:239], v[140:143], v[76:79]
    s_waitcnt lgkmcnt(2)
    v_mfma_f32_16x16x32_bf16 v[64:67], a[240:243], v[144:147], v[64:67]
    v_mfma_f32_16x16x32_bf16 v[68:71], a[244:247], v[144:147], v[68:71]
    v_mfma_f32_16x16x32_bf16 v[72:75], a[240:243], v[148:151], v[72:75]
    v_mfma_f32_16x16x32_bf16 v[76:79], a[244:247], v[148:151], v[76:79]
    s_waitcnt lgkmcnt(0)
    v_mfma_f32_16x16x32_bf16 v[64:67], a[248:251], v[152:155], v[64:67]
    v_mfma_f32_16x16x32_bf16 v[68:71], a[252:255], v[152:155], v[68:71]
    v_mfma_f32_16x16x32_bf16 v[72:75], a[248:251], v[156:159], v[72:75]
    v_mfma_f32_16x16x32_bf16 v[76:79], a[252:255], v[156:159], v[76:79]
    s_waitcnt vmcnt(0)
    s_branch F_FIN
F_RB7:
    s_and_b32 s42, s86, 0xffff0000
    s_xor_b32 s54, s42, 0x80000000
    s_xor_b32 s55, s42, 0xffff0000
    s_bitcmp1_b32 s42, 31
    s_cselect_b32 s42, s54, s55
    v_mov_b32 v16, s42
    v_mul_f32 v16, s36, v16
    v_exp_f32 v16, v16
    v_add_f32_dpp v0, v176, v176 quad_perm:[1,0,3,2] row_mask:0xf bank_mask:0xf
    v_add_f32_dpp v1, v180, v180 quad_perm:[1,0,3,2] row_mask:0xf bank_mask:0xf
    v_add_f32_dpp v2, v177, v177 quad_perm:[1,0,3,2] row_mask:0xf bank_mask:0xf
    v_add_f32_dpp v3, v181, v181 quad_perm:[1,0,3,2] row_mask:0xf bank_mask:0xf
    v_add_f32_dpp v4, v178, v178 quad_perm:[1,0,3,2] row_mask:0xf bank_mask:0xf
    v_add_f32_dpp v5, v182, v182 quad_perm:[1,0,3,2] row_mask:0xf bank_mask:0xf
    v_add_f32_dpp v6, v179, v179 quad_perm:[1,0,3,2] row_mask:0xf bank_mask:0xf
    v_add_f32_dpp v7, v183, v183 quad_perm:[1,0,3,2] row_mask:0xf bank_mask:0xf
    v_add_f32_dpp v0, v0, v0 quad_perm:[2,3,0,1] row_mask:0xf bank_mask:0xf
    v_add_f32_dpp v1, v1, v1 quad_perm:[2,3,0,1] row_mask:0xf bank_mask:0xf
    v_add_f32_dpp v2, v2, v2 quad_perm:[2,3,0,1] row_mask:0xf bank_mask:0xf
    v_add_f32_dpp v3, v3, v3 quad_perm:[2,3,0,1] row_mask:0xf bank_mask:0xf
    v_add_f32_dpp v4, v4, v4 quad_perm:[2,3,0,1] row_mask:0xf bank_mask:0xf
    v_add_f32_dpp v5, v5, v5 quad_perm:[2,3,0,1] row_mask:0xf bank_mask:0xf
    v_add_f32_dpp v6, v6, v6 quad_perm:[2,3,0,1] row_mask:0xf bank_mask:0xf
    v_add_f32_dpp v7, v7, v7 quad_perm:[2,3,0,1] row_mask:0xf bank_mask:0xf
    v_add_f32_dpp v0, v0, v0 row_half_mirror row_mask:0xf bank_mask:0xf
    v_add_f32_dpp v1, v1, v1 row_half_mirror row_mask:0xf bank_mask:0xf
    v_add_f32_dpp v2, v2, v2 row_half_mirror row_mask:0xf bank_mask:0xf
    v_add_f32_dpp v3, v3, v3 row_half_mirror row_mask:0xf bank_mask:0xf
    v_add_f32_dpp v4, v4, v4 row_half_mirror row_mask:0xf bank_mask:0xf
    v_add_f32_dpp v5, v5, v5 row_half_mirror row_mask:0xf bank_mask:0xf
    v_add_f32_dpp v6, v6, v6 row_half_mirror row_mask:0xf bank_mask:0xf
    v_add_f32_dpp v7, v7, v7 row_half_mirror row_mask:0xf bank_mask:0xf
    v_add_f32_dpp v0, v0, v0 row_mirror row_mask:0xf bank_mask:0xf
    v_add_f32_dpp v1, v1, v1 row_mirror row_mask:0xf bank_mask:0xf
    v_add_f32_dpp v2, v2, v2 row_mirror row_mask:0xf bank_mask:0xf
    v_add_f32_dpp v3, v3, v3 row_mirror row_mask:0xf bank_mask:0xf
    v_add_f32_dpp v4, v4, v4 row_mirror row_mask:0xf bank_mask:0xf
    v_add_f32_dpp v5, v5, v5 row_mirror row_mask:0xf bank_mask:0xf
    v_add_f32_dpp v6, v6, v6 row_mirror row_mask:0xf bank_mask:0xf
    v_add_f32_dpp v7, v7, v7 row_mirror row_mask:0xf bank_mask:0xf
    v_add_f32 v16, 1.0, v16
    v_rcp_f32 v16, v16
    s_bfe_u32 s42, s87, 0x4000a
    s_mov_b32 s54, 0x00010001
    s_lshl_b32 s54, s54, s42
    s_mov_b32 s55, s54
    v_cvt_pk_bf16_f32 v16, v16, v16
    v_lshlrev_b32 v16, 16, v16
    v_cvt_pk_bf16_f32 v8, v0, v1
    v_cvt_pk_bf16_f32 v9, v2, v3
    v_cvt_pk_bf16_f32 v10, v4, v5
    v_cvt_pk_bf16_f32 v11, v6, v7
    v_lshlrev_b32 v0, 16, v8
    v_and_b32 v1, 0xffff0000, v8
    v_lshlrev_b32 v2, 16, v9
    v_and_b32 v3, 0xffff0000, v9
    v_lshlrev_b32 v4, 16, v10
    v_and_b32 v5, 0xffff0000, v10
    v_lshlrev_b32 v6, 16, v11
    v_and_b32 v7, 0xffff0000, v11
    v_mul_f32 v0, v0, v16
    v_mul_f32 v1, v1, v16
    v_mul_f32 v2, v2, v16
    v_mul_f32 v3, v3, v16
    v_mul_f32 v4, v4, v16
    v_mul_f32 v5, v5, v16
    v_mul_f32 v6, v6, v16
    v_mul_f32 v7, v7, v16
    v_cvt_pk_bf16_f32 v8, v0, v1
    v_cvt_pk_bf16_f32 v9, v2, v3
    v_cvt_pk_bf16_f32 v10, v4, v5
    v_cvt_pk_bf16_f32 v11, v6, v7
    v_lshlrev_b32 v0, 16, v8
    v_and_b32 v1, 0xffff0000, v8
    v_lshlrev_b32 v2, 16, v9
    v_and_b32 v3, 0xffff0000, v9
    v_lshlrev_b32 v4, 16, v10
    v_and_b32 v5, 0xffff0000, v10
    v_lshlrev_b32 v6, 16, v11
    v_and_b32 v7, 0xffff0000, v11
    s_bitcmp0_b32 s87, 14
    s_cselect_b64 exec, s[54:55], 0
    v_lshlrev_b32 v8, 16, v184
    v_and_b32 v9, 0xffff0000, v184
    v_lshlrev_b32 v10, 16, v185
    v_and_b32 v11, 0xffff0000, v185
    v_lshlrev_b32 v12, 16, v186
    v_and_b32 v13, 0xffff0000, v186
    v_lshlrev_b32 v14, 16, v187
    v_and_b32 v15, 0xffff0000, v187
    v_add_f32 v8, v8, v0
    v_add_f32 v9, v9, v1
    v_add_f32 v10, v10, v2
    v_add_f32 v11, v11, v3
    v_add_f32 v12, v12, v4
    v_add_f32 v13, v13, v5
    v_add_f32 v14, v14, v6
    v_add_f32 v15, v15, v7
    v_cvt_pk_bf16_f32 v184, v8, v9
    v_cvt_pk_bf16_f32 v185, v10, v11
    v_cvt_pk_bf16_f32 v186, v12, v13
    v_cvt_pk_bf16_f32 v187, v14, v15
    s_bitcmp1_b32 s87, 14
    s_cselect_b64 exec, s[54:55], 0
    v_lshlrev_b32 v8, 16, v188
    v_and_b32 v9, 0xffff0000, v188
    v_lshlrev_b32 v10, 16, v189
    v_and_b32 v11, 0xffff0000, v189
    v_lshlrev_b32 v12, 16, v190
    v_and_b32 v13, 0xffff0000, v190
    v_lshlrev_b32 v14, 16, v191
    v_and_b32 v15, 0xffff0000, v191
    v_add_f32 v8, v8, v0
    v_add_f32 v9, v9, v1
    v_add_f32 v10, v10, v2
    v_add_f32 v11, v11, v3
    v_add_f32 v12, v12, v4
    v_add_f32 v13, v13, v5
    v_add_f32 v14, v14, v6
    v_add_f32 v15, v15, v7
    v_cvt_pk_bf16_f32 v188, v8, v9
    v_cvt_pk_bf16_f32 v189, v10, v11
    v_cvt_pk_bf16_f32 v190, v12, v13
    v_cvt_pk_bf16_f32 v191, v14, v15
    s_mov_b64 exec, -1
    s_branch F_RBB7
F_W3_7:
    s_mov_b32 s67, 200000
F_W3_7L:
    s_lshr_b32 s43, s79, 7
    s_load_dwordx2 s[72:73], s[70:71], s43 glc
    s_add_u32 s66, s66, 524288
    s_waitcnt lgkmcnt(0)
    s_cmp_eq_u64 s[72:73], s[64:65]
    s_cbranch_scc1 F_WB3_7
    s_sub_u32 s67, s67, 1
    s_cmp_lg_u32 s67, 0
    s_cbranch_scc1 F_W3_7L
    s_branch F_WB3_7
F_W4_7:
    s_mov_b32 s67, 200000
F_W4_7L:
    s_lshr_b32 s43, s82, 7
    s_load_dwordx2 s[72:73], s[70:71], s43 glc
    s_add_u32 s66, s66, 524288
    s_waitcnt lgkmcnt(0)
    s_cmp_eq_u64 s[72:73], s[64:65]
    s_cbranch_scc1 F_WB4_7
    s_sub_u32 s67, s67, 1
    s_cmp_lg_u32 s67, 0
    s_cbranch_scc1 F_W4_7L
    s_branch F_WB4_7
F_W5_7:
    s_mov_b32 s67, 200000
F_W5_7L:
    s_lshr_b32 s43, s77, 7
    s_load_dwordx2 s[72:73], s[70:71], s43 glc
    s_add_u32 s66, s66, 524288
    s_waitcnt lgkmcnt(0)
    s_cmp_eq_u64 s[72:73], s[64:65]
    s_cbranch_scc1 F_WB5_7
    s_sub_u32 s67, s67, 1
    s_cmp_lg_u32 s67, 0
    s_cbranch_scc1 F_W5_7L
    s_branch F_WB5_7
F_W6_7:
    s_mov_b32 s67, 200000
F_W6_7L:
    s_lshr_b32 s43, s78, 7
    s_load_dwordx2 s[72:73], s[70:71], s43 glc
    s_add_u32 s66, s66, 524288
    s_waitcnt lgkmcnt(0)
    s_cmp_eq_u64 s[72:73], s[64:65]
    s_cbranch_scc1 F_WB6_7
    s_sub_u32 s67, s67, 1
    s_cmp_lg_u32 s67, 0
    s_cbranch_scc1 F_W6_7L
    s_branch F_WB6_7
F_G6:
    ds_read_b128 v[128:131], v192 offset:0
    ds_read_b128 v[132:135], v192 offset:1024
    ds_read_b128 v[136:139], v192 offset:2048
    ds_read_b128 v[140:143], v192 offset:3072
    ds_read_b128 v[144:147], v192 offset:4096
    ds_read_b128 v[148:151], v192 offset:5120
    ds_read_b128 v[152:155], v192 offset:6144
    ds_read_b128 v[156:159], v192 offset:7168
    ds_read_b128 v[160:163], v192 offset:8192
    ds_read_b128 v[164:167], v192 offset:9216
    ds_read_b128 v[168:171], v192 offset:10240
    ds_read_b128 v[172:175], v192 offset:11264
    s_waitcnt lgkmcnt(10)
    v_mfma_f32_16x16x32_bf16 v[80:83], v[224:227], v[128:131], 0
    s_xor_b32 s33, s0, s76
    s_xor_b32 s34, s33, 262144
    s_add_u32 m0, s99, 98304
    v_mfma_f32_16x16x32_bf16 v[84:87], v[228:231], v[128:131], 0
    buffer_load_dwordx4 v222, s[48:51], s34 offen sc1 lds
    v_mfma_f32_16x16x32_bf16 v[88:91], v[224:227], v[132:135], 0
    ds_read_b128 v[128:131], v192 offset:12288
    v_mfma_f32_16x16x32_bf16 v[92:95], v[228:231], v[132:135], 0
    s_waitcnt lgkmcnt(9)
    v_mfma_f32_16x16x32_bf16 v[96:99], v[224:227], v[136:139], 0
    s_lshr_b32 s43, s79, 7
    s_load_dwordx2 s[72:73], s[70:71], s43 glc
    ds_read_b128 v[132:135], v192 offset:13312
    v_mfma_f32_16x16x32_bf16 v[100:103], v[228:231], v[136:139], 0
    buffer_load_dwordx4 v216, s[48:51], s34 offen offset:1024 sc1 lds
    v_mfma_f32_16x16x32_bf16 v[104:107], v[224:227], v[140:143], 0
    ds_read_b128 v[136:139], v192 offset:14336
    v_mfma_f32_16x16x32_bf16 v[108:111], v[228:231], v[140:143], 0
    s_waitcnt lgkmcnt(9)
    v_mfma_f32_16x16x32_bf16 v[112:115], v[224:227], v[144:147], 0
    s_xor_b32 s34, s33, 525312
    s_add_u32 m0, s99, 100352
    ds_read_b128 v[140:143], v192 offset:15360
    v_mfma_f32_16x16x32_bf16 v[116:119], v[228:231], v[144:147], 0
    buffer_load_dwordx4 v222, s[48:51], s34 offen sc1 lds
    v_mfma_f32_16x16x32_bf16 v[120:123], v[224:227], v[148:151], 0
    ds_read_b128 v[144:147], v192 offset:16384
    v_mfma_f32_16x16x32_bf16 v[124:127], v[228:231], v[148:151], 0
    s_waitcnt lgkmcnt(9)
    v_mfma_f32_16x16x32_bf16 v[80:83], v[232:235], v[152:155], v[80:83]
    ds_read_b128 v[148:151], v192 offset:17408
    v_mfma_f32_16x16x32_bf16 v[84:87], v[236:239], v[152:155], v[84:87]
    buffer_load_dwordx4 v216, s[48:51], s34 offen offset:1024 sc1 lds
    v_mfma_f32_16x16x32_bf16 v[88:91], v[232:235], v[156:159], v[88:91]
    ds_read_b128 v[152:155], v192 offset:18432
    v_mfma_f32_16x16x32_bf16 v[92:95], v[236:239], v[156:159], v[92:95]
    s_waitcnt lgkmcnt(9)
    v_mfma_f32_16x16x32_bf16 v[96:99], v[232:235], v[160:163], v[96:99]
    s_xor_b32 s34, s33, 787456
    s_add_u32 m0, s99, 102400
    ds_read_b128 v[156:159], v192 offset:19456
    v_mfma_f32_16x16x32_bf16 v[100:103], v[236:239], v[160:163], v[100:103]
    buffer_load_dwordx4 v222, s[48:51], s34 offen sc1 lds
    v_mfma_f32_16x16x32_bf16 v[104:107], v[232:235], v[164:167], v[104:107]
    ds_read_b128 v[160:163], v192 offset:20480
    v_mfma_f32_16x16x32_bf16 v[108:111], v[236:239], v[164:167], v[108:111]
    s_waitcnt lgkmcnt(9)
    v_mfma_f32_16x16x32_bf16 v[112:115], v[232:235], v[168:171], v[112:115]
    ds_read_b128 v[164:167], v192 offset:21504
    v_mfma_f32_16x16x32_bf16 v[116:119], v[236:239], v[168:171], v[116:119]
    buffer_load_dwordx4 v216, s[48:51], s34 offen offset:1024 sc1 lds
    v_mfma_f32_16x16x32_bf16 v[120:123], v[232:235], v[172:175], v[120:123]
    ds_read_b128 v[168:171], v192 offset:22528
    v_mfma_f32_16x16x32_bf16 v[124:127], v[236:239], v[172:175], v[124:127]
    s_waitcnt lgkmcnt(9)
    v_mfma_f32_16x16x32_bf16 v[80:83], v[240:243], v[128:131], v[80:83]
    s_lshl1_add_u32 s31, s77, s1
    ds_read_b128 v[172:175], v192 offset:23552
    v_mfma_f32_16x16x32_bf16 v[84:87], v[244:247], v[128:131], v[84:87]
    buffer_load_dwordx4 a[160:163], v222, s[48:51], s31 offen offset:0 sc1
    v_mfma_f32_16x16x32_bf16 v[88:91], v[240:243], v[132:135], v[88:91]
    v_mfma_f32_16x16x32_bf16 v[92:95], v[244:247], v[132:135], v[92:95]
    s_waitcnt lgkmcnt(8)
    v_mfma_f32_16x16x32_bf16 v[96:99], v[240:243], v[136:139], v[96:99]
    v_mfma_f32_16x16x32_bf16 v[100:103], v[244:247], v[136:139], v[100:103]
    buffer_load_dwordx4 a[164:167], v222, s[48:51], s31 offen offset:1024 sc1
    v_mfma_f32_16x16x32_bf16 v[104:107], v[240:243], v[140:143], v[104:107]
    v_mfma_f32_16x16x32_bf16 v[108:111], v[244:247], v[140:143], v[108:111]
    s_waitcnt lgkmcnt(6)
    v_mfma_f32_16x16x32_bf16 v[112:115], v[240:243], v[144:147], v[112:115]
    s_waitcnt vmcnt(17) lgkmcnt(0)
    v_mfma_f32_16x16x32_bf16 v[116:119], v[244:247], v[144:147], v[116:119]
    s_cmp_eq_u64 s[72:73], s[64:65]
    s_cbranch_scc0 F_W3_6
F_WB3_6:
    s_barrier
    v_mfma_f32_16x16x32_bf16 v[120:123], v[240:243], v[148:151], v[120:123]
    ds_read_b128 v[128:131], v192 offset:32768
    v_mfma_f32_16x16x32_bf16 v[124:127], v[244:247], v[148:151], v[124:127]
    s_waitcnt lgkmcnt(5)
    ds_read_b128 v[132:135], v192 offset:33792
    v_mfma_f32_16x16x32_bf16 v[80:83], v[248:251], v[152:155], v[80:83]
    ds_read_b128 v[136:139], v192 offset:34816
    v_mfma_f32_16x16x32_bf16 v[84:87], v[252:255], v[152:155], v[84:87]
    ds_read_b128 v[140:143], v192 offset:35840
    v_mfma_f32_16x16x32_bf16 v[88:91], v[248:251], v[156:159], v[88:91]
    ds_read_b128 v[144:147], v192 offset:36864
    v_mfma_f32_16x16x32_bf16 v[92:95], v[252:255], v[156:159], v[92:95]
    s_waitcnt lgkmcnt(7)
    ds_read_b128 v[148:151], v192 offset:37888
    v_mfma_f32_16x16x32_bf16 v[96:99], v[248:251], v[160:163], v[96:99]
    ds_read_b128 v[152:155], v192 offset:38912
    v_mfma_f32_16x16x32_bf16 v[100:103], v[252:255], v[160:163], v[100:103]
    ds_read_b128 v[156:159], v192 offset:39936
    v_mfma_f32_16x16x32_bf16 v[104:107], v[248:251], v[164:167], v[104:107]
    ds_read_b128 v[160:163], v192 offset:40960
    v_mfma_f32_16x16x32_bf16 v[108:111], v[252:255], v[164:167], v[108:111]
    s_waitcnt lgkmcnt(9)
    buffer_load_dwordx4 a[168:171], v222, s[48:51], s31 offen offset:2048 sc1
    v_mfma_f32_16x16x32_bf16 v[112:115], v[248:251], v[168:171], v[112:115]
    ds_read_b128 v[164:167], v192 offset:41984
    v_mfma_f32_16x16x32_bf16 v[116:119], v[252:255], v[168:171], v[116:119]
    v_mfma_f32_16x16x32_bf16 v[120:123], v[248:251], v[172:175], v[120:123]
    s_xor_b32 s33, s0, s79
    s_xor_b32 s34, s33, 262144
    s_add_u32 m0, s99, 32768
    ds_read_b128 v[168:171], v192 offset:43008
    v_mfma_f32_16x16x32_bf16 v[124:127], v[252:255], v[172:175], v[124:127]
    s_waitcnt lgkmcnt(9)
    buffer_load_dwordx4 v222, s[48:51], s34 offen sc1 lds
    v_mfma_f32_16x16x32_bf16 v[80:83], a[192:195], v[128:131], v[80:83]
    ds_read_b128 v[172:175], v192 offset:44032
    v_mfma_f32_16x16x32_bf16 v[84:87], a[196:199], v[128:131], v[84:87]
    v_mfma_f32_16x16x32_bf16 v[88:91], a[192:195], v[132:135], v[88:91]
    ds_read_b128 v[128:131], v192 offset:45056
    v_mfma_f32_16x16x32_bf16 v[92:95], a[196:199], v[132:135], v[92:95]
    s_waitcnt lgkmcnt(9)
    buffer_load_dwordx4 v216, s[48:51], s34 offen offset:1024 sc1 lds
    v_mfma_f32_16x16x32_bf16 v[96:99], a[192:195], v[136:139], v[96:99]
    s_lshr_b32 s43, s82, 7
    s_load_dwordx2 s[72:73], s[70:71], s43 glc
    ds_read_b128 v[132:135], v192 offset:46080
    v_mfma_f32_16x16x32_bf16 v[100:103], a[196:199], v[136:139], v[100:103]
    v_mfma_f32_16x16x32_bf16 v[104:107], a[192:195], v[140:143], v[104:107]
    s_xor_b32 s34, s33, 525312
    s_add_u32 m0, s99, 34816
    ds_read_b128 v[136:139], v192 offset:47104
    v_mfma_f32_16x16x32_bf16 v[108:111], a[196:199], v[140:143], v[108:111]
    s_waitcnt lgkmcnt(9)
    buffer_load_dwordx4 v222, s[48:51], s34 offen sc1 lds
    v_mfma_f32_16x16x32_bf16 v[112:115], a[192:195], v[144:147], v[112:115]
    ds_read_b128 v[140:143], v192 offset:48128
    v_mfma_f32_16x16x32_bf16 v[116:119], a[196:199], v[144:147], v[116:119]
    v_mfma_f32_16x16x32_bf16 v[120:123], a[192:195], v[148:151], v[120:123]
    ds_read_b128 v[144:147], v192 offset:49152
    v_mfma_f32_16x16x32_bf16 v[124:127], a[196:199], v[148:151], v[124:127]
    s_waitcnt lgkmcnt(9)
    buffer_load_dwordx4 v216, s[48:51], s34 offen offset:1024 sc1 lds
    v_mfma_f32_16x16x32_bf16 v[80:83], a[200:203], v[152:155], v[80:83]
    ds_read_b128 v[148:151], v192 offset:50176
    v_mfma_f32_16x16x32_bf16 v[84:87], a[204:207], v[152:155], v[84:87]
    v_mfma_f32_16x16x32_bf16 v[88:91], a[200:203], v[156:159], v[88:91]
    s_xor_b32 s34, s33, 787456
    s_add_u32 m0, s99, 36864
    ds_read_b128 v[152:155], v192 offset:51200
    v_mfma_f32_16x16x32_bf16 v[92:95], a[204:207], v[156:159], v[92:95]
    s_waitcnt lgkmcnt(9)
    buffer_load_dwordx4 v222, s[48:51], s34 offen sc1 lds
    v_mfma_f32_16x16x32_bf16 v[96:99], a[200:203], v[160:163], v[96:99]
    ds_read_b128 v[156:159], v192 offset:52224
    v_mfma_f32_16x16x32_bf16 v[100:103], a[204:207], v[160:163], v[100:103]
    v_mfma_f32_16x16x32_bf16 v[104:107], a[200:203], v[164:167], v[104:107]
    ds_read_b128 v[160:163], v192 offset:53248
    v_mfma_f32_16x16x32_bf16 v[108:111], a[204:207], v[164:167], v[108:111]
    s_waitcnt lgkmcnt(9)
    buffer_load_dwordx4 v216, s[48:51], s34 offen offset:1024 sc1 lds
    v_mfma_f32_16x16x32_bf16 v[112:115], a[200:203], v[168:171], v[112:115]
    ds_read_b128 v[164:167], v192 offset:54272
    v_mfma_f32_16x16x32_bf16 v[116:119], a[204:207], v[168:171], v[116:119]
    v_mfma_f32_16x16x32_bf16 v[120:123], a[200:203], v[172:175], v[120:123]
    ds_read_b128 v[168:171], v192 offset:55296
    v_mfma_f32_16x16x32_bf16 v[124:127], a[204:207], v[172:175], v[124:127]
    s_waitcnt lgkmcnt(9)
    buffer_load_dwordx4 a[172:175], v222, s[48:51], s31 offen offset:3072 sc1
    v_mfma_f32_16x16x32_bf16 v[80:83], a[208:211], v[128:131], v[80:83]
    ds_read_b128 v[172:175], v192 offset:56320
    v_mfma_f32_16x16x32_bf16 v[84:87], a[212:215], v[128:131], v[84:87]
    v_mfma_f32_16x16x32_bf16 v[88:91], a[208:211], v[132:135], v[88:91]
    s_add_u32 s32, s31, 4096
    v_mfma_f32_16x16x32_bf16 v[92:95], a[212:215], v[132:135], v[92:95]
    s_waitcnt lgkmcnt(8)
    buffer_load_dwordx4 a[176:179], v222, s[48:51], s32 offen offset:0 sc1
    v_mfma_f32_16x16x32_bf16 v[96:99], a[208:211], v[136:139], v[96:99]
    v_mfma_f32_16x16x32_bf16 v[100:103], a[212:215], v[136:139], v[100:103]
    v_mfma_f32_16x16x32_bf16 v[104:107], a[208:211], v[140:143], v[104:107]
    v_mfma_f32_16x16x32_bf16 v[108:111], a[212:215], v[140:143], v[108:111]
    s_waitcnt lgkmcnt(6)
    buffer_load_dwordx4 a[180:183], v222, s[48:51], s32 offen offset:1024 sc1
    v_mfma_f32_16x16x32_bf16 v[112:115], a[208:211], v[144:147], v[112:115]
    s_waitcnt vmcnt(12) lgkmcnt(0)
    v_mfma_f32_16x16x32_bf16 v[116:119], a[212:215], v[144:147], v[116:119]
    s_cmp_eq_u64 s[72:73], s[64:65]
    s_cbranch_scc0 F_W4_6
F_WB4_6:
    s_barrier
    v_mfma_f32_16x16x32_bf16 v[120:123], a[208:211], v[148:151], v[120:123]
    ds_read_b128 v[128:131], v193 offset:0
    v_mfma_f32_16x16x32_bf16 v[124:127], a[212:215], v[148:151], v[124:127]
    s_waitcnt lgkmcnt(5)
    ds_read_b128 v[132:135], v193 offset:1024
    v_mfma_f32_16x16x32_bf16 v[80:83], a[216:219], v[152:155], v[80:83]
    s_cmp_eq_u32 s7, 0
    s_cbranch_scc1 F_RB6
F_RBB6:
    ds_read_b128 v[136:139], v193 offset:2048
    v_mfma_f32_16x16x32_bf16 v[84:87], a[220:223], v[152:155], v[84:87]
    ds_read_b128 v[140:143], v193 offset:3072
    v_mfma_f32_16x16x32_bf16 v[88:91], a[216:219], v[156:159], v[88:91]
    ds_read_b128 v[144:147], v193 offset:4096
    v_mfma_f32_16x16x32_bf16 v[92:95], a[220:223], v[156:159], v[92:95]
    s_waitcnt lgkmcnt(7)
    ds_read_b128 v[148:151], v193 offset:5120
    v_mfma_f32_16x16x32_bf16 v[96:99], a[216:219], v[160:163], v[96:99]
    ds_read_b128 v[152:155], v193 offset:6144
    v_mfma_f32_16x16x32_bf16 v[100:103], a[220:223], v[160:163], v[100:103]
    ds_read_b128 v[156:159], v193 offset:7168
    v_mfma_f32_16x16x32_bf16 v[104:107], a[216:219], v[164:167], v[104:107]
    s_xor_b32 s33, s0, s82
    s_xor_b32 s34, s33, 262144
    s_add_u32 m0, s99, 65536
    ds_read_b128 v[160:163], v193 offset:8192
    v_mfma_f32_16x16x32_bf16 v[108:111], a[220:223], v[164:167], v[108:111]
    s_waitcnt lgkmcnt(9)
    buffer_load_dwordx4 v222, s[48:51], s34 offen sc1 lds
    v_mfma_f32_16x16x32_bf16 v[112:115], a[216:219], v[168:171], v[112:115]
    ds_read_b128 v[164:167], v193 offset:9216
    v_mfma_f32_16x16x32_bf16 v[116:119], a[220:223], v[168:171], v[116:119]
    buffer_load_dwordx4 v[48:51], v194, s[16:19], s97 offen
    v_mfma_f32_16x16x32_bf16 v[120:123], a[216:219], v[172:175], v[120:123]
    ds_read_b128 v[168:171], v193 offset:10240
    v_mfma_f32_16x16x32_bf16 v[124:127], a[220:223], v[172:175], v[124:127]
    s_waitcnt vmcnt(21) lgkmcnt(9)
    buffer_load_dwordx4 v216, s[48:51], s34 offen offset:1024 sc1 lds
    v_mfma_f32_16x16x32_bf16 v[80:83], a[128:131], v[128:131], v[80:83]
    ds_read_b128 v[172:175], v193 offset:11264
    v_mfma_f32_16x16x32_bf16 v[84:87], a[132:135], v[128:131], v[84:87]
    buffer_load_dwordx4 v[52:55], v194, s[16:19], s6 offen
    v_mfma_f32_16x16x32_bf16 v[88:91], a[128:131], v[132:135], v[88:91]
    s_xor_b32 s34, s33, 525312
    s_add_u32 m0, s99, 67584
    ds_read_b128 v[128:131], v193 offset:12288
    v_lshlrev_b32 v176, 16, v184
    v_mfma_f32_16x16x32_bf16 v[92:95], a[132:135], v[132:135], v[92:95]
    s_waitcnt lgkmcnt(9)
    buffer_load_dwordx4 v222, s[48:51], s34 offen sc1 lds
    v_mfma_f32_16x16x32_bf16 v[96:99], a[128:131], v[136:139], v[96:99]
    s_lshr_b32 s43, s77, 7
    s_load_dwordx2 s[72:73], s[70:71], s43 glc
    ds_read_b128 v[132:135], v193 offset:13312
    v_and_b32 v177, 0xffff0000, v184
    v_mfma_f32_16x16x32_bf16 v[100:103], a[132:135], v[136:139], v[100:103]
    v_lshlrev_b32 v178, 16, v185
    v_and_b32 v179, 0xffff0000, v185
    v_mfma_f32_16x16x32_bf16 v[104:107], a[128:131], v[140:143], v[104:107]
    ds_read_b128 v[136:139], v193 offset:14336
    v_lshlrev_b32 v180, 16, v186
    v_mfma_f32_16x16x32_bf16 v[108:111], a[132:135], v[140:143], v[108:111]
    s_waitcnt lgkmcnt(9)
    buffer_load_dwordx4 v216, s[48:51], s34 offen offset:1024 sc1 lds
    v_mfma_f32_16x16x32_bf16 v[112:115], a[128:131], v[144:147], v[112:115]
    ds_read_b128 v[140:143], v193 offset:15360
    v_and_b32 v181, 0xffff0000, v186
    v_mfma_f32_16x16x32_bf16 v[116:119], a[132:135], v[144:147], v[116:119]
    v_lshlrev_b32 v182, 16, v187
    v_and_b32 v183, 0xffff0000, v187
    v_mfma_f32_16x16x32_bf16 v[120:123], a[128:131], v[148:151], v[120:123]
    s_xor_b32 s34, s33, 787456
    s_add_u32 m0, s99, 69632
    ds_read_b128 v[144:147], v193 offset:16384
    v_lshlrev_b32 v184, 16, v188
    v_mfma_f32_16x16x32_bf16 v[124:127], a[132:135], v[148:151], v[124:127]
    s_waitcnt lgkmcnt(9)
    buffer_load_dwordx4 v222, s[48:51], s34 offen sc1 lds
    v_mfma_f32_16x16x32_bf16 v[80:83], a[136:139], v[152:155], v[80:83]
    ds_read_b128 v[148:151], v193 offset:17408
    v_and_b32 v185, 0xffff0000, v188
    v_mfma_f32_16x16x32_bf16 v[84:87], a[140:143], v[152:155], v[84:87]
    v_lshlrev_b32 v186, 16, v189
    v_and_b32 v187, 0xffff0000, v189
    v_mfma_f32_16x16x32_bf16 v[88:91], a[136:139], v[156:159], v[88:91]
    ds_read_b128 v[152:155], v193 offset:18432
    v_lshlrev_b32 v188, 16, v190
    v_mfma_f32_16x16x32_bf16 v[92:95], a[140:143], v[156:159], v[92:95]
    s_waitcnt lgkmcnt(9)
    buffer_load_dwordx4 v216, s[48:51], s34 offen offset:1024 sc1 lds
    v_mfma_f32_16x16x32_bf16 v[96:99], a[136:139], v[160:163], v[96:99]
    ds_read_b128 v[156:159], v193 offset:19456
    v_and_b32 v189, 0xffff0000, v190
    v_mfma_f32_16x16x32_bf16 v[100:103], a[140:143], v[160:163], v[100:103]
    v_lshlrev_b32 v190, 16, v191
    v_and_b32 v191, 0xffff0000, v191
    v_mfma_f32_16x16x32_bf16 v[104:107], a[136:139], v[164:167], v[104:107]
    ds_read_b128 v[160:163], v193 offset:20480
    v_mul_f32 v16, s36, v176
    v_mfma_f32_16x16x32_bf16 v[108:111], a[140:143], v[164:167], v[108:111]
    s_waitcnt lgkmcnt(9)
    buffer_load_dwordx4 a[184:187], v222, s[48:51], s32 offen offset:2048 sc1
    v_mfma_f32_16x16x32_bf16 v[112:115], a[136:139], v[168:171], v[112:115]
    ds_read_b128 v[164:167], v193 offset:21504
    v_mul_f32 v17, s36, v177
    v_mfma_f32_16x16x32_bf16 v[116:119], a[140:143], v[168:171], v[116:119]
    v_mul_f32 v18, s36, v178
    v_mul_f32 v19, s36, v179
    v_mfma_f32_16x16x32_bf16 v[120:123], a[136:139], v[172:175], v[120:123]
    ds_read_b128 v[168:171], v193 offset:22528
    v_mul_f32 v20, s36, v180
    v_mfma_f32_16x16x32_bf16 v[124:127], a[140:143], v[172:175], v[124:127]
    s_waitcnt lgkmcnt(9)
    buffer_load_dwordx4 a[188:191], v222, s[48:51], s32 offen offset:3072 sc1
    v_mfma_f32_16x16x32_bf16 v[80:83], a[144:147], v[128:131], v[80:83]
    ds_read_b128 v[172:175], v193 offset:23552
    v_mul_f32 v21, s36, v181
    v_mfma_f32_16x16x32_bf16 v[84:87], a[148:151], v[128:131], v[84:87]
    v_mul_f32 v22, s36, v182
    v_mul_f32 v23, s36, v183
    v_mfma_f32_16x16x32_bf16 v[88:91], a[144:147], v[132:135], v[88:91]
    s_xor_b32 s34, s0, s74
    s_add_u32 m0, s68, 0
    v_mul_f32 v24, s36, v184
    v_mul_f32 v25, s36, v185
    v_mfma_f32_16x16x32_bf16 v[92:95], a[148:151], v[132:135], v[92:95]
    s_waitcnt lgkmcnt(8)
    buffer_load_dwordx4 v222, s[48:51], s34 offen sc1 lds
    v_mfma_f32_16x16x32_bf16 v[96:99], a[144:147], v[136:139], v[96:99]
    v_mul_f32 v26, s36, v186
    v_mul_f32 v27, s36, v187
    v_mfma_f32_16x16x32_bf16 v[100:103], a[148:151], v[136:139], v[100:103]
    v_mul_f32 v28, s36, v188
    v_mul_f32 v29, s36, v189
    v_mfma_f32_16x16x32_bf16 v[104:107], a[144:147], v[140:143], v[104:107]
    v_mul_f32 v30, s36, v190
    v_mul_f32 v31, s36, v191
    v_mfma_f32_16x16x32_bf16 v[108:111], a[148:151], v[140:143], v[108:111]
    s_waitcnt lgkmcnt(6)
    buffer_load_dwordx4 v216, s[48:51], s34 offen offset:1024 sc1 lds
    v_mfma_f32_16x16x32_bf16 v[112:115], a[144:147], v[144:147], v[112:115]
    s_waitcnt vmcnt(15) lgkmcnt(0)
    v_exp_f32 v16, v16
    v_mfma_f32_16x16x32_bf16 v[116:119], a[148:151], v[144:147], v[116:119]
    s_cmp_eq_u64 s[72:73], s[64:65]
    s_cbranch_scc0 F_W5_6
F_WB5_6:
    s_barrier
    v_exp_f32 v17, v17
    v_mfma_f32_16x16x32_bf16 v[120:123], a[144:147], v[148:151], v[120:123]
    ds_read_b128 v[128:131], v192 offset:0
    v_mfma_f32_16x16x32_bf16 v[124:127], a[148:151], v[148:151], v[124:127]
    s_waitcnt lgkmcnt(5)
    ds_read_b128 v[132:135], v192 offset:1024
    v_mfma_f32_16x16x32_bf16 v[80:83], a[152:155], v[152:155], v[80:83]
    ds_read_b128 v[136:139], v192 offset:2048
    v_mfma_f32_16x16x32_bf16 v[84:87], a[156:159], v[152:155], v[84:87]
    ds_read_b128 v[140:143], v192 offset:3072
    v_mfma_f32_16x16x32_bf16 v[88:91], a[152:155], v[156:159], v[88:91]
    ds_read_b128 v[144:147], v192 offset:4096
    v_mfma_f32_16x16x32_bf16 v[92:95], a[156:159], v[156:159], v[92:95]
    s_waitcnt lgkmcnt(7)
    ds_read_b128 v[148:151], v192 offset:5120
    v_mfma_f32_16x16x32_bf16 v[96:99], a[152:155], v[160:163], v[96:99]
    ds_read_b128 v[152:155], v192 offset:6144
    v_mfma_f32_16x16x32_bf16 v[100:103], a[156:159], v[160:163], v[100:103]
    ds_read_b128 v[156:159], v192 offset:7168
    v_mfma_f32_16x16x32_bf16 v[104:107], a[152:155], v[164:167], v[104:107]
    s_xor_b32 s33, s0, s77
    s_xor_b32 s34, s33, 262144
    s_add_u32 m0, s99, 98304
    ds_read_b128 v[160:163], v192 offset:8192
    v_mfma_f32_16x16x32_bf16 v[108:111], a[156:159], v[164:167], v[108:111]
    s_waitcnt lgkmcnt(9)
    buffer_load_dwordx4 v222, s[48:51], s34 offen sc1 lds
    v_mfma_f32_16x16x32_bf16 v[112:115], a[152:155], v[168:171], v[112:115]
    ds_read_b128 v[164:167], v192 offset:9216
    v_mfma_f32_16x16x32_bf16 v[116:119], a[156:159], v[168:171], v[116:119]
    v_exp_f32 v18, v18
    v_mfma_f32_16x16x32_bf16 v[120:123], a[152:155], v[172:175], v[120:123]
    ds_read_b128 v[168:171], v192 offset:10240
    v_mfma_f32_16x16x32_bf16 v[124:127], a[156:159], v[172:175], v[124:127]
    s_waitcnt lgkmcnt(9)
    buffer_load_dwordx4 v216, s[48:51], s34 offen offset:1024 sc1 lds
    v_mfma_f32_16x16x32_bf16 v[80:83], a[0:3], v[128:131], v[80:83]
    ds_read_b128 v[172:175], v192 offset:11264
    v_mfma_f32_16x16x32_bf16 v[84:87], a[4:7], v[128:131], v[84:87]
    v_exp_f32 v19, v19
    v_mfma_f32_16x16x32_bf16 v[88:91], a[0:3], v[132:135], v[88:91]
    s_xor_b32 s34, s33, 525312
    s_add_u32 m0, s99, 100352
    ds_read_b128 v[128:131], v192 offset:12288
    v_mfma_f32_16x16x32_bf16 v[92:95], a[4:7], v[132:135], v[92:95]
    s_waitcnt lgkmcnt(9)
    buffer_load_dwordx4 v222, s[48:51], s34 offen sc1 lds
    v_mfma_f32_16x16x32_bf16 v[96:99], a[0:3], v[136:139], v[96:99]
    ds_read_b128 v[132:135], v192 offset:13312
    v_mfma_f32_16x16x32_bf16 v[100:103], a[4:7], v[136:139], v[100:103]
    v_exp_f32 v20, v20
    v_mfma_f32_16x16x32_bf16 v[104:107], a[0:3], v[140:143], v[104:107]
    ds_read_b128 v[136:139], v192 offset:14336
    v_mfma_f32_16x16x32_bf16 v[108:111], a[4:7], v[140:143], v[108:111]
    s_waitcnt lgkmcnt(9)
    buffer_load_dwordx4 v216, s[48:51], s34 offen offset:1024 sc1 lds
    v_mfma_f32_16x16x32_bf16 v[112:115], a[0:3], v[144:147], v[112:115]
    ds_read_b128 v[140:143], v192 offset:15360
    v_mfma_f32_16x16x32_bf16 v[116:119], a[4:7], v[144:147], v[116:119]
    v_exp_f32 v21, v21
    v_mfma_f32_16x16x32_bf16 v[120:123], a[0:3], v[148:151], v[120:123]
    s_xor_b32 s34, s33, 787456
    s_add_u32 m0, s99, 102400
    ds_read_b128 v[144:147], v192 offset:16384
    v_mfma_f32_16x16x32_bf16 v[124:127], a[4:7], v[148:151], v[124:127]
    s_waitcnt lgkmcnt(9)
    buffer_load_dwordx4 v222, s[48:51], s34 offen sc1 lds
    v_mfma_f32_16x16x32_bf16 v[80:83], a[8:11], v[152:155], v[80:83]
    ds_read_b128 v[148:151], v192 offset:17408
    v_mfma_f32_16x16x32_bf16 v[84:87], a[12:15], v[152:155], v[84:87]
    v_exp_f32 v22, v22
    v_mfma_f32_16x16x32_bf16 v[88:91], a[8:11], v[156:159], v[88:91]
    ds_read_b128 v[152:155], v192 offset:18432
    v_mfma_f32_16x16x32_bf16 v[92:95], a[12:15], v[156:159], v[92:95]
    s_waitcnt lgkmcnt(9)
    buffer_load_dwordx4 v216, s[48:51], s34 offen offset:1024 sc1 lds
    v_mfma_f32_16x16x32_bf16 v[96:99], a[8:11], v[160:163], v[96:99]
    ds_read_b128 v[156:159], v192 offset:19456
    v_mfma_f32_16x16x32_bf16 v[100:103], a[12:15], v[160:163], v[100:103]
    v_exp_f32 v23, v23
    v_mfma_f32_16x16x32_bf16 v[104:107], a[8:11], v[164:167], v[104:107]
    s_xor_b32 s34, s0, s75
    s_add_u32 m0, s68, 8192
    ds_read_b128 v[160:163], v192 offset:20480
    v_mfma_f32_16x16x32_bf16 v[108:111], a[12:15], v[164:167], v[108:111]
    s_waitcnt lgkmcnt(9)
    buffer_load_dwordx4 v222, s[48:51], s34 offen sc1 lds
    v_mfma_f32_16x16x32_bf16 v[112:115], a[8:11], v[168:171], v[112:115]
    ds_read_b128 v[164:167], v192 offset:21504
    v_mfma_f32_16x16x32_bf16 v[116:119], a[12:15], v[168:171], v[116:119]
    v_exp_f32 v24, v24
    v_mfma_f32_16x16x32_bf16 v[120:123], a[8:11], v[172:175], v[120:123]
    ds_read_b128 v[168:171], v192 offset:22528
    v_mfma_f32_16x16x32_bf16 v[124:127], a[12:15], v[172:175], v[124:127]
    s_waitcnt lgkmcnt(9)
    buffer_load_dwordx4 v216, s[48:51], s34 offen offset:1024 sc1 lds
    v_mfma_f32_16x16x32_bf16 v[80:83], a[16:19], v[128:131], v[80:83]
    ds_read_b128 v[172:175], v192 offset:23552
    v_mfma_f32_16x16x32_bf16 v[84:87], a[20:23], v[128:131], v[84:87]
    v_exp_f32 v25, v25
    v_mfma_f32_16x16x32_bf16 v[88:91], a[16:19], v[132:135], v[88:91]
    s_xor_b32 s34, s0, s76
    s_add_u32 m0, s68, 16384
    v_exp_f32 v26, v26
    v_mfma_f32_16x16x32_bf16 v[92:95], a[20:23], v[132:135], v[92:95]
    s_waitcnt lgkmcnt(8)
    buffer_load_dwordx4 v222, s[48:51], s34 offen sc1 lds
    v_mfma_f32_16x16x32_bf16 v[96:99], a[16:19], v[136:139], v[96:99]
    v_exp_f32 v27, v27
    v_mfma_f32_16x16x32_bf16 v[100:103], a[20:23], v[136:139], v[100:103]
    v_exp_f32 v28, v28
    v_mfma_f32_16x16x32_bf16 v[104:107], a[16:19], v[140:143], v[104:107]
    v_exp_f32 v29, v29
    v_mfma_f32_16x16x32_bf16 v[108:111], a[20:23], v[140:143], v[108:111]
    s_waitcnt lgkmcnt(6)
    buffer_load_dwordx4 v216, s[48:51], s34 offen offset:1024 sc1 lds
    v_mfma_f32_16x16x32_bf16 v[112:115], a[16:19], v[144:147], v[112:115]
    s_waitcnt vmcnt(14) lgkmcnt(0)
    v_exp_f32 v30, v30
    v_mfma_f32_16x16x32_bf16 v[116:119], a[20:23], v[144:147], v[116:119]
    s_barrier
    v_exp_f32 v31, v31
    v_mfma_f32_16x16x32_bf16 v[120:123], a[16:19], v[148:151], v[120:123]
    ds_read_b128 v[128:131], v192 offset:32768
    v_add_f32 v16, 1.0, v16
    v_mfma_f32_16x16x32_bf16 v[124:127], a[20:23], v[148:151], v[124:127]
    s_waitcnt lgkmcnt(5)
    ds_read_b128 v[132:135], v192 offset:33792
    v_add_f32 v17, 1.0, v17
    v_mfma_f32_16x16x32_bf16 v[80:83], a[24:27], v[152:155], v[80:83]
    ds_read_b128 v[136:139], v192 offset:34816
    v_add_f32 v18, 1.0, v18
    v_mfma_f32_16x16x32_bf16 v[84:87], a[28:31], v[152:155], v[84:87]
    ds_read_b128 v[140:143], v192 offset:35840
    v_add_f32 v19, 1.0, v19
    v_mfma_f32_16x16x32_bf16 v[88:91], a[24:27], v[156:159], v[88:91]
    ds_read_b128 v[144:147], v192 offset:36864
    v_add_f32 v20, 1.0, v20
    v_mfma_f32_16x16x32_bf16 v[92:95], a[28:31], v[156:159], v[92:95]
    s_waitcnt lgkmcnt(7)
    ds_read_b128 v[148:151], v192 offset:37888
    v_add_f32 v21, 1.0, v21
    v_mfma_f32_16x16x32_bf16 v[96:99], a[24:27], v[160:163], v[96:99]
    ds_read_b128 v[152:155], v192 offset:38912
    v_add_f32 v22, 1.0, v22
    v_mfma_f32_16x16x32_bf16 v[100:103], a[28:31], v[160:163], v[100:103]
    ds_read_b128 v[156:159], v192 offset:39936
    v_add_f32 v23, 1.0, v23
    v_mfma_f32_16x16x32_bf16 v[104:107], a[24:27], v[164:167], v[104:107]
    s_xor_b32 s34, s0, s79
    s_add_u32 m0, s68, 24576
    ds_read_b128 v[160:163], v192 offset:40960
    v_add_f32 v24, 1.0, v24
    v_mfma_f32_16x16x32_bf16 v[108:111], a[28:31], v[164:167], v[108:111]
    s_waitcnt lgkmcnt(9)
    buffer_load_dwordx4 v222, s[48:51], s34 offen sc1 lds
    v_mfma_f32_16x16x32_bf16 v[112:115], a[24:27], v[168:171], v[112:115]
    ds_read_b128 v[164:167], v192 offset:41984
    v_add_f32 v25, 1.0, v25
    v_mfma_f32_16x16x32_bf16 v[116:119], a[28:31], v[168:171], v[116:119]
    v_add_f32 v26, 1.0, v26
    v_add_f32 v27, 1.0, v27
    v_mfma_f32_16x16x32_bf16 v[120:123], a[24:27], v[172:175], v[120:123]
    ds_read_b128 v[168:171], v192 offset:43008
    v_add_f32 v28, 1.0, v28
    v_mfma_f32_16x16x32_bf16 v[124:127], a[28:31], v[172:175], v[124:127]
    s_waitcnt lgkmcnt(9)
    buffer_load_dwordx4 v216, s[48:51], s34 offen offset:1024 sc1 lds
    v_mfma_f32_16x16x32_bf16 v[80:83], a[32:35], v[128:131], v[80:83]
    ds_read_b128 v[172:175], v192 offset:44032
    v_add_f32 v29, 1.0, v29
    v_mfma_f32_16x16x32_bf16 v[84:87], a[36:39], v[128:131], v[84:87]
    v_add_f32 v30, 1.0, v30
    v_add_f32 v31, 1.0, v31
    v_mfma_f32_16x16x32_bf16 v[88:91], a[32:35], v[132:135], v[88:91]
    s_xor_b32 s34, s0, s82
    s_add_u32 m0, s68, 131072
    ds_read_b128 v[128:131], v192 offset:45056
    v_mfma_f32_16x16x32_bf16 v[92:95], a[36:39], v[132:135], v[92:95]
    s_waitcnt lgkmcnt(9)
    buffer_load_dwordx4 v222, s[48:51], s34 offen sc1 lds
    v_mfma_f32_16x16x32_bf16 v[96:99], a[32:35], v[136:139], v[96:99]
    ds_read_b128 v[132:135], v192 offset:46080
    v_mfma_f32_16x16x32_bf16 v[100:103], a[36:39], v[136:139], v[100:103]
    v_rcp_f32 v16, v16
    v_mfma_f32_16x16x32_bf16 v[104:107], a[32:35], v[140:143], v[104:107]
    ds_read_b128 v[136:139], v192 offset:47104
    v_mfma_f32_16x16x32_bf16 v[108:111], a[36:39], v[140:143], v[108:111]
    s_waitcnt lgkmcnt(9)
    buffer_load_dwordx4 v216, s[48:51], s34 offen offset:1024 sc1 lds
    v_mfma_f32_16x16x32_bf16 v[112:115], a[32:35], v[144:147], v[112:115]
    ds_read_b128 v[140:143], v192 offset:48128
    v_mfma_f32_16x16x32_bf16 v[116:119], a[36:39], v[144:147], v[116:119]
    v_rcp_f32 v17, v17
    v_mfma_f32_16x16x32_bf16 v[120:123], a[32:35], v[148:151], v[120:123]
    s_xor_b32 s34, s0, s77
    s_add_u32 m0, s68, 139264
    ds_read_b128 v[144:147], v192 offset:49152
    v_mfma_f32_16x16x32_bf16 v[124:127], a[36:39], v[148:151], v[124:127]
    s_waitcnt lgkmcnt(9)
    buffer_load_dwordx4 v222, s[48:51], s34 offen sc1 lds
    v_mfma_f32_16x16x32_bf16 v[80:83], a[40:43], v[152:155], v[80:83]
    ds_read_b128 v[148:151], v192 offset:50176
    v_mfma_f32_16x16x32_bf16 v[84:87], a[44:47], v[152:155], v[84:87]
    v_rcp_f32 v18, v18
    v_mfma_f32_16x16x32_bf16 v[88:91], a[40:43], v[156:159], v[88:91]
    ds_read_b128 v[152:155], v192 offset:51200
    v_mfma_f32_16x16x32_bf16 v[92:95], a[44:47], v[156:159], v[92:95]
    s_waitcnt lgkmcnt(9)
    buffer_load_dwordx4 v216, s[48:51], s34 offen offset:1024 sc1 lds
    v_mfma_f32_16x16x32_bf16 v[96:99], a[40:43], v[160:163], v[96:99]
    ds_read_b128 v[156:159], v192 offset:52224
    v_mfma_f32_16x16x32_bf16 v[100:103], a[44:47], v[160:163], v[100:103]
    v_rcp_f32 v19, v19
    v_mfma_f32_16x16x32_bf16 v[104:107], a[40:43], v[164:167], v[104:107]
    ds_read_b128 v[160:163], v192 offset:53248
    v_mfma_f32_16x16x32_bf16 v[108:111], a[44:47], v[164:167], v[108:111]
    s_waitcnt lgkmcnt(9)
    v_rcp_f32 v20, v20
    v_mfma_f32_16x16x32_bf16 v[112:115], a[40:43], v[168:171], v[112:115]
    ds_read_b128 v[164:167], v192 offset:54272
    v_mfma_f32_16x16x32_bf16 v[116:119], a[44:47], v[168:171], v[116:119]
    v_rcp_f32 v21, v21
    v_mfma_f32_16x16x32_bf16 v[120:123], a[40:43], v[172:175], v[120:123]
    ds_read_b128 v[168:171], v192 offset:55296
    v_mfma_f32_16x16x32_bf16 v[124:127], a[44:47], v[172:175], v[124:127]
    s_waitcnt lgkmcnt(9)
    v_rcp_f32 v22, v22
    v_mfma_f32_16x16x32_bf16 v[80:83], a[48:51], v[128:131], v[80:83]
    ds_read_b128 v[172:175], v192 offset:56320
    v_mfma_f32_16x16x32_bf16 v[84:87], a[52:55], v[128:131], v[84:87]
    v_rcp_f32 v23, v23
    v_mfma_f32_16x16x32_bf16 v[88:91], a[48:51], v[132:135], v[88:91]
    v_rcp_f32 v24, v24
    v_mfma_f32_16x16x32_bf16 v[92:95], a[52:55], v[132:135], v[92:95]
    s_waitcnt lgkmcnt(8)
    v_rcp_f32 v25, v25
    v_mfma_f32_16x16x32_bf16 v[96:99], a[48:51], v[136:139], v[96:99]
    v_rcp_f32 v26, v26
    v_mfma_f32_16x16x32_bf16 v[100:103], a[52:55], v[136:139], v[100:103]
    v_rcp_f32 v27, v27
    v_mfma_f32_16x16x32_bf16 v[104:107], a[48:51], v[140:143], v[104:107]
    v_rcp_f32 v28, v28
    v_mfma_f32_16x16x32_bf16 v[108:111], a[52:55], v[140:143], v[108:111]
    s_waitcnt lgkmcnt(6)
    v_rcp_f32 v29, v29
    v_mfma_f32_16x16x32_bf16 v[112:115], a[48:51], v[144:147], v[112:115]
    s_waitcnt vmcnt(10) lgkmcnt(0)
    v_rcp_f32 v30, v30
    v_mfma_f32_16x16x32_bf16 v[116:119], a[52:55], v[144:147], v[116:119]
    s_barrier
    v_rcp_f32 v31, v31
    v_mfma_f32_16x16x32_bf16 v[120:123], a[48:51], v[148:151], v[120:123]
    ds_read_b128 v[128:131], v193 offset:0
    v_mul_f32 v16, v16, v176
    v_mfma_f32_16x16x32_bf16 v[124:127], a[52:55], v[148:151], v[124:127]
    s_waitcnt lgkmcnt(5)
    ds_read_b128 v[132:135], v193 offset:1024
    v_mul_f32 v17, v17, v177
    v_mfma_f32_16x16x32_bf16 v[80:83], a[56:59], v[152:155], v[80:83]
    ds_read_b128 v[136:139], v193 offset:6144
    v_mul_f32 v18, v18, v178
    v_mfma_f32_16x16x32_bf16 v[84:87], a[60:63], v[152:155], v[84:87]
    ds_read_b128 v[140:143], v193 offset:7168
    v_mul_f32 v19, v19, v179
    v_mfma_f32_16x16x32_bf16 v[88:91], a[56:59], v[156:159], v[88:91]
    ds_read_b128 v[144:147], v193 offset:12288
    v_mul_f32 v20, v20, v180
    v_mfma_f32_16x16x32_bf16 v[92:95], a[60:63], v[156:159], v[92:95]
    s_waitcnt lgkmcnt(7)
    ds_read_b128 v[148:151], v193 offset:13312
    v_mul_f32 v21, v21, v181
    v_mfma_f32_16x16x32_bf16 v[96:99], a[56:59], v[160:163], v[96:99]
    ds_read_b128 v[152:155], v193 offset:18432
    v_mul_f32 v22, v22, v182
    v_mfma_f32_16x16x32_bf16 v[100:103], a[60:63], v[160:163], v[100:103]
    ds_read_b128 v[156:159], v193 offset:19456
    v_mul_f32 v23, v23, v183
    v_mfma_f32_16x16x32_bf16 v[104:107], a[56:59], v[164:167], v[104:107]
    ds_read_b128 v[160:163], v193 offset:2048
    v_mul_f32 v24, v24, v184
    v_mfma_f32_16x16x32_bf16 v[108:111], a[60:63], v[164:167], v[108:111]
    s_waitcnt lgkmcnt(9)
    v_mul_f32 v25, v25, v185
    v_mul_f32 v26, v26, v186
    v_mfma_f32_16x16x32_bf16 v[112:115], a[56:59], v[168:171], v[112:115]
    ds_read_b128 v[164:167], v193 offset:3072
    v_mul_f32 v27, v27, v187
    v_mfma_f32_16x16x32_bf16 v[116:119], a[60:63], v[168:171], v[116:119]
    v_mul_f32 v28, v28, v188
    v_mul_f32 v29, v29, v189
    v_mfma_f32_16x16x32_bf16 v[120:123], a[56:59], v[172:175], v[120:123]
    ds_read_b128 v[168:171], v193 offset:8192
    v_mul_f32 v30, v30, v190
    v_mfma_f32_16x16x32_bf16 v[124:127], a[60:63], v[172:175], v[124:127]
    s_waitcnt vmcnt(18) lgkmcnt(9)
    v_mul_f32 v31, v31, v191
    v_cvt_pk_bf16_f32 v16, v16, v17
    v_mfma_f32_16x16x32_bf16 v[80:83], a[160:163], v[128:131], v[80:83]
    ds_read_b128 v[172:175], v193 offset:9216
    v_cvt_pk_bf16_f32 v18, v18, v19
    v_mfma_f32_16x16x32_bf16 v[84:87], a[164:167], v[128:131], v[84:87]
    v_cvt_pk_bf16_f32 v20, v20, v21
    v_cvt_pk_bf16_f32 v22, v22, v23
    v_mfma_f32_16x16x32_bf16 v[88:91], a[160:163], v[132:135], v[88:91]
    ds_read_b128 v[128:131], v193 offset:14336
    v_cvt_pk_bf16_f32 v24, v24, v25
    v_mfma_f32_16x16x32_bf16 v[92:95], a[164:167], v[132:135], v[92:95]
    s_waitcnt lgkmcnt(9)
    v_cvt_pk_bf16_f32 v26, v26, v27
    v_cvt_pk_bf16_f32 v28, v28, v29
    v_mfma_f32_16x16x32_bf16 v[80:83], a[168:171], v[136:139], v[80:83]
    ds_read_b128 v[132:135], v193 offset:15360
    v_cvt_pk_bf16_f32 v30, v30, v31
    v_mfma_f32_16x16x32_bf16 v[84:87], a[172:175], v[136:139], v[84:87]
    v_lshlrev_b32 v176, 16, v16
    v_and_b32 v177, 0xffff0000, v16
    v_mfma_f32_16x16x32_bf16 v[88:91], a[168:171], v[140:143], v[88:91]
    ds_read_b128 v[136:139], v193 offset:20480
    v_lshlrev_b32 v178, 16, v18
    v_mfma_f32_16x16x32_bf16 v[92:95], a[172:175], v[140:143], v[92:95]
    s_waitcnt lgkmcnt(9)
    v_and_b32 v179, 0xffff0000, v18
    v_lshlrev_b32 v180, 16, v20
    v_mfma_f32_16x16x32_bf16 v[80:83], a[176:179], v[144:147], v[80:83]
    ds_read_b128 v[140:143], v193 offset:21504
    v_and_b32 v181, 0xffff0000, v20
    v_mfma_f32_16x16x32_bf16 v[84:87], a[180:183], v[144:147], v[84:87]
    v_lshlrev_b32 v182, 16, v22
    v_and_b32 v183, 0xffff0000, v22
    v_mfma_f32_16x16x32_bf16 v[88:91], a[176:179], v[148:151], v[88:91]
    ds_read_b128 v[144:147], v193 offset:4096
    v_lshlrev_b32 v184, 16, v24
    v_mfma_f32_16x16x32_bf16 v[92:95], a[180:183], v[148:151], v[92:95]
    s_waitcnt lgkmcnt(9)
    v_and_b32 v185, 0xffff0000, v24
    v_lshlrev_b32 v186, 16, v26
    v_mfma_f32_16x16x32_bf16 v[80:83], a[184:187], v[152:155], v[80:83]
    ds_read_b128 v[148:151], v193 offset:5120
    v_and_b32 v187, 0xffff0000, v26
    v_mfma_f32_16x16x32_bf16 v[84:87], a[188:191], v[152:155], v[84:87]
    v_lshlrev_b32 v188, 16, v28
    v_and_b32 v189, 0xffff0000, v28
    v_mfma_f32_16x16x32_bf16 v[88:91], a[184:187], v[156:159], v[88:91]
    ds_read_b128 v[152:155], v193 offset:10240
    v_lshlrev_b32 v190, 16, v30
    v_mfma_f32_16x16x32_bf16 v[92:95], a[188:191], v[156:159], v[92:95]
    s_waitcnt lgkmcnt(9)
    v_and_b32 v191, 0xffff0000, v30
    v_mfma_f32_16x16x32_bf16 v[96:99], a[160:163], v[160:163], v[96:99]
    s_waitcnt vmcnt(24)
    ds_read_b128 v[156:159], v193 offset:11264
    v_lshlrev_b32 v32, 16, v48
    v_mfma_f32_16x16x32_bf16 v[100:103], a[164:167], v[160:163], v[100:103]
    v_and_b32 v33, 0xffff0000, v48
    v_lshlrev_b32 v34, 16, v49
    v_mfma_f32_16x16x32_bf16 v[104:107], a[160:163], v[164:167], v[104:107]
    ds_read_b128 v[160:163], v193 offset:16384
    v_and_b32 v35, 0xffff0000, v49
    v_mfma_f32_16x16x32_bf16 v[108:111], a[164:167], v[164:167], v[108:111]
    s_waitcnt lgkmcnt(9)
    v_lshlrev_b32 v36, 16, v50
    v_and_b32 v37, 0xffff0000, v50
    v_mfma_f32_16x16x32_bf16 v[96:99], a[168:171], v[168:171], v[96:99]
    s_add_u32 s42, s98, 4096
    ds_read_b128 v[164:167], v193 offset:17408
    v_cvt_pk_bf16_f32 v80, v80, v81
    v_mfma_f32_16x16x32_bf16 v[100:103], a[172:175], v[168:171], v[100:103]
    v_cvt_pk_bf16_f32 v81, v82, v83
    v_cvt_pk_bf16_f32 v82, v84, v85
    v_mfma_f32_16x16x32_bf16 v[104:107], a[168:171], v[172:175], v[104:107]
    ds_read_b128 v[168:171], v193 offset:22528
    v_cvt_pk_bf16_f32 v83, v86, v87
    v_mfma_f32_16x16x32_bf16 v[108:111], a[172:175], v[172:175], v[108:111]
    s_waitcnt lgkmcnt(9)
    buffer_store_dwordx4 v[80:83], v222, s[48:51], s42 offen offset:0 sc1
    v_mfma_f32_16x16x32_bf16 v[96:99], a[176:179], v[128:131], v[96:99]
    ds_read_b128 v[172:175], v193 offset:23552
    v_cvt_pk_bf16_f32 v84, v88, v89
    v_mfma_f32_16x16x32_bf16 v[100:103], a[180:183], v[128:131], v[100:103]
    v_cvt_pk_bf16_f32 v85, v90, v91
    v_cvt_pk_bf16_f32 v86, v92, v93
    v_mfma_f32_16x16x32_bf16 v[104:107], a[176:179], v[132:135], v[104:107]
    v_cvt_pk_bf16_f32 v87, v94, v95
    v_lshlrev_b32 v38, 16, v51
    v_mfma_f32_16x16x32_bf16 v[108:111], a[180:183], v[132:135], v[108:111]
    s_waitcnt lgkmcnt(8)
    buffer_store_dwordx4 v[84:87], v222, s[48:51], s42 offen offset:1024 sc1
    v_mfma_f32_16x16x32_bf16 v[96:99], a[184:187], v[136:139], v[96:99]
    v_and_b32 v39, 0xffff0000, v51
    v_lshlrev_b32 v40, 16, v52
    v_mfma_f32_16x16x32_bf16 v[100:103], a[188:191], v[136:139], v[100:103]
    v_and_b32 v41, 0xffff0000, v52
    v_lshlrev_b32 v42, 16, v53
    v_mfma_f32_16x16x32_bf16 v[104:107], a[184:187], v[140:143], v[104:107]
    v_and_b32 v43, 0xffff0000, v53
    v_lshlrev_b32 v44, 16, v54
    v_mfma_f32_16x16x32_bf16 v[108:111], a[188:191], v[140:143], v[108:111]
    s_waitcnt lgkmcnt(6)
    v_and_b32 v45, 0xffff0000, v54
    v_lshlrev_b32 v46, 16, v55
    v_mfma_f32_16x16x32_bf16 v[112:115], a[160:163], v[144:147], v[112:115]
    s_waitcnt vmcnt(2) lgkmcnt(0)
    v_and_b32 v47, 0xffff0000, v55
    v_lshrrev_b32 v8, 8, v222
    v_mfma_f32_16x16x32_bf16 v[116:119], a[164:167], v[144:147], v[116:119]
    s_barrier
    v_bfe_u32 v9, v222, 6, 2
    v_and_b32 v12, 16, v222
    v_mfma_f32_16x16x32_bf16 v[120:123], a[160:163], v[148:151], v[120:123]
    ds_read_b128 v[128:131], v222 offset:0
    v_mov_b32 v11, 0x3f80
    v_mfma_f32_16x16x32_bf16 v[124:127], a[164:167], v[148:151], v[124:127]
    s_waitcnt lgkmcnt(5)
    ds_read_b128 v[132:135], v222 offset:1024
    v_cmp_eq_u32 vcc, v8, v9
    v_mfma_f32_16x16x32_bf16 v[112:115], a[168:171], v[152:155], v[112:115]
    ds_read_b128 v[136:139], v222 offset:2048
    v_lshlrev_b32 v11, v12, v11
    v_mfma_f32_16x16x32_bf16 v[116:119], a[172:175], v[152:155], v[116:119]
    s_add_u32 s42, s98, 8192
    ds_read_b128 v[140:143], v222 offset:3072
    v_cvt_pk_bf16_f32 v96, v96, v97
    v_mfma_f32_16x16x32_bf16 v[120:123], a[168:171], v[156:159], v[120:123]
    ds_read_b128 v[144:147], v222 offset:4096
    v_cvt_pk_bf16_f32 v97, v98, v99
    v_mfma_f32_16x16x32_bf16 v[124:127], a[172:175], v[156:159], v[124:127]
    s_waitcnt lgkmcnt(7)
    ds_read_b128 v[148:151], v222 offset:5120
    v_cvt_pk_bf16_f32 v98, v100, v101
    v_mfma_f32_16x16x32_bf16 v[112:115], a[176:179], v[160:163], v[112:115]
    ds_read_b128 v[152:155], v222 offset:6144
    v_cvt_pk_bf16_f32 v99, v102, v103
    v_mfma_f32_16x16x32_bf16 v[116:119], a[180:183], v[160:163], v[116:119]
    ds_read_b128 v[156:159], v222 offset:7168
    v_and_b32 v13, 32, v222
    v_mfma_f32_16x16x32_bf16 v[120:123], a[176:179], v[164:167], v[120:123]
    ds_read_b128 v[160:163], v222 offset:8192
    v_cndmask_b32 v11, 0, v11, vcc
    v_mfma_f32_16x16x32_bf16 v[124:127], a[180:183], v[164:167], v[124:127]
    s_waitcnt lgkmcnt(9)
    buffer_store_dwordx4 v[96:99], v222, s[48:51], s42 offen offset:0 sc1
    v_mfma_f32_16x16x32_bf16 v[112:115], a[184:187], v[168:171], v[112:115]
    ds_read_b128 v[164:167], v222 offset:9216
    v_cvt_pk_bf16_f32 v100, v104, v105
    v_mfma_f32_16x16x32_bf16 v[116:119], a[188:191], v[168:171], v[116:119]
    v_cvt_pk_bf16_f32 v101, v106, v107
    v_cvt_pk_bf16_f32 v102, v108, v109
    v_mfma_f32_16x16x32_bf16 v[120:123], a[184:187], v[172:175], v[120:123]
    ds_read_b128 v[168:171], v222 offset:10240
    v_cvt_pk_bf16_f32 v103, v110, v111
    v_mfma_f32_16x16x32_bf16 v[124:127], a[188:191], v[172:175], v[124:127]
    s_waitcnt lgkmcnt(9)
    buffer_store_dwordx4 v[100:103], v222, s[48:51], s42 offen offset:1024 sc1
    v_mfma_f32_16x16x32_bf16 v[64:67], v[224:227], v[128:131], 0
    ds_read_b128 v[172:175], v222 offset:11264
    v_cmp_eq_u32 vcc, 0, v13
    v_mfma_f32_16x16x32_bf16 v[68:71], v[228:231], v[128:131], 0
    v_mov_b32 v8, 0
    v_mfma_f32_16x16x32_bf16 v[72:75], v[224:227], v[132:135], 0
    ds_read_b128 v[128:131], v222 offset:12288
    v_cndmask_b32 v10, 0, v11, vcc
    v_mfma_f32_16x16x32_bf16 v[76:79], v[228:231], v[132:135], 0
    s_waitcnt lgkmcnt(9)
    v_mov_b32 v9, 0
    v_mov_b32 v12, 0
    v_mfma_f32_16x16x32_bf16 v[64:67], v[232:235], v[136:139], v[64:67]
    ds_read_b128 v[132:135], v222 offset:13312
    v_xor_b32 v11, v11, v10
    v_mfma_f32_16x16x32_bf16 v[68:71], v[236:239], v[136:139], v[68:71]
    s_add_u32 s42, s98, 12288
    v_cvt_pk_bf16_f32 v112, v112, v113
    v_cvt_pk_bf16_f32 v113, v114, v115
    v_mfma_f32_16x16x32_bf16 v[72:75], v[232:235], v[140:143], v[72:75]
    ds_read_b128 v[136:139], v222 offset:14336
    v_cvt_pk_bf16_f32 v114, v116, v117
    v_mfma_f32_16x16x32_bf16 v[76:79], v[236:239], v[140:143], v[76:79]
    s_waitcnt lgkmcnt(9)
    v_cvt_pk_bf16_f32 v115, v118, v119
    v_mov_b32 v13, 0
    v_mfma_f32_16x16x32_bf16 v[64:67], v[240:243], v[144:147], v[64:67]
    ds_read_b128 v[140:143], v222 offset:15360
    v_mfma_f32_16x16x32_bf16 v[68:71], v[244:247], v[144:147], v[68:71]
    buffer_store_dwordx4 v[112:115], v222, s[48:51], s42 offen offset:0 sc1
    v_mfma_f32_16x16x32_bf16 v[72:75], v[240:243], v[148:151], v[72:75]
    ds_read_b128 v[144:147], v222 offset:16384
    v_cvt_pk_bf16_f32 v116, v120, v121
    v_mfma_f32_16x16x32_bf16 v[76:79], v[244:247], v[148:151], v[76:79]
    s_waitcnt lgkmcnt(9)
    v_cvt_pk_bf16_f32 v117, v122, v123
    v_cvt_pk_bf16_f32 v118, v124, v125
    v_mfma_f32_16x16x32_bf16 v[64:67], v[248:251], v[152:155], v[64:67]
    ds_read_b128 v[148:151], v222 offset:17408
    v_cvt_pk_bf16_f32 v119, v126, v127
    v_mfma_f32_16x16x32_bf16 v[68:71], v[252:255], v[152:155], v[68:71]
    buffer_store_dwordx4 v[116:119], v222, s[48:51], s42 offen offset:1024 sc1
    v_mfma_f32_16x16x32_bf16 v[72:75], v[248:251], v[156:159], v[72:75]
    s_xor_b32 s53, s98, 65536
    s_add_u32 s53, s53, 4096
    ds_read_b128 v[152:155], v222 offset:18432
    v_mfma_f32_16x16x32_bf16 v[76:79], v[252:255], v[156:159], v[76:79]
    s_waitcnt lgkmcnt(9)
    v_mfma_f32_16x16x32_bf16 v[64:67], a[192:195], v[160:163], v[64:67]
    s_xor_b32 s54, s98, 131072
    s_add_u32 s54, s54, 8192
    ds_read_b128 v[156:159], v222 offset:19456
    v_mfma_f32_16x16x32_bf16 v[68:71], a[196:199], v[160:163], v[68:71]
    s_xor_b32 s55, s98, 196608
    s_add_u32 s55, s55, 12288
    v_mfma_f32_16x16x32_bf16 v[72:75], a[192:195], v[164:167], v[72:75]
    ds_read_b128 v[160:163], v222 offset:20480
    v_mfma_f32_16x16x32_bf16 v[76:79], a[196:199], v[164:167], v[76:79]
    s_waitcnt lgkmcnt(9)
    v_mfma_f32_16x16x32_bf16 v[64:67], a[200:203], v[168:171], v[64:67]
    ds_read_b128 v[164:167], v222 offset:21504
    v_mfma_f32_16x16x32_bf16 v[68:71], a[204:207], v[168:171], v[68:71]
    v_mfma_f32_16x16x32_bf16 v[72:75], a[200:203], v[172:175], v[72:75]
    ds_read_b128 v[168:171], v222 offset:22528
    v_mfma_f32_16x16x32_bf16 v[76:79], a[204:207], v[172:175], v[76:79]
    s_waitcnt lgkmcnt(9)
    v_mfma_f32_16x16x32_bf16 v[64:67], a[208:211], v[128:131], v[64:67]
    ds_read_b128 v[172:175], v222 offset:23552
    v_mfma_f32_16x16x32_bf16 v[68:71], a[212:215], v[128:131], v[68:71]
    v_mfma_f32_16x16x32_bf16 v[72:75], a[208:211], v[132:135], v[72:75]
    ds_read_b128 v[128:131], v222 offset:24576
    v_mfma_f32_16x16x32_bf16 v[76:79], a[212:215], v[132:135], v[76:79]
    s_waitcnt lgkmcnt(9)
    v_mfma_f32_16x16x32_bf16 v[64:67], a[216:219], v[136:139], v[64:67]
    ds_read_b128 v[132:135], v222 offset:25600
    v_mfma_f32_16x16x32_bf16 v[68:71], a[220:223], v[136:139], v[68:71]
    v_mfma_f32_16x16x32_bf16 v[72:75], a[216:219], v[140:143], v[72:75]
    ds_read_b128 v[136:139], v222 offset:26624
    v_mfma_f32_16x16x32_bf16 v[76:79], a[220:223], v[140:143], v[76:79]
    s_waitcnt lgkmcnt(9)
    v_mfma_f32_16x16x32_bf16 v[64:67], a[128:131], v[144:147], v[64:67]
    ds_read_b128 v[140:143], v222 offset:27648
    v_mfma_f32_16x16x32_bf16 v[68:71], a[132:135], v[144:147], v[68:71]
    v_mfma_f32_16x16x32_bf16 v[72:75], a[128:131], v[148:151], v[72:75]
    ds_read_b128 v[144:147], v222 offset:28672
    v_mfma_f32_16x16x32_bf16 v[76:79], a[132:135], v[148:151], v[76:79]
    s_waitcnt lgkmcnt(9)
    v_mfma_f32_16x16x32_bf16 v[64:67], a[136:139], v[152:155], v[64:67]
    ds_read_b128 v[148:151], v222 offset:29696
    v_mfma_f32_16x16x32_bf16 v[68:71], a[140:143], v[152:155], v[68:71]
    v_mfma_f32_16x16x32_bf16 v[72:75], a[136:139], v[156:159], v[72:75]
    ds_read_b128 v[152:155], v222 offset:30720
    v_mfma_f32_16x16x32_bf16 v[76:79], a[140:143], v[156:159], v[76:79]
    s_waitcnt lgkmcnt(9)
    v_mfma_f32_16x16x32_bf16 v[64:67], a[144:147], v[160:163], v[64:67]
    ds_read_b128 v[156:159], v222 offset:31744
    v_mfma_f32_16x16x32_bf16 v[68:71], a[148:151], v[160:163], v[68:71]
    v_mfma_f32_16x16x32_bf16 v[72:75], a[144:147], v[164:167], v[72:75]
    ds_read_b128 v[160:163], v193 offset:32768
    v_mfma_f32_16x16x32_bf16 v[76:79], a[148:151], v[164:167], v[76:79]
    s_waitcnt lgkmcnt(9)
    v_mfma_f32_16x16x32_bf16 v[64:67], a[152:155], v[168:171], v[64:67]
    ds_read_b128 v[164:167], v193 offset:33792
    v_mfma_f32_16x16x32_bf16 v[68:71], a[156:159], v[168:171], v[68:71]
    v_mfma_f32_16x16x32_bf16 v[72:75], a[152:155], v[172:175], v[72:75]
    ds_read_b128 v[168:171], v193 offset:34816
    v_mfma_f32_16x16x32_bf16 v[76:79], a[156:159], v[172:175], v[76:79]
    s_waitcnt lgkmcnt(9)
    v_mfma_f32_16x16x32_bf16 v[64:67], a[0:3], v[128:131], v[64:67]
    ds_read_b128 v[172:175], v193 offset:35840
    v_mfma_f32_16x16x32_bf16 v[68:71], a[4:7], v[128:131], v[68:71]
    v_mfma_f32_16x16x32_bf16 v[72:75], a[0:3], v[132:135], v[72:75]
    ds_read_b128 v[128:131], v193 offset:36864
    v_mfma_f32_16x16x32_bf16 v[76:79], a[4:7], v[132:135], v[76:79]
    s_waitcnt lgkmcnt(9)
    v_mfma_f32_16x16x32_bf16 v[64:67], a[8:11], v[136:139], v[64:67]
    ds_read_b128 v[132:135], v193 offset:37888
    v_mfma_f32_16x16x32_bf16 v[68:71], a[12:15], v[136:139], v[68:71]
    v_mfma_f32_16x16x32_bf16 v[72:75], a[8:11], v[140:143], v[72:75]
    ds_read_b128 v[136:139], v193 offset:38912
    v_mfma_f32_16x16x32_bf16 v[76:79], a[12:15], v[140:143], v[76:79]
    s_waitcnt lgkmcnt(9)
    buffer_load_dwordx4 v[88:91], v222, s[48:51], s53 offen offset:0 sc1
    v_mfma_f32_16x16x32_bf16 v[64:67], a[16:19], v[144:147], v[64:67]
    ds_read_b128 v[140:143], v193 offset:39936
    v_mfma_f32_16x16x32_bf16 v[68:71], a[20:23], v[144:147], v[68:71]
    buffer_load_dwordx4 v[92:95], v222, s[48:51], s53 offen offset:1024 sc1
    v_mfma_f32_16x16x32_bf16 v[72:75], a[16:19], v[148:151], v[72:75]
    ds_read_b128 v[144:147], v193 offset:40960
    v_mfma_f32_16x16x32_bf16 v[76:79], a[20:23], v[148:151], v[76:79]
    s_waitcnt lgkmcnt(9)
    buffer_load_dwordx4 v[104:107], v222, s[48:51], s54 offen offset:0 sc1
    v_mfma_f32_16x16x32_bf16 v[64:67], a[24:27], v[152:155], v[64:67]
    ds_read_b128 v[148:151], v193 offset:41984
    v_mfma_f32_16x16x32_bf16 v[68:71], a[28:31], v[152:155], v[68:71]
    buffer_load_dwordx4 v[108:111], v222, s[48:51], s54 offen offset:1024 sc1
    v_mfma_f32_16x16x32_bf16 v[72:75], a[24:27], v[156:159], v[72:75]
    ds_read_b128 v[152:155], v193 offset:43008
    v_mfma_f32_16x16x32_bf16 v[76:79], a[28:31], v[156:159], v[76:79]
    s_waitcnt lgkmcnt(9)
    buffer_load_dwordx4 v[120:123], v222, s[48:51], s55 offen offset:0 sc1
    v_mfma_f32_16x16x32_bf16 v[64:67], a[32:35], v[160:163], v[64:67]
    ds_read_b128 v[156:159], v193 offset:44032
    v_mfma_f32_16x16x32_bf16 v[68:71], a[36:39], v[160:163], v[68:71]
    buffer_load_dwordx4 v[124:127], v222, s[48:51], s55 offen offset:1024 sc1
    v_mfma_f32_16x16x32_bf16 v[72:75], a[32:35], v[164:167], v[72:75]
    ds_read_b128 v[160:163], v193 offset:45056
    v_mfma_f32_16x16x32_bf16 v[76:79], a[36:39], v[164:167], v[76:79]
    s_waitcnt lgkmcnt(9)
    v_mfma_f32_16x16x32_bf16 v[64:67], a[40:43], v[168:171], v[64:67]
    ds_read_b128 v[164:167], v193 offset:46080
    v_mfma_f32_16x16x32_bf16 v[68:71], a[44:47], v[168:171], v[68:71]
    v_mfma_f32_16x16x32_bf16 v[72:75], a[40:43], v[172:175], v[72:75]
    ds_read_b128 v[168:171], v193 offset:47104
    v_mfma_f32_16x16x32_bf16 v[76:79], a[44:47], v[172:175], v[76:79]
    s_waitcnt lgkmcnt(9)
    v_mfma_f32_16x16x32_bf16 v[64:67], a[48:51], v[128:131], v[64:67]
    ds_read_b128 v[172:175], v193 offset:48128
    v_mfma_f32_16x16x32_bf16 v[68:71], a[52:55], v[128:131], v[68:71]
    v_mfma_f32_16x16x32_bf16 v[72:75], a[48:51], v[132:135], v[72:75]
    v_mfma_f32_16x16x32_bf16 v[76:79], a[52:55], v[132:135], v[76:79]
    s_waitcnt lgkmcnt(8)
    v_mfma_f32_16x16x32_bf16 v[64:67], a[56:59], v[136:139], v[64:67]
    v_mfma_f32_16x16x32_bf16 v[68:71], a[60:63], v[136:139], v[68:71]
    v_mfma_f32_16x16x32_bf16 v[72:75], a[56:59], v[140:143], v[72:75]
    v_mfma_f32_16x16x32_bf16 v[76:79], a[60:63], v[140:143], v[76:79]
    s_waitcnt lgkmcnt(6)
    v_mfma_f32_16x16x32_bf16 v[64:67], a[160:163], v[144:147], v[64:67]
    v_mfma_f32_16x16x32_bf16 v[68:71], a[164:167], v[144:147], v[68:71]
    v_mfma_f32_16x16x32_bf16 v[72:75], a[160:163], v[148:151], v[72:75]
    v_mfma_f32_16x16x32_bf16 v[76:79], a[164:167], v[148:151], v[76:79]
    s_waitcnt lgkmcnt(4)
    v_mfma_f32_16x16x32_bf16 v[64:67], a[168:171], v[152:155], v[64:67]
    v_mfma_f32_16x16x32_bf16 v[68:71], a[172:175], v[152:155], v[68:71]
    v_mfma_f32_16x16x32_bf16 v[72:75], a[168:171], v[156:159], v[72:75]
    v_mfma_f32_16x16x32_bf16 v[76:79], a[172:175], v[156:159], v[76:79]
    s_waitcnt lgkmcnt(2)
    v_mfma_f32_16x16x32_bf16 v[64:67], a[176:179], v[160:163], v[64:67]
    v_mfma_f32_16x16x32_bf16 v[68:71], a[180:183], v[160:163], v[68:71]
    v_mfma_f32_16x16x32_bf16 v[72:75], a[176:179], v[164:167], v[72:75]
    v_mfma_f32_16x16x32_bf16 v[76:79], a[180:183], v[164:167], v[76:79]
    s_waitcnt lgkmcnt(0)
    v_mfma_f32_16x16x32_bf16 v[64:67], a[184:187], v[168:171], v[64:67]
    v_mfma_f32_16x16x32_bf16 v[68:71], a[188:191], v[168:171], v[68:71]
    v_mfma_f32_16x16x32_bf16 v[72:75], a[184:187], v[172:175], v[72:75]
    v_mfma_f32_16x16x32_bf16 v[76:79], a[188:191], v[172:175], v[76:79]
    s_waitcnt vmcnt(0)
    s_branch F_FIN
F_RB6:
    s_and_b32 s42, s86, 0xffff0000
    s_xor_b32 s54, s42, 0x80000000
    s_xor_b32 s55, s42, 0xffff0000
    s_bitcmp1_b32 s42, 31
    s_cselect_b32 s42, s54, s55
    v_mov_b32 v16, s42
    v_mul_f32 v16, s36, v16
    v_exp_f32 v16, v16
    v_add_f32_dpp v0, v176, v176 quad_perm:[1,0,3,2] row_mask:0xf bank_mask:0xf
    v_add_f32_dpp v1, v180, v180 quad_perm:[1,0,3,2] row_mask:0xf bank_mask:0xf
    v_add_f32_dpp v2, v177, v177 quad_perm:[1,0,3,2] row_mask:0xf bank_mask:0xf
    v_add_f32_dpp v3, v181, v181 quad_perm:[1,0,3,2] row_mask:0xf bank_mask:0xf
    v_add_f32_dpp v4, v178, v178 quad_perm:[1,0,3,2] row_mask:0xf bank_mask:0xf
    v_add_f32_dpp v5, v182, v182 quad_perm:[1,0,3,2] row_mask:0xf bank_mask:0xf
    v_add_f32_dpp v6, v179, v179 quad_perm:[1,0,3,2] row_mask:0xf bank_mask:0xf
    v_add_f32_dpp v7, v183, v183 quad_perm:[1,0,3,2] row_mask:0xf bank_mask:0xf
    v_add_f32_dpp v0, v0, v0 quad_perm:[2,3,0,1] row_mask:0xf bank_mask:0xf
    v_add_f32_dpp v1, v1, v1 quad_perm:[2,3,0,1] row_mask:0xf bank_mask:0xf
    v_add_f32_dpp v2, v2, v2 quad_perm:[2,3,0,1] row_mask:0xf bank_mask:0xf
    v_add_f32_dpp v3, v3, v3 quad_perm:[2,3,0,1] row_mask:0xf bank_mask:0xf
    v_add_f32_dpp v4, v4, v4 quad_perm:[2,3,0,1] row_mask:0xf bank_mask:0xf
    v_add_f32_dpp v5, v5, v5 quad_perm:[2,3,0,1] row_mask:0xf bank_mask:0xf
    v_add_f32_dpp v6, v6, v6 quad_perm:[2,3,0,1] row_mask:0xf bank_mask:0xf
    v_add_f32_dpp v7, v7, v7 quad_perm:[2,3,0,1] row_mask:0xf bank_mask:0xf
    v_add_f32_dpp v0, v0, v0 row_half_mirror row_mask:0xf bank_mask:0xf
    v_add_f32_dpp v1, v1, v1 row_half_mirror row_mask:0xf bank_mask:0xf
    v_add_f32_dpp v2, v2, v2 row_half_mirror row_mask:0xf bank_mask:0xf
    v_add_f32_dpp v3, v3, v3 row_half_mirror row_mask:0xf bank_mask:0xf
    v_add_f32_dpp v4, v4, v4 row_half_mirror row_mask:0xf bank_mask:0xf
    v_add_f32_dpp v5, v5, v5 row_half_mirror row_mask:0xf bank_mask:0xf
    v_add_f32_dpp v6, v6, v6 row_half_mirror row_mask:0xf bank_mask:0xf
    v_add_f32_dpp v7, v7, v7 row_half_mirror row_mask:0xf bank_mask:0xf
    v_add_f32_dpp v0, v0, v0 row_mirror row_mask:0xf bank_mask:0xf
    v_add_f32_dpp v1, v1, v1 row_mirror row_mask:0xf bank_mask:0xf
    v_add_f32_dpp v2, v2, v2 row_mirror row_mask:0xf bank_mask:0xf
    v_add_f32_dpp v3, v3, v3 row_mirror row_mask:0xf bank_mask:0xf
    v_add_f32_dpp v4, v4, v4 row_mirror row_mask:0xf bank_mask:0xf
    v_add_f32_dpp v5, v5, v5 row_mirror row_mask:0xf bank_mask:0xf
    v_add_f32_dpp v6, v6, v6 row_mirror row_mask:0xf bank_mask:0xf
    v_add_f32_dpp v7, v7, v7 row_mirror row_mask:0xf bank_mask:0xf
    v_add_f32 v16, 1.0, v16
    v_rcp_f32 v16, v16
    s_bfe_u32 s42, s87, 0x4000a
    s_mov_b32 s54, 0x00010001
    s_lshl_b32 s54, s54, s42
    s_mov_b32 s55, s54
    v_cvt_pk_bf16_f32 v16, v16, v16
    v_lshlrev_b32 v16, 16, v16
    v_cvt_pk_bf16_f32 v8, v0, v1
    v_cvt_pk_bf16_f32 v9, v2, v3
    v_cvt_pk_bf16_f32 v10, v4, v5
    v_cvt_pk_bf16_f32 v11, v6, v7
    v_lshlrev_b32 v0, 16, v8
    v_and_b32 v1, 0xffff0000, v8
    v_lshlrev_b32 v2, 16, v9
    v_and_b32 v3, 0xffff0000, v9
    v_lshlrev_b32 v4, 16, v10
    v_and_b32 v5, 0xffff0000, v10
    v_lshlrev_b32 v6, 16, v11
    v_and_b32 v7, 0xffff0000, v11
    v_mul_f32 v0, v0, v16
    v_mul_f32 v1, v1, v16
    v_mul_f32 v2, v2, v16
    v_mul_f32 v3, v3, v16
    v_mul_f32 v4, v4, v16
    v_mul_f32 v5, v5, v16
    v_mul_f32 v6, v6, v16
    v_mul_f32 v7, v7, v16
    v_cvt_pk_bf16_f32 v8, v0, v1
    v_cvt_pk_bf16_f32 v9, v2, v3
    v_cvt_pk_bf16_f32 v10, v4, v5
    v_cvt_pk_bf16_f32 v11, v6, v7
    v_lshlrev_b32 v0, 16, v8
    v_and_b32 v1, 0xffff0000, v8
    v_lshlrev_b32 v2, 16, v9
    v_and_b32 v3, 0xffff0000, v9
    v_lshlrev_b32 v4, 16, v10
    v_and_b32 v5, 0xffff0000, v10
    v_lshlrev_b32 v6, 16, v11
    v_and_b32 v7, 0xffff0000, v11
    s_bitcmp0_b32 s87, 14
    s_cselect_b64 exec, s[54:55], 0
    v_lshlrev_b32 v8, 16, v184
    v_and_b32 v9, 0xffff0000, v184
    v_lshlrev_b32 v10, 16, v185
    v_and_b32 v11, 0xffff0000, v185
    v_lshlrev_b32 v12, 16, v186
    v_and_b32 v13, 0xffff0000, v186
    v_lshlrev_b32 v14, 16, v187
    v_and_b32 v15, 0xffff0000, v187
    v_add_f32 v8, v8, v0
    v_add_f32 v9, v9, v1
    v_add_f32 v10, v10, v2
    v_add_f32 v11, v11, v3
    v_add_f32 v12, v12, v4
    v_add_f32 v13, v13, v5
    v_add_f32 v14, v14, v6
    v_add_f32 v15, v15, v7
    v_cvt_pk_bf16_f32 v184, v8, v9
    v_cvt_pk_bf16_f32 v185, v10, v11
    v_cvt_pk_bf16_f32 v186, v12, v13
    v_cvt_pk_bf16_f32 v187, v14, v15
    s_bitcmp1_b32 s87, 14
    s_cselect_b64 exec, s[54:55], 0
    v_lshlrev_b32 v8, 16, v188
    v_and_b32 v9, 0xffff0000, v188
    v_lshlrev_b32 v10, 16, v189
    v_and_b32 v11, 0xffff0000, v189
    v_lshlrev_b32 v12, 16, v190
    v_and_b32 v13, 0xffff0000, v190
    v_lshlrev_b32 v14, 16, v191
    v_and_b32 v15, 0xffff0000, v191
    v_add_f32 v8, v8, v0
    v_add_f32 v9, v9, v1
    v_add_f32 v10, v10, v2
    v_add_f32 v11, v11, v3
    v_add_f32 v12, v12, v4
    v_add_f32 v13, v13, v5
    v_add_f32 v14, v14, v6
    v_add_f32 v15, v15, v7
    v_cvt_pk_bf16_f32 v188, v8, v9
    v_cvt_pk_bf16_f32 v189, v10, v11
    v_cvt_pk_bf16_f32 v190, v12, v13
    v_cvt_pk_bf16_f32 v191, v14, v15
    s_mov_b64 exec, -1
    s_branch F_RBB6
F_W3_6:
    s_mov_b32 s67, 200000
F_W3_6L:
    s_lshr_b32 s43, s79, 7
    s_load_dwordx2 s[72:73], s[70:71], s43 glc
    s_add_u32 s66, s66, 524288
    s_waitcnt lgkmcnt(0)
    s_cmp_eq_u64 s[72:73], s[64:65]
    s_cbranch_scc1 F_WB3_6
    s_sub_u32 s67, s67, 1
    s_cmp_lg_u32 s67, 0
    s_cbranch_scc1 F_W3_6L
    s_branch F_WB3_6
F_W4_6:
    s_mov_b32 s67, 200000
F_W4_6L:
    s_lshr_b32 s43, s82, 7
    s_load_dwordx2 s[72:73], s[70:71], s43 glc
    s_add_u32 s66, s66, 524288
    s_waitcnt lgkmcnt(0)
    s_cmp_eq_u64 s[72:73], s[64:65]
    s_cbranch_scc1 F_WB4_6
    s_sub_u32 s67, s67, 1
    s_cmp_lg_u32 s67, 0
    s_cbranch_scc1 F_W4_6L
    s_branch F_WB4_6
F_W5_6:
    s_mov_b32 s67, 200000
F_W5_6L:
    s_lshr_b32 s43, s77, 7
    s_load_dwordx2 s[72:73], s[70:71], s43 glc
    s_add_u32 s66, s66, 524288
    s_waitcnt lgkmcnt(0)
    s_cmp_eq_u64 s[72:73], s[64:65]
    s_cbranch_scc1 F_WB5_6
    s_sub_u32 s67, s67, 1
    s_cmp_lg_u32 s67, 0
    s_cbranch_scc1 F_W5_6L
    s_branch F_WB5_6
F_G5:
    ds_read_b128 v[128:131], v192 offset:0
    ds_read_b128 v[132:135], v192 offset:1024
    ds_read_b128 v[136:139], v192 offset:2048
    ds_read_b128 v[140:143], v192 offset:3072
    ds_read_b128 v[144:147], v192 offset:4096
    ds_read_b128 v[148:151], v192 offset:5120
    ds_read_b128 v[152:155], v192 offset:6144
    ds_read_b128 v[156:159], v192 offset:7168
    ds_read_b128 v[160:163], v192 offset:8192
    ds_read_b128 v[164:167], v192 offset:9216
    ds_read_b128 v[168:171], v192 offset:10240
    ds_read_b128 v[172:175], v192 offset:11264
    s_waitcnt lgkmcnt(10)
    v_mfma_f32_16x16x32_bf16 v[80:83], v[224:227], v[128:131], 0
    s_xor_b32 s33, s0, s76
    s_xor_b32 s34, s33, 262144
    s_add_u32 m0, s99, 98304
    v_mfma_f32_16x16x32_bf16 v[84:87], v[228:231], v[128:131], 0
    buffer_load_dwordx4 v222, s[48:51], s34 offen sc1 lds
    v_mfma_f32_16x16x32_bf16 v[88:91], v[224:227], v[132:135], 0
    ds_read_b128 v[128:131], v192 offset:12288
    v_mfma_f32_16x16x32_bf16 v[92:95], v[228:231], v[132:135], 0
    s_waitcnt lgkmcnt(9)
    v_mfma_f32_16x16x32_bf16 v[96:99], v[224:227], v[136:139], 0
    s_lshr_b32 s43, s79, 7
    s_load_dwordx2 s[72:73], s[70:71], s43 glc
    ds_read_b128 v[132:135], v192 offset:13312
    v_mfma_f32_16x16x32_bf16 v[100:103], v[228:231], v[136:139], 0
    buffer_load_dwordx4 v216, s[48:51], s34 offen offset:1024 sc1 lds
    v_mfma_f32_16x16x32_bf16 v[104:107], v[224:227], v[140:143], 0
    ds_read_b128 v[136:139], v192 offset:14336
    v_mfma_f32_16x16x32_bf16 v[108:111], v[228:231], v[140:143], 0
    s_waitcnt lgkmcnt(9)
    v_mfma_f32_16x16x32_bf16 v[112:115], v[224:227], v[144:147], 0
    s_xor_b32 s34, s33, 525312
    s_add_u32 m0, s99, 100352
    ds_read_b128 v[140:143], v192 offset:15360
    v_mfma_f32_16x16x32_bf16 v[116:119], v[228:231], v[144:147], 0
    buffer_load_dwordx4 v222, s[48:51], s34 offen sc1 lds
    v_mfma_f32_16x16x32_bf16 v[120:123], v[224:227], v[148:151], 0
    ds_read_b128 v[144:147], v192 offset:16384
    v_mfma_f32_16x16x32_bf16 v[124:127], v[228:231], v[148:151], 0
    s_waitcnt lgkmcnt(9)
    v_mfma_f32_16x16x32_bf16 v[80:83], v[232:235], v[152:155], v[80:83]
    ds_read_b128 v[148:151], v192 offset:17408
    v_mfma_f32_16x16x32_bf16 v[84:87], v[236:239], v[152:155], v[84:87]
    buffer_load_dwordx4 v216, s[48:51], s34 offen offset:1024 sc1 lds
    v_mfma_f32_16x16x32_bf16 v[88:91], v[232:235], v[156:159], v[88:91]
    ds_read_b128 v[152:155], v192 offset:18432
    v_mfma_f32_16x16x32_bf16 v[92:95], v[236:239], v[156:159], v[92:95]
    s_waitcnt lgkmcnt(9)
    v_mfma_f32_16x16x32_bf16 v[96:99], v[232:235], v[160:163], v[96:99]
    s_xor_b32 s34, s33, 787456
    s_add_u32 m0, s99, 102400
    ds_read_b128 v[156:159], v192 offset:19456
    v_mfma_f32_16x16x32_bf16 v[100:103], v[236:239], v[160:163], v[100:103]
    buffer_load_dwordx4 v222, s[48:51], s34 offen sc1 lds
    v_mfma_f32_16x16x32_bf16 v[104:107], v[232:235], v[164:167], v[104:107]
    ds_read_b128 v[160:163], v192 offset:20480
    v_mfma_f32_16x16x32_bf16 v[108:111], v[236:239], v[164:167], v[108:111]
    s_waitcnt lgkmcnt(9)
    v_mfma_f32_16x16x32_bf16 v[112:115], v[232:235], v[168:171], v[112:115]
    ds_read_b128 v[164:167], v192 offset:21504
    v_mfma_f32_16x16x32_bf16 v[116:119], v[236:239], v[168:171], v[116:119]
    buffer_load_dwordx4 v216, s[48:51], s34 offen offset:1024 sc1 lds
    v_mfma_f32_16x16x32_bf16 v[120:123], v[232:235], v[172:175], v[120:123]
    ds_read_b128 v[168:171], v192 offset:22528
    v_mfma_f32_16x16x32_bf16 v[124:127], v[236:239], v[172:175], v[124:127]
    s_waitcnt lgkmcnt(9)
    v_mfma_f32_16x16x32_bf16 v[80:83], v[240:243], v[128:131], v[80:83]
    s_xor_b32 s34, s0, s74
    s_add_u32 m0, s68, 0
    ds_read_b128 v[172:175], v192 offset:23552
    v_mfma_f32_16x16x32_bf16 v[84:87], v[244:247], v[128:131], v[84:87]
    buffer_load_dwordx4 v222, s[48:51], s34 offen sc1 lds
    v_mfma_f32_16x16x32_bf16 v[88:91], v[240:243], v[132:135], v[88:91]
    v_mfma_f32_16x16x32_bf16 v[92:95], v[244:247], v[132:135], v[92:95]
    s_waitcnt lgkmcnt(8)
    v_mfma_f32_16x16x32_bf16 v[96:99], v[240:243], v[136:139], v[96:99]
    v_mfma_f32_16x16x32_bf16 v[100:103], v[244:247], v[136:139], v[100:103]
    buffer_load_dwordx4 v216, s[48:51], s34 offen offset:1024 sc1 lds
    v_mfma_f32_16x16x32_bf16 v[104:107], v[240:243], v[140:143], v[104:107]
    v_mfma_f32_16x16x32_bf16 v[108:111], v[244:247], v[140:143], v[108:111]
    s_waitcnt lgkmcnt(6)
    v_mfma_f32_16x16x32_bf16 v[112:115], v[240:243], v[144:147], v[112:115]
    s_waitcnt vmcnt(17) lgkmcnt(0)
    v_mfma_f32_16x16x32_bf16 v[116:119], v[244:247], v[144:147], v[116:119]
    s_cmp_eq_u64 s[72:73], s[64:65]
    s_cbranch_scc0 F_W3_5
F_WB3_5:
    s_barrier
    v_mfma_f32_16x16x32_bf16 v[120:123], v[240:243], v[148:151], v[120:123]
    ds_read_b128 v[128:131], v192 offset:32768
    v_mfma_f32_16x16x32_bf16 v[124:127], v[244:247], v[148:151], v[124:127]
    s_waitcnt lgkmcnt(5)
    ds_read_b128 v[132:135], v192 offset:33792
    v_mfma_f32_16x16x32_bf16 v[80:83], v[248:251], v[152:155], v[80:83]
    ds_read_b128 v[136:139], v192 offset:34816
    v_mfma_f32_16x16x32_bf16 v[84:87], v[252:255], v[152:155], v[84:87]
    ds_read_b128 v[140:143], v192 offset:35840
    v_mfma_f32_16x16x32_bf16 v[88:91], v[248:251], v[156:159], v[88:91]
    ds_read_b128 v[144:147], v192 offset:36864
    v_mfma_f32_16x16x32_bf16 v[92:95], v[252:255], v[156:159], v[92:95]
    s_waitcnt lgkmcnt(7)
    ds_read_b128 v[148:151], v192 offset:37888
    v_mfma_f32_16x16x32_bf16 v[96:99], v[248:251], v[160:163], v[96:99]
    ds_read_b128 v[152:155], v192 offset:38912
    v_mfma_f32_16x16x32_bf16 v[100:103], v[252:255], v[160:163], v[100:103]
    ds_read_b128 v[156:159], v192 offset:39936
    v_mfma_f32_16x16x32_bf16 v[104:107], v[248:251], v[164:167], v[104:107]
    s_xor_b32 s34, s0, s75
    s_add_u32 m0, s68, 8192
    ds_read_b128 v[160:163], v192 offset:40960
    v_mfma_f32_16x16x32_bf16 v[108:111], v[252:255], v[164:167], v[108:111]
    s_waitcnt lgkmcnt(9)
    buffer_load_dwordx4 v222, s[48:51], s34 offen sc1 lds
    v_mfma_f32_16x16x32_bf16 v[112:115], v[248:251], v[168:171], v[112:115]
    ds_read_b128 v[164:167], v192 offset:41984
    v_mfma_f32_16x16x32_bf16 v[116:119], v[252:255], v[168:171], v[116:119]
    v_mfma_f32_16x16x32_bf16 v[120:123], v[248:251], v[172:175], v[120:123]
    ds_read_b128 v[168:171], v192 offset:43008
    v_mfma_f32_16x16x32_bf16 v[124:127], v[252:255], v[172:175], v[124:127]
    s_waitcnt lgkmcnt(9)
    buffer_load_dwordx4 v216, s[48:51], s34 offen offset:1024 sc1 lds
    v_mfma_f32_16x16x32_bf16 v[80:83], a[192:195], v[128:131], v[80:83]
    ds_read_b128 v[172:175], v192 offset:44032
    v_mfma_f32_16x16x32_bf16 v[84:87], a[196:199], v[128:131], v[84:87]
    v_mfma_f32_16x16x32_bf16 v[88:91], a[192:195], v[132:135], v[88:91]
    s_xor_b32 s33, s0, s79
    s_xor_b32 s34, s33, 262144
    s_add_u32 m0, s99, 32768
    ds_read_b128 v[128:131], v192 offset:45056
    v_mfma_f32_16x16x32_bf16 v[92:95], a[196:199], v[132:135], v[92:95]
    s_waitcnt lgkmcnt(9)
    buffer_load_dwordx4 v222, s[48:51], s34 offen sc1 lds
    v_mfma_f32_16x16x32_bf16 v[96:99], a[192:195], v[136:139], v[96:99]
    s_lshr_b32 s43, s82, 7
    s_load_dwordx2 s[72:73], s[70:71], s43 glc
    ds_read_b128 v[132:135], v192 offset:46080
    v_mfma_f32_16x16x32_bf16 v[100:103], a[196:199], v[136:139], v[100:103]
    v_mfma_f32_16x16x32_bf16 v[104:107], a[192:195], v[140:143], v[104:107]
    ds_read_b128 v[136:139], v192 offset:47104
    v_mfma_f32_16x16x32_bf16 v[108:111], a[196:199], v[140:143], v[108:111]
    s_waitcnt lgkmcnt(9)
    buffer_load_dwordx4 v216, s[48:51], s34 offen offset:1024 sc1 lds
    v_mfma_f32_16x16x32_bf16 v[112:115], a[192:195], v[144:147], v[112:115]
    ds_read_b128 v[140:143], v192 offset:48128
    v_mfma_f32_16x16x32_bf16 v[116:119], a[196:199], v[144:147], v[116:119]
    v_mfma_f32_16x16x32_bf16 v[120:123], a[192:195], v[148:151], v[120:123]
    s_xor_b32 s34, s33, 525312
    s_add_u32 m0, s99, 34816
    ds_read_b128 v[144:147], v192 offset:49152
    v_mfma_f32_16x16x32_bf16 v[124:127], a[196:199], v[148:151], v[124:127]
    s_waitcnt lgkmcnt(9)
    buffer_load_dwordx4 v222, s[48:51], s34 offen sc1 lds
    v_mfma_f32_16x16x32_bf16 v[80:83], a[200:203], v[152:155], v[80:83]
    ds_read_b128 v[148:151], v192 offset:50176
    v_mfma_f32_16x16x32_bf16 v[84:87], a[204:207], v[152:155], v[84:87]
    v_mfma_f32_16x16x32_bf16 v[88:91], a[200:203], v[156:159], v[88:91]
    ds_read_b128 v[152:155], v192 offset:51200
    v_mfma_f32_16x16x32_bf16 v[92:95], a[204:207], v[156:159], v[92:95]
    s_waitcnt lgkmcnt(9)
    buffer_load_dwordx4 v216, s[48:51], s34 offen offset:1024 sc1 lds
    v_mfma_f32_16x16x32_bf16 v[96:99], a[200:203], v[160:163], v[96:99]
    ds_read_b128 v[156:159], v192 offset:52224
    v_mfma_f32_16x16x32_bf16 v[100:103], a[204:207], v[160:163], v[100:103]
    v_mfma_f32_16x16x32_bf16 v[104:107], a[200:203], v[164:167], v[104:107]
    s_xor_b32 s34, s33, 787456
    s_add_u32 m0, s99, 36864
    ds_read_b128 v[160:163], v192 offset:53248
    v_mfma_f32_16x16x32_bf16 v[108:111], a[204:207], v[164:167], v[108:111]
    s_waitcnt lgkmcnt(9)
    buffer_load_dwordx4 v222, s[48:51], s34 offen sc1 lds
    v_mfma_f32_16x16x32_bf16 v[112:115], a[200:203], v[168:171], v[112:115]
    ds_read_b128 v[164:167], v192 offset:54272
    v_mfma_f32_16x16x32_bf16 v[116:119], a[204:207], v[168:171], v[116:119]
    v_mfma_f32_16x16x32_bf16 v[120:123], a[200:203], v[172:175], v[120:123]
    ds_read_b128 v[168:171], v192 offset:55296
    v_mfma_f32_16x16x32_bf16 v[124:127], a[204:207], v[172:175], v[124:127]
    s_waitcnt lgkmcnt(9)
    buffer_load_dwordx4 v216, s[48:51], s34 offen offset:1024 sc1 lds
    v_mfma_f32_16x16x32_bf16 v[80:83], a[208:211], v[128:131], v[80:83]
    ds_read_b128 v[172:175], v192 offset:56320
    v_mfma_f32_16x16x32_bf16 v[84:87], a[212:215], v[128:131], v[84:87]
    v_mfma_f32_16x16x32_bf16 v[88:91], a[208:211], v[132:135], v[88:91]
    s_xor_b32 s34, s0, s76
    s_add_u32 m0, s68, 16384
    v_mfma_f32_16x16x32_bf16 v[92:95], a[212:215], v[132:135], v[92:95]
    s_waitcnt lgkmcnt(8)
    buffer_load_dwordx4 v222, s[48:51], s34 offen sc1 lds
    v_mfma_f32_16x16x32_bf16 v[96:99], a[208:211], v[136:139], v[96:99]
    v_mfma_f32_16x16x32_bf16 v[100:103], a[212:215], v[136:139], v[100:103]
    v_mfma_f32_16x16x32_bf16 v[104:107], a[208:211], v[140:143], v[104:107]
    v_mfma_f32_16x16x32_bf16 v[108:111], a[212:215], v[140:143], v[108:111]
    s_waitcnt lgkmcnt(6)
    buffer_load_dwordx4 v216, s[48:51], s34 offen offset:1024 sc1 lds
    v_mfma_f32_16x16x32_bf16 v[112:115], a[208:211], v[144:147], v[112:115]
    s_waitcnt vmcnt(12) lgkmcnt(0)
    v_mfma_f32_16x16x32_bf16 v[116:119], a[212:215], v[144:147], v[116:119]
    s_cmp_eq_u64 s[72:73], s[64:65]
    s_cbranch_scc0 F_W4_5
F_WB4_5:
    s_barrier
    v_mfma_f32_16x16x32_bf16 v[120:123], a[208:211], v[148:151], v[120:123]
    ds_read_b128 v[128:131], v193 offset:0
    v_mfma_f32_16x16x32_bf16 v[124:127], a[212:215], v[148:151], v[124:127]
    s_waitcnt lgkmcnt(5)
    ds_read_b128 v[132:135], v193 offset:1024
    v_mfma_f32_16x16x32_bf16 v[80:83], a[216:219], v[152:155], v[80:83]
    s_cmp_eq_u32 s7, 0
    s_cbranch_scc1 F_RB5
F_RBB5:
    ds_read_b128 v[136:139], v193 offset:2048
    v_mfma_f32_16x16x32_bf16 v[84:87], a[220:223], v[152:155], v[84:87]
    ds_read_b128 v[140:143], v193 offset:3072
    v_mfma_f32_16x16x32_bf16 v[88:91], a[216:219], v[156:159], v[88:91]
    ds_read_b128 v[144:147], v193 offset:4096
    v_mfma_f32_16x16x32_bf16 v[92:95], a[220:223], v[156:159], v[92:95]
    s_waitcnt lgkmcnt(7)
    ds_read_b128 v[148:151], v193 offset:5120
    v_mfma_f32_16x16x32_bf16 v[96:99], a[216:219], v[160:163], v[96:99]
    ds_read_b128 v[152:155], v193 offset:6144
    v_mfma_f32_16x16x32_bf16 v[100:103], a[220:223], v[160:163], v[100:103]
    ds_read_b128 v[156:159], v193 offset:7168
    v_mfma_f32_16x16x32_bf16 v[104:107], a[216:219], v[164:167], v[104:107]
    s_xor_b32 s33, s0, s82
    s_xor_b32 s34, s33, 262144
    s_add_u32 m0, s99, 65536
    ds_read_b128 v[160:163], v193 offset:8192
    v_mfma_f32_16x16x32_bf16 v[108:111], a[220:223], v[164:167], v[108:111]
    s_waitcnt lgkmcnt(9)
    buffer_load_dwordx4 v222, s[48:51], s34 offen sc1 lds
    v_mfma_f32_16x16x32_bf16 v[112:115], a[216:219], v[168:171], v[112:115]
    ds_read_b128 v[164:167], v193 offset:9216
    v_mfma_f32_16x16x32_bf16 v[116:119], a[220:223], v[168:171], v[116:119]
    buffer_load_dwordx4 v[48:51], v194, s[16:19], s97 offen
    v_mfma_f32_16x16x32_bf16 v[120:123], a[216:219], v[172:175], v[120:123]
    ds_read_b128 v[168:171], v193 offset:10240
    v_mfma_f32_16x16x32_bf16 v[124:127], a[220:223], v[172:175], v[124:127]
    s_waitcnt vmcnt(21) lgkmcnt(9)
    buffer_load_dwordx4 v216, s[48:51], s34 offen offset:1024 sc1 lds
    v_mfma_f32_16x16x32_bf16 v[80:83], a[128:131], v[128:131], v[80:83]
    ds_read_b128 v[172:175], v193 offset:11264
    v_mfma_f32_16x16x32_bf16 v[84:87], a[132:135], v[128:131], v[84:87]
    buffer_load_dwordx4 v[52:55], v194, s[16:19], s6 offen
    v_mfma_f32_16x16x32_bf16 v[88:91], a[128:131], v[132:135], v[88:91]
    s_xor_b32 s34, s33, 525312
    s_add_u32 m0, s99, 67584
    ds_read_b128 v[128:131], v193 offset:12288
    v_lshlrev_b32 v176, 16, v184
    v_mfma_f32_16x16x32_bf16 v[92:95], a[132:135], v[132:135], v[92:95]
    s_waitcnt lgkmcnt(9)
    buffer_load_dwordx4 v222, s[48:51], s34 offen sc1 lds
    v_mfma_f32_16x16x32_bf16 v[96:99], a[128:131], v[136:139], v[96:99]
    ds_read_b128 v[132:135], v193 offset:13312
    v_and_b32 v177, 0xffff0000, v184
    v_mfma_f32_16x16x32_bf16 v[100:103], a[132:135], v[136:139], v[100:103]
    v_lshlrev_b32 v178, 16, v185
    v_and_b32 v179, 0xffff0000, v185
    v_mfma_f32_16x16x32_bf16 v[104:107], a[128:131], v[140:143], v[104:107]
    ds_read_b128 v[136:139], v193 offset:14336
    v_lshlrev_b32 v180, 16, v186
    v_mfma_f32_16x16x32_bf16 v[108:111], a[132:135], v[140:143], v[108:111]
    s_waitcnt lgkmcnt(9)
    buffer_load_dwordx4 v216, s[48:51], s34 offen offset:1024 sc1 lds
    v_mfma_f32_16x16x32_bf16 v[112:115], a[128:131], v[144:147], v[112:115]
    ds_read_b128 v[140:143], v193 offset:15360
    v_and_b32 v181, 0xffff0000, v186
    v_mfma_f32_16x16x32_bf16 v[116:119], a[132:135], v[144:147], v[116:119]
    v_lshlrev_b32 v182, 16, v187
    v_and_b32 v183, 0xffff0000, v187
    v_mfma_f32_16x16x32_bf16 v[120:123], a[128:131], v[148:151], v[120:123]
    s_xor_b32 s34, s33, 787456
    s_add_u32 m0, s99, 69632
    ds_read_b128 v[144:147], v193 offset:16384
    v_lshlrev_b32 v184, 16, v188
    v_mfma_f32_16x16x32_bf16 v[124:127], a[132:135], v[148:151], v[124:127]
    s_waitcnt lgkmcnt(9)
    buffer_load_dwordx4 v222, s[48:51], s34 offen sc1 lds
    v_mfma_f32_16x16x32_bf16 v[80:83], a[136:139], v[152:155], v[80:83]
    ds_read_b128 v[148:151], v193 offset:17408
    v_and_b32 v185, 0xffff0000, v188
    v_mfma_f32_16x16x32_bf16 v[84:87], a[140:143], v[152:155], v[84:87]
    v_lshlrev_b32 v186, 16, v189
    v_and_b32 v187, 0xffff0000, v189
    v_mfma_f32_16x16x32_bf16 v[88:91], a[136:139], v[156:159], v[88:91]
    ds_read_b128 v[152:155], v193 offset:18432
    v_lshlrev_b32 v188, 16, v190
    v_mfma_f32_16x16x32_bf16 v[92:95], a[140:143], v[156:159], v[92:95]
    s_waitcnt lgkmcnt(9)
    buffer_load_dwordx4 v216, s[48:51], s34 offen offset:1024 sc1 lds
    v_mfma_f32_16x16x32_bf16 v[96:99], a[136:139], v[160:163], v[96:99]
    ds_read_b128 v[156:159], v193 offset:19456
    v_and_b32 v189, 0xffff0000, v190
    v_mfma_f32_16x16x32_bf16 v[100:103], a[140:143], v[160:163], v[100:103]
    v_lshlrev_b32 v190, 16, v191
    v_and_b32 v191, 0xffff0000, v191
    v_mfma_f32_16x16x32_bf16 v[104:107], a[136:139], v[164:167], v[104:107]
    s_xor_b32 s34, s0, s79
    s_add_u32 m0, s68, 24576
    ds_read_b128 v[160:163], v193 offset:20480
    v_mul_f32 v16, s36, v176
    v_mfma_f32_16x16x32_bf16 v[108:111], a[140:143], v[164:167], v[108:111]
    s_waitcnt lgkmcnt(9)
    buffer_load_dwordx4 v222, s[48:51], s34 offen sc1 lds
    v_mfma_f32_16x16x32_bf16 v[112:115], a[136:139], v[168:171], v[112:115]
    ds_read_b128 v[164:167], v193 offset:21504
    v_mul_f32 v17, s36, v177
    v_mfma_f32_16x16x32_bf16 v[116:119], a[140:143], v[168:171], v[116:119]
    v_mul_f32 v18, s36, v178
    v_mul_f32 v19, s36, v179
    v_mfma_f32_16x16x32_bf16 v[120:123], a[136:139], v[172:175], v[120:123]
    ds_read_b128 v[168:171], v193 offset:22528
    v_mul_f32 v20, s36, v180
    v_mfma_f32_16x16x32_bf16 v[124:127], a[140:143], v[172:175], v[124:127]
    s_waitcnt lgkmcnt(9)
    buffer_load_dwordx4 v216, s[48:51], s34 offen offset:1024 sc1 lds
    v_mfma_f32_16x16x32_bf16 v[80:83], a[144:147], v[128:131], v[80:83]
    ds_read_b128 v[172:175], v193 offset:23552
    v_mul_f32 v21, s36, v181
    v_mfma_f32_16x16x32_bf16 v[84:87], a[148:151], v[128:131], v[84:87]
    v_mul_f32 v22, s36, v182
    v_mul_f32 v23, s36, v183
    v_mfma_f32_16x16x32_bf16 v[88:91], a[144:147], v[132:135], v[88:91]
    s_xor_b32 s34, s0, s82
    s_add_u32 m0, s68, 131072
    v_mul_f32 v24, s36, v184
    v_mul_f32 v25, s36, v185
    v_mfma_f32_16x16x32_bf16 v[92:95], a[148:151], v[132:135], v[92:95]
    s_waitcnt lgkmcnt(8)
    buffer_load_dwordx4 v222, s[48:51], s34 offen sc1 lds
    v_mfma_f32_16x16x32_bf16 v[96:99], a[144:147], v[136:139], v[96:99]
    v_mul_f32 v26, s36, v186
    v_mul_f32 v27, s36, v187
    v_mfma_f32_16x16x32_bf16 v[100:103], a[148:151], v[136:139], v[100:103]
    v_mul_f32 v28, s36, v188
    v_mul_f32 v29, s36, v189
    v_mfma_f32_16x16x32_bf16 v[104:107], a[144:147], v[140:143], v[104:107]
    v_mul_f32 v30, s36, v190
    v_mul_f32 v31, s36, v191
    v_mfma_f32_16x16x32_bf16 v[108:111], a[148:151], v[140:143], v[108:111]
    s_waitcnt lgkmcnt(6)
    buffer_load_dwordx4 v216, s[48:51], s34 offen offset:1024 sc1 lds
    v_mfma_f32_16x16x32_bf16 v[112:115], a[144:147], v[144:147], v[112:115]
    s_waitcnt vmcnt(14) lgkmcnt(0)
    v_exp_f32 v16, v16
    v_mfma_f32_16x16x32_bf16 v[116:119], a[148:151], v[144:147], v[116:119]
    s_barrier
    v_exp_f32 v17, v17
    v_mfma_f32_16x16x32_bf16 v[120:123], a[144:147], v[148:151], v[120:123]
    ds_read_b128 v[128:131], v192 offset:0
    v_mfma_f32_16x16x32_bf16 v[124:127], a[148:151], v[148:151], v[124:127]
    s_waitcnt lgkmcnt(5)
    ds_read_b128 v[132:135], v192 offset:1024
    v_mfma_f32_16x16x32_bf16 v[80:83], a[152:155], v[152:155], v[80:83]
    ds_read_b128 v[136:139], v192 offset:2048
    v_mfma_f32_16x16x32_bf16 v[84:87], a[156:159], v[152:155], v[84:87]
    ds_read_b128 v[140:143], v192 offset:3072
    v_mfma_f32_16x16x32_bf16 v[88:91], a[152:155], v[156:159], v[88:91]
    ds_read_b128 v[144:147], v192 offset:4096
    v_mfma_f32_16x16x32_bf16 v[92:95], a[156:159], v[156:159], v[92:95]
    s_waitcnt lgkmcnt(7)
    ds_read_b128 v[148:151], v192 offset:5120
    v_mfma_f32_16x16x32_bf16 v[96:99], a[152:155], v[160:163], v[96:99]
    ds_read_b128 v[152:155], v192 offset:6144
    v_mfma_f32_16x16x32_bf16 v[100:103], a[156:159], v[160:163], v[100:103]
    ds_read_b128 v[156:159], v192 offset:7168
    v_mfma_f32_16x16x32_bf16 v[104:107], a[152:155], v[164:167], v[104:107]
    ds_read_b128 v[160:163], v192 offset:8192
    v_mfma_f32_16x16x32_bf16 v[108:111], a[156:159], v[164:167], v[108:111]
    s_waitcnt lgkmcnt(9)
    v_exp_f32 v18, v18
    v_mfma_f32_16x16x32_bf16 v[112:115], a[152:155], v[168:171], v[112:115]
    ds_read_b128 v[164:167], v192 offset:9216
    v_mfma_f32_16x16x32_bf16 v[116:119], a[156:159], v[168:171], v[116:119]
    v_exp_f32 v19, v19
    v_mfma_f32_16x16x32_bf16 v[120:123], a[152:155], v[172:175], v[120:123]
    ds_read_b128 v[168:171], v192 offset:10240
    v_mfma_f32_16x16x32_bf16 v[124:127], a[156:159], v[172:175], v[124:127]
    s_waitcnt lgkmcnt(9)
    v_exp_f32 v20, v20
    v_mfma_f32_16x16x32_bf16 v[80:83], a[0:3], v[128:131], v[80:83]
    ds_read_b128 v[172:175], v192 offset:11264
    v_mfma_f32_16x16x32_bf16 v[84:87], a[4:7], v[128:131], v[84:87]
    v_exp_f32 v21, v21
    v_mfma_f32_16x16x32_bf16 v[88:91], a[0:3], v[132:135], v[88:91]
    ds_read_b128 v[128:131], v192 offset:12288
    v_mfma_f32_16x16x32_bf16 v[92:95], a[4:7], v[132:135], v[92:95]
    s_waitcnt lgkmcnt(9)
    v_exp_f32 v22, v22
    v_mfma_f32_16x16x32_bf16 v[96:99], a[0:3], v[136:139], v[96:99]
    ds_read_b128 v[132:135], v192 offset:13312
    v_mfma_f32_16x16x32_bf16 v[100:103], a[4:7], v[136:139], v[100:103]
    v_exp_f32 v23, v23
    v_mfma_f32_16x16x32_bf16 v[104:107], a[0:3], v[140:143], v[104:107]
    ds_read_b128 v[136:139], v192 offset:14336
    v_mfma_f32_16x16x32_bf16 v[108:111], a[4:7], v[140:143], v[108:111]
    s_waitcnt lgkmcnt(9)
    v_exp_f32 v24, v24
    v_mfma_f32_16x16x32_bf16 v[112:115], a[0:3], v[144:147], v[112:115]
    ds_read_b128 v[140:143], v192 offset:15360
    v_mfma_f32_16x16x32_bf16 v[116:119], a[4:7], v[144:147], v[116:119]
    v_exp_f32 v25, v25
    v_mfma_f32_16x16x32_bf16 v[120:123], a[0:3], v[148:151], v[120:123]
    ds_read_b128 v[144:147], v192 offset:16384
    v_mfma_f32_16x16x32_bf16 v[124:127], a[4:7], v[148:151], v[124:127]
    s_waitcnt lgkmcnt(9)
    v_exp_f32 v26, v26
    v_mfma_f32_16x16x32_bf16 v[80:83], a[8:11], v[152:155], v[80:83]
    ds_read_b128 v[148:151], v192 offset:17408
    v_mfma_f32_16x16x32_bf16 v[84:87], a[12:15], v[152:155], v[84:87]
    v_exp_f32 v27, v27
    v_mfma_f32_16x16x32_bf16 v[88:91], a[8:11], v[156:159], v[88:91]
    ds_read_b128 v[152:155], v192 offset:18432
    v_mfma_f32_16x16x32_bf16 v[92:95], a[12:15], v[156:159], v[92:95]
    s_waitcnt lgkmcnt(9)
    v_exp_f32 v28, v28
    v_mfma_f32_16x16x32_bf16 v[96:99], a[8:11], v[160:163], v[96:99]
    ds_read_b128 v[156:159], v192 offset:19456
    v_mfma_f32_16x16x32_bf16 v[100:103], a[12:15], v[160:163], v[100:103]
    v_exp_f32 v29, v29
    v_mfma_f32_16x16x32_bf16 v[104:107], a[8:11], v[164:167], v[104:107]
    ds_read_b128 v[160:163], v192 offset:20480
    v_mfma_f32_16x16x32_bf16 v[108:111], a[12:15], v[164:167], v[108:111]
    s_waitcnt lgkmcnt(9)
    v_exp_f32 v30, v30
    v_mfma_f32_16x16x32_bf16 v[112:115], a[8:11], v[168:171], v[112:115]
    ds_read_b128 v[164:167], v192 offset:21504
    v_mfma_f32_16x16x32_bf16 v[116:119], a[12:15], v[168:171], v[116:119]
    v_exp_f32 v31, v31
    v_mfma_f32_16x16x32_bf16 v[120:123], a[8:11], v[172:175], v[120:123]
    ds_read_b128 v[168:171], v192 offset:22528
    v_add_f32 v16, 1.0, v16
    v_mfma_f32_16x16x32_bf16 v[124:127], a[12:15], v[172:175], v[124:127]
    s_waitcnt lgkmcnt(9)
    v_add_f32 v17, 1.0, v17
    v_add_f32 v18, 1.0, v18
    v_mfma_f32_16x16x32_bf16 v[80:83], a[16:19], v[128:131], v[80:83]
    ds_read_b128 v[172:175], v192 offset:23552
    v_add_f32 v19, 1.0, v19
    v_mfma_f32_16x16x32_bf16 v[84:87], a[20:23], v[128:131], v[84:87]
    v_add_f32 v20, 1.0, v20
    v_add_f32 v21, 1.0, v21
    v_mfma_f32_16x16x32_bf16 v[88:91], a[16:19], v[132:135], v[88:91]
    v_add_f32 v22, 1.0, v22
    v_add_f32 v23, 1.0, v23
    v_mfma_f32_16x16x32_bf16 v[92:95], a[20:23], v[132:135], v[92:95]
    s_waitcnt lgkmcnt(8)
    v_add_f32 v24, 1.0, v24
    v_add_f32 v25, 1.0, v25
    v_mfma_f32_16x16x32_bf16 v[96:99], a[16:19], v[136:139], v[96:99]
    v_add_f32 v26, 1.0, v26
    v_add_f32 v27, 1.0, v27
    v_mfma_f32_16x16x32_bf16 v[100:103], a[20:23], v[136:139], v[100:103]
    v_add_f32 v28, 1.0, v28
    v_add_f32 v29, 1.0, v29
    v_mfma_f32_16x16x32_bf16 v[104:107], a[16:19], v[140:143], v[104:107]
    v_add_f32 v30, 1.0, v30
    v_add_f32 v31, 1.0, v31
    v_mfma_f32_16x16x32_bf16 v[108:111], a[20:23], v[140:143], v[108:111]
    s_waitcnt lgkmcnt(6)
    v_rcp_f32 v16, v16
    v_mfma_f32_16x16x32_bf16 v[112:115], a[16:19], v[144:147], v[112:115]
    s_waitcnt vmcnt(4) lgkmcnt(0)
    v_rcp_f32 v17, v17
    v_mfma_f32_16x16x32_bf16 v[116:119], a[20:23], v[144:147], v[116:119]
    s_barrier
    v_rcp_f32 v18, v18
    v_mfma_f32_16x16x32_bf16 v[120:123], a[16:19], v[148:151], v[120:123]
    ds_read_b128 v[128:131], v192 offset:32768
    v_mfma_f32_16x16x32_bf16 v[124:127], a[20:23], v[148:151], v[124:127]
    s_waitcnt lgkmcnt(5)
    ds_read_b128 v[132:135], v192 offset:33792
    v_mfma_f32_16x16x32_bf16 v[80:83], a[24:27], v[152:155], v[80:83]
    ds_read_b128 v[136:139], v192 offset:38912
    v_mfma_f32_16x16x32_bf16 v[84:87], a[28:31], v[152:155], v[84:87]
    ds_read_b128 v[140:143], v192 offset:39936
    v_mfma_f32_16x16x32_bf16 v[88:91], a[24:27], v[156:159], v[88:91]
    ds_read_b128 v[144:147], v192 offset:45056
    v_mfma_f32_16x16x32_bf16 v[92:95], a[28:31], v[156:159], v[92:95]
    s_waitcnt lgkmcnt(7)
    ds_read_b128 v[148:151], v192 offset:46080
    v_mfma_f32_16x16x32_bf16 v[96:99], a[24:27], v[160:163], v[96:99]
    ds_read_b128 v[152:155], v192 offset:51200
    v_mfma_f32_16x16x32_bf16 v[100:103], a[28:31], v[160:163], v[100:103]
    ds_read_b128 v[156:159], v192 offset:52224
    v_mfma_f32_16x16x32_bf16 v[104:107], a[24:27], v[164:167], v[104:107]
    ds_read_b128 v[160:163], v192 offset:34816
    v_mfma_f32_16x16x32_bf16 v[108:111], a[28:31], v[164:167], v[108:111]
    s_waitcnt lgkmcnt(9)
    v_rcp_f32 v19, v19
    v_mfma_f32_16x16x32_bf16 v[112:115], a[24:27], v[168:171], v[112:115]
    ds_read_b128 v[164:167], v192 offset:35840
    v_mfma_f32_16x16x32_bf16 v[116:119], a[28:31], v[168:171], v[116:119]
    v_rcp_f32 v20, v20
    v_mfma_f32_16x16x32_bf16 v[120:123], a[24:27], v[172:175], v[120:123]
    ds_read_b128 v[168:171], v192 offset:40960
    v_mfma_f32_16x16x32_bf16 v[124:127], a[28:31], v[172:175], v[124:127]
    s_waitcnt lgkmcnt(9)
    v_rcp_f32 v21, v21
    v_mfma_f32_16x16x32_bf16 v[80:83], a[32:35], v[128:131], v[80:83]
    ds_read_b128 v[172:175], v192 offset:41984
    v_mfma_f32_16x16x32_bf16 v[84:87], a[36:39], v[128:131], v[84:87]
    v_rcp_f32 v22, v22
    v_mfma_f32_16x16x32_bf16 v[88:91], a[32:35], v[132:135], v[88:91]
    ds_read_b128 v[128:131], v192 offset:47104
    v_mfma_f32_16x16x32_bf16 v[92:95], a[36:39], v[132:135], v[92:95]
    s_waitcnt lgkmcnt(9)
    v_rcp_f32 v23, v23
    v_mfma_f32_16x16x32_bf16 v[80:83], a[40:43], v[136:139], v[80:83]
    ds_read_b128 v[132:135], v192 offset:48128
    v_mfma_f32_16x16x32_bf16 v[84:87], a[44:47], v[136:139], v[84:87]
    v_rcp_f32 v24, v24
    v_mfma_f32_16x16x32_bf16 v[88:91], a[40:43], v[140:143], v[88:91]
    ds_read_b128 v[136:139], v192 offset:53248
    v_mfma_f32_16x16x32_bf16 v[92:95], a[44:47], v[140:143], v[92:95]
    s_waitcnt lgkmcnt(9)
    v_rcp_f32 v25, v25
    v_mfma_f32_16x16x32_bf16 v[80:83], a[48:51], v[144:147], v[80:83]
    ds_read_b128 v[140:143], v192 offset:54272
    v_mfma_f32_16x16x32_bf16 v[84:87], a[52:55], v[144:147], v[84:87]
    v_rcp_f32 v26, v26
    v_mfma_f32_16x16x32_bf16 v[88:91], a[48:51], v[148:151], v[88:91]
    ds_read_b128 v[144:147], v192 offset:36864
    v_mfma_f32_16x16x32_bf16 v[92:95], a[52:55], v[148:151], v[92:95]
    s_waitcnt lgkmcnt(9)
    v_rcp_f32 v27, v27
    v_mfma_f32_16x16x32_bf16 v[80:83], a[56:59], v[152:155], v[80:83]
    ds_read_b128 v[148:151], v192 offset:37888
    v_mfma_f32_16x16x32_bf16 v[84:87], a[60:63], v[152:155], v[84:87]
    v_rcp_f32 v28, v28
    v_mfma_f32_16x16x32_bf16 v[88:91], a[56:59], v[156:159], v[88:91]
    ds_read_b128 v[152:155], v192 offset:43008
    v_mfma_f32_16x16x32_bf16 v[92:95], a[60:63], v[156:159], v[92:95]
    s_waitcnt lgkmcnt(9)
    v_rcp_f32 v29, v29
    v_mfma_f32_16x16x32_bf16 v[96:99], a[32:35], v[160:163], v[96:99]
    ds_read_b128 v[156:159], v192 offset:44032
    v_mfma_f32_16x16x32_bf16 v[100:103], a[36:39], v[160:163], v[100:103]
    v_rcp_f32 v30, v30
    v_mfma_f32_16x16x32_bf16 v[104:107], a[32:35], v[164:167], v[104:107]
    ds_read_b128 v[160:163], v192 offset:49152
    v_mfma_f32_16x16x32_bf16 v[108:111], a[36:39], v[164:167], v[108:111]
    s_waitcnt lgkmcnt(9)
    v_rcp_f32 v31, v31
    v_mfma_f32_16x16x32_bf16 v[96:99], a[40:43], v[168:171], v[96:99]
    s_add_u32 s42, s98, 4096
    ds_read_b128 v[164:167], v192 offset:50176
    v_cvt_pk_bf16_f32 v80, v80, v81
    v_mfma_f32_16x16x32_bf16 v[100:103], a[44:47], v[168:171], v[100:103]
    v_cvt_pk_bf16_f32 v81, v82, v83
    v_cvt_pk_bf16_f32 v82, v84, v85
    v_mfma_f32_16x16x32_bf16 v[104:107], a[40:43], v[172:175], v[104:107]
    ds_read_b128 v[168:171], v192 offset:55296
    v_cvt_pk_bf16_f32 v83, v86, v87
    v_mfma_f32_16x16x32_bf16 v[108:111], a[44:47], v[172:175], v[108:111]
    s_waitcnt lgkmcnt(9)
    buffer_store_dwordx4 v[80:83], v222, s[48:51], s42 offen offset:0 sc1
    v_mfma_f32_16x16x32_bf16 v[96:99], a[48:51], v[128:131], v[96:99]
    ds_read_b128 v[172:175], v192 offset:56320
    v_cvt_pk_bf16_f32 v84, v88, v89
    v_mfma_f32_16x16x32_bf16 v[100:103], a[52:55], v[128:131], v[100:103]
    v_cvt_pk_bf16_f32 v85, v90, v91
    v_cvt_pk_bf16_f32 v86, v92, v93
    v_mfma_f32_16x16x32_bf16 v[104:107], a[48:51], v[132:135], v[104:107]
    v_cvt_pk_bf16_f32 v87, v94, v95
    v_mul_f32 v16, v16, v176
    v_mfma_f32_16x16x32_bf16 v[108:111], a[52:55], v[132:135], v[108:111]
    s_waitcnt lgkmcnt(8)
    buffer_store_dwordx4 v[84:87], v222, s[48:51], s42 offen offset:1024 sc1
    v_mfma_f32_16x16x32_bf16 v[96:99], a[56:59], v[136:139], v[96:99]
    v_mul_f32 v17, v17, v177
    v_mul_f32 v18, v18, v178
    v_mfma_f32_16x16x32_bf16 v[100:103], a[60:63], v[136:139], v[100:103]
    v_mul_f32 v19, v19, v179
    v_mul_f32 v20, v20, v180
    v_mfma_f32_16x16x32_bf16 v[104:107], a[56:59], v[140:143], v[104:107]
    v_mul_f32 v21, v21, v181
    v_mul_f32 v22, v22, v182
    v_mfma_f32_16x16x32_bf16 v[108:111], a[60:63], v[140:143], v[108:111]
    s_waitcnt lgkmcnt(6)
    v_mul_f32 v23, v23, v183
    v_mul_f32 v24, v24, v184
    v_mfma_f32_16x16x32_bf16 v[112:115], a[32:35], v[144:147], v[112:115]
    s_waitcnt vmcnt(2) lgkmcnt(0)
    v_mul_f32 v25, v25, v185
    v_mul_f32 v26, v26, v186
    v_mfma_f32_16x16x32_bf16 v[116:119], a[36:39], v[144:147], v[116:119]
    s_barrier
    v_mul_f32 v27, v27, v187
    v_mul_f32 v28, v28, v188
    v_mfma_f32_16x16x32_bf16 v[120:123], a[32:35], v[148:151], v[120:123]
    ds_read_b128 v[128:131], v222 offset:0
    v_mul_f32 v29, v29, v189
    v_mfma_f32_16x16x32_bf16 v[124:127], a[36:39], v[148:151], v[124:127]
    s_waitcnt lgkmcnt(5)
    ds_read_b128 v[132:135], v222 offset:1024
    v_mul_f32 v30, v30, v190
    v_mfma_f32_16x16x32_bf16 v[112:115], a[40:43], v[152:155], v[112:115]
    ds_read_b128 v[136:139], v222 offset:2048
    v_mul_f32 v31, v31, v191
    v_mfma_f32_16x16x32_bf16 v[116:119], a[44:47], v[152:155], v[116:119]
    s_add_u32 s42, s98, 8192
    ds_read_b128 v[140:143], v222 offset:3072
    v_cvt_pk_bf16_f32 v96, v96, v97
    v_mfma_f32_16x16x32_bf16 v[120:123], a[40:43], v[156:159], v[120:123]
    ds_read_b128 v[144:147], v222 offset:4096
    v_cvt_pk_bf16_f32 v97, v98, v99
    v_mfma_f32_16x16x32_bf16 v[124:127], a[44:47], v[156:159], v[124:127]
    s_waitcnt lgkmcnt(7)
    ds_read_b128 v[148:151], v222 offset:5120
    v_cvt_pk_bf16_f32 v98, v100, v101
    v_mfma_f32_16x16x32_bf16 v[112:115], a[48:51], v[160:163], v[112:115]
    ds_read_b128 v[152:155], v222 offset:6144
    v_cvt_pk_bf16_f32 v99, v102, v103
    v_mfma_f32_16x16x32_bf16 v[116:119], a[52:55], v[160:163], v[116:119]
    ds_read_b128 v[156:159], v222 offset:7168
    v_cvt_pk_bf16_f32 v16, v16, v17
    v_mfma_f32_16x16x32_bf16 v[120:123], a[48:51], v[164:167], v[120:123]
    ds_read_b128 v[160:163], v222 offset:8192
    v_cvt_pk_bf16_f32 v18, v18, v19
    v_mfma_f32_16x16x32_bf16 v[124:127], a[52:55], v[164:167], v[124:127]
    s_waitcnt lgkmcnt(9)
    buffer_store_dwordx4 v[96:99], v222, s[48:51], s42 offen offset:0 sc1
    v_mfma_f32_16x16x32_bf16 v[112:115], a[56:59], v[168:171], v[112:115]
    ds_read_b128 v[164:167], v222 offset:9216
    v_cvt_pk_bf16_f32 v100, v104, v105
    v_mfma_f32_16x16x32_bf16 v[116:119], a[60:63], v[168:171], v[116:119]
    v_cvt_pk_bf16_f32 v101, v106, v107
    v_cvt_pk_bf16_f32 v102, v108, v109
    v_mfma_f32_16x16x32_bf16 v[120:123], a[56:59], v[172:175], v[120:123]
    ds_read_b128 v[168:171], v222 offset:10240
    v_cvt_pk_bf16_f32 v103, v110, v111
    v_mfma_f32_16x16x32_bf16 v[124:127], a[60:63], v[172:175], v[124:127]
    s_waitcnt lgkmcnt(9)
    buffer_store_dwordx4 v[100:103], v222, s[48:51], s42 offen offset:1024 sc1
    v_mfma_f32_16x16x32_bf16 v[64:67], v[224:227], v[128:131], 0
    ds_read_b128 v[172:175], v222 offset:11264
    v_cvt_pk_bf16_f32 v20, v20, v21
    v_mfma_f32_16x16x32_bf16 v[68:71], v[228:231], v[128:131], 0
    v_cvt_pk_bf16_f32 v22, v22, v23
    v_cvt_pk_bf16_f32 v24, v24, v25
    v_mfma_f32_16x16x32_bf16 v[72:75], v[224:227], v[132:135], 0
    ds_read_b128 v[128:131], v222 offset:12288
    v_cvt_pk_bf16_f32 v26, v26, v27
    v_mfma_f32_16x16x32_bf16 v[76:79], v[228:231], v[132:135], 0
    s_waitcnt lgkmcnt(9)
    v_cvt_pk_bf16_f32 v28, v28, v29
    v_cvt_pk_bf16_f32 v30, v30, v31
    v_mfma_f32_16x16x32_bf16 v[64:67], v[232:235], v[136:139], v[64:67]
    ds_read_b128 v[132:135], v222 offset:13312
    v_lshlrev_b32 v176, 16, v16
    v_mfma_f32_16x16x32_bf16 v[68:71], v[236:239], v[136:139], v[68:71]
    s_add_u32 s42, s98, 12288
    v_cvt_pk_bf16_f32 v112, v112, v113
    v_cvt_pk_bf16_f32 v113, v114, v115
    v_mfma_f32_16x16x32_bf16 v[72:75], v[232:235], v[140:143], v[72:75]
    ds_read_b128 v[136:139], v222 offset:14336
    v_cvt_pk_bf16_f32 v114, v116, v117
    v_mfma_f32_16x16x32_bf16 v[76:79], v[236:239], v[140:143], v[76:79]
    s_waitcnt lgkmcnt(9)
    v_cvt_pk_bf16_f32 v115, v118, v119
    v_and_b32 v177, 0xffff0000, v16
    v_mfma_f32_16x16x32_bf16 v[64:67], v[240:243], v[144:147], v[64:67]
    ds_read_b128 v[140:143], v222 offset:15360
    v_lshlrev_b32 v178, 16, v18
    v_mfma_f32_16x16x32_bf16 v[68:71], v[244:247], v[144:147], v[68:71]
    buffer_store_dwordx4 v[112:115], v222, s[48:51], s42 offen offset:0 sc1
    v_mfma_f32_16x16x32_bf16 v[72:75], v[240:243], v[148:151], v[72:75]
    ds_read_b128 v[144:147], v222 offset:16384
    v_cvt_pk_bf16_f32 v116, v120, v121
    v_mfma_f32_16x16x32_bf16 v[76:79], v[244:247], v[148:151], v[76:79]
    s_waitcnt lgkmcnt(9)
    v_cvt_pk_bf16_f32 v117, v122, v123
    v_cvt_pk_bf16_f32 v118, v124, v125
    v_mfma_f32_16x16x32_bf16 v[64:67], v[248:251], v[152:155], v[64:67]
    ds_read_b128 v[148:151], v222 offset:17408
    v_cvt_pk_bf16_f32 v119, v126, v127
    v_mfma_f32_16x16x32_bf16 v[68:71], v[252:255], v[152:155], v[68:71]
    buffer_store_dwordx4 v[116:119], v222, s[48:51], s42 offen offset:1024 sc1
    v_mfma_f32_16x16x32_bf16 v[72:75], v[248:251], v[156:159], v[72:75]
    s_xor_b32 s53, s98, 65536
    s_add_u32 s53, s53, 4096
    ds_read_b128 v[152:155], v222 offset:18432
    v_and_b32 v179, 0xffff0000, v18
    v_mfma_f32_16x16x32_bf16 v[76:79], v[252:255], v[156:159], v[76:79]
    s_waitcnt lgkmcnt(9)
    v_lshlrev_b32 v180, 16, v20
    v_and_b32 v181, 0xffff0000, v20
    v_mfma_f32_16x16x32_bf16 v[64:67], a[192:195], v[160:163], v[64:67]
    s_xor_b32 s54, s98, 131072
    s_add_u32 s54, s54, 8192
    ds_read_b128 v[156:159], v222 offset:19456
    v_lshlrev_b32 v182, 16, v22
    v_mfma_f32_16x16x32_bf16 v[68:71], a[196:199], v[160:163], v[68:71]
    s_xor_b32 s55, s98, 196608
    s_add_u32 s55, s55, 12288
    v_and_b32 v183, 0xffff0000, v22
    v_lshlrev_b32 v184, 16, v24
    v_mfma_f32_16x16x32_bf16 v[72:75], a[192:195], v[164:167], v[72:75]
    ds_read_b128 v[160:163], v222 offset:20480
    v_and_b32 v185, 0xffff0000, v24
    v_mfma_f32_16x16x32_bf16 v[76:79], a[196:199], v[164:167], v[76:79]
    s_waitcnt lgkmcnt(9)
    v_lshlrev_b32 v186, 16, v26
    v_and_b32 v187, 0xffff0000, v26
    v_mfma_f32_16x16x32_bf16 v[64:67], a[200:203], v[168:171], v[64:67]
    ds_read_b128 v[164:167], v222 offset:21504
    v_lshlrev_b32 v188, 16, v28
    v_mfma_f32_16x16x32_bf16 v[68:71], a[204:207], v[168:171], v[68:71]
    v_and_b32 v189, 0xffff0000, v28
    v_lshlrev_b32 v190, 16, v30
    v_mfma_f32_16x16x32_bf16 v[72:75], a[200:203], v[172:175], v[72:75]
    ds_read_b128 v[168:171], v222 offset:22528
    v_and_b32 v191, 0xffff0000, v30
    v_mfma_f32_16x16x32_bf16 v[76:79], a[204:207], v[172:175], v[76:79]
    s_waitcnt lgkmcnt(9)
    v_mfma_f32_16x16x32_bf16 v[64:67], a[208:211], v[128:131], v[64:67]
    s_waitcnt vmcnt(14)
    ds_read_b128 v[172:175], v222 offset:23552
    v_lshlrev_b32 v32, 16, v48
    v_mfma_f32_16x16x32_bf16 v[68:71], a[212:215], v[128:131], v[68:71]
    v_and_b32 v33, 0xffff0000, v48
    v_lshlrev_b32 v34, 16, v49
    v_mfma_f32_16x16x32_bf16 v[72:75], a[208:211], v[132:135], v[72:75]
    ds_read_b128 v[128:131], v222 offset:24576
    v_and_b32 v35, 0xffff0000, v49
    v_mfma_f32_16x16x32_bf16 v[76:79], a[212:215], v[132:135], v[76:79]
    s_waitcnt lgkmcnt(9)
    v_lshlrev_b32 v36, 16, v50
    v_and_b32 v37, 0xffff0000, v50
    v_mfma_f32_16x16x32_bf16 v[64:67], a[216:219], v[136:139], v[64:67]
    ds_read_b128 v[132:135], v222 offset:25600
    v_lshlrev_b32 v38, 16, v51
    v_mfma_f32_16x16x32_bf16 v[68:71], a[220:223], v[136:139], v[68:71]
    v_and_b32 v39, 0xffff0000, v51
    v_lshlrev_b32 v40, 16, v52
    v_mfma_f32_16x16x32_bf16 v[72:75], a[216:219], v[140:143], v[72:75]
    ds_read_b128 v[136:139], v222 offset:26624
    v_and_b32 v41, 0xffff0000, v52
    v_mfma_f32_16x16x32_bf16 v[76:79], a[220:223], v[140:143], v[76:79]
    s_waitcnt lgkmcnt(9)
    v_lshlrev_b32 v42, 16, v53
    v_and_b32 v43, 0xffff0000, v53
    v_mfma_f32_16x16x32_bf16 v[64:67], a[128:131], v[144:147], v[64:67]
    ds_read_b128 v[140:143], v222 offset:27648
    v_lshlrev_b32 v44, 16, v54
    v_mfma_f32_16x16x32_bf16 v[68:71], a[132:135], v[144:147], v[68:71]
    v_and_b32 v45, 0xffff0000, v54
    v_lshlrev_b32 v46, 16, v55
    v_mfma_f32_16x16x32_bf16 v[72:75], a[128:131], v[148:151], v[72:75]
    ds_read_b128 v[144:147], v222 offset:28672
    v_and_b32 v47, 0xffff0000, v55
    v_mfma_f32_16x16x32_bf16 v[76:79], a[132:135], v[148:151], v[76:79]
    s_waitcnt lgkmcnt(9)
    v_lshrrev_b32 v8, 8, v222
    v_bfe_u32 v9, v222, 6, 2
    v_mfma_f32_16x16x32_bf16 v[64:67], a[136:139], v[152:155], v[64:67]
    ds_read_b128 v[148:151], v222 offset:29696
    v_and_b32 v12, 16, v222
    v_mfma_f32_16x16x32_bf16 v[68:71], a[140:143], v[152:155], v[68:71]
    v_mov_b32 v11, 0x3f80
    v_cmp_eq_u32 vcc, v8, v9
    v_mfma_f32_16x16x32_bf16 v[72:75], a[136:139], v[156:159], v[72:75]
    ds_read_b128 v[152:155], v222 offset:30720
    v_lshlrev_b32 v11, v12, v11
    v_mfma_f32_16x16x32_bf16 v[76:79], a[140:143], v[156:159], v[76:79]
    s_waitcnt lgkmcnt(9)
    buffer_load_dwordx4 v[88:91], v222, s[48:51], s53 offen offset:0 sc1
    v_mfma_f32_16x16x32_bf16 v[64:67], a[144:147], v[160:163], v[64:67]
    ds_read_b128 v[156:159], v222 offset:31744
    v_and_b32 v13, 32, v222
    v_mfma_f32_16x16x32_bf16 v[68:71], a[148:151], v[160:163], v[68:71]
    buffer_load_dwordx4 v[92:95], v222, s[48:51], s53 offen offset:1024 sc1
    v_mfma_f32_16x16x32_bf16 v[72:75], a[144:147], v[164:167], v[72:75]
    ds_read_b128 v[160:163], v193 offset:32768
    v_cndmask_b32 v11, 0, v11, vcc
    v_mfma_f32_16x16x32_bf16 v[76:79], a[148:151], v[164:167], v[76:79]
    s_waitcnt lgkmcnt(9)
    buffer_load_dwordx4 v[104:107], v222, s[48:51], s54 offen offset:0 sc1
    v_mfma_f32_16x16x32_bf16 v[64:67], a[152:155], v[168:171], v[64:67]
    ds_read_b128 v[164:167], v193 offset:33792
    v_cmp_eq_u32 vcc, 0, v13
    v_mfma_f32_16x16x32_bf16 v[68:71], a[156:159], v[168:171], v[68:71]
    buffer_load_dwordx4 v[108:111], v222, s[48:51], s54 offen offset:1024 sc1
    v_mfma_f32_16x16x32_bf16 v[72:75], a[152:155], v[172:175], v[72:75]
    ds_read_b128 v[168:171], v193 offset:34816
    v_mov_b32 v8, 0
    v_mfma_f32_16x16x32_bf16 v[76:79], a[156:159], v[172:175], v[76:79]
    s_waitcnt lgkmcnt(9)
    buffer_load_dwordx4 v[120:123], v222, s[48:51], s55 offen offset:0 sc1
    v_mfma_f32_16x16x32_bf16 v[64:67], a[0:3], v[128:131], v[64:67]
    ds_read_b128 v[172:175], v193 offset:35840
    v_cndmask_b32 v10, 0, v11, vcc
    v_mfma_f32_16x16x32_bf16 v[68:71], a[4:7], v[128:131], v[68:71]
    buffer_load_dwordx4 v[124:127], v222, s[48:51], s55 offen offset:1024 sc1
    v_mfma_f32_16x16x32_bf16 v[72:75], a[0:3], v[132:135], v[72:75]
    ds_read_b128 v[128:131], v193 offset:36864
    v_mov_b32 v9, 0
    v_mfma_f32_16x16x32_bf16 v[76:79], a[4:7], v[132:135], v[76:79]
    s_waitcnt lgkmcnt(9)
    v_mov_b32 v12, 0
    v_xor_b32 v11, v11, v10
    v_mfma_f32_16x16x32_bf16 v[64:67], a[8:11], v[136:139], v[64:67]
    ds_read_b128 v[132:135], v193 offset:37888
    v_mov_b32 v13, 0
    v_mfma_f32_16x16x32_bf16 v[68:71], a[12:15], v[136:139], v[68:71]
    v_mfma_f32_16x16x32_bf16 v[72:75], a[8:11], v[140:143], v[72:75]
    ds_read_b128 v[136:139], v193 offset:38912
    v_mfma_f32_16x16x32_bf16 v[76:79], a[12:15], v[140:143], v[76:79]
    s_waitcnt lgkmcnt(9)
    v_mfma_f32_16x16x32_bf16 v[64:67], a[16:19], v[144:147], v[64:67]
    ds_read_b128 v[140:143], v193 offset:39936
    v_mfma_f32_16x16x32_bf16 v[68:71], a[20:23], v[144:147], v[68:71]
    v_mfma_f32_16x16x32_bf16 v[72:75], a[16:19], v[148:151], v[72:75]
    v_mfma_f32_16x16x32_bf16 v[76:79], a[20:23], v[148:151], v[76:79]
    s_waitcnt lgkmcnt(8)
    v_mfma_f32_16x16x32_bf16 v[64:67], a[24:27], v[152:155], v[64:67]
    v_mfma_f32_16x16x32_bf16 v[68:71], a[28:31], v[152:155], v[68:71]
    v_mfma_f32_16x16x32_bf16 v[72:75], a[24:27], v[156:159], v[72:75]
    v_mfma_f32_16x16x32_bf16 v[76:79], a[28:31], v[156:159], v[76:79]
    s_waitcnt lgkmcnt(6)
    v_mfma_f32_16x16x32_bf16 v[64:67], a[32:35], v[160:163], v[64:67]
    v_mfma_f32_16x16x32_bf16 v[68:71], a[36:39], v[160:163], v[68:71]
    v_mfma_f32_16x16x32_bf16 v[72:75], a[32:35], v[164:167], v[72:75]
    v_mfma_f32_16x16x32_bf16 v[76:79], a[36:39], v[164:167], v[76:79]
    s_waitcnt lgkmcnt(4)
    v_mfma_f32_16x16x32_bf16 v[64:67], a[40:43], v[168:171], v[64:67]
    v_mfma_f32_16x16x32_bf16 v[68:71], a[44:47], v[168:171], v[68:71]
    v_mfma_f32_16x16x32_bf16 v[72:75], a[40:43], v[172:175], v[72:75]
    v_mfma_f32_16x16x32_bf16 v[76:79], a[44:47], v[172:175], v[76:79]
    s_waitcnt lgkmcnt(2)
    v_mfma_f32_16x16x32_bf16 v[64:67], a[48:51], v[128:131], v[64:67]
    v_mfma_f32_16x16x32_bf16 v[68:71], a[52:55], v[128:131], v[68:71]
    v_mfma_f32_16x16x32_bf16 v[72:75], a[48:51], v[132:135], v[72:75]
    v_mfma_f32_16x16x32_bf16 v[76:79], a[52:55], v[132:135], v[76:79]
    s_waitcnt lgkmcnt(0)
    v_mfma_f32_16x16x32_bf16 v[64:67], a[56:59], v[136:139], v[64:67]
    v_mfma_f32_16x16x32_bf16 v[68:71], a[60:63], v[136:139], v[68:71]
    v_mfma_f32_16x16x32_bf16 v[72:75], a[56:59], v[140:143], v[72:75]
    v_mfma_f32_16x16x32_bf16 v[76:79], a[60:63], v[140:143], v[76:79]
    s_waitcnt vmcnt(0)
    s_branch F_FIN
F_RB5:
    s_and_b32 s42, s86, 0xffff0000
    s_xor_b32 s54, s42, 0x80000000
    s_xor_b32 s55, s42, 0xffff0000
    s_bitcmp1_b32 s42, 31
    s_cselect_b32 s42, s54, s55
    v_mov_b32 v16, s42
    v_mul_f32 v16, s36, v16
    v_exp_f32 v16, v16
    v_add_f32_dpp v0, v176, v176 quad_perm:[1,0,3,2] row_mask:0xf bank_mask:0xf
    v_add_f32_dpp v1, v180, v180 quad_perm:[1,0,3,2] row_mask:0xf bank_mask:0xf
    v_add_f32_dpp v2, v177, v177 quad_perm:[1,0,3,2] row_mask:0xf bank_mask:0xf
    v_add_f32_dpp v3, v181, v181 quad_perm:[1,0,3,2] row_mask:0xf bank_mask:0xf
    v_add_f32_dpp v4, v178, v178 quad_perm:[1,0,3,2] row_mask:0xf bank_mask:0xf
    v_add_f32_dpp v5, v182, v182 quad_perm:[1,0,3,2] row_mask:0xf bank_mask:0xf
    v_add_f32_dpp v6, v179, v179 quad_perm:[1,0,3,2] row_mask:0xf bank_mask:0xf
    v_add_f32_dpp v7, v183, v183 quad_perm:[1,0,3,2] row_mask:0xf bank_mask:0xf
    v_add_f32_dpp v0, v0, v0 quad_perm:[2,3,0,1] row_mask:0xf bank_mask:0xf
    v_add_f32_dpp v1, v1, v1 quad_perm:[2,3,0,1] row_mask:0xf bank_mask:0xf
    v_add_f32_dpp v2, v2, v2 quad_perm:[2,3,0,1] row_mask:0xf bank_mask:0xf
    v_add_f32_dpp v3, v3, v3 quad_perm:[2,3,0,1] row_mask:0xf bank_mask:0xf
    v_add_f32_dpp v4, v4, v4 quad_perm:[2,3,0,1] row_mask:0xf bank_mask:0xf
    v_add_f32_dpp v5, v5, v5 quad_perm:[2,3,0,1] row_mask:0xf bank_mask:0xf
    v_add_f32_dpp v6, v6, v6 quad_perm:[2,3,0,1] row_mask:0xf bank_mask:0xf
    v_add_f32_dpp v7, v7, v7 quad_perm:[2,3,0,1] row_mask:0xf bank_mask:0xf
    v_add_f32_dpp v0, v0, v0 row_half_mirror row_mask:0xf bank_mask:0xf
    v_add_f32_dpp v1, v1, v1 row_half_mirror row_mask:0xf bank_mask:0xf
    v_add_f32_dpp v2, v2, v2 row_half_mirror row_mask:0xf bank_mask:0xf
    v_add_f32_dpp v3, v3, v3 row_half_mirror row_mask:0xf bank_mask:0xf
    v_add_f32_dpp v4, v4, v4 row_half_mirror row_mask:0xf bank_mask:0xf
    v_add_f32_dpp v5, v5, v5 row_half_mirror row_mask:0xf bank_mask:0xf
    v_add_f32_dpp v6, v6, v6 row_half_mirror row_mask:0xf bank_mask:0xf
    v_add_f32_dpp v7, v7, v7 row_half_mirror row_mask:0xf bank_mask:0xf
    v_add_f32_dpp v0, v0, v0 row_mirror row_mask:0xf bank_mask:0xf
    v_add_f32_dpp v1, v1, v1 row_mirror row_mask:0xf bank_mask:0xf
    v_add_f32_dpp v2, v2, v2 row_mirror row_mask:0xf bank_mask:0xf
    v_add_f32_dpp v3, v3, v3 row_mirror row_mask:0xf bank_mask:0xf
    v_add_f32_dpp v4, v4, v4 row_mirror row_mask:0xf bank_mask:0xf
    v_add_f32_dpp v5, v5, v5 row_mirror row_mask:0xf bank_mask:0xf
    v_add_f32_dpp v6, v6, v6 row_mirror row_mask:0xf bank_mask:0xf
    v_add_f32_dpp v7, v7, v7 row_mirror row_mask:0xf bank_mask:0xf
    v_add_f32 v16, 1.0, v16
    v_rcp_f32 v16, v16
    s_bfe_u32 s42, s87, 0x4000a
    s_mov_b32 s54, 0x00010001
    s_lshl_b32 s54, s54, s42
    s_mov_b32 s55, s54
    v_cvt_pk_bf16_f32 v16, v16, v16
    v_lshlrev_b32 v16, 16, v16
    v_cvt_pk_bf16_f32 v8, v0, v1
    v_cvt_pk_bf16_f32 v9, v2, v3
    v_cvt_pk_bf16_f32 v10, v4, v5
    v_cvt_pk_bf16_f32 v11, v6, v7
    v_lshlrev_b32 v0, 16, v8
    v_and_b32 v1, 0xffff0000, v8
    v_lshlrev_b32 v2, 16, v9
    v_and_b32 v3, 0xffff0000, v9
    v_lshlrev_b32 v4, 16, v10
    v_and_b32 v5, 0xffff0000, v10
    v_lshlrev_b32 v6, 16, v11
    v_and_b32 v7, 0xffff0000, v11
    v_mul_f32 v0, v0, v16
    v_mul_f32 v1, v1, v16
    v_mul_f32 v2, v2, v16
    v_mul_f32 v3, v3, v16
    v_mul_f32 v4, v4, v16
    v_mul_f32 v5, v5, v16
    v_mul_f32 v6, v6, v16
    v_mul_f32 v7, v7, v16
    v_cvt_pk_bf16_f32 v8, v0, v1
    v_cvt_pk_bf16_f32 v9, v2, v3
    v_cvt_pk_bf16_f32 v10, v4, v5
    v_cvt_pk_bf16_f32 v11, v6, v7
    v_lshlrev_b32 v0, 16, v8
    v_and_b32 v1, 0xffff0000, v8
    v_lshlrev_b32 v2, 16, v9
    v_and_b32 v3, 0xffff0000, v9
    v_lshlrev_b32 v4, 16, v10
    v_and_b32 v5, 0xffff0000, v10
    v_lshlrev_b32 v6, 16, v11
    v_and_b32 v7, 0xffff0000, v11
    s_bitcmp0_b32 s87, 14
    s_cselect_b64 exec, s[54:55], 0
    v_lshlrev_b32 v8, 16, v184
    v_and_b32 v9, 0xffff0000, v184
    v_lshlrev_b32 v10, 16, v185
    v_and_b32 v11, 0xffff0000, v185
    v_lshlrev_b32 v12, 16, v186
    v_and_b32 v13, 0xffff0000, v186
    v_lshlrev_b32 v14, 16, v187
    v_and_b32 v15, 0xffff0000, v187
    v_add_f32 v8, v8, v0
    v_add_f32 v9, v9, v1
    v_add_f32 v10, v10, v2
    v_add_f32 v11, v11, v3
    v_add_f32 v12, v12, v4
    v_add_f32 v13, v13, v5
    v_add_f32 v14, v14, v6
    v_add_f32 v15, v15, v7
    v_cvt_pk_bf16_f32 v184, v8, v9
    v_cvt_pk_bf16_f32 v185, v10, v11
    v_cvt_pk_bf16_f32 v186, v12, v13
    v_cvt_pk_bf16_f32 v187, v14, v15
    s_bitcmp1_b32 s87, 14
    s_cselect_b64 exec, s[54:55], 0
    v_lshlrev_b32 v8, 16, v188
    v_and_b32 v9, 0xffff0000, v188
    v_lshlrev_b32 v10, 16, v189
    v_and_b32 v11, 0xffff0000, v189
    v_lshlrev_b32 v12, 16, v190
    v_and_b32 v13, 0xffff0000, v190
    v_lshlrev_b32 v14, 16, v191
    v_and_b32 v15, 0xffff0000, v191
    v_add_f32 v8, v8, v0
    v_add_f32 v9, v9, v1
    v_add_f32 v10, v10, v2
    v_add_f32 v11, v11, v3
    v_add_f32 v12, v12, v4
    v_add_f32 v13, v13, v5
    v_add_f32 v14, v14, v6
    v_add_f32 v15, v15, v7
    v_cvt_pk_bf16_f32 v188, v8, v9
    v_cvt_pk_bf16_f32 v189, v10, v11
    v_cvt_pk_bf16_f32 v190, v12, v13
    v_cvt_pk_bf16_f32 v191, v14, v15
    s_mov_b64 exec, -1
    s_branch F_RBB5
F_W3_5:
    s_mov_b32 s67, 200000
F_W3_5L:
    s_lshr_b32 s43, s79, 7
    s_load_dwordx2 s[72:73], s[70:71], s43 glc
    s_add_u32 s66, s66, 524288
    s_waitcnt lgkmcnt(0)
    s_cmp_eq_u64 s[72:73], s[64:65]
    s_cbranch_scc1 F_WB3_5
    s_sub_u32 s67, s67, 1
    s_cmp_lg_u32 s67, 0
    s_cbranch_scc1 F_W3_5L
    s_branch F_WB3_5
F_W4_5:
    s_mov_b32 s67, 200000
F_W4_5L:
    s_lshr_b32 s43, s82, 7
    s_load_dwordx2 s[72:73], s[70:71], s43 glc
    s_add_u32 s66, s66, 524288
    s_waitcnt lgkmcnt(0)
    s_cmp_eq_u64 s[72:73], s[64:65]
    s_cbranch_scc1 F_WB4_5
    s_sub_u32 s67, s67, 1
    s_cmp_lg_u32 s67, 0
    s_cbranch_scc1 F_W4_5L
    s_branch F_WB4_5
F_SPIN1:
    s_mov_b32 s67, 200000
F_SPINL1:
    v_and_b32 v215, 0xf0, v222
    v_lshrrev_b32 v215, 1, v215
    buffer_load_dwordx2 v[208:209], v215, s[48:51], s42 offen offset:0 sc1
    buffer_load_dwordx2 v[210:211], v215, s[48:51], s42 offen offset:128 sc1
    buffer_load_dwordx2 v[212:213], v215, s[48:51], s42 offen offset:256 sc1
    buffer_load_dwordx2 v[214:215], v215, s[48:51], s42 offen offset:384 sc1
    s_add_u32 s66, s66, 1
    s_waitcnt vmcnt(0)
    v_cmp_eq_u32 s[56:57], s44, v209
    v_cmp_eq_u32 s[58:59], s44, v211
    v_cmp_eq_u32 s[72:73], s44, v213
    v_cmp_eq_u32 vcc, s44, v215
    s_nop 3
    s_and_b64 s[56:57], s[56:57], s[58:59]
    s_and_b64 vcc, vcc, s[72:73]
    s_and_b64 vcc, vcc, s[56:57]
    s_cmp_eq_u64 vcc, -1
    s_cbranch_scc1 F_BACK1
    s_sub_u32 s67, s67, 1
    s_cmp_lg_u32 s67, 0
    s_cbranch_scc1 F_SPINL1
    s_branch F_BACK1
F_SPIN2:
    s_mov_b32 s67, 200000
F_SPINL2:
    buffer_load_dwordx4 v[224:227], v222, s[48:51], s42 offen offset:0 sc1
    buffer_load_dwordx4 v[228:231], v222, s[48:51], s42 offen offset:1024 sc1
    s_add_u32 s66, s66, 16
    s_waitcnt vmcnt(0)
    v_cmp_eq_u32 s[52:53], s44, v225
    v_cmp_eq_u32 s[54:55], s44, v227
    v_cmp_eq_u32 s[56:57], s44, v229
    v_cmp_eq_u32 vcc, s44, v231
    s_nop 3
    s_and_b64 s[52:53], s[52:53], s[54:55]
    s_and_b64 vcc, vcc, s[56:57]
    s_and_b64 vcc, vcc, s[52:53]
    s_cmp_eq_u64 vcc, -1
    s_cbranch_scc1 F_BACK2
    s_sub_u32 s67, s67, 1
    s_cmp_lg_u32 s67, 0
    s_cbranch_scc1 F_SPINL2
    s_branch F_BACK2
F_SPIN3:
    s_mov_b32 s67, 200000
F_SPINL3:
    s_and_b32 s43, s2, 4
    s_lshr_b32 s52, s2, 6
    s_add_u32 s43, s43, s52
    s_lshl_b32 s43, s43, 12
    s_add_u32 s43, s43, 3276800
    s_mov_b32 s42, 3276800
    s_andn2_b32 s52, s2, 3
    s_lshl_b32 s52, s52, 7
    s_add_u32 s56, s52, s42
    buffer_load_dwordx2 v[226:227], v224, s[48:51], s42 offen sc1
    buffer_load_dwordx2 v[228:229], v225, s[48:51], s43 offen offset:8 sc1
    buffer_load_dwordx2 v[230:231], v232, s[48:51], s56 offen offset:8 sc1
    s_add_u32 s66, s66, 256
    s_waitcnt vmcnt(0)
    v_cmp_eq_u32 vcc, s44, v226
    v_cmp_eq_u32 s[52:53], s45, v227
    v_cmp_eq_u32 s[54:55], s44, v229
    v_cmp_eq_u32 s[58:59], s44, v231
    s_nop 3
    s_and_b64 vcc, vcc, s[52:53]
    s_and_b64 s[54:55], s[54:55], s[58:59]
    s_and_b64 vcc, vcc, s[54:55]
    s_cmp_eq_u64 vcc, -1
    s_cbranch_scc1 F_BACK3
    s_sub_u32 s67, s67, 1
    s_cmp_lg_u32 s67, 0
    s_cbranch_scc1 F_SPINL3
    s_branch F_BACK3
F_FB:
    s_mov_b32 s37, -1
    s_waitcnt vmcnt(0) lgkmcnt(0)
    s_nop 7
    v_mov_b32 v160, 0xff800000
    v_mov_b32 v161, 0xff800000
    v_mov_b32 v162, 0xff800000
    v_mov_b32 v163, 0xff800000
    v_mov_b32 v164, 0xff800000
    v_mov_b32 v165, 0xff800000
    v_mov_b32 v166, 0xff800000
    v_mov_b32 v167, 0xff800000
    v_mov_b32 v168, 0xff800000
    v_mov_b32 v169, 0xff800000
    v_mov_b32 v170, 0xff800000
    v_mov_b32 v171, 0xff800000
    v_mov_b32 v172, 0xff800000
    v_mov_b32 v173, 0xff800000
    v_mov_b32 v174, 0xff800000
    v_mov_b32 v175, 0xff800000
    v_lshrrev_b32 v224, 8, v222
    v_bfe_u32 v225, v222, 4, 4
    v_lshl_add_u32 v226, v224, 8, s30
    v_add_u32 v227, 0, v224
    v_xor_b32 v227, v227, v225
    v_lshl_add_u32 v216, v227, 4, v226
    v_add_u32 v227, 4, v224
    v_xor_b32 v227, v227, v225
    v_lshl_add_u32 v217, v227, 4, v226
    v_add_u32 v227, 8, v224
    v_xor_b32 v227, v227, v225
    v_lshl_add_u32 v218, v227, 4, v226
    v_add_u32 v227, 12, v224
    v_xor_b32 v227, v227, v225
    v_lshl_add_u32 v219, v227, 4, v226
    s_mov_b32 s31, 0
    s_mov_b32 s32, 4096
    s_mov_b32 s52, 0
F_FBT:
    s_barrier
    s_add_u32 m0, s30, 0
    s_nop 0
    buffer_load_dwordx4 v216, s[8:11], s31 offen offset:0 lds
    buffer_load_dwordx4 v217, s[8:11], s31 offen offset:1024 lds
    buffer_load_dwordx4 v218, s[8:11], s31 offen offset:2048 lds
    buffer_load_dwordx4 v219, s[8:11], s31 offen offset:3072 lds
    s_add_u32 m0, s30, 4096
    s_nop 0
    buffer_load_dwordx4 v216, s[8:11], s32 offen offset:0 lds
    buffer_load_dwordx4 v217, s[8:11], s32 offen offset:1024 lds
    buffer_load_dwordx4 v218, s[8:11], s32 offen offset:2048 lds
    buffer_load_dwordx4 v219, s[8:11], s32 offen offset:3072 lds
    s_add_u32 s31, s31, 32768
    s_add_u32 s32, s32, 32768
    s_waitcnt vmcnt(0)
    s_barrier
    s_mov_b32 s53, 0
F_FBI:
    ds_read_b128 a[192:195], v204 offset:0
    ds_read_b128 a[196:199], v205 offset:0
    ds_read_b128 a[200:203], v206 offset:0
    ds_read_b128 a[204:207], v207 offset:0
    v_add_u32 v204, 4096, v204
    v_add_u32 v205, 4096, v205
    v_add_u32 v206, 4096, v206
    v_add_u32 v207, 4096, v207
    s_waitcnt lgkmcnt(0)
    v_mfma_f32_16x16x32_bf16 v[128:131], a[192:195], a[128:131], 0
    v_mfma_f32_16x16x32_bf16 v[128:131], a[196:199], a[132:135], v[128:131]
    v_mfma_f32_16x16x32_bf16 v[128:131], a[200:203], a[136:139], v[128:131]
    v_mfma_f32_16x16x32_bf16 v[128:131], a[204:207], a[140:143], v[128:131]
    v_mfma_f32_16x16x32_bf16 v[132:135], a[192:195], a[144:147], 0
    v_mfma_f32_16x16x32_bf16 v[132:135], a[196:199], a[148:151], v[132:135]
    v_mfma_f32_16x16x32_bf16 v[132:135], a[200:203], a[152:155], v[132:135]
    v_mfma_f32_16x16x32_bf16 v[132:135], a[204:207], a[156:159], v[132:135]
    v_mfma_f32_16x16x32_bf16 v[136:139], a[192:195], a[160:163], 0
    v_mfma_f32_16x16x32_bf16 v[136:139], a[196:199], a[164:167], v[136:139]
    v_mfma_f32_16x16x32_bf16 v[136:139], a[200:203], a[168:171], v[136:139]
    v_mfma_f32_16x16x32_bf16 v[136:139], a[204:207], a[172:175], v[136:139]
    v_mfma_f32_16x16x32_bf16 v[140:143], a[192:195], a[176:179], 0
    v_mfma_f32_16x16x32_bf16 v[140:143], a[196:199], a[180:183], v[140:143]
    v_mfma_f32_16x16x32_bf16 v[140:143], a[200:203], a[184:187], v[140:143]
    v_mfma_f32_16x16x32_bf16 v[140:143], a[204:207], a[188:191], v[140:143]
    s_nop 7
    v_max_f32 v160, v160, v128
    v_max_f32 v161, v161, v129
    v_max_f32 v162, v162, v130
    v_max_f32 v163, v163, v131
    v_max_f32 v164, v164, v132
    v_max_f32 v165, v165, v133
    v_max_f32 v166, v166, v134
    v_max_f32 v167, v167, v135
    v_max_f32 v168, v168, v136
    v_max_f32 v169, v169, v137
    v_max_f32 v170, v170, v138
    v_max_f32 v171, v171, v139
    v_max_f32 v172, v172, v140
    v_max_f32 v173, v173, v141
    v_max_f32 v174, v174, v142
    v_max_f32 v175, v175, v143
    s_add_u32 s53, s53, 1
    s_cmp_lt_u32 s53, 8
    s_cbranch_scc1 F_FBI
    v_subrev_u32 v204, 32768, v204
    v_subrev_u32 v205, 32768, v205
    v_subrev_u32 v206, 32768, v206
    v_subrev_u32 v207, 32768, v207
    s_add_u32 s52, s52, 1
    s_cmp_lt_u32 s52, 16
    s_cbranch_scc1 F_FBT
    v_max3_f32 v224, v160, v161, v162
    v_max_f32 v224, v224, v163
    v_max3_f32 v225, v164, v165, v166
    v_max_f32 v225, v225, v167
    v_max3_f32 v226, v168, v169, v170
    v_max_f32 v226, v226, v171
    v_max3_f32 v227, v172, v173, v174
    v_max_f32 v227, v227, v175
    v_mov_b32 v228, v224
    v_mov_b32 v229, v225
    v_mov_b32 v230, v226
    v_mov_b32 v231, v227
    v_permlane16_swap_b32 v224, v228
    v_permlane16_swap_b32 v225, v229
    v_permlane16_swap_b32 v226, v230
    v_permlane16_swap_b32 v227, v231
    v_max_f32 v224, v224, v228
    v_max_f32 v225, v225, v229
    v_max_f32 v226, v226, v230
    v_max_f32 v227, v227, v231
    v_mov_b32 v228, v224
    v_mov_b32 v229, v225
    v_mov_b32 v230, v226
    v_mov_b32 v231, v227
    v_permlane32_swap_b32 v224, v228
    v_permlane32_swap_b32 v225, v229
    v_permlane32_swap_b32 v226, v230
    v_permlane32_swap_b32 v227, v231
    v_max_f32 v224, v224, v228
    v_max_f32 v225, v225, v229
    v_max_f32 v226, v226, v230
    v_max_f32 v227, v227, v231
    v_sub_f32 v160, 0, v224
    v_sub_f32 v161, 0, v224
    v_sub_f32 v162, 0, v224
    v_sub_f32 v163, 0, v224
    v_sub_f32 v164, 0, v225
    v_sub_f32 v165, 0, v225
    v_sub_f32 v166, 0, v225
    v_sub_f32 v167, 0, v225
    v_sub_f32 v168, 0, v226
    v_sub_f32 v169, 0, v226
    v_sub_f32 v170, 0, v226
    v_sub_f32 v171, 0, v226
    v_sub_f32 v172, 0, v227
    v_sub_f32 v173, 0, v227
    v_sub_f32 v174, 0, v227
    v_sub_f32 v175, 0, v227
    v_accvgpr_write_b32 a0, 0
    v_accvgpr_write_b32 a1, 0
    v_accvgpr_write_b32 a2, 0
    v_accvgpr_write_b32 a3, 0
    v_accvgpr_write_b32 a4, 0
    v_accvgpr_write_b32 a5, 0
    v_accvgpr_write_b32 a6, 0
    v_accvgpr_write_b32 a7, 0
    v_accvgpr_write_b32 a8, 0
    v_accvgpr_write_b32 a9, 0
    v_accvgpr_write_b32 a10, 0
    v_accvgpr_write_b32 a11, 0
    v_accvgpr_write_b32 a12, 0
    v_accvgpr_write_b32 a13, 0
    v_accvgpr_write_b32 a14, 0
    v_accvgpr_write_b32 a15, 0
    v_accvgpr_write_b32 a16, 0
    v_accvgpr_write_b32 a17, 0
    v_accvgpr_write_b32 a18, 0
    v_accvgpr_write_b32 a19, 0
    v_accvgpr_write_b32 a20, 0
    v_accvgpr_write_b32 a21, 0
    v_accvgpr_write_b32 a22, 0
    v_accvgpr_write_b32 a23, 0
    v_accvgpr_write_b32 a24, 0
    v_accvgpr_write_b32 a25, 0
    v_accvgpr_write_b32 a26, 0
    v_accvgpr_write_b32 a27, 0
    v_accvgpr_write_b32 a28, 0
    v_accvgpr_write_b32 a29, 0
    v_accvgpr_write_b32 a30, 0
    v_accvgpr_write_b32 a31, 0
    v_accvgpr_write_b32 a32, 0
    v_accvgpr_write_b32 a33, 0
    v_accvgpr_write_b32 a34, 0
    v_accvgpr_write_b32 a35, 0
    v_accvgpr_write_b32 a36, 0
    v_accvgpr_write_b32 a37, 0
    v_accvgpr_write_b32 a38, 0
    v_accvgpr_write_b32 a39, 0
    v_accvgpr_write_b32 a40, 0
    v_accvgpr_write_b32 a41, 0
    v_accvgpr_write_b32 a42, 0
    v_accvgpr_write_b32 a43, 0
    v_accvgpr_write_b32 a44, 0
    v_accvgpr_write_b32 a45, 0
    v_accvgpr_write_b32 a46, 0
    v_accvgpr_write_b32 a47, 0
    v_accvgpr_write_b32 a48, 0
    v_accvgpr_write_b32 a49, 0
    v_accvgpr_write_b32 a50, 0
    v_accvgpr_write_b32 a51, 0
    v_accvgpr_write_b32 a52, 0
    v_accvgpr_write_b32 a53, 0
    v_accvgpr_write_b32 a54, 0
    v_accvgpr_write_b32 a55, 0
    v_accvgpr_write_b32 a56, 0
    v_accvgpr_write_b32 a57, 0
    v_accvgpr_write_b32 a58, 0
    v_accvgpr_write_b32 a59, 0
    v_accvgpr_write_b32 a60, 0
    v_accvgpr_write_b32 a61, 0
    v_accvgpr_write_b32 a62, 0
    v_accvgpr_write_b32 a63, 0
    v_accvgpr_write_b32 a64, 0
    v_accvgpr_write_b32 a65, 0
    v_accvgpr_write_b32 a66, 0
    v_accvgpr_write_b32 a67, 0
    v_accvgpr_write_b32 a68, 0
    v_accvgpr_write_b32 a69, 0
    v_accvgpr_write_b32 a70, 0
    v_accvgpr_write_b32 a71, 0
    v_accvgpr_write_b32 a72, 0
    v_accvgpr_write_b32 a73, 0
    v_accvgpr_write_b32 a74, 0
    v_accvgpr_write_b32 a75, 0
    v_accvgpr_write_b32 a76, 0
    v_accvgpr_write_b32 a77, 0
    v_accvgpr_write_b32 a78, 0
    v_accvgpr_write_b32 a79, 0
    v_accvgpr_write_b32 a80, 0
    v_accvgpr_write_b32 a81, 0
    v_accvgpr_write_b32 a82, 0
    v_accvgpr_write_b32 a83, 0
    v_accvgpr_write_b32 a84, 0
    v_accvgpr_write_b32 a85, 0
    v_accvgpr_write_b32 a86, 0
    v_accvgpr_write_b32 a87, 0
    v_accvgpr_write_b32 a88, 0
    v_accvgpr_write_b32 a89, 0
    v_accvgpr_write_b32 a90, 0
    v_accvgpr_write_b32 a91, 0
    v_accvgpr_write_b32 a92, 0
    v_accvgpr_write_b32 a93, 0
    v_accvgpr_write_b32 a94, 0
    v_accvgpr_write_b32 a95, 0
    v_accvgpr_write_b32 a96, 0
    v_accvgpr_write_b32 a97, 0
    v_accvgpr_write_b32 a98, 0
    v_accvgpr_write_b32 a99, 0
    v_accvgpr_write_b32 a100, 0
    v_accvgpr_write_b32 a101, 0
    v_accvgpr_write_b32 a102, 0
    v_accvgpr_write_b32 a103, 0
    v_accvgpr_write_b32 a104, 0
    v_accvgpr_write_b32 a105, 0
    v_accvgpr_write_b32 a106, 0
    v_accvgpr_write_b32 a107, 0
    v_accvgpr_write_b32 a108, 0
    v_accvgpr_write_b32 a109, 0
    v_accvgpr_write_b32 a110, 0
    v_accvgpr_write_b32 a111, 0
    v_accvgpr_write_b32 a112, 0
    v_accvgpr_write_b32 a113, 0
    v_accvgpr_write_b32 a114, 0
    v_accvgpr_write_b32 a115, 0
    v_accvgpr_write_b32 a116, 0
    v_accvgpr_write_b32 a117, 0
    v_accvgpr_write_b32 a118, 0
    v_accvgpr_write_b32 a119, 0
    v_accvgpr_write_b32 a120, 0
    v_accvgpr_write_b32 a121, 0
    v_accvgpr_write_b32 a122, 0
    v_accvgpr_write_b32 a123, 0
    v_accvgpr_write_b32 a124, 0
    v_accvgpr_write_b32 a125, 0
    v_accvgpr_write_b32 a126, 0
    v_accvgpr_write_b32 a127, 0
    s_mov_b32 s31, 0
    s_mov_b32 s32, 4096
    s_mov_b32 s33, 0
    s_mov_b32 s34, 4096
    s_barrier
    s_add_u32 m0, s30, 0
    s_nop 0
    buffer_load_dwordx4 v216, s[8:11], s31 offen offset:0 lds
    buffer_load_dwordx4 v217, s[8:11], s31 offen offset:1024 lds
    buffer_load_dwordx4 v218, s[8:11], s31 offen offset:2048 lds
    buffer_load_dwordx4 v219, s[8:11], s31 offen offset:3072 lds
    s_add_u32 m0, s30, 4096
    s_nop 0
    buffer_load_dwordx4 v216, s[8:11], s32 offen offset:0 lds
    buffer_load_dwordx4 v217, s[8:11], s32 offen offset:1024 lds
    buffer_load_dwordx4 v218, s[8:11], s32 offen offset:2048 lds
    buffer_load_dwordx4 v219, s[8:11], s32 offen offset:3072 lds
    s_add_u32 s31, s31, 32768
    s_add_u32 s32, s32, 32768
    s_add_u32 m0, s30, 32768
    s_nop 0
    buffer_load_dwordx4 v216, s[8:11], s31 offen offset:0 lds
    buffer_load_dwordx4 v217, s[8:11], s31 offen offset:1024 lds
    buffer_load_dwordx4 v218, s[8:11], s31 offen offset:2048 lds
    buffer_load_dwordx4 v219, s[8:11], s31 offen offset:3072 lds
    s_add_u32 m0, s30, 36864
    s_nop 0
    buffer_load_dwordx4 v216, s[8:11], s32 offen offset:0 lds
    buffer_load_dwordx4 v217, s[8:11], s32 offen offset:1024 lds
    buffer_load_dwordx4 v218, s[8:11], s32 offen offset:2048 lds
    buffer_load_dwordx4 v219, s[8:11], s32 offen offset:3072 lds
    s_add_u32 s31, s31, 32768
    s_add_u32 s32, s32, 32768
    s_add_u32 m0, s30, 65536
    s_nop 0
    buffer_load_dwordx4 v220, s[12:15], s33 offen offset:0 lds
    buffer_load_dwordx4 v221, s[12:15], s33 offen offset:1024 lds
    buffer_load_dwordx4 v220, s[12:15], s33 offen offset:2048 lds
    buffer_load_dwordx4 v221, s[12:15], s33 offen offset:3072 lds
    s_add_u32 m0, s30, 69632
    s_nop 0
    buffer_load_dwordx4 v220, s[12:15], s34 offen offset:0 lds
    buffer_load_dwordx4 v221, s[12:15], s34 offen offset:1024 lds
    buffer_load_dwordx4 v220, s[12:15], s34 offen offset:2048 lds
    buffer_load_dwordx4 v221, s[12:15], s34 offen offset:3072 lds
    s_add_u32 s33, s33, 32768
    s_add_u32 s34, s34, 32768
    s_waitcnt vmcnt(0)
    s_barrier
    ds_read_b128 a[192:195], v204 offset:0
    ds_read_b128 a[196:199], v205 offset:0
    ds_read_b128 a[200:203], v206 offset:0
    ds_read_b128 a[204:207], v207 offset:0
    s_branch F_QK0
.section .rodata,"a"
.p2align 6
.amdhsa_kernel recurrent_scan__mha_block_cached__moe_arch_mod__prompt_kernel
  .amdhsa_next_free_vgpr 512
  .amdhsa_next_free_sgpr 102
  .amdhsa_accum_offset 256
  .amdhsa_group_segment_fixed_size 0
  .amdhsa_kernarg_size 104
  .amdhsa_user_sgpr_count 2
  .amdhsa_user_sgpr_kernarg_segment_ptr 1
  .amdhsa_system_sgpr_workgroup_id_x 1
.end_amdhsa_kernel
```
